```python
import torch

def _softmax(x, axis=-1):
    return torch.softmax(x, dim=axis)
def _gelu(x):
    return torch.nn.functional.gelu(x, approximate="tanh")
def _silu(x):
    return torch.nn.functional.silu(x)
def _sigmoid(x):
    return torch.sigmoid(x)
def _layernorm(x, axis=-1, eps=1e-5):
    m = x.mean(dim=axis, keepdim=True)
    v = x.var(dim=axis, keepdim=True, unbiased=False)
    return (x - m) / torch.sqrt(v + eps)
def _scatter_add(tgt, idx, src, axis=0):
    return tgt.clone().index_add_(axis, idx, src)
def _segment_sum(src, seg, n):
    out = torch.zeros((n,) + src.shape[1:], dtype=src.dtype)
    return out.index_add_(0, seg, src)
def _pad(x, pw):
    flat = tuple(v for pair in reversed(pw) for v in pair)
    return torch.nn.functional.pad(x, flat)

kernel_name = 'standalone__gqa_softmax__near_ridge'

def setup_inputs():

    _w = (lambda a: (lambda t: t.to(torch.bfloat16) if t.is_floating_point() else t)(torch.as_tensor(a)))
    B, Hq, Hkv, Sq, Sk, D = 32, 32, 8, 384, 384, 128
    return {
        "q": _w((lambda *s: torch.randn(*s, dtype=torch.bfloat16) * 0.8)(B, Hq, Sq, D)),
        "k": _w((lambda *s: torch.randn(*s, dtype=torch.bfloat16) * 0.8)(B, Hkv, Sk, D)),
        "v": _w((lambda *s: torch.randn(*s, dtype=torch.bfloat16) * 0.05)(B, Hkv, Sk, D)),
    }

def reference(q, k, v):
    B, Hq, Sq, D = q.shape
    Hkv = k.shape[1]
    rep = Hq // Hkv
    k = (lambda x, n, axis: torch.repeat_interleave(x, n, dim=axis))(k, rep, axis=1)
    v = (lambda x, n, axis: torch.repeat_interleave(x, n, dim=axis))(v, rep, axis=1)
    scale = D ** -0.5
    scores = torch.einsum("bhqd,bhkd->bhqk", q, k) * scale
    p = _softmax(scores, axis=-1)
    return torch.einsum("bhqk,bhkd->bhqd", p, v)
```

```asm
; @launch grid=(256,1,1) block=(256,1,1) lds=163840
.amdgcn_target "amdgcn-amd-amdhsa--gfx950"
.text
.globl standalone__gqa_softmax__near_ridge_kernel
.p2align 12
.p2align 8
.type standalone__gqa_softmax__near_ridge_kernel,@function
standalone__gqa_softmax__near_ridge_kernel:

 s_cmp_ge_u32 s2, 256
 s_cbranch_scc1 L_end
 s_load_dwordx4 s[44:47], s[0:1], 0
 s_load_dwordx4 s[48:51], s[0:1], 16
 s_and_b32 s3, s2, 7
 s_lshl_b32 s3, s3, 5
 s_lshr_b32 s4, s2, 3
 s_or_b32 s3, s3, s4
 s_getpc_b64 s[52:53]
 v_and_b32 v1, 63, v0
 v_lshrrev_b32 v2, 6, v0
 v_lshlrev_b32 v244, 4, v1
 v_readfirstlane_b32 s24, v2
 s_lshr_b32 s54, s2, 3
 s_lshl_b32 s54, s54, 2
 s_add_u32 s54, s54, s24
 s_mul_i32 s55, s54, 5042
 s_lshr_b32 s55, s55, 16
 s_mul_i32 s55, s55, 13
 s_sub_u32 s54, s54, s55
 s_lshl_b32 s54, s54, 13
 v_lshl_add_u32 v246, v1, 7, s54
 global_load_dword v247, v246, s[52:53]
 v_and_b32 v7, 7, v1
 v_lshrrev_b32 v8, 3, v1
 v_lshlrev_b32 v5, 8, v7
 v_lshl_add_u32 v252, v8, 4, v5
 s_mul_i32 s26, s3, 98304
 s_lshr_b32 s34, s24, 1
 s_lshl_b32 s34, s34, 13
 s_add_u32 s26, s26, s34
 s_and_b32 s34, s24, 1
 s_lshl_b32 s36, s34, 11
 s_add_u32 s36, s36, s26
 s_lshl_b32 s37, s34, 7
 s_add_u32 s37, s37, s26
 s_lshl_b32 s38, s24, 12
 s_mul_i32 s25, s3, 393216
 s_mul_i32 s34, s24, 98304
 s_add_u32 s25, s25, s34
 v_and_b32 v5, 3, v8
 v_lshrrev_b32 v6, 5, v1
 v_lshl_add_u32 v5, v5, 2, v6
 v_lshlrev_b32 v5, 8, v5
 v_lshl_add_u32 v253, v7, 4, v5
 v_and_b32 v5, 3, v7
 v_lshrrev_b32 v6, 2, v7
 v_lshl_add_u32 v5, v5, 2, v6
 v_lshlrev_b32 v5, 8, v5
 v_lshl_add_u32 v120, v8, 4, v5
 v_and_b32 v3, 15, v1
 v_lshrrev_b32 v4, 4, v1
 s_mov_b32 s10, 100663296
 s_mov_b32 s11, 0x20000
 s_mov_b32 s14, 25165824
 s_mov_b32 s15, 0x20000
 s_mov_b32 s18, 25165824
 s_mov_b32 s19, 0x20000
 s_waitcnt lgkmcnt(0)
 s_mov_b32 s12, s46
 s_mov_b32 s13, s47
 s_mov_b32 s8, s44
 s_mov_b32 s9, s45
 s_mov_b32 s16, s48
 s_mov_b32 s17, s49

 s_add_u32 s39, s36, 0
 s_add_u32 m0, s38, 65536
 s_nop 0
 buffer_load_dwordx4 v252, s[12:15], s39 offen offset:0 nt lds
 s_add_u32 m0, s38, 66432
 s_nop 0
 buffer_load_dwordx4 v252, s[12:15], s39 offen offset:128 nt lds
 s_add_u32 s40, s36, 4096
 s_add_u32 m0, s38, 67584
 s_nop 0
 buffer_load_dwordx4 v252, s[12:15], s40 offen offset:0 nt lds
 s_add_u32 m0, s38, 68480
 s_nop 0
 buffer_load_dwordx4 v252, s[12:15], s40 offen offset:128 nt lds
 s_add_u32 s32, s25, 0
 s_add_u32 m0, s38, 147456
 s_nop 0
 buffer_load_dwordx4 v120, s[8:11], s32 offen offset:0 nt lds
 s_add_u32 m0, s38, 148352
 s_nop 0
 buffer_load_dwordx4 v120, s[8:11], s32 offen offset:128 nt lds
 s_mov_b64 exec, 0
 s_cmp_eq_u32 s24, 0
 s_cbranch_scc1 L_pg0
 s_cmp_eq_u32 s24, 1
 s_cbranch_scc1 L_pg1
 s_cmp_eq_u32 s24, 2
 s_cbranch_scc1 L_pg2
 s_branch L_pg3
L_wb0:
 s_mov_b64 exec, -1
 s_add_u32 m0, s38, 148992
 s_nop 0
 buffer_load_dwordx4 v120, s[8:11], s32 offen offset:512 nt lds
 s_add_u32 m0, s38, 149888
 s_nop 0
 buffer_load_dwordx4 v120, s[8:11], s32 offen offset:640 nt lds
 v_and_b32 v5, 3, v3
 v_lshrrev_b32 v6, 2, v3
 v_lshl_add_u32 v5, v5, 2, v6
 v_lshlrev_b32 v5, 8, v5
 v_lshl_add_u32 v245, v4, 4, v5
 v_lshrrev_b32 v5, 3, v3
 v_lshlrev_b32 v5, 12, v5
 v_lshl_add_u32 v5, v4, 7, v5
 v_lshl_add_u32 v248, v7, 4, v5
 v_add_u32 v249, 0x10000, v248
 v_add_u32 v250, 0x20000, v248
 v_lshlrev_b32 v9, 12, v2
 v_add_u32 v251, v9, v244
 v_add_u32 v251, 0x10000, v251
 v_lshl_add_u32 v254, v1, 3, v9
 v_and_b32 v5, 1, v1
 v_lshl_add_u32 v5, v5, 11, v9
 v_lshl_add_u32 v5, v4, 7, v5
 v_lshrrev_b32 v6, 1, v3
 v_lshl_add_u32 v255, v6, 4, v5
 v_lshrrev_b32 v5, 3, v3
 v_lshl_add_u32 v5, v5, 11, v9
 v_lshl_add_u32 v5, v4, 7, v5
 v_lshl_add_u32 v121, v7, 4, v5
 v_add_u32 v122, 0x18000, v121
 v_bfe_u32 v5, v1, 1, 1
 v_lshrrev_b32 v6, 5, v1
 v_cmp_eq_u32 vcc, v5, v6
 v_mov_b32 v5, 0x3f803f80
 v_and_b32 v6, 3, v1
 v_cndmask_b32 v236, 0, v5, vcc
 v_cndmask_b32 v237, 0, v5, vcc
 v_cndmask_b32 v238, 0, v5, vcc
 v_cndmask_b32 v239, 0, v5, vcc
 v_cmp_eq_u32 vcc, 0, v6
 v_and_b32 v6, 1, v1
 v_mul_u32_u24 v6, 0xaaaa, v6
 v_cndmask_b32 v140, 0, v5, vcc
 v_cndmask_b32 v141, 0, v5, vcc
 v_cndmask_b32 v142, 0, v5, vcc
 v_cndmask_b32 v143, 0, v5, vcc
 v_or_b32 v138, 0x4444, v6
 v_mov_b32 v128, 0
 v_mov_b32 v129, 0
 v_mov_b32 v130, 0
 v_mov_b32 v131, 0
 v_mov_b32 v132, 0
 v_mov_b32 v133, 0
 v_mov_b32 v134, 0
 v_mov_b32 v135, 0
 v_mov_b32 v136, 0
 v_mov_b32 v137, 0
 s_mov_b32 s27, 0x3e0293ee
 s_mov_b32 s28, 0x5d800000
 s_mov_b32 s29, 0
 s_mov_b32 s30, 0x05040100
 s_mov_b32 s31, 0x07060302
 s_mov_b32 s20, s50
 s_mov_b32 s21, s51
 s_mov_b32 s22, 100663296
 s_mov_b32 s23, 0x20000
 s_add_u32 s41, s37, 0
 s_add_u32 m0, s38, 0
 s_nop 0
 buffer_load_dwordx4 v253, s[16:19], s41 offen offset:0 nt lds
 s_add_u32 m0, s38, 512
 s_nop 0
 buffer_load_dwordx4 v253, s[16:19], s41 offen offset:512 nt lds
 s_waitcnt vmcnt(9)
 ds_read_b128 v[184:187], v251 offset:0
 s_waitcnt vmcnt(8)
 ds_read_b128 v[188:191], v251 offset:1024
 s_waitcnt vmcnt(7)
 ds_read_b128 v[192:195], v251 offset:2048
 s_waitcnt vmcnt(6)
 ds_read_b128 v[196:199], v251 offset:3072
 s_waitcnt lgkmcnt(3)
 v_lshlrev_b32 v240, 16, v184
 v_and_b32 v241, 0xffff0000, v184
 v_mul_f32 v240, s27, v240
 v_mul_f32 v241, s27, v241
 v_cvt_pk_bf16_f32 v184, v240, v241
 v_lshlrev_b32 v242, 16, v185
 v_and_b32 v243, 0xffff0000, v185
 v_mul_f32 v242, s27, v242
 v_mul_f32 v243, s27, v243
 v_cvt_pk_bf16_f32 v185, v242, v243
 v_lshlrev_b32 v240, 16, v186
 v_and_b32 v241, 0xffff0000, v186
 v_mul_f32 v240, s27, v240
 v_mul_f32 v241, s27, v241
 v_cvt_pk_bf16_f32 v186, v240, v241
 v_lshlrev_b32 v242, 16, v187
 v_and_b32 v243, 0xffff0000, v187
 v_mul_f32 v242, s27, v242
 v_mul_f32 v243, s27, v243
 v_cvt_pk_bf16_f32 v187, v242, v243
 ds_write_b128 v251, v[184:187] offset:0
 s_waitcnt lgkmcnt(3)
 v_lshlrev_b32 v240, 16, v188
 v_and_b32 v241, 0xffff0000, v188
 v_mul_f32 v240, s27, v240
 v_mul_f32 v241, s27, v241
 v_cvt_pk_bf16_f32 v188, v240, v241
 s_add_u32 s42, s37, 4096
 s_add_u32 m0, s38, 2048
 s_nop 0
 buffer_load_dwordx4 v253, s[16:19], s42 offen offset:0 nt lds
 v_lshlrev_b32 v242, 16, v189
 v_and_b32 v243, 0xffff0000, v189
 v_mul_f32 v242, s27, v242
 v_mul_f32 v243, s27, v243
 v_cvt_pk_bf16_f32 v189, v242, v243
 v_lshlrev_b32 v240, 16, v190
 v_and_b32 v241, 0xffff0000, v190
 v_mul_f32 v240, s27, v240
 v_mul_f32 v241, s27, v241
 v_cvt_pk_bf16_f32 v190, v240, v241
 v_lshlrev_b32 v242, 16, v191
 v_and_b32 v243, 0xffff0000, v191
 v_mul_f32 v242, s27, v242
 v_mul_f32 v243, s27, v243
 v_cvt_pk_bf16_f32 v191, v242, v243
 ds_write_b128 v251, v[188:191] offset:1024
 s_waitcnt lgkmcnt(3)
 v_lshlrev_b32 v240, 16, v192
 v_and_b32 v241, 0xffff0000, v192
 v_mul_f32 v240, s27, v240
 v_mul_f32 v241, s27, v241
 v_cvt_pk_bf16_f32 v192, v240, v241
 v_lshlrev_b32 v242, 16, v193
 v_and_b32 v243, 0xffff0000, v193
 v_mul_f32 v242, s27, v242
 v_mul_f32 v243, s27, v243
 v_cvt_pk_bf16_f32 v193, v242, v243
 v_lshlrev_b32 v240, 16, v194
 v_and_b32 v241, 0xffff0000, v194
 v_mul_f32 v240, s27, v240
 v_mul_f32 v241, s27, v241
 s_add_u32 m0, s38, 2560
 s_nop 0
 buffer_load_dwordx4 v253, s[16:19], s42 offen offset:512 nt lds
 v_cvt_pk_bf16_f32 v194, v240, v241
 v_lshlrev_b32 v242, 16, v195
 v_and_b32 v243, 0xffff0000, v195
 v_mul_f32 v242, s27, v242
 v_mul_f32 v243, s27, v243
 v_cvt_pk_bf16_f32 v195, v242, v243
 ds_write_b128 v251, v[192:195] offset:2048
 s_waitcnt lgkmcnt(3)
 v_lshlrev_b32 v240, 16, v196
 v_and_b32 v241, 0xffff0000, v196
 v_mul_f32 v240, s27, v240
 v_mul_f32 v241, s27, v241
 v_cvt_pk_bf16_f32 v196, v240, v241
 v_lshlrev_b32 v242, 16, v197
 v_and_b32 v243, 0xffff0000, v197
 v_mul_f32 v242, s27, v242
 v_mul_f32 v243, s27, v243
 v_cvt_pk_bf16_f32 v197, v242, v243
 v_lshlrev_b32 v240, 16, v198
 v_and_b32 v241, 0xffff0000, v198
 v_mul_f32 v240, s27, v240
 v_mul_f32 v241, s27, v241
 v_cvt_pk_bf16_f32 v198, v240, v241
 v_lshlrev_b32 v242, 16, v199
 v_and_b32 v243, 0xffff0000, v199
 v_mul_f32 v242, s27, v242
 v_mul_f32 v243, s27, v243
 v_cvt_pk_bf16_f32 v199, v242, v243
 ds_write_b128 v251, v[196:199] offset:3072
 s_waitcnt lgkmcnt(0)
 s_barrier
 ds_read_b128 a[64:67], v249 offset:0
 s_add_u32 s32, s25, 4096
 s_add_u32 m0, s38, 131072
 s_nop 0
 buffer_load_dwordx4 v120, s[8:11], s32 offen offset:0 nt lds
 ds_read_b128 a[68:71], v249 offset:512
 ds_read_b128 a[72:75], v249 offset:1024
 ds_read_b128 a[76:79], v249 offset:1536
 ds_read_b128 a[80:83], v249 offset:2048
 ds_read_b128 a[84:87], v249 offset:2560
 ds_read_b128 a[88:91], v249 offset:3072
 ds_read_b128 a[92:95], v249 offset:3584
 ds_read_b128 a[96:99], v249 offset:8192
 ds_read_b128 a[100:103], v249 offset:8704
 ds_read_b128 a[104:107], v249 offset:9216
 ds_read_b128 a[108:111], v249 offset:9728
 ds_read_b128 a[112:115], v249 offset:10240
 ds_read_b128 a[116:119], v249 offset:10752
 ds_read_b128 a[120:123], v249 offset:11264
 ds_read_b128 a[124:127], v249 offset:11776
 s_add_u32 m0, s38, 131968
 s_nop 0
 buffer_load_dwordx4 v120, s[8:11], s32 offen offset:128 nt lds
 s_waitcnt vmcnt(7)
 ds_read_b128 a[0:3], v122 offset:49152
 s_waitcnt lgkmcnt(0)
 v_mfma_f32_16x16x32_bf16 v[144:147], a[64:67], a[0:3], 0
 s_waitcnt vmcnt(6)
 s_add_u32 m0, s38, 132608
 ds_read_b128 a[4:7], v122 offset:49664
 ds_read_b128 a[8:11], v122 offset:50176
 ds_read_b128 a[12:15], v122 offset:50688
 s_waitcnt lgkmcnt(2)
 v_mfma_f32_16x16x32_bf16 v[144:147], a[68:71], a[4:7], v[144:147]
 s_waitcnt lgkmcnt(1)
 v_mfma_f32_16x16x32_bf16 v[144:147], a[72:75], a[8:11], v[144:147]
 s_waitcnt lgkmcnt(0)
 v_mfma_f32_16x16x32_bf16 v[144:147], a[76:79], a[12:15], v[144:147]
 s_nop 7
 v_max3_f32 v246, v144, v145, v146
 v_max_f32 v246, v246, v147
 v_mov_b32 v247, v246
 s_nop 1
 v_permlane16_swap_b32 v246, v247
 v_max_f32 v246, v246, v247
 v_mov_b32 v247, v246
 s_nop 1
 v_permlane32_swap_b32 v246, v247
 v_min_f32 v246, -v246, -v247
 v_add_f32 v160, v144, v246
 v_add_f32 v161, v145, v246
 v_add_f32 v162, v146, v246
 v_add_f32 v163, v147, v246
 v_mov_b32 v144, v246
 v_mov_b32 v145, v246
 v_mov_b32 v146, v246
 v_mov_b32 v147, v246
 s_nop 1
 v_mfma_f32_16x16x32_bf16 v[164:167], a[92:95], a[12:15], v[144:147]
 v_exp_f32 v163, v163
 v_mfma_f32_16x16x32_bf16 v[164:167], a[88:91], a[8:11], v[164:167]
 v_exp_f32 v160, v160
 v_mfma_f32_16x16x32_bf16 v[164:167], a[84:87], a[4:7], v[164:167]
 buffer_load_dwordx4 v120, s[8:11], s32 offen offset:512 nt lds
 v_mfma_f32_16x16x32_bf16 v[164:167], a[80:83], a[0:3], v[164:167]
 s_add_u32 m0, s38, 133504
 s_add_u32 s39, s36, 16384
 s_nop 0
 v_mfma_f32_16x16x32_bf16 v[168:171], a[96:99], a[0:3], v[144:147]
 v_exp_f32 v161, v161
 v_mfma_f32_16x16x32_bf16 v[168:171], a[100:103], a[4:7], v[168:171]
 buffer_load_dwordx4 v120, s[8:11], s32 offen offset:640 nt lds
 v_mfma_f32_16x16x32_bf16 v[168:171], a[104:107], a[8:11], v[168:171]
 s_add_u32 m0, s38, 81920
 v_exp_f32 v166, v166
 v_mfma_f32_16x16x32_bf16 v[168:171], a[108:111], a[12:15], v[168:171]
 v_exp_f32 v162, v162
 v_mfma_f32_16x16x32_bf16 v[172:175], a[124:127], a[12:15], v[144:147]
 buffer_load_dwordx4 v252, s[12:15], s39 offen offset:0 nt lds
 v_exp_f32 v164, v164
 v_exp_f32 v165, v165
 v_exp_f32 v167, v167
 v_mfma_f32_16x16x32_bf16 v[172:175], a[120:123], a[8:11], v[172:175]
 s_add_u32 m0, s38, 82816
 v_cvt_pk_bf16_f32 v176, v160, v161
 v_cvt_pk_bf16_f32 v177, v162, v163
 v_cvt_pk_bf16_f32 v178, v164, v165
 v_cvt_pk_bf16_f32 v179, v166, v167
 v_mfma_f32_16x16x32_bf16 v[172:175], a[116:119], a[4:7], v[172:175]
 s_add_u32 s40, s36, 20480
 v_exp_f32 v168, v168
 v_mfma_f32_16x16x32_bf16 v[172:175], a[112:115], a[0:3], v[172:175]
 s_waitcnt vmcnt(5)
 buffer_load_dwordx4 v252, s[12:15], s39 offen offset:128 nt lds
 ds_read_b64 v[200:201], v254 offset:0
 ds_read_b64 v[202:203], v254 offset:512
 ds_read_b64 v[204:205], v254 offset:1024
 ds_read_b64 v[206:207], v254 offset:1536
 ds_read_b64 v[208:209], v254 offset:2048
 ds_read_b64 v[210:211], v254 offset:2560
 ds_read_b64 v[212:213], v254 offset:3072
 ds_read_b64 v[214:215], v254 offset:3584
 v_mfma_f32_16x16x32_bf16 v[128:131], v[140:143], v[176:179], v[128:131]
 s_waitcnt lgkmcnt(0)
 s_add_u32 m0, s38, 83968
 v_exp_f32 v169, v169
 v_perm_b32 v216, v202, v200, s30
 v_perm_b32 v217, v206, v204, s30
 v_perm_b32 v218, v210, v208, s30
 v_perm_b32 v219, v214, v212, s30
 ds_write_b128 v255, v[216:219] offset:0
 s_nop 1
 v_perm_b32 v216, v202, v200, s31
 v_perm_b32 v217, v206, v204, s31
 v_perm_b32 v218, v210, v208, s31
 v_perm_b32 v219, v214, v212, s31
 ds_write_b128 v255, v[216:219] offset:512
 s_nop 1
 v_perm_b32 v216, v203, v201, s30
 v_perm_b32 v217, v207, v205, s30
 v_perm_b32 v218, v211, v209, s30
 v_perm_b32 v219, v215, v213, s30
 ds_write_b128 v255, v[216:219] offset:1024
 s_nop 1
 v_perm_b32 v216, v203, v201, s31
 v_perm_b32 v217, v207, v205, s31
 v_perm_b32 v218, v211, v209, s31
 v_perm_b32 v219, v215, v213, s31
 ds_write_b128 v255, v[216:219] offset:1536
 s_waitcnt lgkmcnt(0)
 s_barrier
 ds_read_b128 a[224:227], v248 offset:0
 s_waitcnt lgkmcnt(0)
 v_mfma_f32_16x16x32_bf16 v[0:3], v[176:179], a[224:227], 0
 ds_read_b128 a[228:231], v248 offset:512
 ds_read_b128 a[232:235], v248 offset:1024
 ds_read_b128 a[236:239], v248 offset:1536
 ds_read_b128 a[240:243], v248 offset:2048
 ds_read_b128 a[244:247], v248 offset:2560
 ds_read_b128 a[248:251], v248 offset:3072
 ds_read_b128 a[252:255], v248 offset:3584
 ds_read_b128 a[224:227], v248 offset:8192
 s_waitcnt lgkmcnt(7)
 v_mfma_f32_16x16x32_bf16 v[4:7], v[176:179], a[228:231], 0
 s_waitcnt lgkmcnt(6)
 buffer_load_dwordx4 v252, s[12:15], s40 offen offset:0 nt lds
 ds_read_b128 a[228:231], v248 offset:8704
 v_mfma_f32_16x16x32_bf16 v[8:11], v[176:179], a[232:235], 0
 s_waitcnt lgkmcnt(6)
 s_add_u32 m0, s38, 84864
 s_add_u32 s41, s37, 16384
 ds_read_b128 a[232:235], v248 offset:9216
 v_exp_f32 v170, v170
 v_mfma_f32_16x16x32_bf16 v[12:15], v[176:179], a[236:239], 0
 s_waitcnt lgkmcnt(6)
 ds_read_b128 a[236:239], v248 offset:9728
 v_exp_f32 v171, v171
 v_mfma_f32_16x16x32_bf16 v[16:19], v[176:179], a[240:243], 0
 s_waitcnt lgkmcnt(6)
 buffer_load_dwordx4 v252, s[12:15], s40 offen offset:128 nt lds
 ds_read_b128 a[240:243], v248 offset:10240
 v_exp_f32 v172, v172
 v_exp_f32 v173, v173
 v_exp_f32 v174, v174
 v_exp_f32 v175, v175
 v_mfma_f32_16x16x32_bf16 v[20:23], v[176:179], a[244:247], 0
 s_waitcnt lgkmcnt(6)
 s_add_u32 m0, s38, 16384
 ds_read_b128 a[244:247], v248 offset:10752
 v_mfma_f32_16x16x32_bf16 v[24:27], v[176:179], a[248:251], 0
 s_waitcnt lgkmcnt(6)
 ds_read_b128 a[248:251], v248 offset:11264
 v_mfma_f32_16x16x32_bf16 v[28:31], v[176:179], a[252:255], 0
 s_waitcnt lgkmcnt(6)
 ds_read_b128 a[252:255], v248 offset:11776
 v_cvt_pk_bf16_f32 v176, v168, v169
 v_cvt_pk_bf16_f32 v177, v170, v171
 v_cvt_pk_bf16_f32 v178, v172, v173
 v_cvt_pk_bf16_f32 v179, v174, v175
 s_nop 1
 v_mfma_f32_16x16x32_bf16 v[0:3], v[176:179], a[224:227], v[0:3]
 s_waitcnt lgkmcnt(6)
 buffer_load_dwordx4 v253, s[16:19], s41 offen offset:0 nt lds
 v_mfma_f32_16x16x32_bf16 v[4:7], v[176:179], a[228:231], v[4:7]
 s_waitcnt lgkmcnt(5)
 s_add_u32 m0, s38, 16896
 s_add_u32 s42, s37, 20480
 ds_read_b128 a[224:227], v248 offset:0
 v_mfma_f32_16x16x32_bf16 v[8:11], v[176:179], a[232:235], v[8:11]
 s_waitcnt lgkmcnt(5)
 ds_read_b128 a[228:231], v248 offset:512
 ds_read_b128 a[232:235], v248 offset:1024
 v_mfma_f32_16x16x32_bf16 v[12:15], v[176:179], a[236:239], v[12:15]
 s_waitcnt vmcnt(5) lgkmcnt(6)
 buffer_load_dwordx4 v253, s[16:19], s41 offen offset:512 nt lds
 ds_read_b128 a[16:19], v122 offset:32768
 ds_read_b128 a[20:23], v122 offset:33280
 ds_read_b128 a[24:27], v122 offset:33792
 ds_read_b128 a[28:31], v122 offset:34304
 v_mfma_f32_16x16x32_bf16 v[16:19], v[176:179], a[240:243], v[16:19]
 s_waitcnt lgkmcnt(9)
 s_add_u32 m0, s38, 18432
 ds_read_b128 a[236:239], v248 offset:1536
 ds_read_b128 a[240:243], v248 offset:2048
 v_mfma_f32_16x16x32_bf16 v[20:23], v[176:179], a[244:247], v[20:23]
 s_waitcnt lgkmcnt(10)
 ds_read_b128 a[244:247], v248 offset:2560
 v_mfma_f32_16x16x32_bf16 v[24:27], v[176:179], a[248:251], v[24:27]
 s_waitcnt lgkmcnt(10)
 buffer_load_dwordx4 v253, s[16:19], s42 offen offset:0 nt lds
 v_mfma_f32_16x16x32_bf16 v[28:31], v[176:179], a[252:255], v[28:31]
 s_waitcnt lgkmcnt(6)
 s_add_u32 m0, s38, 18944
 s_add_u32 s32, s25, 8192
 ds_read_b128 a[248:251], v248 offset:3072
 v_mfma_f32_16x16x32_bf16 v[148:151], a[64:67], a[16:19], 0
 s_waitcnt lgkmcnt(6)
 ds_read_b128 a[252:255], v248 offset:3584
 v_mfma_f32_16x16x32_bf16 v[148:151], a[68:71], a[20:23], v[148:151]
 s_waitcnt lgkmcnt(6)
 buffer_load_dwordx4 v253, s[16:19], s42 offen offset:512 nt lds
 v_mfma_f32_16x16x32_bf16 v[148:151], a[72:75], a[24:27], v[148:151]
 s_waitcnt lgkmcnt(5)
 s_add_u32 m0, s38, 49152
 v_mfma_f32_16x16x32_bf16 v[148:151], a[76:79], a[28:31], v[148:151]
 s_nop 7
 v_max3_f32 v246, v148, v149, v150
 v_max_f32 v246, v246, v151
 v_mov_b32 v247, v246
 s_nop 1
 v_permlane16_swap_b32 v246, v247
 v_max_f32 v246, v246, v247
 v_mov_b32 v247, v246
 s_nop 1
 v_permlane32_swap_b32 v246, v247
 v_min_f32 v246, -v246, -v247
 v_add_f32 v160, v148, v246
 v_add_f32 v161, v149, v246
 v_add_f32 v162, v150, v246
 v_add_f32 v163, v151, v246
 v_mov_b32 v148, v246
 v_mov_b32 v149, v246
 v_mov_b32 v150, v246
 v_mov_b32 v151, v246
 s_nop 1
 v_mfma_f32_16x16x32_bf16 v[164:167], a[92:95], a[28:31], v[148:151]
 buffer_load_dwordx4 v120, s[8:11], s32 offen offset:0 nt lds
 v_mfma_f32_16x16x32_bf16 v[164:167], a[88:91], a[24:27], v[164:167]
 s_add_u32 m0, s38, 50048
 v_exp_f32 v163, v163
 v_mfma_f32_16x16x32_bf16 v[164:167], a[84:87], a[20:23], v[164:167]
 v_exp_f32 v160, v160
 v_mfma_f32_16x16x32_bf16 v[164:167], a[80:83], a[16:19], v[164:167]
 s_waitcnt vmcnt(5)
 buffer_load_dwordx4 v120, s[8:11], s32 offen offset:128 nt lds
 ds_read_b128 v[184:187], v251 offset:16384
 ds_read_b128 v[188:191], v251 offset:17408
 ds_read_b128 v[192:195], v251 offset:18432
 ds_read_b128 v[196:199], v251 offset:19456
 v_mfma_f32_16x16x32_bf16 v[168:171], a[96:99], a[16:19], v[148:151]
 s_add_u32 m0, s38, 50688
 v_exp_f32 v161, v161
 v_mfma_f32_16x16x32_bf16 v[168:171], a[100:103], a[20:23], v[168:171]
 v_exp_f32 v166, v166
 v_mfma_f32_16x16x32_bf16 v[168:171], a[104:107], a[24:27], v[168:171]
 buffer_load_dwordx4 v120, s[8:11], s32 offen offset:512 nt lds
 v_mfma_f32_16x16x32_bf16 v[168:171], a[108:111], a[28:31], v[168:171]
 s_add_u32 m0, s38, 51584
 v_exp_f32 v167, v167
 v_mfma_f32_16x16x32_bf16 v[172:175], a[124:127], a[28:31], v[148:151]
 v_cvt_pk_bf16_f32 v180, v160, v161
 v_cvt_pk_bf16_f32 v183, v166, v167
 v_exp_f32 v162, v162
 v_exp_f32 v164, v164
 v_exp_f32 v165, v165
 v_mfma_f32_16x16x32_bf16 v[172:175], a[120:123], a[24:27], v[172:175]
 buffer_load_dwordx4 v120, s[8:11], s32 offen offset:640 nt lds
 v_cvt_pk_bf16_f32 v181, v162, v163
 v_cvt_pk_bf16_f32 v182, v164, v165
 v_mfma_f32_16x16x32_bf16 v[172:175], a[116:119], a[20:23], v[172:175]
 s_add_u32 s32, s25, 12288
 s_add_u32 m0, s38, 114688
 v_mfma_f32_16x16x32_bf16 v[172:175], a[112:115], a[16:19], v[172:175]
 v_exp_f32 v168, v168
 v_smfmac_f32_16x16x64_bf16 v[128:131], v[236:239], v[176:183], v138
 s_waitcnt lgkmcnt(0)
 v_lshlrev_b32 v240, 16, v184
 v_and_b32 v241, 0xffff0000, v184
 v_mul_f32 v240, s27, v240
 v_mul_f32 v241, s27, v241
 v_cvt_pk_bf16_f32 v184, v240, v241
 v_lshlrev_b32 v242, 16, v185
 v_and_b32 v243, 0xffff0000, v185
 v_mul_f32 v242, s27, v242
 v_mul_f32 v243, s27, v243
 v_cvt_pk_bf16_f32 v185, v242, v243
 v_lshlrev_b32 v240, 16, v186
 v_and_b32 v241, 0xffff0000, v186
 v_mul_f32 v240, s27, v240
 v_mul_f32 v241, s27, v241
 v_cvt_pk_bf16_f32 v186, v240, v241
 v_lshlrev_b32 v242, 16, v187
 v_and_b32 v243, 0xffff0000, v187
 v_mul_f32 v242, s27, v242
 v_mul_f32 v243, s27, v243
 v_cvt_pk_bf16_f32 v187, v242, v243
 v_lshlrev_b32 v240, 16, v188
 v_and_b32 v241, 0xffff0000, v188
 v_mul_f32 v240, s27, v240
 v_mul_f32 v241, s27, v241
 v_cvt_pk_bf16_f32 v188, v240, v241
 v_lshlrev_b32 v242, 16, v189
 v_and_b32 v243, 0xffff0000, v189
 v_mul_f32 v242, s27, v242
 v_mul_f32 v243, s27, v243
 v_cvt_pk_bf16_f32 v189, v242, v243
 v_lshlrev_b32 v240, 16, v190
 v_and_b32 v241, 0xffff0000, v190
 v_mul_f32 v240, s27, v240
 v_mul_f32 v241, s27, v241
 v_cvt_pk_bf16_f32 v190, v240, v241
 v_lshlrev_b32 v242, 16, v191
 v_and_b32 v243, 0xffff0000, v191
 v_mul_f32 v242, s27, v242
 v_mul_f32 v243, s27, v243
 v_cvt_pk_bf16_f32 v191, v242, v243
 v_lshlrev_b32 v240, 16, v192
 v_and_b32 v241, 0xffff0000, v192
 v_mul_f32 v240, s27, v240
 v_mul_f32 v241, s27, v241
 v_cvt_pk_bf16_f32 v192, v240, v241
 v_lshlrev_b32 v242, 16, v193
 v_and_b32 v243, 0xffff0000, v193
 v_mul_f32 v242, s27, v242
 v_mul_f32 v243, s27, v243
 v_cvt_pk_bf16_f32 v193, v242, v243
 v_lshlrev_b32 v240, 16, v194
 v_and_b32 v241, 0xffff0000, v194
 v_mul_f32 v240, s27, v240
 v_mul_f32 v241, s27, v241
 v_cvt_pk_bf16_f32 v194, v240, v241
 v_lshlrev_b32 v242, 16, v195
 v_and_b32 v243, 0xffff0000, v195
 v_mul_f32 v242, s27, v242
 v_mul_f32 v243, s27, v243
 v_cvt_pk_bf16_f32 v195, v242, v243
 v_lshlrev_b32 v240, 16, v196
 v_and_b32 v241, 0xffff0000, v196
 v_mul_f32 v240, s27, v240
 v_mul_f32 v241, s27, v241
 v_cvt_pk_bf16_f32 v196, v240, v241
 v_lshlrev_b32 v242, 16, v197
 v_and_b32 v243, 0xffff0000, v197
 v_mul_f32 v242, s27, v242
 v_mul_f32 v243, s27, v243
 v_cvt_pk_bf16_f32 v197, v242, v243
 v_lshlrev_b32 v240, 16, v198
 v_and_b32 v241, 0xffff0000, v198
 v_mul_f32 v240, s27, v240
 v_mul_f32 v241, s27, v241
 v_cvt_pk_bf16_f32 v198, v240, v241
 v_lshlrev_b32 v242, 16, v199
 v_and_b32 v243, 0xffff0000, v199
 v_mul_f32 v242, s27, v242
 v_mul_f32 v243, s27, v243
 v_cvt_pk_bf16_f32 v199, v242, v243
 v_mfma_f32_16x16x32_bf16 v[32:35], v[180:183], a[224:227], 0
 ds_write_b128 v251, v[184:187] offset:16384
 buffer_load_dwordx4 v120, s[8:11], s32 offen offset:0 nt lds
 v_mfma_f32_16x16x32_bf16 v[36:39], v[180:183], a[228:231], 0
 s_add_u32 m0, s38, 115584
 v_exp_f32 v169, v169
 v_mfma_f32_16x16x32_bf16 v[40:43], v[180:183], a[232:235], 0
 v_exp_f32 v170, v170
 v_mfma_f32_16x16x32_bf16 v[44:47], v[180:183], a[236:239], 0
 v_exp_f32 v171, v171
 v_mfma_f32_16x16x32_bf16 v[48:51], v[180:183], a[240:243], 0
 ds_write_b128 v251, v[188:191] offset:17408
 v_mfma_f32_16x16x32_bf16 v[52:55], v[180:183], a[244:247], 0
 v_exp_f32 v172, v172
 v_mfma_f32_16x16x32_bf16 v[56:59], v[180:183], a[248:251], 0
 ds_read_b128 a[224:227], v248 offset:8192
 ds_read_b128 a[228:231], v248 offset:8704
 v_mfma_f32_16x16x32_bf16 v[60:63], v[180:183], a[252:255], 0
 v_exp_f32 v173, v173
 ds_write_b128 v251, v[192:195] offset:18432
 ds_write_b128 v251, v[196:199] offset:19456
 s_waitcnt lgkmcnt(0)
 s_barrier
 ds_read_b128 a[128:131], v249 offset:16384
 s_waitcnt lgkmcnt(0)
 v_mfma_f32_16x16x32_bf16 v[160:163], a[128:131], a[0:3], v[144:147]
 ds_read_b128 a[132:135], v249 offset:16896
 ds_read_b128 a[136:139], v249 offset:17408
 ds_read_b128 a[140:143], v249 offset:17920
 ds_read_b128 a[156:159], v249 offset:19968
 ds_read_b128 a[152:155], v249 offset:19456
 ds_read_b128 a[148:151], v249 offset:18944
 ds_read_b128 a[144:147], v249 offset:18432
 ds_read_b128 a[160:163], v249 offset:24576
 ds_read_b128 a[164:167], v249 offset:25088
 ds_read_b128 a[168:171], v249 offset:25600
 ds_read_b128 a[172:175], v249 offset:26112
L_pg0:
 s_cbranch_execz L_pg4
 ds_read_b128 a[176:179], v249 offset:26624
 ds_read_b128 a[180:183], v249 offset:27136
 ds_read_b128 a[184:187], v249 offset:27648
 ds_read_b128 a[188:191], v249 offset:28160
 s_waitcnt lgkmcnt(14)
 v_mfma_f32_16x16x32_bf16 v[160:163], a[132:135], a[4:7], v[160:163]
 s_waitcnt lgkmcnt(13)
 ds_read_b128 a[232:235], v248 offset:9216
 v_exp_f32 v174, v174
 v_mfma_f32_16x16x32_bf16 v[160:163], a[136:139], a[8:11], v[160:163]
 s_waitcnt lgkmcnt(13)
 ds_read_b128 a[236:239], v248 offset:9728
 v_exp_f32 v175, v175
 v_mfma_f32_16x16x32_bf16 v[160:163], a[140:143], a[12:15], v[160:163]
 s_waitcnt vmcnt(5) lgkmcnt(13)
 buffer_load_dwordx4 v120, s[8:11], s32 offen offset:128 nt lds
 ds_read_b64 v[200:201], v254 offset:16384
 ds_read_b64 v[202:203], v254 offset:16896
 ds_read_b64 v[204:205], v254 offset:17408
 ds_read_b64 v[206:207], v254 offset:17920
 ds_read_b64 v[208:209], v254 offset:18432
 ds_read_b64 v[210:211], v254 offset:18944
 ds_read_b64 v[212:213], v254 offset:19456
 ds_read_b64 v[214:215], v254 offset:19968
 ds_read_b128 a[240:243], v248 offset:10240
 v_mfma_f32_16x16x32_bf16 v[164:167], a[156:159], a[12:15], v[144:147]
 s_waitcnt lgkmcnt(15)
 s_add_u32 m0, s38, 116224
 ds_read_b128 a[244:247], v248 offset:10752
 v_cvt_pk_bf16_f32 v176, v168, v169
 v_mfma_f32_16x16x32_bf16 v[164:167], a[152:155], a[8:11], v[164:167]
 s_waitcnt lgkmcnt(15)
 ds_read_b128 a[248:251], v248 offset:11264
 v_cvt_pk_bf16_f32 v177, v170, v171
 v_cvt_pk_bf16_f32 v178, v172, v173
 v_cvt_pk_bf16_f32 v179, v174, v175
 v_mfma_f32_16x16x32_bf16 v[164:167], a[148:151], a[4:7], v[164:167]
 s_waitcnt lgkmcnt(15)
 ds_read_b128 a[252:255], v248 offset:11776
 v_mfma_f32_16x16x32_bf16 v[164:167], a[144:147], a[0:3], v[164:167]
 v_exp_f32 v160, v160
 v_mfma_f32_16x16x32_bf16 v[130:133], v[140:143], v[176:179], v[130:133]
 v_exp_f32 v161, v161
 v_mfma_f32_16x16x32_bf16 v[32:35], v[176:179], a[224:227], v[32:35]
 v_exp_f32 v162, v162
 v_mfma_f32_16x16x32_bf16 v[36:39], v[176:179], a[228:231], v[36:39]
 s_waitcnt lgkmcnt(3)
 v_exp_f32 v163, v163
 v_mfma_f32_16x16x32_bf16 v[40:43], v[176:179], a[232:235], v[40:43]
 v_exp_f32 v164, v164
 v_mfma_f32_16x16x32_bf16 v[44:47], v[176:179], a[236:239], v[44:47]
 v_perm_b32 v216, v202, v200, s30
 v_perm_b32 v217, v206, v204, s30
 v_perm_b32 v218, v210, v208, s30
 v_perm_b32 v219, v214, v212, s30
 v_mfma_f32_16x16x32_bf16 v[48:51], v[176:179], a[240:243], v[48:51]
 s_waitcnt lgkmcnt(0)
 ds_write_b128 v255, v[216:219] offset:16384
 v_mfma_f32_16x16x32_bf16 v[52:55], v[176:179], a[244:247], v[52:55]
 buffer_load_dwordx4 v120, s[8:11], s32 offen offset:512 nt lds
 v_perm_b32 v216, v202, v200, s31
 v_perm_b32 v217, v206, v204, s31
 v_perm_b32 v218, v210, v208, s31
 v_perm_b32 v219, v214, v212, s31
 v_mfma_f32_16x16x32_bf16 v[56:59], v[176:179], a[248:251], v[56:59]
 s_add_u32 m0, s38, 117120
 v_exp_f32 v165, v165
 v_mfma_f32_16x16x32_bf16 v[60:63], v[176:179], a[252:255], v[60:63]
 s_add_u32 s39, s36, 32768
 v_exp_f32 v166, v166
 v_mfma_f32_16x16x32_bf16 v[168:171], a[128:131], a[16:19], v[148:151]
 ds_write_b128 v255, v[216:219] offset:16896
 v_mfma_f32_16x16x32_bf16 v[168:171], a[132:135], a[20:23], v[168:171]
 v_exp_f32 v167, v167
 v_perm_b32 v216, v203, v201, s30
 v_perm_b32 v217, v207, v205, s30
 v_perm_b32 v218, v211, v209, s30
 v_perm_b32 v219, v215, v213, s30
 v_mfma_f32_16x16x32_bf16 v[168:171], a[136:139], a[24:27], v[168:171]
 v_cvt_pk_bf16_f32 v176, v160, v161
 v_cvt_pk_bf16_f32 v177, v162, v163
 v_mfma_f32_16x16x32_bf16 v[168:171], a[140:143], a[28:31], v[168:171]
 v_cvt_pk_bf16_f32 v178, v164, v165
 v_cvt_pk_bf16_f32 v179, v166, v167
 v_mfma_f32_16x16x32_bf16 v[172:175], a[156:159], a[28:31], v[148:151]
 ds_write_b128 v255, v[216:219] offset:17408
 v_mfma_f32_16x16x32_bf16 v[172:175], a[152:155], a[24:27], v[172:175]
 s_nop 1
 v_mfma_f32_16x16x32_bf16 v[172:175], a[148:151], a[20:23], v[172:175]
 v_perm_b32 v216, v203, v201, s31
 v_perm_b32 v217, v207, v205, s31
 v_perm_b32 v218, v211, v209, s31
 v_perm_b32 v219, v215, v213, s31
 v_mfma_f32_16x16x32_bf16 v[172:175], a[144:147], a[16:19], v[172:175]
 v_exp_f32 v168, v168
 ds_write_b128 v255, v[216:219] offset:17920
 s_waitcnt lgkmcnt(0)
 s_barrier
 ds_read_b128 a[224:227], v248 offset:16384
 s_waitcnt lgkmcnt(0)
 v_mfma_f32_16x16x32_bf16 v[0:3], v[176:179], a[224:227], v[0:3]
 ds_read_b128 a[228:231], v248 offset:16896
 ds_read_b128 a[232:235], v248 offset:17408
 ds_read_b128 a[236:239], v248 offset:17920
 ds_read_b128 a[240:243], v248 offset:18432
 ds_read_b128 a[244:247], v248 offset:18944
 ds_read_b128 a[248:251], v248 offset:19456
 ds_read_b128 a[252:255], v248 offset:19968
 s_waitcnt lgkmcnt(6)
 v_mfma_f32_16x16x32_bf16 v[4:7], v[176:179], a[228:231], v[4:7]
 s_waitcnt lgkmcnt(5)
 buffer_load_dwordx4 v120, s[8:11], s32 offen offset:640 nt lds
 v_mfma_f32_16x16x32_bf16 v[8:11], v[176:179], a[232:235], v[8:11]
 s_waitcnt lgkmcnt(4)
 s_add_u32 m0, s38, 98304
 v_exp_f32 v169, v169
 v_mfma_f32_16x16x32_bf16 v[12:15], v[176:179], a[236:239], v[12:15]
 s_waitcnt lgkmcnt(3)
 v_exp_f32 v170, v170
 v_mfma_f32_16x16x32_bf16 v[16:19], v[176:179], a[240:243], v[16:19]
 s_waitcnt lgkmcnt(2)
 v_exp_f32 v171, v171
 v_mfma_f32_16x16x32_bf16 v[20:23], v[176:179], a[244:247], v[20:23]
 s_waitcnt lgkmcnt(1)
 v_exp_f32 v172, v172
 v_mfma_f32_16x16x32_bf16 v[24:27], v[176:179], a[248:251], v[24:27]
 s_waitcnt lgkmcnt(0)
 v_exp_f32 v173, v173
 v_mfma_f32_16x16x32_bf16 v[28:31], v[176:179], a[252:255], v[28:31]
 v_exp_f32 v174, v174
 v_mfma_f32_16x16x32_bf16 v[160:163], a[160:163], a[0:3], v[144:147]
 v_exp_f32 v175, v175
 v_mfma_f32_16x16x32_bf16 v[160:163], a[164:167], a[4:7], v[160:163]
 v_cvt_pk_bf16_f32 v180, v168, v169
 v_cvt_pk_bf16_f32 v181, v170, v171
 v_mfma_f32_16x16x32_bf16 v[160:163], a[168:171], a[8:11], v[160:163]
 v_cvt_pk_bf16_f32 v182, v172, v173
 v_cvt_pk_bf16_f32 v183, v174, v175
 v_mfma_f32_16x16x32_bf16 v[160:163], a[172:175], a[12:15], v[160:163]
 buffer_load_dwordx4 v252, s[12:15], s39 offen offset:0 nt lds
 v_mfma_f32_16x16x32_bf16 v[164:167], a[188:191], a[12:15], v[144:147]
 s_add_u32 m0, s38, 99200
 s_add_u32 s40, s36, 36864
 s_nop 0
 v_mfma_f32_16x16x32_bf16 v[164:167], a[184:187], a[8:11], v[164:167]
 s_nop 1
 v_mfma_f32_16x16x32_bf16 v[164:167], a[180:183], a[4:7], v[164:167]
 v_exp_f32 v160, v160
 v_mfma_f32_16x16x32_bf16 v[164:167], a[176:179], a[0:3], v[164:167]
 v_exp_f32 v161, v161
 v_smfmac_f32_16x16x64_bf16 v[128:131], v[236:239], v[176:183], v138
 v_cvt_pk_bf16_f32 v176, v160, v161
 v_mfma_f32_16x16x32_bf16 v[32:35], v[180:183], a[224:227], v[32:35]
 v_exp_f32 v162, v162
 v_mfma_f32_16x16x32_bf16 v[36:39], v[180:183], a[228:231], v[36:39]
 v_exp_f32 v163, v163
 v_mfma_f32_16x16x32_bf16 v[40:43], v[180:183], a[232:235], v[40:43]
 v_exp_f32 v164, v164
 v_mfma_f32_16x16x32_bf16 v[44:47], v[180:183], a[236:239], v[44:47]
 v_exp_f32 v165, v165
 v_mfma_f32_16x16x32_bf16 v[48:51], v[180:183], a[240:243], v[48:51]
 v_exp_f32 v166, v166
 v_mfma_f32_16x16x32_bf16 v[52:55], v[180:183], a[244:247], v[52:55]
 ds_read_b128 a[224:227], v248 offset:24576
 ds_read_b128 a[228:231], v248 offset:25088
 v_mfma_f32_16x16x32_bf16 v[56:59], v[180:183], a[248:251], v[56:59]
 buffer_load_dwordx4 v252, s[12:15], s39 offen offset:128 nt lds
 v_mfma_f32_16x16x32_bf16 v[60:63], v[180:183], a[252:255], v[60:63]
 s_add_u32 m0, s38, 100352
 v_exp_f32 v167, v167
 v_mfma_f32_16x16x32_bf16 v[168:171], a[160:163], a[16:19], v[148:151]
 ds_read_b128 a[232:235], v248 offset:25600
 ds_read_b128 a[248:251], v248 offset:27648
 v_mfma_f32_16x16x32_bf16 v[168:171], a[164:167], a[20:23], v[168:171]
 ds_read_b128 a[236:239], v248 offset:26112
 v_cvt_pk_bf16_f32 v177, v162, v163
 v_mfma_f32_16x16x32_bf16 v[168:171], a[168:171], a[24:27], v[168:171]
 ds_read_b128 a[240:243], v248 offset:26624
 v_cvt_pk_bf16_f32 v178, v164, v165
 v_mfma_f32_16x16x32_bf16 v[168:171], a[172:175], a[28:31], v[168:171]
 ds_read_b128 a[244:247], v248 offset:27136
 v_cvt_pk_bf16_f32 v179, v166, v167
 v_mfma_f32_16x16x32_bf16 v[172:175], a[188:191], a[28:31], v[148:151]
 ds_read_b128 a[252:255], v248 offset:28160
 s_nop 0
 v_mfma_f32_16x16x32_bf16 v[172:175], a[184:187], a[24:27], v[172:175]
 s_nop 1
 v_mfma_f32_16x16x32_bf16 v[172:175], a[180:183], a[20:23], v[172:175]
 v_exp_f32 v168, v168
 v_mfma_f32_16x16x32_bf16 v[172:175], a[176:179], a[16:19], v[172:175]
 s_waitcnt lgkmcnt(4)
 v_exp_f32 v169, v169
 v_mfma_f32_16x16x32_bf16 v[0:3], v[176:179], a[224:227], v[0:3]
 buffer_load_dwordx4 v252, s[12:15], s40 offen offset:0 nt lds
 v_mfma_f32_16x16x32_bf16 v[4:7], v[176:179], a[228:231], v[4:7]
 s_add_u32 m0, s38, 101248
 v_exp_f32 v170, v170
 v_mfma_f32_16x16x32_bf16 v[8:11], v[176:179], a[232:235], v[8:11]
 s_waitcnt lgkmcnt(1)
 s_add_u32 s41, s37, 32768
 v_exp_f32 v171, v171
 v_mfma_f32_16x16x32_bf16 v[12:15], v[176:179], a[236:239], v[12:15]
 v_exp_f32 v173, v173
 v_mfma_f32_16x16x32_bf16 v[16:19], v[176:179], a[240:243], v[16:19]
 v_exp_f32 v174, v174
 v_exp_f32 v172, v172
 v_exp_f32 v175, v175
 v_mfma_f32_16x16x32_bf16 v[20:23], v[176:179], a[244:247], v[20:23]
 v_cvt_pk_bf16_f32 v180, v168, v169
 v_cvt_pk_bf16_f32 v181, v170, v171
 v_cvt_pk_bf16_f32 v182, v172, v173
 v_cvt_pk_bf16_f32 v183, v174, v175
 v_mfma_f32_16x16x32_bf16 v[24:27], v[176:179], a[248:251], v[24:27]
 s_waitcnt lgkmcnt(0)
 v_mfma_f32_16x16x32_bf16 v[28:31], v[176:179], a[252:255], v[28:31]
 v_smfmac_f32_16x16x64_bf16 v[128:131], v[236:239], v[176:183], v138
 v_mfma_f32_16x16x32_bf16 v[32:35], v[180:183], a[224:227], v[32:35]
 ds_read_b128 a[224:227], v248 offset:0
 v_mfma_f32_16x16x32_bf16 v[36:39], v[180:183], a[228:231], v[36:39]
 s_waitcnt vmcnt(8)
 ds_read_b128 a[32:35], v121 offset:49152
 ds_read_b128 a[228:231], v248 offset:512
 v_mfma_f32_16x16x32_bf16 v[40:43], v[180:183], a[232:235], v[40:43]
 buffer_load_dwordx4 v252, s[12:15], s40 offen offset:128 nt lds
 v_mfma_f32_16x16x32_bf16 v[44:47], v[180:183], a[236:239], v[44:47]
 s_waitcnt vmcnt(8)
 s_add_u32 m0, s38, 32768
 ds_read_b128 a[36:39], v121 offset:49664
 ds_read_b128 a[40:43], v121 offset:50176
 v_mfma_f32_16x16x32_bf16 v[48:51], v[180:183], a[240:243], v[48:51]
 ds_read_b128 a[44:47], v121 offset:50688
 ds_read_b128 a[232:235], v248 offset:1024
 v_mfma_f32_16x16x32_bf16 v[52:55], v[180:183], a[244:247], v[52:55]
 ds_read_b128 a[236:239], v248 offset:1536
 ds_read_b128 a[240:243], v248 offset:2048
 v_mfma_f32_16x16x32_bf16 v[56:59], v[180:183], a[248:251], v[56:59]
 ds_read_b128 a[244:247], v248 offset:2560
 ds_read_b128 a[248:251], v248 offset:3072
 v_mfma_f32_16x16x32_bf16 v[60:63], v[180:183], a[252:255], v[60:63]
 s_waitcnt vmcnt(5)
 ds_read_b128 a[252:255], v248 offset:3584
 buffer_load_dwordx4 v253, s[16:19], s41 offen offset:0 nt lds
 s_add_u32 m0, s38, 33280
 s_nop 0
 buffer_load_dwordx4 v253, s[16:19], s41 offen offset:512 nt lds
 ds_read_b128 a[48:51], v122 offset:16384
 s_waitcnt lgkmcnt(0)
 v_mfma_f32_16x16x32_bf16 v[156:159], a[64:67], a[48:51], 0
 s_waitcnt vmcnt(6)
 s_add_u32 s42, s37, 36864
 ds_read_b128 a[52:55], v122 offset:16896
 ds_read_b128 a[56:59], v122 offset:17408
 ds_read_b128 a[60:63], v122 offset:17920
 s_waitcnt lgkmcnt(2)
 v_mfma_f32_16x16x32_bf16 v[156:159], a[68:71], a[52:55], v[156:159]
 s_waitcnt lgkmcnt(1)
 s_add_u32 m0, s38, 34816
 v_mfma_f32_16x16x32_bf16 v[156:159], a[72:75], a[56:59], v[156:159]
 s_waitcnt lgkmcnt(0)
 v_mfma_f32_16x16x32_bf16 v[156:159], a[76:79], a[60:63], v[156:159]
 v_mfma_f32_16x16x32_bf16 v[152:155], a[64:67], a[32:35], 0
 v_mfma_f32_16x16x32_bf16 v[152:155], a[68:71], a[36:39], v[152:155]
 v_mfma_f32_16x16x32_bf16 v[152:155], a[72:75], a[40:43], v[152:155]
 s_waitcnt vmcnt(5)
 ds_read_b128 v[184:187], v251 offset:32768
 v_mfma_f32_16x16x32_bf16 v[152:155], a[76:79], a[44:47], v[152:155]
 s_nop 7
 v_max3_f32 v246, v152, v153, v154
 v_max_f32 v246, v246, v155
 v_mov_b32 v247, v246
 s_nop 1
 v_permlane16_swap_b32 v246, v247
 v_max_f32 v246, v246, v247
 v_mov_b32 v247, v246
 s_nop 1
 v_permlane32_swap_b32 v246, v247
 v_min_f32 v246, -v246, -v247
 v_add_f32 v160, v152, v246
 v_add_f32 v161, v153, v246
 v_add_f32 v162, v154, v246
 v_add_f32 v163, v155, v246
 v_mov_b32 v152, v246
 v_mov_b32 v153, v246
 v_mov_b32 v154, v246
 v_mov_b32 v155, v246
 s_nop 1
 v_mfma_f32_16x16x32_bf16 v[164:167], a[92:95], a[44:47], v[152:155]
 v_max3_f32 v246, v156, v157, v158
 v_max_f32 v246, v246, v159
 v_mov_b32 v247, v246
 v_mfma_f32_16x16x32_bf16 v[164:167], a[88:91], a[40:43], v[164:167]
 v_exp_f32 v160, v160
 v_permlane16_swap_b32 v246, v247
 v_max_f32 v246, v246, v247
 v_mov_b32 v247, v246
 v_mfma_f32_16x16x32_bf16 v[164:167], a[84:87], a[36:39], v[164:167]
 v_exp_f32 v161, v161
 v_permlane32_swap_b32 v246, v247
 v_min_f32 v246, -v246, -v247
 v_add_f32 v168, v156, v246
 v_add_f32 v169, v157, v246
 v_add_f32 v170, v158, v246
 v_add_f32 v171, v159, v246
 v_mov_b32 v156, v246
 v_mov_b32 v157, v246
 v_mov_b32 v158, v246
 v_mov_b32 v159, v246
 v_mfma_f32_16x16x32_bf16 v[164:167], a[80:83], a[32:35], v[164:167]
 v_exp_f32 v162, v162
 v_mfma_f32_16x16x32_bf16 v[172:175], a[92:95], a[60:63], v[156:159]
 v_exp_f32 v163, v163
 v_mfma_f32_16x16x32_bf16 v[172:175], a[88:91], a[56:59], v[172:175]
 v_cvt_pk_bf16_f32 v176, v160, v161
 v_cvt_pk_bf16_f32 v177, v162, v163
 v_mfma_f32_16x16x32_bf16 v[172:175], a[84:87], a[52:55], v[172:175]
 v_exp_f32 v170, v170
 v_exp_f32 v164, v164
 v_exp_f32 v165, v165
 v_exp_f32 v166, v166
 v_exp_f32 v167, v167
 v_mfma_f32_16x16x32_bf16 v[172:175], a[80:83], a[48:51], v[172:175]
 v_cvt_pk_bf16_f32 v178, v164, v165
 v_cvt_pk_bf16_f32 v179, v166, v167
 s_nop 1
 v_mfma_f32_16x16x32_bf16 v[64:67], v[176:179], a[224:227], 0
 v_exp_f32 v171, v171
 v_mfma_f32_16x16x32_bf16 v[68:71], v[176:179], a[228:231], 0
 v_exp_f32 v168, v168
 v_mfma_f32_16x16x32_bf16 v[72:75], v[176:179], a[232:235], 0
 v_exp_f32 v169, v169
 v_mfma_f32_16x16x32_bf16 v[76:79], v[176:179], a[236:239], 0
 v_exp_f32 v173, v173
 v_mfma_f32_16x16x32_bf16 v[80:83], v[176:179], a[240:243], 0
 v_exp_f32 v174, v174
 v_mfma_f32_16x16x32_bf16 v[84:87], v[176:179], a[244:247], 0
 v_exp_f32 v175, v175
 v_mfma_f32_16x16x32_bf16 v[88:91], v[176:179], a[248:251], 0
 v_cvt_pk_bf16_f32 v180, v168, v169
 v_cvt_pk_bf16_f32 v181, v170, v171
 v_mfma_f32_16x16x32_bf16 v[92:95], v[176:179], a[252:255], 0
 v_exp_f32 v172, v172
 v_mfma_f32_16x16x32_bf16 v[160:163], a[96:99], a[32:35], v[152:155]
 s_waitcnt vmcnt(4)
 ds_read_b128 v[188:191], v251 offset:33792
 v_cvt_pk_bf16_f32 v182, v172, v173
 v_mfma_f32_16x16x32_bf16 v[160:163], a[100:103], a[36:39], v[160:163]
 s_waitcnt lgkmcnt(1)
 v_cvt_pk_bf16_f32 v183, v174, v175
 v_lshlrev_b32 v240, 16, v184
 v_mfma_f32_16x16x32_bf16 v[160:163], a[104:107], a[40:43], v[160:163]
 v_and_b32 v241, 0xffff0000, v184
 v_mul_f32 v240, s27, v240
 v_mfma_f32_16x16x32_bf16 v[160:163], a[108:111], a[44:47], v[160:163]
 v_mul_f32 v241, s27, v241
 v_cvt_pk_bf16_f32 v184, v240, v241
 v_mfma_f32_16x16x32_bf16 v[164:167], a[124:127], a[44:47], v[152:155]
 s_waitcnt vmcnt(3)
 ds_read_b128 v[192:195], v251 offset:34816
 v_lshlrev_b32 v242, 16, v185
 v_mfma_f32_16x16x32_bf16 v[164:167], a[120:123], a[40:43], v[164:167]
 buffer_load_dwordx4 v253, s[16:19], s42 offen offset:0 nt lds
 v_mfma_f32_16x16x32_bf16 v[164:167], a[116:119], a[36:39], v[164:167]
 s_add_u32 m0, s38, 35328
 v_and_b32 v243, 0xffff0000, v185
 v_mul_f32 v242, s27, v242
 v_mfma_f32_16x16x32_bf16 v[164:167], a[112:115], a[32:35], v[164:167]
 s_add_u32 s39, s36, 49152
 v_mul_f32 v243, s27, v243
 v_cvt_pk_bf16_f32 v185, v242, v243
 v_smfmac_f32_16x16x64_bf16 v[132:135], v[236:239], v[176:183], v138
 v_lshlrev_b32 v240, 16, v186
 v_mfma_f32_16x16x32_bf16 v[96:99], v[180:183], a[224:227], 0
 v_exp_f32 v162, v162
 v_mfma_f32_16x16x32_bf16 v[100:103], v[180:183], a[228:231], 0
 v_exp_f32 v163, v163
 v_mfma_f32_16x16x32_bf16 v[104:107], v[180:183], a[232:235], 0
 v_exp_f32 v160, v160
 v_mfma_f32_16x16x32_bf16 v[108:111], v[180:183], a[236:239], 0
 v_exp_f32 v161, v161
 v_mfma_f32_16x16x32_bf16 v[112:115], v[180:183], a[240:243], 0
 v_cvt_pk_bf16_f32 v176, v160, v161
 v_and_b32 v241, 0xffff0000, v186
 v_mfma_f32_16x16x32_bf16 v[116:119], v[180:183], a[244:247], 0
 buffer_load_dwordx4 v253, s[16:19], s42 offen offset:512 nt lds
 v_mfma_f32_16x16x32_bf16 v[120:123], v[180:183], a[248:251], 0
 s_waitcnt vmcnt(4)
 s_add_u32 m0, s38, 114688
 ds_read_b128 v[196:199], v251 offset:35840
 ds_read_b128 a[224:227], v248 offset:8192
 v_cvt_pk_bf16_f32 v177, v162, v163
 v_mfma_f32_16x16x32_bf16 v[124:127], v[180:183], a[252:255], 0
 ds_read_b128 a[228:231], v248 offset:8704
 v_mul_f32 v240, s27, v240
 v_mul_f32 v241, s27, v241
 v_mfma_f32_16x16x32_bf16 v[168:171], a[96:99], a[48:51], v[156:159]
 ds_read_b128 a[232:235], v248 offset:9216
 v_cvt_pk_bf16_f32 v186, v240, v241
 v_lshlrev_b32 v242, 16, v187
 v_mfma_f32_16x16x32_bf16 v[168:171], a[100:103], a[52:55], v[168:171]
 ds_read_b128 a[236:239], v248 offset:9728
 v_and_b32 v243, 0xffff0000, v187
 v_mul_f32 v242, s27, v242
 v_mfma_f32_16x16x32_bf16 v[168:171], a[104:107], a[56:59], v[168:171]
 ds_read_b128 a[240:243], v248 offset:10240
 v_mul_f32 v243, s27, v243
 v_cvt_pk_bf16_f32 v187, v242, v243
 v_mfma_f32_16x16x32_bf16 v[168:171], a[108:111], a[60:63], v[168:171]
 ds_write_b128 v251, v[184:187] offset:32768
 ds_read_b128 a[244:247], v248 offset:10752
 v_mfma_f32_16x16x32_bf16 v[172:175], a[124:127], a[60:63], v[156:159]
 s_waitcnt lgkmcnt(8)
 ds_read_b128 a[248:251], v248 offset:11264
 v_lshlrev_b32 v240, 16, v188
 v_and_b32 v241, 0xffff0000, v188
 v_exp_f32 v164, v164
 v_exp_f32 v165, v165
 v_exp_f32 v166, v166
 v_exp_f32 v167, v167
 v_mfma_f32_16x16x32_bf16 v[172:175], a[120:123], a[56:59], v[172:175]
 ds_read_b128 a[252:255], v248 offset:11776
 v_mul_f32 v240, s27, v240
 v_mul_f32 v241, s27, v241
 v_cvt_pk_bf16_f32 v178, v164, v165
 v_cvt_pk_bf16_f32 v179, v166, v167
 v_mfma_f32_16x16x32_bf16 v[172:175], a[116:119], a[52:55], v[172:175]
 v_cvt_pk_bf16_f32 v188, v240, v241
 v_lshlrev_b32 v242, 16, v189
 v_mfma_f32_16x16x32_bf16 v[172:175], a[112:115], a[48:51], v[172:175]
 s_waitcnt lgkmcnt(6)
 v_and_b32 v243, 0xffff0000, v189
 v_mul_f32 v242, s27, v242
 v_mfma_f32_16x16x32_bf16 v[64:67], v[176:179], a[224:227], v[64:67]
 v_mul_f32 v243, s27, v243
 v_cvt_pk_bf16_f32 v189, v242, v243
 v_mfma_f32_16x16x32_bf16 v[68:71], v[176:179], a[228:231], v[68:71]
 v_lshlrev_b32 v240, 16, v190
 v_and_b32 v241, 0xffff0000, v190
 v_mfma_f32_16x16x32_bf16 v[72:75], v[176:179], a[232:235], v[72:75]
 s_waitcnt lgkmcnt(2)
 buffer_load_dwordx4 v252, s[12:15], s39 offen offset:0 nt lds
 v_mul_f32 v240, s27, v240
 v_mul_f32 v241, s27, v241
 v_mfma_f32_16x16x32_bf16 v[76:79], v[176:179], a[236:239], v[76:79]
 s_add_u32 m0, s38, 115584
 v_cvt_pk_bf16_f32 v190, v240, v241
 v_lshlrev_b32 v242, 16, v191
 v_mfma_f32_16x16x32_bf16 v[80:83], v[176:179], a[240:243], v[80:83]
 s_add_u32 s40, s36, 53248
 v_exp_f32 v168, v168
 v_mfma_f32_16x16x32_bf16 v[84:87], v[176:179], a[244:247], v[84:87]
 s_waitcnt lgkmcnt(0)
 v_exp_f32 v169, v169
 v_mfma_f32_16x16x32_bf16 v[88:91], v[176:179], a[248:251], v[88:91]
 v_exp_f32 v170, v170
 v_mfma_f32_16x16x32_bf16 v[92:95], v[176:179], a[252:255], v[92:95]
 v_exp_f32 v171, v171
 v_mfma_f32_16x16x32_bf16 v[160:163], a[128:131], a[32:35], v[152:155]
 v_cvt_pk_bf16_f32 v180, v168, v169
 v_cvt_pk_bf16_f32 v181, v170, v171
 v_mfma_f32_16x16x32_bf16 v[160:163], a[132:135], a[36:39], v[160:163]
 v_and_b32 v243, 0xffff0000, v191
 v_mul_f32 v242, s27, v242
 v_mfma_f32_16x16x32_bf16 v[160:163], a[136:139], a[40:43], v[160:163]
 v_mul_f32 v243, s27, v243
 v_cvt_pk_bf16_f32 v191, v242, v243
 v_mfma_f32_16x16x32_bf16 v[160:163], a[140:143], a[44:47], v[160:163]
 ds_write_b128 v251, v[188:191] offset:33792
 v_mfma_f32_16x16x32_bf16 v[164:167], a[156:159], a[44:47], v[152:155]
 v_lshlrev_b32 v240, 16, v192
 v_and_b32 v241, 0xffff0000, v192
 v_exp_f32 v172, v172
 v_exp_f32 v173, v173
 v_exp_f32 v174, v174
 v_exp_f32 v175, v175
 v_mfma_f32_16x16x32_bf16 v[164:167], a[152:155], a[40:43], v[164:167]
 buffer_load_dwordx4 v252, s[12:15], s39 offen offset:128 nt lds
 v_mul_f32 v240, s27, v240
 v_mul_f32 v241, s27, v241
 v_cvt_pk_bf16_f32 v182, v172, v173
 v_cvt_pk_bf16_f32 v183, v174, v175
 v_mfma_f32_16x16x32_bf16 v[164:167], a[148:151], a[36:39], v[164:167]
 s_add_u32 m0, s38, 116736
 v_cvt_pk_bf16_f32 v192, v240, v241
 v_lshlrev_b32 v242, 16, v193
 v_mfma_f32_16x16x32_bf16 v[164:167], a[144:147], a[32:35], v[164:167]
 v_and_b32 v243, 0xffff0000, v193
 v_mul_f32 v242, s27, v242
 v_smfmac_f32_16x16x64_bf16 v[132:135], v[236:239], v[176:183], v138
 v_mul_f32 v243, s27, v243
 v_mfma_f32_16x16x32_bf16 v[96:99], v[180:183], a[224:227], v[96:99]
 v_cvt_pk_bf16_f32 v193, v242, v243
 v_lshlrev_b32 v240, 16, v194
 v_mfma_f32_16x16x32_bf16 v[100:103], v[180:183], a[228:231], v[100:103]
 v_and_b32 v241, 0xffff0000, v194
 v_mul_f32 v240, s27, v240
 v_mfma_f32_16x16x32_bf16 v[104:107], v[180:183], a[232:235], v[104:107]
 v_mul_f32 v241, s27, v241
 v_cvt_pk_bf16_f32 v194, v240, v241
 v_mfma_f32_16x16x32_bf16 v[108:111], v[180:183], a[236:239], v[108:111]
 v_lshlrev_b32 v242, 16, v195
 v_and_b32 v243, 0xffff0000, v195
 v_mfma_f32_16x16x32_bf16 v[112:115], v[180:183], a[240:243], v[112:115]
 v_mul_f32 v242, s27, v242
 v_mul_f32 v243, s27, v243
 v_mfma_f32_16x16x32_bf16 v[116:119], v[180:183], a[244:247], v[116:119]
 v_cvt_pk_bf16_f32 v195, v242, v243
 v_lshlrev_b32 v240, 16, v196
 v_mfma_f32_16x16x32_bf16 v[120:123], v[180:183], a[248:251], v[120:123]
 ds_write_b128 v251, v[192:195] offset:34816
 ds_read_b128 a[224:227], v248 offset:16384
 v_mfma_f32_16x16x32_bf16 v[124:127], v[180:183], a[252:255], v[124:127]
 buffer_load_dwordx4 v252, s[12:15], s40 offen offset:0 nt lds
 ds_read_b128 a[228:231], v248 offset:16896
 v_and_b32 v241, 0xffff0000, v196
 v_mul_f32 v240, s27, v240
 v_mfma_f32_16x16x32_bf16 v[168:171], a[128:131], a[48:51], v[156:159]
 s_add_u32 m0, s38, 117632
 ds_read_b128 a[232:235], v248 offset:17408
 v_mul_f32 v241, s27, v241
 v_cvt_pk_bf16_f32 v196, v240, v241
 v_mfma_f32_16x16x32_bf16 v[168:171], a[132:135], a[52:55], v[168:171]
 s_add_u32 s41, s37, 49152
 ds_read_b128 a[236:239], v248 offset:17920
 v_lshlrev_b32 v242, 16, v197
 v_and_b32 v243, 0xffff0000, v197
 v_mfma_f32_16x16x32_bf16 v[168:171], a[136:139], a[56:59], v[168:171]
 s_waitcnt vmcnt(6)
 ds_read_b64 v[200:201], v254 offset:32768
 ds_read_b128 a[240:243], v248 offset:18432
 v_mul_f32 v242, s27, v242
 v_mfma_f32_16x16x32_bf16 v[168:171], a[140:143], a[60:63], v[168:171]
 ds_read_b64 v[202:203], v254 offset:33280
 ds_read_b128 a[244:247], v248 offset:18944
 v_mul_f32 v243, s27, v243
 v_mfma_f32_16x16x32_bf16 v[172:175], a[156:159], a[60:63], v[156:159]
 s_waitcnt vmcnt(5)
 ds_read_b64 v[204:205], v254 offset:33792
 ds_read_b128 a[248:251], v248 offset:19456
 v_cvt_pk_bf16_f32 v197, v242, v243
 v_exp_f32 v160, v160
 v_exp_f32 v161, v161
 v_exp_f32 v162, v162
 v_exp_f32 v163, v163
 v_exp_f32 v164, v164
 v_exp_f32 v165, v165
 v_exp_f32 v166, v166
 v_exp_f32 v167, v167
 v_mfma_f32_16x16x32_bf16 v[172:175], a[152:155], a[56:59], v[172:175]
 ds_read_b64 v[206:207], v254 offset:34304
 ds_read_b128 a[252:255], v248 offset:19968
 v_lshlrev_b32 v240, 16, v198
 v_cvt_pk_bf16_f32 v176, v160, v161
 v_cvt_pk_bf16_f32 v177, v162, v163
 v_cvt_pk_bf16_f32 v178, v164, v165
 v_cvt_pk_bf16_f32 v179, v166, v167
 v_mfma_f32_16x16x32_bf16 v[172:175], a[148:151], a[52:55], v[172:175]
 s_waitcnt vmcnt(4)
 ds_read_b64 v[208:209], v254 offset:34816
 v_and_b32 v241, 0xffff0000, v198
 v_mfma_f32_16x16x32_bf16 v[172:175], a[144:147], a[48:51], v[172:175]
 s_waitcnt lgkmcnt(10)
 ds_read_b64 v[210:211], v254 offset:35328
 v_mul_f32 v240, s27, v240
 v_mfma_f32_16x16x32_bf16 v[64:67], v[176:179], a[224:227], v[64:67]
 v_mul_f32 v241, s27, v241
 v_cvt_pk_bf16_f32 v198, v240, v241
 v_mfma_f32_16x16x32_bf16 v[68:71], v[176:179], a[228:231], v[68:71]
 s_waitcnt vmcnt(3)
 ds_read_b64 v[212:213], v254 offset:35840
 ds_read_b64 v[214:215], v254 offset:36352
 v_mfma_f32_16x16x32_bf16 v[72:75], v[176:179], a[232:235], v[72:75]
 s_waitcnt lgkmcnt(8)
 buffer_load_dwordx4 v252, s[12:15], s40 offen offset:128 nt lds
 v_lshlrev_b32 v242, 16, v199
 v_and_b32 v243, 0xffff0000, v199
 v_mfma_f32_16x16x32_bf16 v[76:79], v[176:179], a[236:239], v[76:79]
 s_add_u32 m0, s38, 49152
 v_mul_f32 v242, s27, v242
 v_mul_f32 v243, s27, v243
 v_mfma_f32_16x16x32_bf16 v[80:83], v[176:179], a[240:243], v[80:83]
 v_cvt_pk_bf16_f32 v199, v242, v243
 v_perm_b32 v216, v202, v200, s30
 v_mfma_f32_16x16x32_bf16 v[84:87], v[176:179], a[244:247], v[84:87]
 s_waitcnt lgkmcnt(3)
 ds_write_b128 v251, v[196:199] offset:35840
 v_mfma_f32_16x16x32_bf16 v[88:91], v[176:179], a[248:251], v[88:91]
 v_exp_f32 v168, v168
 v_mfma_f32_16x16x32_bf16 v[92:95], v[176:179], a[252:255], v[92:95]
 v_exp_f32 v169, v169
 v_mfma_f32_16x16x32_bf16 v[160:163], a[160:163], a[32:35], v[152:155]
 s_waitcnt lgkmcnt(1)
 v_perm_b32 v217, v206, v204, s30
 v_perm_b32 v218, v210, v208, s30
 v_mfma_f32_16x16x32_bf16 v[160:163], a[164:167], a[36:39], v[160:163]
 v_exp_f32 v170, v170
 v_mfma_f32_16x16x32_bf16 v[160:163], a[168:171], a[40:43], v[160:163]
 v_exp_f32 v171, v171
 v_mfma_f32_16x16x32_bf16 v[160:163], a[172:175], a[44:47], v[160:163]
 v_cvt_pk_bf16_f32 v180, v168, v169
 v_cvt_pk_bf16_f32 v181, v170, v171
 v_mfma_f32_16x16x32_bf16 v[164:167], a[188:191], a[44:47], v[152:155]
 v_exp_f32 v172, v172
 v_exp_f32 v173, v173
 v_exp_f32 v174, v174
 v_exp_f32 v175, v175
 v_mfma_f32_16x16x32_bf16 v[164:167], a[184:187], a[40:43], v[164:167]
 buffer_load_dwordx4 v253, s[16:19], s41 offen offset:0 nt lds
 v_cvt_pk_bf16_f32 v182, v172, v173
 v_perm_b32 v219, v214, v212, s30
 v_cvt_pk_bf16_f32 v183, v174, v175
 v_mfma_f32_16x16x32_bf16 v[164:167], a[180:183], a[36:39], v[164:167]
 s_add_u32 m0, s38, 49664
 ds_write_b128 v255, v[216:219] offset:32768
 v_mfma_f32_16x16x32_bf16 v[164:167], a[176:179], a[32:35], v[164:167]
 s_add_u32 s42, s37, 53248
 v_exp_f32 v160, v160
 v_smfmac_f32_16x16x64_bf16 v[132:135], v[236:239], v[176:183], v138
 v_perm_b32 v216, v202, v200, s31
 v_mfma_f32_16x16x32_bf16 v[96:99], v[180:183], a[224:227], v[96:99]
L_pg1:
 s_cbranch_execz L_pg5
 v_perm_b32 v217, v206, v204, s31
 v_perm_b32 v218, v210, v208, s31
 v_perm_b32 v219, v214, v212, s31
 v_mfma_f32_16x16x32_bf16 v[100:103], v[180:183], a[228:231], v[100:103]
 ds_write_b128 v255, v[216:219] offset:33280
 v_mfma_f32_16x16x32_bf16 v[104:107], v[180:183], a[232:235], v[104:107]
 v_exp_f32 v161, v161
 v_perm_b32 v216, v203, v201, s30
 v_perm_b32 v217, v207, v205, s30
 v_perm_b32 v218, v211, v209, s30
 v_perm_b32 v219, v215, v213, s30
 v_mfma_f32_16x16x32_bf16 v[108:111], v[180:183], a[236:239], v[108:111]
 v_exp_f32 v162, v162
 v_mfma_f32_16x16x32_bf16 v[112:115], v[180:183], a[240:243], v[112:115]
 v_exp_f32 v163, v163
 v_mfma_f32_16x16x32_bf16 v[116:119], v[180:183], a[244:247], v[116:119]
 ds_write_b128 v255, v[216:219] offset:33792
 v_mfma_f32_16x16x32_bf16 v[120:123], v[180:183], a[248:251], v[120:123]
 ds_read_b128 a[224:227], v248 offset:24576
 v_exp_f32 v164, v164
 v_perm_b32 v216, v203, v201, s31
 v_perm_b32 v217, v207, v205, s31
 v_perm_b32 v218, v211, v209, s31
 v_perm_b32 v219, v215, v213, s31
 v_mfma_f32_16x16x32_bf16 v[124:127], v[180:183], a[252:255], v[124:127]
 buffer_load_dwordx4 v253, s[16:19], s41 offen offset:512 nt lds
 ds_read_b128 a[228:231], v248 offset:25088
 v_exp_f32 v165, v165
 v_mfma_f32_16x16x32_bf16 v[168:171], a[160:163], a[48:51], v[156:159]
 s_add_u32 m0, s38, 51200
 ds_read_b128 a[232:235], v248 offset:25600
 v_exp_f32 v166, v166
 v_mfma_f32_16x16x32_bf16 v[168:171], a[164:167], a[52:55], v[168:171]
 ds_write_b128 v255, v[216:219] offset:34304
 ds_read_b128 a[236:239], v248 offset:26112
 v_mfma_f32_16x16x32_bf16 v[168:171], a[168:171], a[56:59], v[168:171]
 ds_read_b128 a[240:243], v248 offset:26624
 v_exp_f32 v167, v167
 v_mfma_f32_16x16x32_bf16 v[168:171], a[172:175], a[60:63], v[168:171]
 ds_read_b128 a[244:247], v248 offset:27136
 v_cvt_pk_bf16_f32 v176, v160, v161
 v_cvt_pk_bf16_f32 v177, v162, v163
 v_mfma_f32_16x16x32_bf16 v[172:175], a[188:191], a[60:63], v[156:159]
 ds_read_b128 a[248:251], v248 offset:27648
 v_cvt_pk_bf16_f32 v178, v164, v165
 v_cvt_pk_bf16_f32 v179, v166, v167
 v_mfma_f32_16x16x32_bf16 v[172:175], a[184:187], a[56:59], v[172:175]
 s_waitcnt vmcnt(5)
 ds_read_b128 a[252:255], v248 offset:28160
 ds_read_b128 v[184:187], v251 offset:49152
 v_mfma_f32_16x16x32_bf16 v[172:175], a[180:183], a[52:55], v[172:175]
 v_exp_f32 v168, v168
 v_mfma_f32_16x16x32_bf16 v[172:175], a[176:179], a[48:51], v[172:175]
 s_waitcnt lgkmcnt(7)
 v_exp_f32 v169, v169
 v_mfma_f32_16x16x32_bf16 v[64:67], v[176:179], a[224:227], v[64:67]
 v_exp_f32 v170, v170
 v_mfma_f32_16x16x32_bf16 v[68:71], v[176:179], a[228:231], v[68:71]
 v_exp_f32 v171, v171
 v_mfma_f32_16x16x32_bf16 v[72:75], v[176:179], a[232:235], v[72:75]
 s_waitcnt lgkmcnt(3)
 s_barrier
 ds_read_b128 a[192:195], v249 offset:32768
 ds_read_b128 a[196:199], v249 offset:33280
 ds_read_b128 a[200:203], v249 offset:33792
 ds_read_b128 a[204:207], v249 offset:34304
 buffer_load_dwordx4 v253, s[16:19], s42 offen offset:0 nt lds
 ds_read_b128 a[220:223], v249 offset:36352
 v_mfma_f32_16x16x32_bf16 v[76:79], v[176:179], a[236:239], v[76:79]
 s_add_u32 m0, s38, 51712
 ds_read_b128 a[212:215], v249 offset:35328
 ds_read_b128 a[216:219], v249 offset:35840
 v_mfma_f32_16x16x32_bf16 v[80:83], v[176:179], a[240:243], v[80:83]
 s_add_u32 s39, s36, 65536
 ds_read_b128 a[208:211], v249 offset:34816
 v_cvt_pk_bf16_f32 v180, v168, v169
 v_mfma_f32_16x16x32_bf16 v[84:87], v[176:179], a[244:247], v[84:87]
 s_waitcnt lgkmcnt(8)
 v_exp_f32 v173, v173
 v_mfma_f32_16x16x32_bf16 v[88:91], v[176:179], a[248:251], v[88:91]
 v_exp_f32 v174, v174
 v_mfma_f32_16x16x32_bf16 v[92:95], v[176:179], a[252:255], v[92:95]
 s_waitcnt lgkmcnt(7)
 v_exp_f32 v175, v175
 v_mfma_f32_16x16x32_bf16 v[160:163], a[192:195], a[0:3], v[144:147]
 s_waitcnt lgkmcnt(6)
 v_exp_f32 v172, v172
 v_mfma_f32_16x16x32_bf16 v[160:163], a[196:199], a[4:7], v[160:163]
 s_waitcnt lgkmcnt(3)
 v_cvt_pk_bf16_f32 v181, v170, v171
 v_cvt_pk_bf16_f32 v182, v172, v173
 v_mfma_f32_16x16x32_bf16 v[160:163], a[200:203], a[8:11], v[160:163]
 s_waitcnt vmcnt(5)
 ds_read_b128 v[188:191], v251 offset:50176
 v_cvt_pk_bf16_f32 v183, v174, v175
 v_mfma_f32_16x16x32_bf16 v[160:163], a[204:207], a[12:15], v[160:163]
 s_waitcnt vmcnt(4)
 ds_read_b128 v[192:195], v251 offset:51200
 v_lshlrev_b32 v240, 16, v184
 v_mfma_f32_16x16x32_bf16 v[164:167], a[220:223], a[12:15], v[144:147]
 s_waitcnt lgkmcnt(2)
 v_and_b32 v241, 0xffff0000, v184
 v_mul_f32 v240, s27, v240
 v_mfma_f32_16x16x32_bf16 v[164:167], a[216:219], a[8:11], v[164:167]
 buffer_load_dwordx4 v253, s[16:19], s42 offen offset:512 nt lds
 v_mul_f32 v241, s27, v241
 v_cvt_pk_bf16_f32 v184, v240, v241
 v_mfma_f32_16x16x32_bf16 v[164:167], a[212:215], a[4:7], v[164:167]
 s_waitcnt vmcnt(4)
 s_add_u32 m0, s38, 131072
 ds_read_b128 v[196:199], v251 offset:52224
 v_lshlrev_b32 v242, 16, v185
 v_mfma_f32_16x16x32_bf16 v[164:167], a[208:211], a[0:3], v[164:167]
 v_and_b32 v243, 0xffff0000, v185
 v_mul_f32 v242, s27, v242
 v_smfmac_f32_16x16x64_bf16 v[132:135], v[236:239], v[176:183], v138
 v_mul_f32 v243, s27, v243
 v_mfma_f32_16x16x32_bf16 v[96:99], v[180:183], a[224:227], v[96:99]
 v_cvt_pk_bf16_f32 v185, v242, v243
 v_lshlrev_b32 v240, 16, v186
 v_mfma_f32_16x16x32_bf16 v[100:103], v[180:183], a[228:231], v[100:103]
 v_exp_f32 v161, v161
 v_mfma_f32_16x16x32_bf16 v[104:107], v[180:183], a[232:235], v[104:107]
 v_exp_f32 v162, v162
 v_mfma_f32_16x16x32_bf16 v[108:111], v[180:183], a[236:239], v[108:111]
 v_exp_f32 v163, v163
 v_mfma_f32_16x16x32_bf16 v[112:115], v[180:183], a[240:243], v[112:115]
 v_exp_f32 v165, v165
 v_mfma_f32_16x16x32_bf16 v[116:119], v[180:183], a[244:247], v[116:119]
 v_exp_f32 v166, v166
 v_mfma_f32_16x16x32_bf16 v[120:123], v[180:183], a[248:251], v[120:123]
 ds_read_b128 a[224:227], v248 offset:32768
 v_exp_f32 v167, v167
 v_mfma_f32_16x16x32_bf16 v[124:127], v[180:183], a[252:255], v[124:127]
 buffer_load_dwordx4 v252, s[12:15], s39 offen offset:0 nt lds
 ds_read_b128 a[228:231], v248 offset:33280
 v_and_b32 v241, 0xffff0000, v186
 v_cvt_pk_bf16_f32 v177, v162, v163
 v_mfma_f32_16x16x32_bf16 v[168:171], a[192:195], a[16:19], v[148:151]
 s_add_u32 m0, s38, 131968
 ds_read_b128 a[232:235], v248 offset:33792
 v_exp_f32 v160, v160
 v_mfma_f32_16x16x32_bf16 v[168:171], a[196:199], a[20:23], v[168:171]
 s_add_u32 s40, s36, 69632
 ds_read_b128 a[236:239], v248 offset:34304
 v_cvt_pk_bf16_f32 v176, v160, v161
 v_cvt_pk_bf16_f32 v179, v166, v167
 v_mfma_f32_16x16x32_bf16 v[168:171], a[200:203], a[24:27], v[168:171]
 ds_read_b128 a[240:243], v248 offset:34816
 v_exp_f32 v164, v164
 v_mfma_f32_16x16x32_bf16 v[168:171], a[204:207], a[28:31], v[168:171]
 ds_read_b128 a[244:247], v248 offset:35328
 v_cvt_pk_bf16_f32 v178, v164, v165
 v_mul_f32 v240, s27, v240
 v_mfma_f32_16x16x32_bf16 v[172:175], a[220:223], a[28:31], v[148:151]
 ds_read_b128 a[248:251], v248 offset:35840
 v_mul_f32 v241, s27, v241
 v_cvt_pk_bf16_f32 v186, v240, v241
 v_mfma_f32_16x16x32_bf16 v[172:175], a[216:219], a[24:27], v[172:175]
 ds_read_b128 a[252:255], v248 offset:36352
 v_lshlrev_b32 v242, 16, v187
 v_and_b32 v243, 0xffff0000, v187
 v_mfma_f32_16x16x32_bf16 v[172:175], a[212:215], a[20:23], v[172:175]
 v_mul_f32 v242, s27, v242
 v_mul_f32 v243, s27, v243
 v_mfma_f32_16x16x32_bf16 v[172:175], a[208:211], a[16:19], v[172:175]
 s_waitcnt lgkmcnt(5)
 v_cvt_pk_bf16_f32 v187, v242, v243
 v_lshlrev_b32 v240, 16, v188
 v_mfma_f32_16x16x32_bf16 v[0:3], v[176:179], a[224:227], v[0:3]
 ds_write_b128 v251, v[184:187] offset:49152
 v_mfma_f32_16x16x32_bf16 v[4:7], v[176:179], a[228:231], v[4:7]
 v_and_b32 v241, 0xffff0000, v188
 v_mul_f32 v240, s27, v240
 v_mfma_f32_16x16x32_bf16 v[8:11], v[176:179], a[232:235], v[8:11]
 s_waitcnt lgkmcnt(3)
 buffer_load_dwordx4 v252, s[12:15], s39 offen offset:128 nt lds
 v_mul_f32 v241, s27, v241
 v_cvt_pk_bf16_f32 v188, v240, v241
 v_mfma_f32_16x16x32_bf16 v[12:15], v[176:179], a[236:239], v[12:15]
 s_add_u32 m0, s38, 133120
 v_exp_f32 v168, v168
 v_mfma_f32_16x16x32_bf16 v[16:19], v[176:179], a[240:243], v[16:19]
 v_exp_f32 v169, v169
 v_mfma_f32_16x16x32_bf16 v[20:23], v[176:179], a[244:247], v[20:23]
 s_waitcnt lgkmcnt(1)
 v_exp_f32 v170, v170
 v_mfma_f32_16x16x32_bf16 v[24:27], v[176:179], a[248:251], v[24:27]
 v_exp_f32 v171, v171
 v_mfma_f32_16x16x32_bf16 v[28:31], v[176:179], a[252:255], v[28:31]
 v_exp_f32 v175, v175
 v_mfma_f32_16x16x32_bf16 v[160:163], a[192:195], a[32:35], v[152:155]
 v_lshlrev_b32 v242, 16, v189
 v_cvt_pk_bf16_f32 v180, v168, v169
 v_mfma_f32_16x16x32_bf16 v[160:163], a[196:199], a[36:39], v[160:163]
 v_cvt_pk_bf16_f32 v181, v170, v171
 v_and_b32 v243, 0xffff0000, v189
 v_mfma_f32_16x16x32_bf16 v[160:163], a[200:203], a[40:43], v[160:163]
 v_exp_f32 v172, v172
 v_mfma_f32_16x16x32_bf16 v[160:163], a[204:207], a[44:47], v[160:163]
 v_exp_f32 v173, v173
 v_mfma_f32_16x16x32_bf16 v[164:167], a[220:223], a[44:47], v[152:155]
 v_exp_f32 v174, v174
 v_mfma_f32_16x16x32_bf16 v[164:167], a[216:219], a[40:43], v[164:167]
 buffer_load_dwordx4 v252, s[12:15], s40 offen offset:0 nt lds
 v_cvt_pk_bf16_f32 v182, v172, v173
 v_cvt_pk_bf16_f32 v183, v174, v175
 v_mfma_f32_16x16x32_bf16 v[164:167], a[212:215], a[36:39], v[164:167]
 s_add_u32 m0, s38, 134016
 v_mul_f32 v242, s27, v242
 v_mul_f32 v243, s27, v243
 v_mfma_f32_16x16x32_bf16 v[164:167], a[208:211], a[32:35], v[164:167]
 s_add_u32 s41, s37, 65536
 v_cvt_pk_bf16_f32 v189, v242, v243
 v_lshlrev_b32 v240, 16, v190
 v_smfmac_f32_16x16x64_bf16 v[128:131], v[236:239], v[176:183], v138
 v_and_b32 v241, 0xffff0000, v190
 v_mfma_f32_16x16x32_bf16 v[32:35], v[180:183], a[224:227], v[32:35]
 v_mul_f32 v240, s27, v240
 v_mul_f32 v241, s27, v241
 v_mfma_f32_16x16x32_bf16 v[36:39], v[180:183], a[228:231], v[36:39]
 v_cvt_pk_bf16_f32 v190, v240, v241
 v_lshlrev_b32 v242, 16, v191
 v_mfma_f32_16x16x32_bf16 v[40:43], v[180:183], a[232:235], v[40:43]
 v_and_b32 v243, 0xffff0000, v191
 v_mul_f32 v242, s27, v242
 v_mfma_f32_16x16x32_bf16 v[44:47], v[180:183], a[236:239], v[44:47]
 v_mul_f32 v243, s27, v243
 v_cvt_pk_bf16_f32 v191, v242, v243
 v_mfma_f32_16x16x32_bf16 v[48:51], v[180:183], a[240:243], v[48:51]
 ds_write_b128 v251, v[188:191] offset:50176
 v_mfma_f32_16x16x32_bf16 v[52:55], v[180:183], a[244:247], v[52:55]
 v_exp_f32 v161, v161
 v_mfma_f32_16x16x32_bf16 v[56:59], v[180:183], a[248:251], v[56:59]
 v_exp_f32 v162, v162
 v_mfma_f32_16x16x32_bf16 v[60:63], v[180:183], a[252:255], v[60:63]
 buffer_load_dwordx4 v252, s[12:15], s40 offen offset:128 nt lds
 v_exp_f32 v163, v163
 v_mfma_f32_16x16x32_bf16 v[168:171], a[192:195], a[48:51], v[156:159]
 s_add_u32 m0, s38, 65536
 v_exp_f32 v164, v164
 v_mfma_f32_16x16x32_bf16 v[168:171], a[196:199], a[52:55], v[168:171]
 v_exp_f32 v165, v165
 v_mfma_f32_16x16x32_bf16 v[168:171], a[200:203], a[56:59], v[168:171]
 v_exp_f32 v166, v166
 v_mfma_f32_16x16x32_bf16 v[168:171], a[204:207], a[60:63], v[168:171]
 v_exp_f32 v160, v160
 v_mfma_f32_16x16x32_bf16 v[172:175], a[220:223], a[60:63], v[156:159]
 v_exp_f32 v167, v167
 v_mfma_f32_16x16x32_bf16 v[172:175], a[216:219], a[56:59], v[172:175]
 v_lshlrev_b32 v240, 16, v192
 v_cvt_pk_bf16_f32 v176, v160, v161
 v_cvt_pk_bf16_f32 v177, v162, v163
 v_cvt_pk_bf16_f32 v178, v164, v165
 v_cvt_pk_bf16_f32 v179, v166, v167
 v_mfma_f32_16x16x32_bf16 v[172:175], a[212:215], a[52:55], v[172:175]
 ds_read_b128 a[192:195], v249 offset:40960
 v_and_b32 v241, 0xffff0000, v192
 v_mul_f32 v240, s27, v240
 v_mfma_f32_16x16x32_bf16 v[172:175], a[208:211], a[48:51], v[172:175]
 ds_read_b128 a[196:199], v249 offset:41472
 v_mul_f32 v241, s27, v241
 v_cvt_pk_bf16_f32 v192, v240, v241
 v_mfma_f32_16x16x32_bf16 v[64:67], v[176:179], a[224:227], v[64:67]
 ds_read_b128 a[200:203], v249 offset:41984
 v_lshlrev_b32 v242, 16, v193
 v_and_b32 v243, 0xffff0000, v193
 v_mfma_f32_16x16x32_bf16 v[68:71], v[176:179], a[228:231], v[68:71]
 ds_read_b128 a[204:207], v249 offset:42496
 v_mul_f32 v242, s27, v242
 v_mul_f32 v243, s27, v243
 v_mfma_f32_16x16x32_bf16 v[72:75], v[176:179], a[232:235], v[72:75]
 buffer_load_dwordx4 v253, s[16:19], s41 offen offset:0 nt lds
 ds_read_b128 a[220:223], v249 offset:44544
 v_cvt_pk_bf16_f32 v193, v242, v243
 v_lshlrev_b32 v240, 16, v194
 v_mfma_f32_16x16x32_bf16 v[76:79], v[176:179], a[236:239], v[76:79]
 s_add_u32 m0, s38, 66048
 ds_read_b128 a[216:219], v249 offset:44032
 v_and_b32 v241, 0xffff0000, v194
 v_mul_f32 v240, s27, v240
 v_mfma_f32_16x16x32_bf16 v[80:83], v[176:179], a[240:243], v[80:83]
 s_add_u32 s42, s37, 69632
 ds_read_b128 a[212:215], v249 offset:43520
 v_mul_f32 v241, s27, v241
 v_cvt_pk_bf16_f32 v194, v240, v241
 v_mfma_f32_16x16x32_bf16 v[84:87], v[176:179], a[244:247], v[84:87]
 ds_read_b128 a[208:211], v249 offset:43008
 v_exp_f32 v168, v168
 v_mfma_f32_16x16x32_bf16 v[88:91], v[176:179], a[248:251], v[88:91]
 v_exp_f32 v169, v169
 v_mfma_f32_16x16x32_bf16 v[92:95], v[176:179], a[252:255], v[92:95]
 s_waitcnt lgkmcnt(5)
 v_exp_f32 v170, v170
 v_mfma_f32_16x16x32_bf16 v[160:163], a[192:195], a[0:3], v[144:147]
 v_exp_f32 v171, v171
 v_mfma_f32_16x16x32_bf16 v[160:163], a[196:199], a[4:7], v[160:163]
 v_exp_f32 v175, v175
 v_mfma_f32_16x16x32_bf16 v[160:163], a[200:203], a[8:11], v[160:163]
 s_waitcnt lgkmcnt(2)
 v_lshlrev_b32 v242, 16, v195
 v_cvt_pk_bf16_f32 v180, v168, v169
 v_mfma_f32_16x16x32_bf16 v[160:163], a[204:207], a[12:15], v[160:163]
 v_cvt_pk_bf16_f32 v181, v170, v171
 v_and_b32 v243, 0xffff0000, v195
 v_mfma_f32_16x16x32_bf16 v[164:167], a[220:223], a[12:15], v[144:147]
 v_exp_f32 v172, v172
 v_exp_f32 v173, v173
 v_exp_f32 v174, v174
 v_mfma_f32_16x16x32_bf16 v[164:167], a[216:219], a[8:11], v[164:167]
 s_waitcnt lgkmcnt(0)
 buffer_load_dwordx4 v253, s[16:19], s41 offen offset:512 nt lds
 v_cvt_pk_bf16_f32 v182, v172, v173
 v_cvt_pk_bf16_f32 v183, v174, v175
 v_mfma_f32_16x16x32_bf16 v[164:167], a[212:215], a[4:7], v[164:167]
 s_add_u32 m0, s38, 67584
 v_mul_f32 v242, s27, v242
 v_mul_f32 v243, s27, v243
 v_mfma_f32_16x16x32_bf16 v[164:167], a[208:211], a[0:3], v[164:167]
 v_cvt_pk_bf16_f32 v195, v242, v243
 v_lshlrev_b32 v240, 16, v196
 v_smfmac_f32_16x16x64_bf16 v[132:135], v[236:239], v[176:183], v138
 v_and_b32 v241, 0xffff0000, v196
 v_mfma_f32_16x16x32_bf16 v[96:99], v[180:183], a[224:227], v[96:99]
 ds_write_b128 v251, v[192:195] offset:51200
 v_mfma_f32_16x16x32_bf16 v[100:103], v[180:183], a[228:231], v[100:103]
 v_mul_f32 v240, s27, v240
 v_mul_f32 v241, s27, v241
 v_mfma_f32_16x16x32_bf16 v[104:107], v[180:183], a[232:235], v[104:107]
 v_cvt_pk_bf16_f32 v196, v240, v241
 v_lshlrev_b32 v242, 16, v197
 v_mfma_f32_16x16x32_bf16 v[108:111], v[180:183], a[236:239], v[108:111]
 v_and_b32 v243, 0xffff0000, v197
 v_mul_f32 v242, s27, v242
 v_mfma_f32_16x16x32_bf16 v[112:115], v[180:183], a[240:243], v[112:115]
 v_mul_f32 v243, s27, v243
 v_cvt_pk_bf16_f32 v197, v242, v243
 v_mfma_f32_16x16x32_bf16 v[116:119], v[180:183], a[244:247], v[116:119]
 v_exp_f32 v161, v161
 v_mfma_f32_16x16x32_bf16 v[120:123], v[180:183], a[248:251], v[120:123]
 ds_read_b128 a[224:227], v248 offset:40960
 v_exp_f32 v162, v162
 v_mfma_f32_16x16x32_bf16 v[124:127], v[180:183], a[252:255], v[124:127]
 buffer_load_dwordx4 v253, s[16:19], s42 offen offset:0 nt lds
 ds_read_b128 a[228:231], v248 offset:41472
 v_exp_f32 v163, v163
 v_mfma_f32_16x16x32_bf16 v[168:171], a[192:195], a[16:19], v[148:151]
 s_add_u32 m0, s38, 68096
 ds_read_b128 a[232:235], v248 offset:41984
 v_exp_f32 v160, v160
 v_mfma_f32_16x16x32_bf16 v[168:171], a[196:199], a[20:23], v[168:171]
 s_add_u32 s39, s36, 81920
 ds_read_b128 a[236:239], v248 offset:42496
 v_lshlrev_b32 v240, 16, v198
 v_cvt_pk_bf16_f32 v176, v160, v161
 v_mfma_f32_16x16x32_bf16 v[168:171], a[200:203], a[24:27], v[168:171]
 ds_read_b128 a[240:243], v248 offset:43008
 v_exp_f32 v164, v164
 v_mfma_f32_16x16x32_bf16 v[168:171], a[204:207], a[28:31], v[168:171]
 ds_read_b128 a[244:247], v248 offset:43520
 v_exp_f32 v165, v165
 v_mfma_f32_16x16x32_bf16 v[172:175], a[220:223], a[28:31], v[148:151]
 ds_read_b128 a[248:251], v248 offset:44032
 v_cvt_pk_bf16_f32 v177, v162, v163
 v_cvt_pk_bf16_f32 v178, v164, v165
 v_exp_f32 v166, v166
 v_exp_f32 v167, v167
 v_mfma_f32_16x16x32_bf16 v[172:175], a[216:219], a[24:27], v[172:175]
 s_waitcnt vmcnt(10)
 ds_read_b64 v[200:201], v254 offset:49152
 ds_read_b64 v[202:203], v254 offset:49664
 ds_read_b128 a[252:255], v248 offset:44544
 v_cvt_pk_bf16_f32 v179, v166, v167
 v_mfma_f32_16x16x32_bf16 v[172:175], a[212:215], a[20:23], v[172:175]
 s_waitcnt vmcnt(9)
 ds_read_b64 v[204:205], v254 offset:50176
 ds_read_b64 v[206:207], v254 offset:50688
 v_and_b32 v241, 0xffff0000, v198
 v_mfma_f32_16x16x32_bf16 v[172:175], a[208:211], a[16:19], v[172:175]
 s_waitcnt lgkmcnt(9)
 v_mul_f32 v240, s27, v240
 v_mul_f32 v241, s27, v241
 v_mfma_f32_16x16x32_bf16 v[0:3], v[176:179], a[224:227], v[0:3]
 v_cvt_pk_bf16_f32 v198, v240, v241
 v_lshlrev_b32 v242, 16, v199
 v_mfma_f32_16x16x32_bf16 v[4:7], v[176:179], a[228:231], v[4:7]
 v_and_b32 v243, 0xffff0000, v199
 v_mul_f32 v242, s27, v242
 v_mfma_f32_16x16x32_bf16 v[8:11], v[176:179], a[232:235], v[8:11]
 s_waitcnt vmcnt(8) lgkmcnt(6)
 ds_read_b64 v[208:209], v254 offset:51200
 ds_read_b64 v[210:211], v254 offset:51712
 buffer_load_dwordx4 v253, s[16:19], s42 offen offset:512 nt lds
 v_mfma_f32_16x16x32_bf16 v[12:15], v[176:179], a[236:239], v[12:15]
 s_waitcnt vmcnt(8)
 s_add_u32 m0, s38, 147456
 ds_read_b64 v[212:213], v254 offset:52224
 v_mul_f32 v243, s27, v243
 v_mfma_f32_16x16x32_bf16 v[16:19], v[176:179], a[240:243], v[16:19]
 ds_read_b64 v[214:215], v254 offset:52736
 v_cvt_pk_bf16_f32 v199, v242, v243
 v_mfma_f32_16x16x32_bf16 v[20:23], v[176:179], a[244:247], v[20:23]
 s_waitcnt lgkmcnt(4)
 ds_write_b128 v251, v[196:199] offset:52224
 v_mfma_f32_16x16x32_bf16 v[24:27], v[176:179], a[248:251], v[24:27]
 v_perm_b32 v216, v202, v200, s30
 v_add_u32 v251, 0x10000, v251
 v_mfma_f32_16x16x32_bf16 v[28:31], v[176:179], a[252:255], v[28:31]
 s_waitcnt vmcnt(7)
 ds_read_b128 v[184:187], v251 offset:0
 v_perm_b32 v217, v206, v204, s30
 v_mfma_f32_16x16x32_bf16 v[160:163], a[192:195], a[32:35], v[152:155]
 v_exp_f32 v168, v168
 v_mfma_f32_16x16x32_bf16 v[160:163], a[196:199], a[36:39], v[160:163]
 v_exp_f32 v169, v169
 v_mfma_f32_16x16x32_bf16 v[160:163], a[200:203], a[40:43], v[160:163]
 v_exp_f32 v170, v170
 v_mfma_f32_16x16x32_bf16 v[160:163], a[204:207], a[44:47], v[160:163]
 v_exp_f32 v171, v171
 v_mfma_f32_16x16x32_bf16 v[164:167], a[220:223], a[44:47], v[152:155]
 v_exp_f32 v174, v174
 v_exp_f32 v172, v172
 v_exp_f32 v173, v173
 v_exp_f32 v175, v175
 v_mfma_f32_16x16x32_bf16 v[164:167], a[216:219], a[40:43], v[164:167]
 s_waitcnt lgkmcnt(1)
 buffer_load_dwordx4 v252, s[12:15], s39 offen offset:0 nt lds
 v_perm_b32 v218, v210, v208, s30
 v_cvt_pk_bf16_f32 v180, v168, v169
 v_cvt_pk_bf16_f32 v181, v170, v171
 v_cvt_pk_bf16_f32 v182, v172, v173
 v_cvt_pk_bf16_f32 v183, v174, v175
 v_mfma_f32_16x16x32_bf16 v[164:167], a[212:215], a[36:39], v[164:167]
 s_add_u32 m0, s38, 148352
 s_add_u32 s40, s36, 86016
 v_perm_b32 v219, v214, v212, s30
 v_mfma_f32_16x16x32_bf16 v[164:167], a[208:211], a[32:35], v[164:167]
 ds_write_b128 v255, v[216:219] offset:49152
 v_smfmac_f32_16x16x64_bf16 v[128:131], v[236:239], v[176:183], v138
 s_waitcnt vmcnt(7)
 ds_read_b128 v[188:191], v251 offset:1024
 v_mfma_f32_16x16x32_bf16 v[32:35], v[180:183], a[224:227], v[32:35]
 v_perm_b32 v216, v202, v200, s31
 v_perm_b32 v217, v206, v204, s31
 v_perm_b32 v218, v210, v208, s31
 v_perm_b32 v219, v214, v212, s31
 v_mfma_f32_16x16x32_bf16 v[36:39], v[180:183], a[228:231], v[36:39]
 v_exp_f32 v160, v160
 v_mfma_f32_16x16x32_bf16 v[40:43], v[180:183], a[232:235], v[40:43]
 ds_write_b128 v255, v[216:219] offset:49664
 v_mfma_f32_16x16x32_bf16 v[44:47], v[180:183], a[236:239], v[44:47]
 v_exp_f32 v161, v161
 v_perm_b32 v216, v203, v201, s30
 v_perm_b32 v217, v207, v205, s30
 v_perm_b32 v218, v211, v209, s30
 v_perm_b32 v219, v215, v213, s30
 v_mfma_f32_16x16x32_bf16 v[48:51], v[180:183], a[240:243], v[48:51]
 v_exp_f32 v162, v162
 v_mfma_f32_16x16x32_bf16 v[52:55], v[180:183], a[244:247], v[52:55]
 v_exp_f32 v163, v163
 v_mfma_f32_16x16x32_bf16 v[56:59], v[180:183], a[248:251], v[56:59]
 ds_write_b128 v255, v[216:219] offset:50176
 v_mfma_f32_16x16x32_bf16 v[60:63], v[180:183], a[252:255], v[60:63]
 buffer_load_dwordx4 v252, s[12:15], s39 offen offset:128 nt lds
 v_exp_f32 v164, v164
 v_perm_b32 v216, v203, v201, s31
 v_perm_b32 v217, v207, v205, s31
 v_perm_b32 v218, v211, v209, s31
 v_perm_b32 v219, v215, v213, s31
 v_mfma_f32_16x16x32_bf16 v[168:171], a[192:195], a[48:51], v[156:159]
 s_add_u32 m0, s38, 149504
 v_exp_f32 v165, v165
 v_mfma_f32_16x16x32_bf16 v[168:171], a[196:199], a[52:55], v[168:171]
 v_exp_f32 v166, v166
 v_mfma_f32_16x16x32_bf16 v[168:171], a[200:203], a[56:59], v[168:171]
 ds_write_b128 v255, v[216:219] offset:50688
 v_mfma_f32_16x16x32_bf16 v[168:171], a[204:207], a[60:63], v[168:171]
 v_exp_f32 v167, v167
 v_mfma_f32_16x16x32_bf16 v[172:175], a[220:223], a[60:63], v[156:159]
 v_cvt_pk_bf16_f32 v176, v160, v161
 v_cvt_pk_bf16_f32 v177, v162, v163
 v_mfma_f32_16x16x32_bf16 v[172:175], a[216:219], a[56:59], v[172:175]
 v_cvt_pk_bf16_f32 v178, v164, v165
 v_cvt_pk_bf16_f32 v179, v166, v167
 v_mfma_f32_16x16x32_bf16 v[172:175], a[212:215], a[52:55], v[172:175]
 v_exp_f32 v168, v168
 v_mfma_f32_16x16x32_bf16 v[172:175], a[208:211], a[48:51], v[172:175]
 v_exp_f32 v169, v169
 v_mfma_f32_16x16x32_bf16 v[64:67], v[176:179], a[224:227], v[64:67]
 v_exp_f32 v170, v170
 v_mfma_f32_16x16x32_bf16 v[68:71], v[176:179], a[228:231], v[68:71]
 buffer_load_dwordx4 v252, s[12:15], s40 offen offset:0 nt lds
 v_mfma_f32_16x16x32_bf16 v[72:75], v[176:179], a[232:235], v[72:75]
 s_add_u32 m0, s38, 150400
 v_exp_f32 v171, v171
 v_mfma_f32_16x16x32_bf16 v[76:79], v[176:179], a[236:239], v[76:79]
 s_waitcnt lgkmcnt(0)
 s_barrier
 s_add_u32 s41, s37, 81920
 ds_read_b128 a[192:195], v249 offset:49152
 ds_read_b128 a[196:199], v249 offset:49664
 ds_read_b128 a[200:203], v249 offset:50176
 ds_read_b128 a[204:207], v249 offset:50688
 ds_read_b128 a[220:223], v249 offset:52736
 ds_read_b128 a[216:219], v249 offset:52224
 v_mfma_f32_16x16x32_bf16 v[80:83], v[176:179], a[240:243], v[80:83]
 ds_read_b128 a[212:215], v249 offset:51712
 ds_read_b128 a[208:211], v249 offset:51200
 v_mfma_f32_16x16x32_bf16 v[84:87], v[176:179], a[244:247], v[84:87]
 v_exp_f32 v172, v172
 v_mfma_f32_16x16x32_bf16 v[88:91], v[176:179], a[248:251], v[88:91]
 v_exp_f32 v173, v173
 v_mfma_f32_16x16x32_bf16 v[92:95], v[176:179], a[252:255], v[92:95]
 s_waitcnt lgkmcnt(7)
 v_exp_f32 v174, v174
 v_mfma_f32_16x16x32_bf16 v[160:163], a[192:195], a[0:3], v[144:147]
 s_waitcnt lgkmcnt(6)
 v_exp_f32 v175, v175
 v_mfma_f32_16x16x32_bf16 v[160:163], a[196:199], a[4:7], v[160:163]
 s_waitcnt lgkmcnt(5)
 v_cvt_pk_bf16_f32 v180, v168, v169
 v_cvt_pk_bf16_f32 v181, v170, v171
 v_mfma_f32_16x16x32_bf16 v[160:163], a[200:203], a[8:11], v[160:163]
 s_waitcnt lgkmcnt(2)
 v_cvt_pk_bf16_f32 v182, v172, v173
 v_cvt_pk_bf16_f32 v183, v174, v175
 v_mfma_f32_16x16x32_bf16 v[160:163], a[204:207], a[12:15], v[160:163]
 s_waitcnt vmcnt(7)
 ds_read_b128 v[192:195], v251 offset:2048
 ds_read_b128 v[196:199], v251 offset:3072
 v_mfma_f32_16x16x32_bf16 v[164:167], a[220:223], a[12:15], v[144:147]
 v_lshlrev_b32 v240, 16, v184
 v_and_b32 v241, 0xffff0000, v184
 v_mfma_f32_16x16x32_bf16 v[164:167], a[216:219], a[8:11], v[164:167]
 s_waitcnt lgkmcnt(2)
 buffer_load_dwordx4 v252, s[12:15], s40 offen offset:128 nt lds
 v_mul_f32 v240, s27, v240
 v_mul_f32 v241, s27, v241
 v_mfma_f32_16x16x32_bf16 v[164:167], a[212:215], a[4:7], v[164:167]
 s_add_u32 m0, s38, 81920
 v_cvt_pk_bf16_f32 v184, v240, v241
 v_lshlrev_b32 v242, 16, v185
 v_mfma_f32_16x16x32_bf16 v[164:167], a[208:211], a[0:3], v[164:167]
 v_exp_f32 v161, v161
 v_smfmac_f32_16x16x64_bf16 v[132:135], v[236:239], v[176:183], v138
 v_and_b32 v243, 0xffff0000, v185
 v_mfma_f32_16x16x32_bf16 v[96:99], v[180:183], a[224:227], v[96:99]
 v_exp_f32 v162, v162
 v_mfma_f32_16x16x32_bf16 v[100:103], v[180:183], a[228:231], v[100:103]
 v_exp_f32 v163, v163
 v_mfma_f32_16x16x32_bf16 v[104:107], v[180:183], a[232:235], v[104:107]
 v_exp_f32 v165, v165
 v_mfma_f32_16x16x32_bf16 v[108:111], v[180:183], a[236:239], v[108:111]
 v_exp_f32 v166, v166
 v_mfma_f32_16x16x32_bf16 v[112:115], v[180:183], a[240:243], v[112:115]
 v_exp_f32 v160, v160
 v_mfma_f32_16x16x32_bf16 v[116:119], v[180:183], a[244:247], v[116:119]
 v_exp_f32 v167, v167
 v_mfma_f32_16x16x32_bf16 v[120:123], v[180:183], a[248:251], v[120:123]
 ds_read_b128 a[224:227], v248 offset:49152
 v_cvt_pk_bf16_f32 v176, v160, v161
 v_cvt_pk_bf16_f32 v177, v162, v163
 v_mfma_f32_16x16x32_bf16 v[124:127], v[180:183], a[252:255], v[124:127]
 buffer_load_dwordx4 v253, s[16:19], s41 offen offset:0 nt lds
 ds_read_b128 a[228:231], v248 offset:49664
 v_exp_f32 v164, v164
 v_mfma_f32_16x16x32_bf16 v[168:171], a[192:195], a[16:19], v[148:151]
 s_add_u32 m0, s38, 82432
 ds_read_b128 a[232:235], v248 offset:50176
 v_cvt_pk_bf16_f32 v178, v164, v165
 v_mul_f32 v242, s27, v242
 v_mfma_f32_16x16x32_bf16 v[168:171], a[196:199], a[20:23], v[168:171]
 s_add_u32 s42, s37, 86016
 ds_read_b128 a[236:239], v248 offset:50688
 v_cvt_pk_bf16_f32 v179, v166, v167
 v_mul_f32 v243, s27, v243
 v_mfma_f32_16x16x32_bf16 v[168:171], a[200:203], a[24:27], v[168:171]
 ds_read_b128 a[240:243], v248 offset:51200
 v_cvt_pk_bf16_f32 v185, v242, v243
 v_lshlrev_b32 v240, 16, v186
 v_mfma_f32_16x16x32_bf16 v[168:171], a[204:207], a[28:31], v[168:171]
 ds_read_b128 a[244:247], v248 offset:51712
 v_and_b32 v241, 0xffff0000, v186
 v_mul_f32 v240, s27, v240
 v_mfma_f32_16x16x32_bf16 v[172:175], a[220:223], a[28:31], v[148:151]
 ds_read_b128 a[248:251], v248 offset:52224
 v_mul_f32 v241, s27, v241
 v_cvt_pk_bf16_f32 v186, v240, v241
 v_mfma_f32_16x16x32_bf16 v[172:175], a[216:219], a[24:27], v[172:175]
 ds_read_b128 a[252:255], v248 offset:52736
 v_lshlrev_b32 v242, 16, v187
 v_and_b32 v243, 0xffff0000, v187
 v_mfma_f32_16x16x32_bf16 v[172:175], a[212:215], a[20:23], v[172:175]
 v_mul_f32 v242, s27, v242
 v_mul_f32 v243, s27, v243
 v_mfma_f32_16x16x32_bf16 v[172:175], a[208:211], a[16:19], v[172:175]
 s_waitcnt lgkmcnt(5)
 v_cvt_pk_bf16_f32 v187, v242, v243
 v_lshlrev_b32 v240, 16, v188
 v_mfma_f32_16x16x32_bf16 v[0:3], v[176:179], a[224:227], v[0:3]
L_pg2:
 s_cbranch_execz L_pg6
 ds_write_b128 v251, v[184:187] offset:0
 v_mfma_f32_16x16x32_bf16 v[4:7], v[176:179], a[228:231], v[4:7]
 v_exp_f32 v168, v168
 v_mfma_f32_16x16x32_bf16 v[8:11], v[176:179], a[232:235], v[8:11]
 s_waitcnt lgkmcnt(3)
 buffer_load_dwordx4 v253, s[16:19], s41 offen offset:512 nt lds
 v_exp_f32 v169, v169
 v_mfma_f32_16x16x32_bf16 v[12:15], v[176:179], a[236:239], v[12:15]
 s_add_u32 m0, s38, 83968
 v_exp_f32 v170, v170
 v_mfma_f32_16x16x32_bf16 v[16:19], v[176:179], a[240:243], v[16:19]
 v_exp_f32 v171, v171
 v_mfma_f32_16x16x32_bf16 v[20:23], v[176:179], a[244:247], v[20:23]
 s_waitcnt lgkmcnt(1)
 v_exp_f32 v174, v174
 v_mfma_f32_16x16x32_bf16 v[24:27], v[176:179], a[248:251], v[24:27]
 v_exp_f32 v175, v175
 v_mfma_f32_16x16x32_bf16 v[28:31], v[176:179], a[252:255], v[28:31]
 v_cvt_pk_bf16_f32 v180, v168, v169
 v_cvt_pk_bf16_f32 v181, v170, v171
 v_mfma_f32_16x16x32_bf16 v[160:163], a[192:195], a[32:35], v[152:155]
 v_exp_f32 v172, v172
 v_mfma_f32_16x16x32_bf16 v[160:163], a[196:199], a[36:39], v[160:163]
 v_exp_f32 v173, v173
 v_mfma_f32_16x16x32_bf16 v[160:163], a[200:203], a[40:43], v[160:163]
 v_cvt_pk_bf16_f32 v182, v172, v173
 v_and_b32 v241, 0xffff0000, v188
 v_mfma_f32_16x16x32_bf16 v[160:163], a[204:207], a[44:47], v[160:163]
 v_cvt_pk_bf16_f32 v183, v174, v175
 v_mul_f32 v240, s27, v240
 v_mfma_f32_16x16x32_bf16 v[164:167], a[220:223], a[44:47], v[152:155]
 v_mul_f32 v241, s27, v241
 v_cvt_pk_bf16_f32 v188, v240, v241
 v_mfma_f32_16x16x32_bf16 v[164:167], a[216:219], a[40:43], v[164:167]
 buffer_load_dwordx4 v253, s[16:19], s42 offen offset:0 nt lds
 v_lshlrev_b32 v242, 16, v189
 v_and_b32 v243, 0xffff0000, v189
 v_mfma_f32_16x16x32_bf16 v[164:167], a[212:215], a[36:39], v[164:167]
 s_add_u32 m0, s38, 84480
 v_mul_f32 v242, s27, v242
 v_mul_f32 v243, s27, v243
 v_mfma_f32_16x16x32_bf16 v[164:167], a[208:211], a[32:35], v[164:167]
 s_add_u32 s32, s25, 16384
 v_cvt_pk_bf16_f32 v189, v242, v243
 v_lshlrev_b32 v240, 16, v190
 v_smfmac_f32_16x16x64_bf16 v[128:131], v[236:239], v[176:183], v138
 v_and_b32 v241, 0xffff0000, v190
 v_mfma_f32_16x16x32_bf16 v[32:35], v[180:183], a[224:227], v[32:35]
 v_mul_f32 v240, s27, v240
 v_mul_f32 v241, s27, v241
 v_mfma_f32_16x16x32_bf16 v[36:39], v[180:183], a[228:231], v[36:39]
 v_cvt_pk_bf16_f32 v190, v240, v241
 v_lshlrev_b32 v242, 16, v191
 v_mfma_f32_16x16x32_bf16 v[40:43], v[180:183], a[232:235], v[40:43]
 v_exp_f32 v161, v161
 v_mfma_f32_16x16x32_bf16 v[44:47], v[180:183], a[236:239], v[44:47]
 v_exp_f32 v162, v162
 v_mfma_f32_16x16x32_bf16 v[48:51], v[180:183], a[240:243], v[48:51]
 v_exp_f32 v163, v163
 v_mfma_f32_16x16x32_bf16 v[52:55], v[180:183], a[244:247], v[52:55]
 v_and_b32 v243, 0xffff0000, v191
 v_mul_f32 v242, s27, v242
 v_mfma_f32_16x16x32_bf16 v[56:59], v[180:183], a[248:251], v[56:59]
 v_exp_f32 v165, v165
 v_mfma_f32_16x16x32_bf16 v[60:63], v[180:183], a[252:255], v[60:63]
 buffer_load_dwordx4 v253, s[16:19], s42 offen offset:512 nt lds
 v_exp_f32 v166, v166
 v_mfma_f32_16x16x32_bf16 v[168:171], a[192:195], a[48:51], v[156:159]
 v_exp_f32 v167, v167
 v_mfma_f32_16x16x32_bf16 v[168:171], a[196:199], a[52:55], v[168:171]
 v_exp_f32 v160, v160
 v_mfma_f32_16x16x32_bf16 v[168:171], a[200:203], a[56:59], v[168:171]
 v_cvt_pk_bf16_f32 v176, v160, v161
 v_cvt_pk_bf16_f32 v177, v162, v163
 v_mfma_f32_16x16x32_bf16 v[168:171], a[204:207], a[60:63], v[168:171]
 v_exp_f32 v164, v164
 v_mfma_f32_16x16x32_bf16 v[172:175], a[220:223], a[60:63], v[156:159]
 v_cvt_pk_bf16_f32 v178, v164, v165
 v_cvt_pk_bf16_f32 v179, v166, v167
 v_mfma_f32_16x16x32_bf16 v[172:175], a[216:219], a[56:59], v[172:175]
 v_mul_f32 v243, s27, v243
 v_cvt_pk_bf16_f32 v191, v242, v243
 v_mfma_f32_16x16x32_bf16 v[172:175], a[212:215], a[52:55], v[172:175]
 ds_write_b128 v251, v[188:191] offset:1024
 ds_read_b128 a[192:195], v249 offset:57344
 v_mfma_f32_16x16x32_bf16 v[172:175], a[208:211], a[48:51], v[172:175]
 ds_read_b128 a[196:199], v249 offset:57856
 v_lshlrev_b32 v240, 16, v192
 v_and_b32 v241, 0xffff0000, v192
 v_mfma_f32_16x16x32_bf16 v[64:67], v[176:179], a[224:227], v[64:67]
 ds_read_b128 a[200:203], v249 offset:58368
 v_mul_f32 v240, s27, v240
 v_mul_f32 v241, s27, v241
 v_mfma_f32_16x16x32_bf16 v[68:71], v[176:179], a[228:231], v[68:71]
 ds_read_b128 a[204:207], v249 offset:58880
 v_cvt_pk_bf16_f32 v192, v240, v241
 v_lshlrev_b32 v242, 16, v193
 v_mfma_f32_16x16x32_bf16 v[72:75], v[176:179], a[232:235], v[72:75]
 ds_read_b128 a[220:223], v249 offset:60928
 v_and_b32 v243, 0xffff0000, v193
 v_mul_f32 v242, s27, v242
 v_mfma_f32_16x16x32_bf16 v[76:79], v[176:179], a[236:239], v[76:79]
 ds_read_b128 a[216:219], v249 offset:60416
 v_mul_f32 v243, s27, v243
 v_cvt_pk_bf16_f32 v193, v242, v243
 v_mfma_f32_16x16x32_bf16 v[80:83], v[176:179], a[240:243], v[80:83]
 ds_read_b128 a[212:215], v249 offset:59904
 v_exp_f32 v168, v168
 v_mfma_f32_16x16x32_bf16 v[84:87], v[176:179], a[244:247], v[84:87]
 ds_read_b128 a[208:211], v249 offset:59392
 v_exp_f32 v169, v169
 v_mfma_f32_16x16x32_bf16 v[88:91], v[176:179], a[248:251], v[88:91]
 v_exp_f32 v170, v170
 v_mfma_f32_16x16x32_bf16 v[92:95], v[176:179], a[252:255], v[92:95]
 s_waitcnt lgkmcnt(5)
 v_exp_f32 v171, v171
 v_mfma_f32_16x16x32_bf16 v[160:163], a[192:195], a[0:3], v[144:147]
 v_exp_f32 v175, v175
 v_mfma_f32_16x16x32_bf16 v[160:163], a[196:199], a[4:7], v[160:163]
 v_lshlrev_b32 v240, 16, v194
 v_and_b32 v241, 0xffff0000, v194
 v_mfma_f32_16x16x32_bf16 v[160:163], a[200:203], a[8:11], v[160:163]
 s_waitcnt lgkmcnt(2)
 v_cvt_pk_bf16_f32 v180, v168, v169
 v_cvt_pk_bf16_f32 v181, v170, v171
 v_mfma_f32_16x16x32_bf16 v[160:163], a[204:207], a[12:15], v[160:163]
 v_exp_f32 v172, v172
 v_mfma_f32_16x16x32_bf16 v[164:167], a[220:223], a[12:15], v[144:147]
 v_exp_f32 v173, v173
 v_exp_f32 v174, v174
 v_mfma_f32_16x16x32_bf16 v[164:167], a[216:219], a[8:11], v[164:167]
 s_waitcnt lgkmcnt(0)
 v_cvt_pk_bf16_f32 v182, v172, v173
 v_cvt_pk_bf16_f32 v183, v174, v175
 v_mfma_f32_16x16x32_bf16 v[164:167], a[212:215], a[4:7], v[164:167]
 v_mul_f32 v240, s27, v240
 v_mul_f32 v241, s27, v241
 v_mfma_f32_16x16x32_bf16 v[164:167], a[208:211], a[0:3], v[164:167]
 v_cvt_pk_bf16_f32 v194, v240, v241
 v_lshlrev_b32 v242, 16, v195
 v_smfmac_f32_16x16x64_bf16 v[132:135], v[236:239], v[176:183], v138
 v_and_b32 v243, 0xffff0000, v195
 v_mfma_f32_16x16x32_bf16 v[96:99], v[180:183], a[224:227], v[96:99]
 v_mul_f32 v242, s27, v242
 v_mul_f32 v243, s27, v243
 v_mfma_f32_16x16x32_bf16 v[100:103], v[180:183], a[228:231], v[100:103]
 v_cvt_pk_bf16_f32 v195, v242, v243
 v_lshlrev_b32 v240, 16, v196
 v_mfma_f32_16x16x32_bf16 v[104:107], v[180:183], a[232:235], v[104:107]
 ds_write_b128 v251, v[192:195] offset:2048
 v_mfma_f32_16x16x32_bf16 v[108:111], v[180:183], a[236:239], v[108:111]
 v_and_b32 v241, 0xffff0000, v196
 v_mul_f32 v240, s27, v240
 v_mfma_f32_16x16x32_bf16 v[112:115], v[180:183], a[240:243], v[112:115]
 v_mul_f32 v241, s27, v241
 v_cvt_pk_bf16_f32 v196, v240, v241
 v_mfma_f32_16x16x32_bf16 v[116:119], v[180:183], a[244:247], v[116:119]
 v_lshlrev_b32 v242, 16, v197
 v_and_b32 v243, 0xffff0000, v197
 v_mfma_f32_16x16x32_bf16 v[120:123], v[180:183], a[248:251], v[120:123]
 ds_read_b128 a[224:227], v248 offset:57344
 v_exp_f32 v162, v162
 v_mfma_f32_16x16x32_bf16 v[124:127], v[180:183], a[252:255], v[124:127]
 ds_read_b128 a[228:231], v248 offset:57856
 v_exp_f32 v163, v163
 v_mfma_f32_16x16x32_bf16 v[168:171], a[192:195], a[16:19], v[148:151]
 ds_read_b128 a[232:235], v248 offset:58368
 v_exp_f32 v160, v160
 v_mfma_f32_16x16x32_bf16 v[168:171], a[196:199], a[20:23], v[168:171]
 ds_read_b128 a[236:239], v248 offset:58880
 v_exp_f32 v161, v161
 v_mfma_f32_16x16x32_bf16 v[168:171], a[200:203], a[24:27], v[168:171]
 ds_read_b128 a[240:243], v248 offset:59392
 v_cvt_pk_bf16_f32 v176, v160, v161
 v_mul_f32 v242, s27, v242
 v_mfma_f32_16x16x32_bf16 v[168:171], a[204:207], a[28:31], v[168:171]
 ds_read_b128 a[244:247], v248 offset:59904
 v_cvt_pk_bf16_f32 v177, v162, v163
 v_mul_f32 v243, s27, v243
 v_mfma_f32_16x16x32_bf16 v[172:175], a[220:223], a[28:31], v[148:151]
 ds_read_b128 a[248:251], v248 offset:60416
 v_cvt_pk_bf16_f32 v197, v242, v243
 v_lshlrev_b32 v240, 16, v198
 v_exp_f32 v164, v164
 v_exp_f32 v165, v165
 v_exp_f32 v166, v166
 v_exp_f32 v167, v167
 v_mfma_f32_16x16x32_bf16 v[172:175], a[216:219], a[24:27], v[172:175]
 ds_read_b128 a[252:255], v248 offset:60928
 v_and_b32 v241, 0xffff0000, v198
 v_mul_f32 v240, s27, v240
 v_cvt_pk_bf16_f32 v178, v164, v165
 v_cvt_pk_bf16_f32 v179, v166, v167
 v_mfma_f32_16x16x32_bf16 v[172:175], a[212:215], a[20:23], v[172:175]
 v_add_u32 v254, 0x10000, v254
 v_mul_f32 v241, s27, v241
 v_mfma_f32_16x16x32_bf16 v[172:175], a[208:211], a[16:19], v[172:175]
 s_waitcnt lgkmcnt(5)
 v_add_u32 v255, 0x10000, v255
 v_cvt_pk_bf16_f32 v198, v240, v241
 v_mfma_f32_16x16x32_bf16 v[0:3], v[176:179], a[224:227], v[0:3]
 s_waitcnt vmcnt(8)
 ds_read_b64 v[200:201], v254 offset:0
 v_lshlrev_b32 v242, 16, v199
 v_mfma_f32_16x16x32_bf16 v[4:7], v[176:179], a[228:231], v[4:7]
 ds_read_b64 v[202:203], v254 offset:512
 ds_read_b64 v[204:205], v254 offset:1024
 v_mfma_f32_16x16x32_bf16 v[8:11], v[176:179], a[232:235], v[8:11]
 s_waitcnt lgkmcnt(5)
 ds_read_b64 v[206:207], v254 offset:1536
 ds_read_b64 v[208:209], v254 offset:2048
 v_mfma_f32_16x16x32_bf16 v[12:15], v[176:179], a[236:239], v[12:15]
 ds_read_b64 v[210:211], v254 offset:2560
 ds_read_b64 v[212:213], v254 offset:3072
 v_mfma_f32_16x16x32_bf16 v[16:19], v[176:179], a[240:243], v[16:19]
 ds_read_b64 v[214:215], v254 offset:3584
 v_and_b32 v243, 0xffff0000, v199
 v_mfma_f32_16x16x32_bf16 v[20:23], v[176:179], a[244:247], v[20:23]
 s_waitcnt lgkmcnt(8)
 v_mul_f32 v242, s27, v242
 v_mul_f32 v243, s27, v243
 v_mfma_f32_16x16x32_bf16 v[24:27], v[176:179], a[248:251], v[24:27]
 s_waitcnt vmcnt(7)
 ds_read_b128 v[184:187], v251 offset:16384
 v_cvt_pk_bf16_f32 v199, v242, v243
 v_mfma_f32_16x16x32_bf16 v[28:31], v[176:179], a[252:255], v[28:31]
 ds_write_b128 v251, v[196:199] offset:3072
 v_mfma_f32_16x16x32_bf16 v[160:163], a[192:195], a[32:35], v[152:155]
 v_exp_f32 v168, v168
 v_mfma_f32_16x16x32_bf16 v[160:163], a[196:199], a[36:39], v[160:163]
 v_exp_f32 v169, v169
 v_mfma_f32_16x16x32_bf16 v[160:163], a[200:203], a[40:43], v[160:163]
 v_exp_f32 v170, v170
 v_mfma_f32_16x16x32_bf16 v[160:163], a[204:207], a[44:47], v[160:163]
 v_exp_f32 v171, v171
 v_mfma_f32_16x16x32_bf16 v[164:167], a[220:223], a[44:47], v[152:155]
 v_exp_f32 v174, v174
 v_exp_f32 v172, v172
 v_exp_f32 v173, v173
 v_exp_f32 v175, v175
 v_mfma_f32_16x16x32_bf16 v[164:167], a[216:219], a[40:43], v[164:167]
 buffer_load_dwordx4 v[220:223], v245, s[8:11], s32 offen offset:0
 v_cvt_pk_bf16_f32 v180, v168, v169
 v_cvt_pk_bf16_f32 v181, v170, v171
 v_cvt_pk_bf16_f32 v182, v172, v173
 v_cvt_pk_bf16_f32 v183, v174, v175
 v_mfma_f32_16x16x32_bf16 v[164:167], a[212:215], a[36:39], v[164:167]
 s_waitcnt lgkmcnt(0)
 v_perm_b32 v216, v202, v200, s30
 v_perm_b32 v217, v206, v204, s30
 v_mfma_f32_16x16x32_bf16 v[164:167], a[208:211], a[32:35], v[164:167]
 v_perm_b32 v218, v210, v208, s30
 v_perm_b32 v219, v214, v212, s30
 v_smfmac_f32_16x16x64_bf16 v[128:131], v[236:239], v[176:183], v138
 s_waitcnt vmcnt(7)
 ds_read_b128 v[188:191], v251 offset:17408
 ds_write_b128 v255, v[216:219] offset:0
 v_mfma_f32_16x16x32_bf16 v[32:35], v[180:183], a[224:227], v[32:35]
 buffer_load_dwordx4 v[224:227], v245, s[8:11], s32 offen offset:64
 v_perm_b32 v216, v202, v200, s31
 v_perm_b32 v217, v206, v204, s31
 v_perm_b32 v218, v210, v208, s31
 v_perm_b32 v219, v214, v212, s31
 v_mfma_f32_16x16x32_bf16 v[36:39], v[180:183], a[228:231], v[36:39]
 v_exp_f32 v160, v160
 v_mfma_f32_16x16x32_bf16 v[40:43], v[180:183], a[232:235], v[40:43]
 v_exp_f32 v161, v161
 v_mfma_f32_16x16x32_bf16 v[44:47], v[180:183], a[236:239], v[44:47]
 ds_write_b128 v255, v[216:219] offset:512
 v_mfma_f32_16x16x32_bf16 v[48:51], v[180:183], a[240:243], v[48:51]
 buffer_load_dwordx4 v[228:231], v245, s[8:11], s32 offen offset:128
 v_perm_b32 v216, v203, v201, s30
 v_perm_b32 v217, v207, v205, s30
 v_perm_b32 v218, v211, v209, s30
 v_perm_b32 v219, v215, v213, s30
 v_mfma_f32_16x16x32_bf16 v[52:55], v[180:183], a[244:247], v[52:55]
 v_exp_f32 v162, v162
 v_mfma_f32_16x16x32_bf16 v[56:59], v[180:183], a[248:251], v[56:59]
 v_exp_f32 v163, v163
 v_mfma_f32_16x16x32_bf16 v[60:63], v[180:183], a[252:255], v[60:63]
 ds_write_b128 v255, v[216:219] offset:1024
 v_mfma_f32_16x16x32_bf16 v[168:171], a[192:195], a[48:51], v[156:159]
 buffer_load_dwordx4 v[232:235], v245, s[8:11], s32 offen offset:192
 v_perm_b32 v216, v203, v201, s31
 v_perm_b32 v217, v207, v205, s31
 v_perm_b32 v218, v211, v209, s31
 v_perm_b32 v219, v215, v213, s31
 v_mfma_f32_16x16x32_bf16 v[168:171], a[196:199], a[52:55], v[168:171]
 s_add_u32 s32, s25, 20480
 v_exp_f32 v164, v164
 v_mfma_f32_16x16x32_bf16 v[168:171], a[200:203], a[56:59], v[168:171]
 v_exp_f32 v165, v165
 v_mfma_f32_16x16x32_bf16 v[168:171], a[204:207], a[60:63], v[168:171]
 ds_write_b128 v255, v[216:219] offset:1536
 v_mfma_f32_16x16x32_bf16 v[172:175], a[220:223], a[60:63], v[156:159]
 v_exp_f32 v166, v166
 v_exp_f32 v167, v167
 v_mfma_f32_16x16x32_bf16 v[172:175], a[216:219], a[56:59], v[172:175]
 v_cvt_pk_bf16_f32 v176, v160, v161
 v_cvt_pk_bf16_f32 v177, v162, v163
 v_cvt_pk_bf16_f32 v178, v164, v165
 v_cvt_pk_bf16_f32 v179, v166, v167
 v_mfma_f32_16x16x32_bf16 v[172:175], a[212:215], a[52:55], v[172:175]
 v_exp_f32 v168, v168
 v_mfma_f32_16x16x32_bf16 v[172:175], a[208:211], a[48:51], v[172:175]
 v_exp_f32 v169, v169
 v_mfma_f32_16x16x32_bf16 v[64:67], v[176:179], a[224:227], v[64:67]
 v_exp_f32 v170, v170
 v_mfma_f32_16x16x32_bf16 v[68:71], v[176:179], a[228:231], v[68:71]
 v_exp_f32 v171, v171
 v_mfma_f32_16x16x32_bf16 v[72:75], v[176:179], a[232:235], v[72:75]
 v_cvt_pk_bf16_f32 v180, v168, v169
 v_cvt_pk_bf16_f32 v181, v170, v171
 v_mfma_f32_16x16x32_bf16 v[76:79], v[176:179], a[236:239], v[76:79]
 v_exp_f32 v172, v172
 v_mfma_f32_16x16x32_bf16 v[80:83], v[176:179], a[240:243], v[80:83]
 s_waitcnt lgkmcnt(0)
 s_barrier
 ds_read_b128 a[192:195], v250 offset:0
 ds_read_b128 a[196:199], v250 offset:512
 ds_read_b128 a[200:203], v250 offset:1024
 ds_read_b128 a[204:207], v250 offset:1536
 ds_read_b128 a[220:223], v250 offset:3584
 ds_read_b128 a[216:219], v250 offset:3072
 ds_read_b128 a[212:215], v250 offset:2560
 v_mfma_f32_16x16x32_bf16 v[84:87], v[176:179], a[244:247], v[84:87]
 s_waitcnt vmcnt(8)
 ds_read_b128 a[208:211], v250 offset:2048
 ds_read_b128 v[192:195], v251 offset:18432
 v_mfma_f32_16x16x32_bf16 v[88:91], v[176:179], a[248:251], v[88:91]
 v_exp_f32 v173, v173
 v_mfma_f32_16x16x32_bf16 v[92:95], v[176:179], a[252:255], v[92:95]
 s_waitcnt lgkmcnt(8)
 v_exp_f32 v174, v174
 v_mfma_f32_16x16x32_bf16 v[160:163], a[192:195], a[0:3], v[144:147]
 s_waitcnt lgkmcnt(7)
 v_exp_f32 v175, v175
 v_mfma_f32_16x16x32_bf16 v[160:163], a[196:199], a[4:7], v[160:163]
 s_waitcnt lgkmcnt(6)
 v_cvt_pk_bf16_f32 v182, v172, v173
 v_cvt_pk_bf16_f32 v183, v174, v175
 v_mfma_f32_16x16x32_bf16 v[160:163], a[200:203], a[8:11], v[160:163]
 s_waitcnt lgkmcnt(5)
 ds_read_b128 v[196:199], v251 offset:19456
 v_lshlrev_b32 v240, 16, v184
 v_mfma_f32_16x16x32_bf16 v[160:163], a[204:207], a[12:15], v[160:163]
 s_waitcnt lgkmcnt(3)
 v_and_b32 v241, 0xffff0000, v184
 v_mul_f32 v240, s27, v240
 v_mfma_f32_16x16x32_bf16 v[164:167], a[220:223], a[12:15], v[144:147]
 v_mul_f32 v241, s27, v241
 v_cvt_pk_bf16_f32 v184, v240, v241
 v_mfma_f32_16x16x32_bf16 v[164:167], a[216:219], a[8:11], v[164:167]
 v_lshlrev_b32 v242, 16, v185
 v_and_b32 v243, 0xffff0000, v185
 v_mfma_f32_16x16x32_bf16 v[164:167], a[212:215], a[4:7], v[164:167]
 s_waitcnt lgkmcnt(1)
 v_exp_f32 v161, v161
 v_mfma_f32_16x16x32_bf16 v[164:167], a[208:211], a[0:3], v[164:167]
 v_exp_f32 v162, v162
 v_smfmac_f32_16x16x64_bf16 v[132:135], v[236:239], v[176:183], v138
 v_mul_f32 v242, s27, v242
 v_mfma_f32_16x16x32_bf16 v[96:99], v[180:183], a[224:227], v[96:99]
 v_exp_f32 v163, v163
 v_mfma_f32_16x16x32_bf16 v[100:103], v[180:183], a[228:231], v[100:103]
 v_exp_f32 v160, v160
 v_mfma_f32_16x16x32_bf16 v[104:107], v[180:183], a[232:235], v[104:107]
 v_exp_f32 v165, v165
 v_mfma_f32_16x16x32_bf16 v[108:111], v[180:183], a[236:239], v[108:111]
 v_exp_f32 v166, v166
 v_mfma_f32_16x16x32_bf16 v[112:115], v[180:183], a[240:243], v[112:115]
 v_exp_f32 v167, v167
 v_mfma_f32_16x16x32_bf16 v[116:119], v[180:183], a[244:247], v[116:119]
 v_cvt_pk_bf16_f32 v176, v160, v161
 v_cvt_pk_bf16_f32 v177, v162, v163
 v_mfma_f32_16x16x32_bf16 v[120:123], v[180:183], a[248:251], v[120:123]
 ds_read_b128 a[224:227], v249 offset:0
 v_exp_f32 v164, v164
 v_mfma_f32_16x16x32_bf16 v[124:127], v[180:183], a[252:255], v[124:127]
 ds_read_b128 a[228:231], v249 offset:512
 v_cvt_pk_bf16_f32 v178, v164, v165
 v_cvt_pk_bf16_f32 v179, v166, v167
 v_mfma_f32_16x16x32_bf16 v[168:171], a[192:195], a[16:19], v[148:151]
 ds_read_b128 a[232:235], v249 offset:1024
 v_mul_f32 v243, s27, v243
 v_cvt_pk_bf16_f32 v185, v242, v243
 v_mfma_f32_16x16x32_bf16 v[168:171], a[196:199], a[20:23], v[168:171]
 ds_read_b128 a[236:239], v249 offset:1536
 v_lshlrev_b32 v240, 16, v186
 v_and_b32 v241, 0xffff0000, v186
 v_mfma_f32_16x16x32_bf16 v[168:171], a[200:203], a[24:27], v[168:171]
 ds_read_b128 a[240:243], v249 offset:2048
 v_mul_f32 v240, s27, v240
 v_mul_f32 v241, s27, v241
 v_mfma_f32_16x16x32_bf16 v[168:171], a[204:207], a[28:31], v[168:171]
 ds_read_b128 a[244:247], v249 offset:2560
 v_cvt_pk_bf16_f32 v186, v240, v241
 v_lshlrev_b32 v242, 16, v187
 v_mfma_f32_16x16x32_bf16 v[172:175], a[220:223], a[28:31], v[148:151]
 ds_read_b128 a[248:251], v249 offset:3072
 v_and_b32 v243, 0xffff0000, v187
 v_mul_f32 v242, s27, v242
 v_mfma_f32_16x16x32_bf16 v[172:175], a[216:219], a[24:27], v[172:175]
 ds_read_b128 a[252:255], v249 offset:3584
 v_mul_f32 v243, s27, v243
 v_mfma_f32_16x16x32_bf16 v[172:175], a[212:215], a[20:23], v[172:175]
 v_exp_f32 v168, v168
 v_mfma_f32_16x16x32_bf16 v[172:175], a[208:211], a[16:19], v[172:175]
 s_waitcnt lgkmcnt(5)
 v_exp_f32 v169, v169
 v_mfma_f32_16x16x32_bf16 v[0:3], v[176:179], a[224:227], v[0:3]
 v_exp_f32 v170, v170
 v_mfma_f32_16x16x32_bf16 v[4:7], v[176:179], a[228:231], v[4:7]
 v_exp_f32 v171, v171
 v_mfma_f32_16x16x32_bf16 v[8:11], v[176:179], a[232:235], v[8:11]
 s_waitcnt lgkmcnt(2)
 v_cvt_pk_bf16_f32 v180, v168, v169
 v_cvt_pk_bf16_f32 v181, v170, v171
 v_mfma_f32_16x16x32_bf16 v[12:15], v[176:179], a[236:239], v[12:15]
 v_exp_f32 v174, v174
 v_mfma_f32_16x16x32_bf16 v[16:19], v[176:179], a[240:243], v[16:19]
 v_exp_f32 v175, v175
 v_mfma_f32_16x16x32_bf16 v[20:23], v[176:179], a[244:247], v[20:23]
 s_waitcnt lgkmcnt(0)
 v_exp_f32 v172, v172
 v_mfma_f32_16x16x32_bf16 v[24:27], v[176:179], a[248:251], v[24:27]
 v_exp_f32 v173, v173
 v_mfma_f32_16x16x32_bf16 v[28:31], v[176:179], a[252:255], v[28:31]
 v_cvt_pk_bf16_f32 v182, v172, v173
 v_cvt_pk_bf16_f32 v187, v242, v243
 v_mfma_f32_16x16x32_bf16 v[160:163], a[192:195], a[32:35], v[152:155]
 ds_write_b128 v251, v[184:187] offset:16384
 v_mfma_f32_16x16x32_bf16 v[160:163], a[196:199], a[36:39], v[160:163]
 v_cvt_pk_bf16_f32 v183, v174, v175
 v_lshlrev_b32 v240, 16, v188
 v_mfma_f32_16x16x32_bf16 v[160:163], a[200:203], a[40:43], v[160:163]
 v_and_b32 v241, 0xffff0000, v188
 v_mul_f32 v240, s27, v240
 v_mfma_f32_16x16x32_bf16 v[160:163], a[204:207], a[44:47], v[160:163]
 v_mul_f32 v241, s27, v241
 v_cvt_pk_bf16_f32 v188, v240, v241
 v_mfma_f32_16x16x32_bf16 v[164:167], a[220:223], a[44:47], v[152:155]
 v_lshlrev_b32 v242, 16, v189
 v_and_b32 v243, 0xffff0000, v189
 v_mfma_f32_16x16x32_bf16 v[164:167], a[216:219], a[40:43], v[164:167]
 v_mul_f32 v242, s27, v242
 v_mul_f32 v243, s27, v243
 v_mfma_f32_16x16x32_bf16 v[164:167], a[212:215], a[36:39], v[164:167]
 v_cvt_pk_bf16_f32 v189, v242, v243
 v_lshlrev_b32 v240, 16, v190
 v_mfma_f32_16x16x32_bf16 v[164:167], a[208:211], a[32:35], v[164:167]
 v_and_b32 v241, 0xffff0000, v190
 v_mul_f32 v240, s27, v240
 v_smfmac_f32_16x16x64_bf16 v[128:131], v[236:239], v[176:183], v138
 v_mul_f32 v241, s27, v241
 v_mfma_f32_16x16x32_bf16 v[32:35], v[180:183], a[224:227], v[32:35]
 v_exp_f32 v161, v161
 v_mfma_f32_16x16x32_bf16 v[36:39], v[180:183], a[228:231], v[36:39]
 v_exp_f32 v162, v162
 v_mfma_f32_16x16x32_bf16 v[40:43], v[180:183], a[232:235], v[40:43]
 v_exp_f32 v163, v163
 v_mfma_f32_16x16x32_bf16 v[44:47], v[180:183], a[236:239], v[44:47]
 v_exp_f32 v166, v166
 v_mfma_f32_16x16x32_bf16 v[48:51], v[180:183], a[240:243], v[48:51]
 v_exp_f32 v167, v167
 v_mfma_f32_16x16x32_bf16 v[52:55], v[180:183], a[244:247], v[52:55]
 v_exp_f32 v160, v160
 v_mfma_f32_16x16x32_bf16 v[56:59], v[180:183], a[248:251], v[56:59]
 v_cvt_pk_bf16_f32 v176, v160, v161
 v_cvt_pk_bf16_f32 v177, v162, v163
 v_mfma_f32_16x16x32_bf16 v[60:63], v[180:183], a[252:255], v[60:63]
 v_exp_f32 v164, v164
 v_mfma_f32_16x16x32_bf16 v[168:171], a[192:195], a[48:51], v[156:159]
 v_exp_f32 v165, v165
 v_mfma_f32_16x16x32_bf16 v[168:171], a[196:199], a[52:55], v[168:171]
 v_cvt_pk_bf16_f32 v178, v164, v165
 v_cvt_pk_bf16_f32 v179, v166, v167
 v_mfma_f32_16x16x32_bf16 v[168:171], a[200:203], a[56:59], v[168:171]
 v_cvt_pk_bf16_f32 v190, v240, v241
 v_lshlrev_b32 v242, 16, v191
 v_mfma_f32_16x16x32_bf16 v[168:171], a[204:207], a[60:63], v[168:171]
 v_and_b32 v243, 0xffff0000, v191
 v_mul_f32 v242, s27, v242
 v_mfma_f32_16x16x32_bf16 v[172:175], a[220:223], a[60:63], v[156:159]
 v_mul_f32 v243, s27, v243
 v_cvt_pk_bf16_f32 v191, v242, v243
 v_mfma_f32_16x16x32_bf16 v[172:175], a[216:219], a[56:59], v[172:175]
 ds_write_b128 v251, v[188:191] offset:17408
 v_mfma_f32_16x16x32_bf16 v[172:175], a[212:215], a[52:55], v[172:175]
 ds_read_b128 a[196:199], v250 offset:8704
 ds_read_b128 a[192:195], v250 offset:8192
 v_lshlrev_b32 v240, 16, v192
 v_mfma_f32_16x16x32_bf16 v[172:175], a[208:211], a[48:51], v[172:175]
 v_and_b32 v241, 0xffff0000, v192
 v_mul_f32 v240, s27, v240
 v_mfma_f32_16x16x32_bf16 v[64:67], v[176:179], a[224:227], v[64:67]
 ds_read_b128 a[200:203], v250 offset:9216
 v_mul_f32 v241, s27, v241
 v_cvt_pk_bf16_f32 v192, v240, v241
 v_mfma_f32_16x16x32_bf16 v[68:71], v[176:179], a[228:231], v[68:71]
 ds_read_b128 a[204:207], v250 offset:9728
 v_lshlrev_b32 v242, 16, v193
 v_and_b32 v243, 0xffff0000, v193
 v_mfma_f32_16x16x32_bf16 v[72:75], v[176:179], a[232:235], v[72:75]
 ds_read_b128 a[220:223], v250 offset:11776
 v_exp_f32 v171, v171
 v_mfma_f32_16x16x32_bf16 v[76:79], v[176:179], a[236:239], v[76:79]
 ds_read_b128 a[216:219], v250 offset:11264
 v_mul_f32 v242, s27, v242
 v_mul_f32 v243, s27, v243
 v_mfma_f32_16x16x32_bf16 v[80:83], v[176:179], a[240:243], v[80:83]
 ds_read_b128 a[212:215], v250 offset:10752
 v_exp_f32 v168, v168
 v_mfma_f32_16x16x32_bf16 v[84:87], v[176:179], a[244:247], v[84:87]
 ds_read_b128 a[208:211], v250 offset:10240
 v_exp_f32 v169, v169
 v_mfma_f32_16x16x32_bf16 v[88:91], v[176:179], a[248:251], v[88:91]
 v_exp_f32 v170, v170
 v_mfma_f32_16x16x32_bf16 v[92:95], v[176:179], a[252:255], v[92:95]
 s_waitcnt lgkmcnt(5)
 v_cvt_pk_bf16_f32 v180, v168, v169
 v_cvt_pk_bf16_f32 v181, v170, v171
 v_mfma_f32_16x16x32_bf16 v[160:163], a[192:195], a[0:3], v[144:147]
 v_cvt_pk_bf16_f32 v193, v242, v243
 v_lshlrev_b32 v240, 16, v194
 v_mfma_f32_16x16x32_bf16 v[160:163], a[196:199], a[4:7], v[160:163]
 v_and_b32 v241, 0xffff0000, v194
 v_mul_f32 v240, s27, v240
 v_mfma_f32_16x16x32_bf16 v[160:163], a[200:203], a[8:11], v[160:163]
 s_waitcnt lgkmcnt(2)
 v_mul_f32 v241, s27, v241
 v_cvt_pk_bf16_f32 v194, v240, v241
 v_mfma_f32_16x16x32_bf16 v[160:163], a[204:207], a[12:15], v[160:163]
 v_lshlrev_b32 v242, 16, v195
 v_and_b32 v243, 0xffff0000, v195
 v_mfma_f32_16x16x32_bf16 v[164:167], a[220:223], a[12:15], v[144:147]
 v_mul_f32 v242, s27, v242
 v_mul_f32 v243, s27, v243
 v_exp_f32 v172, v172
 v_exp_f32 v173, v173
 v_exp_f32 v174, v174
 v_exp_f32 v175, v175
 v_mfma_f32_16x16x32_bf16 v[164:167], a[216:219], a[8:11], v[164:167]
 s_waitcnt lgkmcnt(0)
 v_cvt_pk_bf16_f32 v195, v242, v243
 v_lshlrev_b32 v240, 16, v196
 v_cvt_pk_bf16_f32 v182, v172, v173
 v_cvt_pk_bf16_f32 v183, v174, v175
 v_mfma_f32_16x16x32_bf16 v[164:167], a[212:215], a[4:7], v[164:167]
 ds_write_b128 v251, v[192:195] offset:18432
 v_mfma_f32_16x16x32_bf16 v[164:167], a[208:211], a[0:3], v[164:167]
 v_and_b32 v241, 0xffff0000, v196
 v_mul_f32 v240, s27, v240
 v_smfmac_f32_16x16x64_bf16 v[132:135], v[236:239], v[176:183], v138
 v_mul_f32 v241, s27, v241
 v_mfma_f32_16x16x32_bf16 v[96:99], v[180:183], a[224:227], v[96:99]
 v_exp_f32 v161, v161
 v_mfma_f32_16x16x32_bf16 v[100:103], v[180:183], a[228:231], v[100:103]
 v_exp_f32 v162, v162
 v_mfma_f32_16x16x32_bf16 v[104:107], v[180:183], a[232:235], v[104:107]
 v_exp_f32 v163, v163
 v_mfma_f32_16x16x32_bf16 v[108:111], v[180:183], a[236:239], v[108:111]
 v_exp_f32 v160, v160
 v_mfma_f32_16x16x32_bf16 v[112:115], v[180:183], a[240:243], v[112:115]
 v_cvt_pk_bf16_f32 v176, v160, v161
 v_cvt_pk_bf16_f32 v177, v162, v163
 v_mfma_f32_16x16x32_bf16 v[116:119], v[180:183], a[244:247], v[116:119]
 v_exp_f32 v166, v166
 v_mfma_f32_16x16x32_bf16 v[120:123], v[180:183], a[248:251], v[120:123]
 ds_read_b128 a[224:227], v249 offset:8192
 v_exp_f32 v167, v167
 v_mfma_f32_16x16x32_bf16 v[124:127], v[180:183], a[252:255], v[124:127]
 ds_read_b128 a[228:231], v249 offset:8704
 v_cvt_pk_bf16_f32 v179, v166, v167
 v_cvt_pk_bf16_f32 v196, v240, v241
 v_mfma_f32_16x16x32_bf16 v[168:171], a[192:195], a[16:19], v[148:151]
 ds_read_b128 a[232:235], v249 offset:9216
 v_lshlrev_b32 v242, 16, v197
 v_and_b32 v243, 0xffff0000, v197
 v_mfma_f32_16x16x32_bf16 v[168:171], a[196:199], a[20:23], v[168:171]
 ds_read_b128 a[236:239], v249 offset:9728
 v_mul_f32 v242, s27, v242
 v_mul_f32 v243, s27, v243
 v_mfma_f32_16x16x32_bf16 v[168:171], a[200:203], a[24:27], v[168:171]
 ds_read_b128 a[240:243], v249 offset:10240
 v_cvt_pk_bf16_f32 v197, v242, v243
 v_lshlrev_b32 v240, 16, v198
 v_mfma_f32_16x16x32_bf16 v[168:171], a[204:207], a[28:31], v[168:171]
 s_waitcnt vmcnt(4)
 ds_read_b64 v[200:201], v254 offset:16384
 ds_read_b128 a[244:247], v249 offset:10752
 v_and_b32 v241, 0xffff0000, v198
 v_mfma_f32_16x16x32_bf16 v[172:175], a[220:223], a[28:31], v[148:151]
 ds_read_b64 v[202:203], v254 offset:16896
 ds_read_b64 v[204:205], v254 offset:17408
 ds_read_b128 a[248:251], v249 offset:11264
 v_exp_f32 v164, v164
 v_exp_f32 v165, v165
 v_mfma_f32_16x16x32_bf16 v[172:175], a[216:219], a[24:27], v[172:175]
 ds_read_b64 v[206:207], v254 offset:17920
 ds_read_b64 v[208:209], v254 offset:18432
 ds_read_b128 a[252:255], v249 offset:11776
 v_cvt_pk_bf16_f32 v178, v164, v165
 v_mfma_f32_16x16x32_bf16 v[172:175], a[212:215], a[20:23], v[172:175]
 ds_read_b64 v[210:211], v254 offset:18944
 ds_read_b64 v[212:213], v254 offset:19456
 v_mfma_f32_16x16x32_bf16 v[172:175], a[208:211], a[16:19], v[172:175]
 s_waitcnt lgkmcnt(12)
 ds_read_b64 v[214:215], v254 offset:19968
 v_mul_f32 v240, s27, v240
 v_mfma_f32_16x16x32_bf16 v[0:3], v[176:179], a[224:227], v[0:3]
 v_mul_f32 v241, s27, v241
 v_cvt_pk_bf16_f32 v198, v240, v241
 v_mfma_f32_16x16x32_bf16 v[4:7], v[176:179], a[228:231], v[4:7]
L_pg3:
 s_cbranch_execz L_pg7
 v_lshlrev_b32 v242, 16, v199
 v_and_b32 v243, 0xffff0000, v199
 v_mfma_f32_16x16x32_bf16 v[8:11], v[176:179], a[232:235], v[8:11]
 s_waitcnt lgkmcnt(9)
 v_mul_f32 v242, s27, v242
 v_mul_f32 v243, s27, v243
 v_mfma_f32_16x16x32_bf16 v[12:15], v[176:179], a[236:239], v[12:15]
 v_exp_f32 v168, v168
 v_mfma_f32_16x16x32_bf16 v[16:19], v[176:179], a[240:243], v[16:19]
 v_exp_f32 v169, v169
 v_mfma_f32_16x16x32_bf16 v[20:23], v[176:179], a[244:247], v[20:23]
 s_waitcnt lgkmcnt(1)
 v_exp_f32 v170, v170
 v_mfma_f32_16x16x32_bf16 v[24:27], v[176:179], a[248:251], v[24:27]
 v_exp_f32 v171, v171
 v_mfma_f32_16x16x32_bf16 v[28:31], v[176:179], a[252:255], v[28:31]
 v_exp_f32 v173, v173
 v_mfma_f32_16x16x32_bf16 v[160:163], a[192:195], a[32:35], v[152:155]
 v_exp_f32 v174, v174
 v_mfma_f32_16x16x32_bf16 v[160:163], a[196:199], a[36:39], v[160:163]
 v_exp_f32 v175, v175
 v_mfma_f32_16x16x32_bf16 v[160:163], a[200:203], a[40:43], v[160:163]
 v_cvt_pk_bf16_f32 v180, v168, v169
 v_cvt_pk_bf16_f32 v181, v170, v171
 v_mfma_f32_16x16x32_bf16 v[160:163], a[204:207], a[44:47], v[160:163]
 v_exp_f32 v172, v172
 v_mfma_f32_16x16x32_bf16 v[164:167], a[220:223], a[44:47], v[152:155]
 v_cvt_pk_bf16_f32 v182, v172, v173
 v_cvt_pk_bf16_f32 v199, v242, v243
 v_mfma_f32_16x16x32_bf16 v[164:167], a[216:219], a[40:43], v[164:167]
 ds_write_b128 v251, v[196:199] offset:19456
 v_cvt_pk_bf16_f32 v183, v174, v175
 v_mfma_f32_16x16x32_bf16 v[164:167], a[212:215], a[36:39], v[164:167]
 v_perm_b32 v216, v202, v200, s30
 v_perm_b32 v217, v206, v204, s30
 v_mfma_f32_16x16x32_bf16 v[164:167], a[208:211], a[32:35], v[164:167]
 s_waitcnt lgkmcnt(1)
 v_perm_b32 v218, v210, v208, s30
 v_perm_b32 v219, v214, v212, s30
 v_smfmac_f32_16x16x64_bf16 v[128:131], v[236:239], v[176:183], v138
 s_nop 0
 v_mfma_f32_16x16x32_bf16 v[32:35], v[180:183], a[224:227], v[32:35]
 ds_write_b128 v255, v[216:219] offset:16384
 v_mfma_f32_16x16x32_bf16 v[36:39], v[180:183], a[228:231], v[36:39]
 v_exp_f32 v160, v160
 v_perm_b32 v216, v202, v200, s31
 v_perm_b32 v217, v206, v204, s31
 v_perm_b32 v218, v210, v208, s31
 v_perm_b32 v219, v214, v212, s31
 v_mfma_f32_16x16x32_bf16 v[40:43], v[180:183], a[232:235], v[40:43]
 v_exp_f32 v161, v161
 v_mfma_f32_16x16x32_bf16 v[44:47], v[180:183], a[236:239], v[44:47]
 v_exp_f32 v162, v162
 v_mfma_f32_16x16x32_bf16 v[48:51], v[180:183], a[240:243], v[48:51]
 ds_write_b128 v255, v[216:219] offset:16896
 v_mfma_f32_16x16x32_bf16 v[52:55], v[180:183], a[244:247], v[52:55]
 v_exp_f32 v163, v163
 v_perm_b32 v216, v203, v201, s30
 v_perm_b32 v217, v207, v205, s30
 v_perm_b32 v218, v211, v209, s30
 v_perm_b32 v219, v215, v213, s30
 v_mfma_f32_16x16x32_bf16 v[56:59], v[180:183], a[248:251], v[56:59]
 v_exp_f32 v164, v164
 v_mfma_f32_16x16x32_bf16 v[60:63], v[180:183], a[252:255], v[60:63]
 v_exp_f32 v165, v165
 v_mfma_f32_16x16x32_bf16 v[168:171], a[192:195], a[48:51], v[156:159]
 ds_write_b128 v255, v[216:219] offset:17408
 v_mfma_f32_16x16x32_bf16 v[168:171], a[196:199], a[52:55], v[168:171]
 v_exp_f32 v166, v166
 v_perm_b32 v216, v203, v201, s31
 v_perm_b32 v217, v207, v205, s31
 v_perm_b32 v218, v211, v209, s31
 v_perm_b32 v219, v215, v213, s31
 v_mfma_f32_16x16x32_bf16 v[168:171], a[200:203], a[56:59], v[168:171]
 v_exp_f32 v167, v167
 v_mfma_f32_16x16x32_bf16 v[168:171], a[204:207], a[60:63], v[168:171]
 v_cvt_pk_bf16_f32 v176, v160, v161
 v_cvt_pk_bf16_f32 v177, v162, v163
 v_mfma_f32_16x16x32_bf16 v[172:175], a[220:223], a[60:63], v[156:159]
 ds_write_b128 v255, v[216:219] offset:17920
 v_mfma_f32_16x16x32_bf16 v[172:175], a[216:219], a[56:59], v[172:175]
 v_cvt_pk_bf16_f32 v178, v164, v165
 v_cvt_pk_bf16_f32 v179, v166, v167
 v_mfma_f32_16x16x32_bf16 v[172:175], a[212:215], a[52:55], v[172:175]
 v_exp_f32 v168, v168
 v_mfma_f32_16x16x32_bf16 v[172:175], a[208:211], a[48:51], v[172:175]
 v_exp_f32 v169, v169
 v_mfma_f32_16x16x32_bf16 v[64:67], v[176:179], a[224:227], v[64:67]
 v_exp_f32 v170, v170
 v_mfma_f32_16x16x32_bf16 v[68:71], v[176:179], a[228:231], v[68:71]
 v_exp_f32 v171, v171
 v_mfma_f32_16x16x32_bf16 v[72:75], v[176:179], a[232:235], v[72:75]
 v_cvt_pk_bf16_f32 v180, v168, v169
 v_cvt_pk_bf16_f32 v181, v170, v171
 v_mfma_f32_16x16x32_bf16 v[76:79], v[176:179], a[236:239], v[76:79]
 v_exp_f32 v172, v172
 v_mfma_f32_16x16x32_bf16 v[80:83], v[176:179], a[240:243], v[80:83]
 v_exp_f32 v173, v173
 v_mfma_f32_16x16x32_bf16 v[84:87], v[176:179], a[244:247], v[84:87]
 s_waitcnt lgkmcnt(0)
 s_barrier
 ds_read_b128 a[192:195], v250 offset:16384
 ds_read_b128 a[196:199], v250 offset:16896
 ds_read_b128 a[200:203], v250 offset:17408
 ds_read_b128 a[204:207], v250 offset:17920
 ds_read_b128 a[220:223], v250 offset:19968
 ds_read_b128 a[216:219], v250 offset:19456
 ds_read_b128 a[212:215], v250 offset:18944
 ds_read_b128 a[208:211], v250 offset:18432
 v_mfma_f32_16x16x32_bf16 v[88:91], v[176:179], a[248:251], v[88:91]
 v_exp_f32 v174, v174
 v_mfma_f32_16x16x32_bf16 v[92:95], v[176:179], a[252:255], v[92:95]
 s_waitcnt lgkmcnt(7)
 v_exp_f32 v175, v175
 v_mfma_f32_16x16x32_bf16 v[160:163], a[192:195], a[0:3], v[144:147]
 s_waitcnt lgkmcnt(6)
 v_cvt_pk_bf16_f32 v182, v172, v173
 v_cvt_pk_bf16_f32 v183, v174, v175
 v_mfma_f32_16x16x32_bf16 v[160:163], a[196:199], a[4:7], v[160:163]
 s_waitcnt lgkmcnt(5)
 v_mfma_f32_16x16x32_bf16 v[160:163], a[200:203], a[8:11], v[160:163]
 s_waitcnt lgkmcnt(4)
 v_mfma_f32_16x16x32_bf16 v[160:163], a[204:207], a[12:15], v[160:163]
 s_waitcnt lgkmcnt(3)
 s_nop 1
 v_mfma_f32_16x16x32_bf16 v[164:167], a[220:223], a[12:15], v[144:147]
 s_waitcnt lgkmcnt(0)
 s_nop 1
 v_mfma_f32_16x16x32_bf16 v[164:167], a[216:219], a[8:11], v[164:167]
 s_nop 1
 v_mfma_f32_16x16x32_bf16 v[164:167], a[212:215], a[4:7], v[164:167]
 v_exp_f32 v160, v160
 v_mfma_f32_16x16x32_bf16 v[164:167], a[208:211], a[0:3], v[164:167]
 v_exp_f32 v161, v161
 v_smfmac_f32_16x16x64_bf16 v[132:135], v[236:239], v[176:183], v138
 v_cvt_pk_bf16_f32 v176, v160, v161
 v_mfma_f32_16x16x32_bf16 v[96:99], v[180:183], a[224:227], v[96:99]
 v_exp_f32 v162, v162
 v_mfma_f32_16x16x32_bf16 v[100:103], v[180:183], a[228:231], v[100:103]
 ds_read_b128 a[224:227], v249 offset:16384
 ds_read_b128 a[228:231], v249 offset:16896
 v_mfma_f32_16x16x32_bf16 v[104:107], v[180:183], a[232:235], v[104:107]
 v_exp_f32 v163, v163
 v_mfma_f32_16x16x32_bf16 v[108:111], v[180:183], a[236:239], v[108:111]
 ds_read_b128 a[232:235], v249 offset:17408
 ds_read_b128 a[236:239], v249 offset:17920
 v_mfma_f32_16x16x32_bf16 v[112:115], v[180:183], a[240:243], v[112:115]
 v_exp_f32 v164, v164
 v_mfma_f32_16x16x32_bf16 v[116:119], v[180:183], a[244:247], v[116:119]
 v_exp_f32 v165, v165
 v_mfma_f32_16x16x32_bf16 v[120:123], v[180:183], a[248:251], v[120:123]
 v_exp_f32 v166, v166
 v_mfma_f32_16x16x32_bf16 v[124:127], v[180:183], a[252:255], v[124:127]
 v_exp_f32 v167, v167
 v_mfma_f32_16x16x32_bf16 v[168:171], a[192:195], a[16:19], v[148:151]
 ds_read_b128 a[240:243], v249 offset:18432
 ds_read_b128 a[244:247], v249 offset:18944
 v_mfma_f32_16x16x32_bf16 v[168:171], a[196:199], a[20:23], v[168:171]
 ds_read_b128 a[248:251], v249 offset:19456
 v_cvt_pk_bf16_f32 v177, v162, v163
 v_mfma_f32_16x16x32_bf16 v[168:171], a[200:203], a[24:27], v[168:171]
 v_cvt_pk_bf16_f32 v178, v164, v165
 v_cvt_pk_bf16_f32 v179, v166, v167
 v_mfma_f32_16x16x32_bf16 v[168:171], a[204:207], a[28:31], v[168:171]
 ds_read_b128 a[252:255], v249 offset:19968
 s_nop 0
 v_mfma_f32_16x16x32_bf16 v[172:175], a[220:223], a[28:31], v[148:151]
 s_nop 1
 v_mfma_f32_16x16x32_bf16 v[172:175], a[216:219], a[24:27], v[172:175]
 s_nop 1
 v_mfma_f32_16x16x32_bf16 v[172:175], a[212:215], a[20:23], v[172:175]
 v_exp_f32 v168, v168
 v_mfma_f32_16x16x32_bf16 v[172:175], a[208:211], a[16:19], v[172:175]
 s_waitcnt lgkmcnt(2)
 v_exp_f32 v169, v169
 v_mfma_f32_16x16x32_bf16 v[0:3], v[176:179], a[224:227], v[0:3]
 v_exp_f32 v170, v170
 v_mfma_f32_16x16x32_bf16 v[4:7], v[176:179], a[228:231], v[4:7]
 v_exp_f32 v171, v171
 v_mfma_f32_16x16x32_bf16 v[8:11], v[176:179], a[232:235], v[8:11]
 v_cvt_pk_bf16_f32 v180, v168, v169
 v_cvt_pk_bf16_f32 v181, v170, v171
 v_mfma_f32_16x16x32_bf16 v[12:15], v[176:179], a[236:239], v[12:15]
 v_exp_f32 v172, v172
 v_mfma_f32_16x16x32_bf16 v[16:19], v[176:179], a[240:243], v[16:19]
 v_exp_f32 v173, v173
 v_mfma_f32_16x16x32_bf16 v[20:23], v[176:179], a[244:247], v[20:23]
 s_waitcnt lgkmcnt(0)
 v_exp_f32 v174, v174
 v_mfma_f32_16x16x32_bf16 v[24:27], v[176:179], a[248:251], v[24:27]
 v_exp_f32 v175, v175
 v_mfma_f32_16x16x32_bf16 v[28:31], v[176:179], a[252:255], v[28:31]
 v_cvt_pk_bf16_f32 v182, v172, v173
 v_cvt_pk_bf16_f32 v183, v174, v175
 v_mfma_f32_16x16x32_bf16 v[160:163], a[192:195], a[32:35], v[152:155]
 v_mfma_f32_16x16x32_bf16 v[160:163], a[196:199], a[36:39], v[160:163]
 v_mfma_f32_16x16x32_bf16 v[160:163], a[200:203], a[40:43], v[160:163]
 v_mfma_f32_16x16x32_bf16 v[160:163], a[204:207], a[44:47], v[160:163]
 s_nop 1
 v_mfma_f32_16x16x32_bf16 v[164:167], a[220:223], a[44:47], v[152:155]
 s_nop 1
 v_mfma_f32_16x16x32_bf16 v[164:167], a[216:219], a[40:43], v[164:167]
 s_nop 1
 v_mfma_f32_16x16x32_bf16 v[164:167], a[212:215], a[36:39], v[164:167]
 v_exp_f32 v160, v160
 v_mfma_f32_16x16x32_bf16 v[164:167], a[208:211], a[32:35], v[164:167]
 v_exp_f32 v161, v161
 v_smfmac_f32_16x16x64_bf16 v[128:131], v[236:239], v[176:183], v138
 v_cvt_pk_bf16_f32 v176, v160, v161
 v_mfma_f32_16x16x32_bf16 v[32:35], v[180:183], a[224:227], v[32:35]
 v_exp_f32 v162, v162
 v_mfma_f32_16x16x32_bf16 v[36:39], v[180:183], a[228:231], v[36:39]
 v_exp_f32 v163, v163
 v_mfma_f32_16x16x32_bf16 v[40:43], v[180:183], a[232:235], v[40:43]
 v_exp_f32 v164, v164
 v_mfma_f32_16x16x32_bf16 v[44:47], v[180:183], a[236:239], v[44:47]
 v_exp_f32 v165, v165
 v_mfma_f32_16x16x32_bf16 v[48:51], v[180:183], a[240:243], v[48:51]
 v_exp_f32 v166, v166
 v_mfma_f32_16x16x32_bf16 v[52:55], v[180:183], a[244:247], v[52:55]
 v_exp_f32 v167, v167
 v_mfma_f32_16x16x32_bf16 v[56:59], v[180:183], a[248:251], v[56:59]
 v_cvt_pk_bf16_f32 v177, v162, v163
 v_cvt_pk_bf16_f32 v178, v164, v165
 v_mfma_f32_16x16x32_bf16 v[60:63], v[180:183], a[252:255], v[60:63]
 v_cvt_pk_bf16_f32 v179, v166, v167
 v_mfma_f32_16x16x32_bf16 v[168:171], a[192:195], a[48:51], v[156:159]
 ds_read_b128 a[192:195], v250 offset:24576
 v_mfma_f32_16x16x32_bf16 v[168:171], a[196:199], a[52:55], v[168:171]
 ds_read_b128 a[196:199], v250 offset:25088
 v_mfma_f32_16x16x32_bf16 v[168:171], a[200:203], a[56:59], v[168:171]
 ds_read_b128 a[200:203], v250 offset:25600
 v_mfma_f32_16x16x32_bf16 v[168:171], a[204:207], a[60:63], v[168:171]
 ds_read_b128 a[204:207], v250 offset:26112
 s_nop 0
 v_mfma_f32_16x16x32_bf16 v[172:175], a[220:223], a[60:63], v[156:159]
 ds_read_b128 a[220:223], v250 offset:28160
 s_nop 0
 v_mfma_f32_16x16x32_bf16 v[172:175], a[216:219], a[56:59], v[172:175]
 ds_read_b128 a[216:219], v250 offset:27648
 s_nop 0
 v_mfma_f32_16x16x32_bf16 v[172:175], a[212:215], a[52:55], v[172:175]
 v_exp_f32 v168, v168
 v_mfma_f32_16x16x32_bf16 v[172:175], a[208:211], a[48:51], v[172:175]
 ds_read_b128 a[208:211], v250 offset:26624
 ds_read_b128 a[212:215], v250 offset:27136
 v_mfma_f32_16x16x32_bf16 v[64:67], v[176:179], a[224:227], v[64:67]
 v_exp_f32 v169, v169
 v_mfma_f32_16x16x32_bf16 v[68:71], v[176:179], a[228:231], v[68:71]
 v_exp_f32 v170, v170
 v_mfma_f32_16x16x32_bf16 v[72:75], v[176:179], a[232:235], v[72:75]
 v_exp_f32 v171, v171
 v_mfma_f32_16x16x32_bf16 v[76:79], v[176:179], a[236:239], v[76:79]
 v_exp_f32 v172, v172
 v_mfma_f32_16x16x32_bf16 v[80:83], v[176:179], a[240:243], v[80:83]
 v_exp_f32 v173, v173
 v_mfma_f32_16x16x32_bf16 v[84:87], v[176:179], a[244:247], v[84:87]
 v_exp_f32 v174, v174
 v_mfma_f32_16x16x32_bf16 v[88:91], v[176:179], a[248:251], v[88:91]
 v_exp_f32 v175, v175
 v_mfma_f32_16x16x32_bf16 v[92:95], v[176:179], a[252:255], v[92:95]
 s_waitcnt lgkmcnt(0)
 v_cvt_pk_bf16_f32 v180, v168, v169
 v_cvt_pk_bf16_f32 v181, v170, v171
 v_mfma_f32_16x16x32_bf16 v[160:163], a[192:195], a[0:3], v[144:147]
 v_cvt_pk_bf16_f32 v182, v172, v173
 v_cvt_pk_bf16_f32 v183, v174, v175
 v_mfma_f32_16x16x32_bf16 v[160:163], a[196:199], a[4:7], v[160:163]
 v_mfma_f32_16x16x32_bf16 v[160:163], a[200:203], a[8:11], v[160:163]
 v_mfma_f32_16x16x32_bf16 v[160:163], a[204:207], a[12:15], v[160:163]
 s_nop 1
 v_mfma_f32_16x16x32_bf16 v[164:167], a[220:223], a[12:15], v[144:147]
 buffer_load_dwordx4 a[12:15], v245, s[8:11], s32 offen offset:192
 v_mfma_f32_16x16x32_bf16 v[164:167], a[216:219], a[8:11], v[164:167]
 s_nop 1
 v_mfma_f32_16x16x32_bf16 v[164:167], a[212:215], a[4:7], v[164:167]
 v_exp_f32 v160, v160
 v_mfma_f32_16x16x32_bf16 v[164:167], a[208:211], a[0:3], v[164:167]
 v_exp_f32 v161, v161
 v_smfmac_f32_16x16x64_bf16 v[132:135], v[236:239], v[176:183], v138
 buffer_load_dwordx4 a[0:3], v245, s[8:11], s32 offen offset:0
 v_cvt_pk_bf16_f32 v176, v160, v161
 v_mfma_f32_16x16x32_bf16 v[96:99], v[180:183], a[224:227], v[96:99]
 v_exp_f32 v162, v162
 v_mfma_f32_16x16x32_bf16 v[100:103], v[180:183], a[228:231], v[100:103]
 ds_read_b128 a[224:227], v249 offset:24576
 ds_read_b128 a[228:231], v249 offset:25088
 v_mfma_f32_16x16x32_bf16 v[104:107], v[180:183], a[232:235], v[104:107]
 v_exp_f32 v163, v163
 v_mfma_f32_16x16x32_bf16 v[108:111], v[180:183], a[236:239], v[108:111]
 buffer_load_dwordx4 a[4:7], v245, s[8:11], s32 offen offset:64
 v_mfma_f32_16x16x32_bf16 v[112:115], v[180:183], a[240:243], v[112:115]
 ds_read_b128 a[232:235], v249 offset:25600
 ds_read_b128 a[236:239], v249 offset:26112
 v_mfma_f32_16x16x32_bf16 v[116:119], v[180:183], a[244:247], v[116:119]
 v_exp_f32 v164, v164
 v_mfma_f32_16x16x32_bf16 v[120:123], v[180:183], a[248:251], v[120:123]
 v_exp_f32 v165, v165
 v_mfma_f32_16x16x32_bf16 v[124:127], v[180:183], a[252:255], v[124:127]
 buffer_load_dwordx4 a[8:11], v245, s[8:11], s32 offen offset:128
 v_mfma_f32_16x16x32_bf16 v[168:171], a[192:195], a[16:19], v[148:151]
 s_add_u32 s32, s25, 24576
 v_exp_f32 v166, v166
 v_mfma_f32_16x16x32_bf16 v[168:171], a[196:199], a[20:23], v[168:171]
 v_exp_f32 v167, v167
 v_mfma_f32_16x16x32_bf16 v[168:171], a[200:203], a[24:27], v[168:171]
 ds_read_b128 a[240:243], v249 offset:26624
 ds_read_b128 a[244:247], v249 offset:27136
 v_mfma_f32_16x16x32_bf16 v[168:171], a[204:207], a[28:31], v[168:171]
 ds_read_b128 a[248:251], v249 offset:27648
 v_cvt_pk_bf16_f32 v177, v162, v163
 v_mfma_f32_16x16x32_bf16 v[172:175], a[220:223], a[28:31], v[148:151]
 v_cvt_pk_bf16_f32 v178, v164, v165
 v_cvt_pk_bf16_f32 v179, v166, v167
 v_mfma_f32_16x16x32_bf16 v[172:175], a[216:219], a[24:27], v[172:175]
 ds_read_b128 a[252:255], v249 offset:28160
 s_nop 0
 v_mfma_f32_16x16x32_bf16 v[172:175], a[212:215], a[20:23], v[172:175]
 v_exp_f32 v168, v168
 v_mfma_f32_16x16x32_bf16 v[172:175], a[208:211], a[16:19], v[172:175]
 s_waitcnt lgkmcnt(4)
 v_exp_f32 v169, v169
 v_mfma_f32_16x16x32_bf16 v[0:3], v[176:179], a[224:227], v[0:3]
 v_exp_f32 v170, v170
 v_mfma_f32_16x16x32_bf16 v[4:7], v[176:179], a[228:231], v[4:7]
 v_exp_f32 v171, v171
 v_mfma_f32_16x16x32_bf16 v[8:11], v[176:179], a[232:235], v[8:11]
 v_cvt_pk_bf16_f32 v180, v168, v169
 v_cvt_pk_bf16_f32 v181, v170, v171
 v_mfma_f32_16x16x32_bf16 v[12:15], v[176:179], a[236:239], v[12:15]
 s_waitcnt lgkmcnt(1)
 v_exp_f32 v172, v172
 v_mfma_f32_16x16x32_bf16 v[16:19], v[176:179], a[240:243], v[16:19]
 v_exp_f32 v173, v173
 v_mfma_f32_16x16x32_bf16 v[20:23], v[176:179], a[244:247], v[20:23]
 v_exp_f32 v174, v174
 v_mfma_f32_16x16x32_bf16 v[24:27], v[176:179], a[248:251], v[24:27]
 s_waitcnt lgkmcnt(0)
 v_exp_f32 v175, v175
 v_mfma_f32_16x16x32_bf16 v[28:31], v[176:179], a[252:255], v[28:31]
 s_waitcnt vmcnt(4)
 v_cvt_pk_bf16_f32 v182, v172, v173
 v_cvt_pk_bf16_f32 v183, v174, v175
 v_mfma_f32_16x16x32_bf16 v[252:255], a[64:67], v[220:223], 0
 v_mfma_f32_16x16x32_bf16 v[252:255], a[68:71], v[224:227], v[252:255]
 v_mfma_f32_16x16x32_bf16 v[252:255], a[72:75], v[228:231], v[252:255]
 v_mfma_f32_16x16x32_bf16 v[252:255], a[76:79], v[232:235], v[252:255]
 s_nop 1
 v_mfma_f32_16x16x32_bf16 v[160:163], a[192:195], a[32:35], v[152:155]
 s_nop 1
 v_mfma_f32_16x16x32_bf16 v[160:163], a[196:199], a[36:39], v[160:163]
 s_nop 1
 v_mfma_f32_16x16x32_bf16 v[160:163], a[200:203], a[40:43], v[160:163]
 v_max3_f32 v246, v252, v253, v254
 v_max_f32 v246, v246, v255
 v_mfma_f32_16x16x32_bf16 v[160:163], a[204:207], a[44:47], v[160:163]
 v_mov_b32 v247, v246
 s_nop 0
 v_mfma_f32_16x16x32_bf16 v[164:167], a[220:223], a[44:47], v[152:155]
 v_permlane16_swap_b32 v246, v247
 v_max_f32 v246, v246, v247
 v_mfma_f32_16x16x32_bf16 v[164:167], a[216:219], a[40:43], v[164:167]
 v_mov_b32 v247, v246
 s_nop 0
 v_mfma_f32_16x16x32_bf16 v[164:167], a[212:215], a[36:39], v[164:167]
 v_exp_f32 v161, v161
 v_mfma_f32_16x16x32_bf16 v[164:167], a[208:211], a[32:35], v[164:167]
 v_exp_f32 v162, v162
 v_smfmac_f32_16x16x64_bf16 v[128:131], v[236:239], v[176:183], v138
 v_permlane32_swap_b32 v246, v247
 v_mfma_f32_16x16x32_bf16 v[32:35], v[180:183], a[224:227], v[32:35]
 v_exp_f32 v163, v163
 v_mfma_f32_16x16x32_bf16 v[36:39], v[180:183], a[228:231], v[36:39]
 v_exp_f32 v160, v160
 v_mfma_f32_16x16x32_bf16 v[40:43], v[180:183], a[232:235], v[40:43]
 v_exp_f32 v166, v166
 v_mfma_f32_16x16x32_bf16 v[44:47], v[180:183], a[236:239], v[44:47]
 v_exp_f32 v167, v167
 v_mfma_f32_16x16x32_bf16 v[48:51], v[180:183], a[240:243], v[48:51]
 v_cvt_pk_bf16_f32 v176, v160, v161
 v_cvt_pk_bf16_f32 v177, v162, v163
 v_mfma_f32_16x16x32_bf16 v[52:55], v[180:183], a[244:247], v[52:55]
 v_exp_f32 v164, v164
 v_mfma_f32_16x16x32_bf16 v[56:59], v[180:183], a[248:251], v[56:59]
 v_exp_f32 v165, v165
 v_mfma_f32_16x16x32_bf16 v[60:63], v[180:183], a[252:255], v[60:63]
 v_cvt_pk_bf16_f32 v178, v164, v165
 v_cvt_pk_bf16_f32 v179, v166, v167
 v_mfma_f32_16x16x32_bf16 v[168:171], a[192:195], a[48:51], v[156:159]
 v_min_f32 v246, -v246, -v247
 v_mov_b32 v144, v246
 v_mfma_f32_16x16x32_bf16 v[168:171], a[196:199], a[52:55], v[168:171]
 v_mov_b32 v145, v246
 v_mov_b32 v146, v246
 v_mfma_f32_16x16x32_bf16 v[168:171], a[200:203], a[56:59], v[168:171]
 v_mov_b32 v147, v246
 v_add_f32 v252, v252, v246
 v_mfma_f32_16x16x32_bf16 v[168:171], a[204:207], a[60:63], v[168:171]
 buffer_load_dwordx4 a[16:19], v245, s[8:11], s32 offen offset:0
 v_mfma_f32_16x16x32_bf16 v[172:175], a[220:223], a[60:63], v[156:159]
 v_add_f32 v253, v253, v246
 v_add_f32 v254, v254, v246
 v_mfma_f32_16x16x32_bf16 v[172:175], a[216:219], a[56:59], v[172:175]
 v_exp_f32 v252, v252
 v_mfma_f32_16x16x32_bf16 v[172:175], a[212:215], a[52:55], v[172:175]
 v_exp_f32 v253, v253
 v_mfma_f32_16x16x32_bf16 v[172:175], a[208:211], a[48:51], v[172:175]
 buffer_load_dwordx4 a[20:23], v245, s[8:11], s32 offen offset:64
 v_mfma_f32_16x16x32_bf16 v[64:67], v[176:179], a[224:227], v[64:67]
 v_exp_f32 v168, v168
 v_mfma_f32_16x16x32_bf16 v[68:71], v[176:179], a[228:231], v[68:71]
 v_exp_f32 v169, v169
 v_mfma_f32_16x16x32_bf16 v[72:75], v[176:179], a[232:235], v[72:75]
 v_exp_f32 v170, v170
 v_mfma_f32_16x16x32_bf16 v[76:79], v[176:179], a[236:239], v[76:79]
 buffer_load_dwordx4 a[24:27], v245, s[8:11], s32 offen offset:128
 v_mfma_f32_16x16x32_bf16 v[80:83], v[176:179], a[240:243], v[80:83]
 v_exp_f32 v171, v171
 v_mfma_f32_16x16x32_bf16 v[84:87], v[176:179], a[244:247], v[84:87]
 v_exp_f32 v172, v172
 v_mfma_f32_16x16x32_bf16 v[88:91], v[176:179], a[248:251], v[88:91]
 v_exp_f32 v173, v173
 v_mfma_f32_16x16x32_bf16 v[92:95], v[176:179], a[252:255], v[92:95]
 buffer_load_dwordx4 a[28:31], v245, s[8:11], s32 offen offset:192
 v_mfma_f32_16x16x32_bf16 v[164:167], a[92:95], v[232:235], v[144:147]
 s_add_u32 s32, s25, 28672
 v_exp_f32 v174, v174
 v_exp_f32 v175, v175
 v_mfma_f32_16x16x32_bf16 v[164:167], a[88:91], v[228:231], v[164:167]
 v_cvt_pk_bf16_f32 v180, v168, v169
 v_cvt_pk_bf16_f32 v181, v170, v171
 v_cvt_pk_bf16_f32 v182, v172, v173
 v_cvt_pk_bf16_f32 v183, v174, v175
 v_mfma_f32_16x16x32_bf16 v[164:167], a[84:87], v[224:227], v[164:167]
 v_add_f32 v255, v255, v246
 v_add_f32 v216, v128, v129
 v_mfma_f32_16x16x32_bf16 v[164:167], a[80:83], v[220:223], v[164:167]
 v_exp_f32 v254, v254
 v_smfmac_f32_16x16x64_bf16 v[132:135], v[236:239], v[176:183], v138
 v_mov_b32 v128, 0
 v_mfma_f32_16x16x32_bf16 v[96:99], v[180:183], a[224:227], v[96:99]
 v_exp_f32 v255, v255
 v_mfma_f32_16x16x32_bf16 v[100:103], v[180:183], a[228:231], v[100:103]
 ds_read_b128 a[224:227], v248 offset:0
 v_mov_b32 v129, 0
 v_mfma_f32_16x16x32_bf16 v[104:107], v[180:183], a[232:235], v[104:107]
 v_exp_f32 v164, v164
 v_mfma_f32_16x16x32_bf16 v[108:111], v[180:183], a[236:239], v[108:111]
 v_exp_f32 v165, v165
 v_mfma_f32_16x16x32_bf16 v[112:115], v[180:183], a[240:243], v[112:115]
 v_exp_f32 v166, v166
 v_mfma_f32_16x16x32_bf16 v[116:119], v[180:183], a[244:247], v[116:119]
 v_exp_f32 v167, v167
 v_mfma_f32_16x16x32_bf16 v[120:123], v[180:183], a[248:251], v[120:123]
 ds_read_b128 a[240:243], v248 offset:2048
 ds_read_b128 a[244:247], v248 offset:2560
 v_mfma_f32_16x16x32_bf16 v[124:127], v[180:183], a[252:255], v[124:127]
 ds_read_b128 a[228:231], v248 offset:512
 v_add_f32 v217, v130, v131
 v_mfma_f32_16x16x32_bf16 v[168:171], a[96:99], v[220:223], v[144:147]
 v_mov_b32 v130, 0
 v_mov_b32 v131, 0
 v_mfma_f32_16x16x32_bf16 v[168:171], a[100:103], v[224:227], v[168:171]
 ds_read_b128 a[232:235], v248 offset:1024
 v_cvt_pk_bf16_f32 v176, v252, v253
 v_mfma_f32_16x16x32_bf16 v[168:171], a[104:107], v[228:231], v[168:171]
 ds_read_b128 a[236:239], v248 offset:1536
 v_cvt_pk_bf16_f32 v177, v254, v255
 v_mfma_f32_16x16x32_bf16 v[168:171], a[108:111], v[232:235], v[168:171]
 v_cvt_pk_bf16_f32 v178, v164, v165
 v_cvt_pk_bf16_f32 v179, v166, v167
 v_mfma_f32_16x16x32_bf16 v[172:175], a[124:127], v[232:235], v[144:147]
 ds_read_b128 a[248:251], v248 offset:3072
 v_cmp_nge_f32 vcc, s28, v216
 v_mfma_f32_16x16x32_bf16 v[172:175], a[120:123], v[228:231], v[172:175]
 s_cmp_lg_u64 vcc, 0
 v_rcp_f32 v216, v216
 v_mfma_f32_16x16x32_bf16 v[172:175], a[116:119], v[224:227], v[172:175]
 s_cselect_b32 s34, 1, 0
 ds_read_b128 a[252:255], v248 offset:3584
 v_mov_b32_dpp v216, v216 row_shl:4 row_mask:0x2 bank_mask:0xf
 v_mfma_f32_16x16x32_bf16 v[172:175], a[112:115], v[220:223], v[172:175]
 s_or_b32 s29, s29, s34
 v_exp_f32 v168, v168
 v_mfma_f32_16x16x32_bf16 v[128:131], v[140:143], v[176:179], v[128:131]
 s_waitcnt lgkmcnt(3)
 s_add_u32 s33, s25, 0
 ds_read_b128 a[192:195], v249 offset:32768
 v_mov_b32_dpp v216, v216 row_shl:8 row_mask:0x4 bank_mask:0xf
 v_mfma_f32_16x16x32_bf16 v[184:187], v[176:179], a[224:227], 0
 ds_read_b128 a[224:227], v248 offset:8192
 v_mov_b32_dpp v216, v216 row_shl:12 row_mask:0x8 bank_mask:0xf
 v_mfma_f32_16x16x32_bf16 v[188:191], v[176:179], a[228:231], 0
 v_exp_f32 v173, v173
 v_mfma_f32_16x16x32_bf16 v[192:195], v[176:179], a[232:235], 0
 s_waitcnt lgkmcnt(3)
 v_mul_f32_dpp v0, v216, v0 row_newbcast:0 row_mask:0xf bank_mask:0xf
 v_mul_f32_dpp v4, v216, v4 row_newbcast:0 row_mask:0xf bank_mask:0xf
 v_mfma_f32_16x16x32_bf16 v[196:199], v[176:179], a[236:239], 0
 v_cvt_pk_bf16_f32 v240, v0, v4
 v_mul_f32_dpp v8, v216, v8 row_newbcast:0 row_mask:0xf bank_mask:0xf
 v_mfma_f32_16x16x32_bf16 v[200:203], v[176:179], a[240:243], 0
 v_mul_f32_dpp v12, v216, v12 row_newbcast:0 row_mask:0xf bank_mask:0xf
 v_cvt_pk_bf16_f32 v241, v8, v12
 v_mfma_f32_16x16x32_bf16 v[204:207], v[176:179], a[244:247], 0
 v_mul_f32_dpp v16, v216, v16 row_newbcast:0 row_mask:0xf bank_mask:0xf
 v_mul_f32_dpp v20, v216, v20 row_newbcast:0 row_mask:0xf bank_mask:0xf
 v_mfma_f32_16x16x32_bf16 v[208:211], v[176:179], a[248:251], 0
 s_waitcnt lgkmcnt(1)
 v_cvt_pk_bf16_f32 v242, v16, v20
 v_mul_f32_dpp v24, v216, v24 row_newbcast:0 row_mask:0xf bank_mask:0xf
 v_mfma_f32_16x16x32_bf16 v[212:215], v[176:179], a[252:255], 0
 v_mul_f32_dpp v28, v216, v28 row_newbcast:0 row_mask:0xf bank_mask:0xf
 v_cvt_pk_bf16_f32 v243, v24, v28
 v_mfma_f32_16x16x32_bf16 v[160:163], a[128:131], v[220:223], v[144:147]
 buffer_store_dwordx4 v[240:243], v244, s[20:23], s33 offen offset:0 sc1
 ds_read_b128 a[228:231], v248 offset:8704
 v_mfma_f32_16x16x32_bf16 v[160:163], a[132:135], v[224:227], v[160:163]
 ds_read_b128 a[232:235], v248 offset:9216
 v_exp_f32 v174, v174
 v_mfma_f32_16x16x32_bf16 v[160:163], a[136:139], v[228:231], v[160:163]
 ds_read_b128 a[236:239], v248 offset:9728
 v_exp_f32 v175, v175
 v_mfma_f32_16x16x32_bf16 v[160:163], a[140:143], v[232:235], v[160:163]
 ds_read_b128 a[240:243], v248 offset:10240
 v_exp_f32 v169, v169
 v_mfma_f32_16x16x32_bf16 v[164:167], a[156:159], v[232:235], v[144:147]
 ds_read_b128 a[244:247], v248 offset:10752
 v_exp_f32 v170, v170
 v_exp_f32 v171, v171
 v_exp_f32 v172, v172
 v_mfma_f32_16x16x32_bf16 v[164:167], a[152:155], v[228:231], v[164:167]
 ds_read_b128 a[248:251], v248 offset:11264
 v_cvt_pk_bf16_f32 v180, v168, v169
 v_cvt_pk_bf16_f32 v181, v170, v171
 v_cvt_pk_bf16_f32 v182, v172, v173
 v_cvt_pk_bf16_f32 v183, v174, v175
 v_mfma_f32_16x16x32_bf16 v[164:167], a[148:151], v[224:227], v[164:167]
 ds_read_b128 a[252:255], v248 offset:11776
 v_mul_f32_dpp v1, v216, v1 row_newbcast:1 row_mask:0xf bank_mask:0xf
 v_mfma_f32_16x16x32_bf16 v[164:167], a[144:147], v[220:223], v[164:167]
 v_exp_f32 v160, v160
 v_mfma_f32_16x16x32_bf16 v[128:131], v[140:143], v[180:183], v[128:131]
 s_waitcnt lgkmcnt(5)
 v_exp_f32 v161, v161
 v_mfma_f32_16x16x32_bf16 v[184:187], v[180:183], a[224:227], v[184:187]
 v_exp_f32 v162, v162
 v_mfma_f32_16x16x32_bf16 v[188:191], v[180:183], a[228:231], v[188:191]
 v_exp_f32 v163, v163
 v_mfma_f32_16x16x32_bf16 v[192:195], v[180:183], a[232:235], v[192:195]
 s_waitcnt lgkmcnt(2)
 v_exp_f32 v166, v166
 v_mfma_f32_16x16x32_bf16 v[196:199], v[180:183], a[236:239], v[196:199]
 v_exp_f32 v167, v167
 v_mfma_f32_16x16x32_bf16 v[200:203], v[180:183], a[240:243], v[200:203]
 v_mul_f32_dpp v5, v216, v5 row_newbcast:1 row_mask:0xf bank_mask:0xf
 v_cvt_pk_bf16_f32 v240, v1, v5
 v_mfma_f32_16x16x32_bf16 v[204:207], v[180:183], a[244:247], v[204:207]
 s_waitcnt lgkmcnt(0)
 v_mul_f32_dpp v9, v216, v9 row_newbcast:1 row_mask:0xf bank_mask:0xf
 v_mul_f32_dpp v13, v216, v13 row_newbcast:1 row_mask:0xf bank_mask:0xf
 v_mfma_f32_16x16x32_bf16 v[208:211], v[180:183], a[248:251], v[208:211]
 v_cvt_pk_bf16_f32 v241, v9, v13
 v_mul_f32_dpp v17, v216, v17 row_newbcast:1 row_mask:0xf bank_mask:0xf
 v_mfma_f32_16x16x32_bf16 v[212:215], v[180:183], a[252:255], v[212:215]
 s_waitcnt vmcnt(7)
 v_mul_f32_dpp v21, v216, v21 row_newbcast:1 row_mask:0xf bank_mask:0xf
 v_cvt_pk_bf16_f32 v242, v17, v21
 v_mfma_f32_16x16x32_bf16 v[252:255], a[160:163], a[0:3], 0
 s_waitcnt vmcnt(6)
 v_mul_f32_dpp v25, v216, v25 row_newbcast:1 row_mask:0xf bank_mask:0xf
 v_mul_f32_dpp v29, v216, v29 row_newbcast:1 row_mask:0xf bank_mask:0xf
 v_mfma_f32_16x16x32_bf16 v[252:255], a[164:167], a[4:7], v[252:255]
 s_waitcnt vmcnt(5)
 ds_read_b128 a[240:243], v248 offset:18432
 v_cvt_pk_bf16_f32 v243, v25, v29
 v_mfma_f32_16x16x32_bf16 v[252:255], a[168:171], a[8:11], v[252:255]
 buffer_store_dwordx4 v[240:243], v244, s[20:23], s33 offen offset:1024 sc1
 v_mfma_f32_16x16x32_bf16 v[252:255], a[172:175], a[12:15], v[252:255]
 ds_read_b128 a[244:247], v248 offset:18944
 ds_read_b128 a[224:227], v248 offset:16384
 v_cvt_pk_bf16_f32 v176, v160, v161
 v_mfma_f32_16x16x32_bf16 v[168:171], a[160:163], v[220:223], v[144:147]
 ds_read_b128 a[228:231], v248 offset:16896
 v_cvt_pk_bf16_f32 v177, v162, v163
 v_cvt_pk_bf16_f32 v179, v166, v167
 v_mfma_f32_16x16x32_bf16 v[168:171], a[164:167], v[224:227], v[168:171]
 ds_read_b128 a[232:235], v248 offset:17408
 v_exp_f32 v164, v164
 v_mfma_f32_16x16x32_bf16 v[168:171], a[168:171], v[228:231], v[168:171]
 ds_read_b128 a[236:239], v248 offset:17920
 v_exp_f32 v165, v165
 v_mfma_f32_16x16x32_bf16 v[168:171], a[172:175], v[232:235], v[168:171]
 buffer_load_dwordx4 a[32:35], v245, s[8:11], s32 offen offset:0
 v_mfma_f32_16x16x32_bf16 v[172:175], a[188:191], v[232:235], v[144:147]
 ds_read_b128 a[248:251], v248 offset:19456
 v_cvt_pk_bf16_f32 v178, v164, v165
 v_mfma_f32_16x16x32_bf16 v[172:175], a[184:187], v[228:231], v[172:175]
 ds_read_b128 a[252:255], v248 offset:19968
 v_max3_f32 v246, v252, v253, v254
 v_mfma_f32_16x16x32_bf16 v[172:175], a[180:183], v[224:227], v[172:175]
 v_max_f32 v246, v246, v255
 v_mov_b32 v247, v246
 v_mfma_f32_16x16x32_bf16 v[172:175], a[176:179], v[220:223], v[172:175]
 buffer_load_dwordx4 a[36:39], v245, s[8:11], s32 offen offset:64
 v_mfma_f32_16x16x32_bf16 v[128:131], v[140:143], v[176:179], v[128:131]
 s_waitcnt lgkmcnt(3)
 v_permlane16_swap_b32 v246, v247
 v_max_f32 v246, v246, v247
 v_mfma_f32_16x16x32_bf16 v[184:187], v[176:179], a[224:227], v[184:187]
L_pg4:
 s_cbranch_execz L_pg8
 ds_read_b128 a[196:199], v249 offset:33280
 v_mov_b32 v247, v246
 v_mfma_f32_16x16x32_bf16 v[188:191], v[176:179], a[228:231], v[188:191]
 v_exp_f32 v168, v168
 v_mfma_f32_16x16x32_bf16 v[192:195], v[176:179], a[232:235], v[192:195]
 s_waitcnt lgkmcnt(2)
 buffer_load_dwordx4 a[40:43], v245, s[8:11], s32 offen offset:128
 ds_read_b128 a[224:227], v248 offset:24576
 v_mfma_f32_16x16x32_bf16 v[196:199], v[176:179], a[236:239], v[196:199]
 ds_read_b128 a[228:231], v248 offset:25088
 v_permlane32_swap_b32 v246, v247
 v_min_f32 v246, -v246, -v247
 v_mfma_f32_16x16x32_bf16 v[200:203], v[176:179], a[240:243], v[200:203]
 ds_read_b128 a[232:235], v248 offset:25600
 v_mov_b32 v148, v246
 v_mov_b32 v149, v246
 v_mfma_f32_16x16x32_bf16 v[204:207], v[176:179], a[244:247], v[204:207]
 ds_read_b128 a[236:239], v248 offset:26112
 v_mov_b32 v150, v246
 v_mov_b32 v151, v246
 v_mfma_f32_16x16x32_bf16 v[208:211], v[176:179], a[248:251], v[208:211]
 s_waitcnt lgkmcnt(5)
 buffer_load_dwordx4 a[44:47], v245, s[8:11], s32 offen offset:192
 ds_read_b128 a[240:243], v248 offset:26624
 v_mfma_f32_16x16x32_bf16 v[212:215], v[176:179], a[252:255], v[212:215]
 ds_read_b128 a[244:247], v248 offset:27136
 v_exp_f32 v169, v169
 v_mfma_f32_16x16x32_bf16 v[164:167], a[188:191], a[12:15], v[148:151]
 ds_read_b128 a[248:251], v248 offset:27648
 v_exp_f32 v170, v170
 v_exp_f32 v171, v171
 v_exp_f32 v172, v172
 v_exp_f32 v173, v173
 v_exp_f32 v174, v174
 v_exp_f32 v175, v175
 v_mfma_f32_16x16x32_bf16 v[164:167], a[184:187], a[8:11], v[164:167]
 ds_read_b128 a[200:203], v249 offset:33792
 ds_read_b128 a[252:255], v248 offset:28160
 v_mul_f32_dpp v2, v216, v2 row_newbcast:2 row_mask:0xf bank_mask:0xf
 v_cvt_pk_bf16_f32 v176, v168, v169
 v_cvt_pk_bf16_f32 v177, v170, v171
 v_cvt_pk_bf16_f32 v178, v172, v173
 v_cvt_pk_bf16_f32 v179, v174, v175
 v_mfma_f32_16x16x32_bf16 v[164:167], a[180:183], a[4:7], v[164:167]
 v_mul_f32_dpp v6, v216, v6 row_newbcast:2 row_mask:0xf bank_mask:0xf
 v_cvt_pk_bf16_f32 v240, v2, v6
 v_mfma_f32_16x16x32_bf16 v[164:167], a[176:179], a[0:3], v[164:167]
 s_waitcnt lgkmcnt(6)
 v_mul_f32_dpp v10, v216, v10 row_newbcast:2 row_mask:0xf bank_mask:0xf
 v_mul_f32_dpp v14, v216, v14 row_newbcast:2 row_mask:0xf bank_mask:0xf
 v_mfma_f32_16x16x32_bf16 v[184:187], v[176:179], a[224:227], v[184:187]
 v_cvt_pk_bf16_f32 v241, v10, v14
 v_mul_f32_dpp v18, v216, v18 row_newbcast:2 row_mask:0xf bank_mask:0xf
 v_mfma_f32_16x16x32_bf16 v[188:191], v[176:179], a[228:231], v[188:191]
 ds_read_b128 a[204:207], v249 offset:34304
 v_mul_f32_dpp v22, v216, v22 row_newbcast:2 row_mask:0xf bank_mask:0xf
 v_cvt_pk_bf16_f32 v242, v18, v22
 v_mul_f32_dpp v26, v216, v26 row_newbcast:2 row_mask:0xf bank_mask:0xf
 v_mul_f32_dpp v30, v216, v30 row_newbcast:2 row_mask:0xf bank_mask:0xf
 v_cvt_pk_bf16_f32 v243, v26, v30
 v_mfma_f32_16x16x32_bf16 v[192:195], v[176:179], a[232:235], v[192:195]
 s_waitcnt lgkmcnt(4)
 buffer_store_dwordx4 v[240:243], v244, s[20:23], s33 offen offset:2048 sc1
 ds_read_b128 a[220:223], v249 offset:36352
 v_mfma_f32_16x16x32_bf16 v[196:199], v[176:179], a[236:239], v[196:199]
 ds_read_b128 a[216:219], v249 offset:35840
 ds_read_b128 a[208:211], v249 offset:34816
 v_mfma_f32_16x16x32_bf16 v[200:203], v[176:179], a[240:243], v[200:203]
 ds_read_b128 a[212:215], v249 offset:35328
 v_add_f32 v252, v252, v246
 v_mfma_f32_16x16x32_bf16 v[204:207], v[176:179], a[244:247], v[204:207]
 s_waitcnt lgkmcnt(5)
 v_add_f32 v253, v253, v246
 v_add_f32 v254, v254, v246
 v_mfma_f32_16x16x32_bf16 v[208:211], v[176:179], a[248:251], v[208:211]
 v_add_f32 v255, v255, v246
 v_mul_f32_dpp v3, v216, v3 row_newbcast:3 row_mask:0xf bank_mask:0xf
 v_mfma_f32_16x16x32_bf16 v[212:215], v[176:179], a[252:255], v[212:215]
 v_exp_f32 v252, v252
 v_mfma_f32_16x16x32_bf16 v[168:171], a[192:195], v[220:223], v[144:147]
 v_exp_f32 v253, v253
 v_mfma_f32_16x16x32_bf16 v[168:171], a[196:199], v[224:227], v[168:171]
 v_exp_f32 v254, v254
 v_mfma_f32_16x16x32_bf16 v[168:171], a[200:203], v[228:231], v[168:171]
 s_waitcnt lgkmcnt(1)
 v_exp_f32 v255, v255
 v_mfma_f32_16x16x32_bf16 v[168:171], a[204:207], v[232:235], v[168:171]
 v_exp_f32 v164, v164
 v_mfma_f32_16x16x32_bf16 v[172:175], a[220:223], v[232:235], v[144:147]
 v_exp_f32 v165, v165
 v_exp_f32 v166, v166
 v_exp_f32 v167, v167
 v_mfma_f32_16x16x32_bf16 v[172:175], a[216:219], v[228:231], v[172:175]
 s_waitcnt lgkmcnt(0)
 v_cvt_pk_bf16_f32 v180, v252, v253
 v_cvt_pk_bf16_f32 v181, v254, v255
 v_cvt_pk_bf16_f32 v182, v164, v165
 v_cvt_pk_bf16_f32 v183, v166, v167
 v_mfma_f32_16x16x32_bf16 v[172:175], a[212:215], v[224:227], v[172:175]
 v_mul_f32_dpp v7, v216, v7 row_newbcast:3 row_mask:0xf bank_mask:0xf
 v_cvt_pk_bf16_f32 v240, v3, v7
 v_mfma_f32_16x16x32_bf16 v[172:175], a[208:211], v[220:223], v[172:175]
 v_mul_f32_dpp v11, v216, v11 row_newbcast:3 row_mask:0xf bank_mask:0xf
 v_mul_f32_dpp v15, v216, v15 row_newbcast:3 row_mask:0xf bank_mask:0xf
 v_smfmac_f32_16x16x64_bf16 v[128:131], v[236:239], v[176:183], v138
 v_cvt_pk_bf16_f32 v241, v11, v15
 v_mfma_f32_16x16x32_bf16 v[0:3], v[180:183], a[224:227], 0
 v_mul_f32_dpp v19, v216, v19 row_newbcast:3 row_mask:0xf bank_mask:0xf
 v_mul_f32_dpp v23, v216, v23 row_newbcast:3 row_mask:0xf bank_mask:0xf
 v_mfma_f32_16x16x32_bf16 v[4:7], v[180:183], a[228:231], 0
 v_cvt_pk_bf16_f32 v242, v19, v23
 v_mul_f32_dpp v27, v216, v27 row_newbcast:3 row_mask:0xf bank_mask:0xf
 v_mfma_f32_16x16x32_bf16 v[8:11], v[180:183], a[232:235], 0
 v_mul_f32_dpp v31, v216, v31 row_newbcast:3 row_mask:0xf bank_mask:0xf
 v_cvt_pk_bf16_f32 v243, v27, v31
 v_mfma_f32_16x16x32_bf16 v[12:15], v[180:183], a[236:239], 0
 buffer_store_dwordx4 v[240:243], v244, s[20:23], s33 offen offset:3072 sc1
 v_mfma_f32_16x16x32_bf16 v[16:19], v[180:183], a[240:243], 0
 ds_read_b128 a[224:227], v248 offset:32768
 ds_read_b128 a[228:231], v248 offset:33280
 v_mfma_f32_16x16x32_bf16 v[20:23], v[180:183], a[244:247], 0
 ds_read_b128 a[232:235], v248 offset:33792
 ds_read_b128 a[236:239], v248 offset:34304
 v_mfma_f32_16x16x32_bf16 v[24:27], v[180:183], a[248:251], 0
 v_exp_f32 v168, v168
 v_mfma_f32_16x16x32_bf16 v[28:31], v[180:183], a[252:255], 0
 v_exp_f32 v169, v169
 v_mfma_f32_16x16x32_bf16 v[160:163], a[192:195], a[0:3], v[148:151]
 v_exp_f32 v170, v170
 v_mfma_f32_16x16x32_bf16 v[160:163], a[196:199], a[4:7], v[160:163]
 v_exp_f32 v171, v171
 v_mfma_f32_16x16x32_bf16 v[160:163], a[200:203], a[8:11], v[160:163]
 ds_read_b128 a[240:243], v248 offset:34816
 v_exp_f32 v172, v172
 v_mfma_f32_16x16x32_bf16 v[160:163], a[204:207], a[12:15], v[160:163]
 ds_read_b128 a[244:247], v248 offset:35328
 v_exp_f32 v173, v173
 v_mfma_f32_16x16x32_bf16 v[164:167], a[220:223], a[12:15], v[148:151]
 ds_read_b128 a[248:251], v248 offset:35840
 v_exp_f32 v174, v174
 v_exp_f32 v175, v175
 v_mfma_f32_16x16x32_bf16 v[164:167], a[216:219], a[8:11], v[164:167]
 ds_read_b128 a[252:255], v248 offset:36352
 v_cvt_pk_bf16_f32 v176, v168, v169
 v_cvt_pk_bf16_f32 v177, v170, v171
 v_cvt_pk_bf16_f32 v178, v172, v173
 v_cvt_pk_bf16_f32 v179, v174, v175
 v_mfma_f32_16x16x32_bf16 v[164:167], a[212:215], a[4:7], v[164:167]
 ds_read_b128 a[192:195], v249 offset:40960
 ds_read_b128 a[196:199], v249 offset:41472
 v_mfma_f32_16x16x32_bf16 v[164:167], a[208:211], a[0:3], v[164:167]
 s_waitcnt lgkmcnt(6)
 ds_read_b128 a[200:203], v249 offset:41984
 ds_read_b128 a[204:207], v249 offset:42496
 v_mfma_f32_16x16x32_bf16 v[184:187], v[176:179], a[224:227], v[184:187]
 ds_read_b128 a[216:219], v249 offset:44032
 ds_read_b128 a[220:223], v249 offset:44544
 v_mfma_f32_16x16x32_bf16 v[188:191], v[176:179], a[228:231], v[188:191]
 ds_read_b128 a[208:211], v249 offset:43008
 ds_read_b128 a[212:215], v249 offset:43520
 v_mfma_f32_16x16x32_bf16 v[192:195], v[176:179], a[232:235], v[192:195]
 v_exp_f32 v160, v160
 v_mfma_f32_16x16x32_bf16 v[196:199], v[176:179], a[236:239], v[196:199]
 s_waitcnt lgkmcnt(9)
 v_exp_f32 v161, v161
 v_mfma_f32_16x16x32_bf16 v[200:203], v[176:179], a[240:243], v[200:203]
 v_exp_f32 v162, v162
 v_mfma_f32_16x16x32_bf16 v[204:207], v[176:179], a[244:247], v[204:207]
 v_exp_f32 v163, v163
 v_mfma_f32_16x16x32_bf16 v[208:211], v[176:179], a[248:251], v[208:211]
 s_waitcnt lgkmcnt(4)
 v_exp_f32 v164, v164
 v_mfma_f32_16x16x32_bf16 v[212:215], v[176:179], a[252:255], v[212:215]
 v_exp_f32 v165, v165
 v_mfma_f32_16x16x32_bf16 v[168:171], a[192:195], v[220:223], v[144:147]
 v_exp_f32 v166, v166
 v_mfma_f32_16x16x32_bf16 v[168:171], a[196:199], v[224:227], v[168:171]
 v_exp_f32 v167, v167
 v_mfma_f32_16x16x32_bf16 v[168:171], a[200:203], v[228:231], v[168:171]
 v_cvt_pk_bf16_f32 v180, v160, v161
 v_cvt_pk_bf16_f32 v181, v162, v163
 v_mfma_f32_16x16x32_bf16 v[168:171], a[204:207], v[232:235], v[168:171]
 s_waitcnt lgkmcnt(0)
 v_cvt_pk_bf16_f32 v182, v164, v165
 v_cvt_pk_bf16_f32 v183, v166, v167
 v_mfma_f32_16x16x32_bf16 v[172:175], a[220:223], v[232:235], v[144:147]
 v_cmp_nge_f32 vcc, s28, v217
 v_add_f32 v218, v132, v133
 v_mfma_f32_16x16x32_bf16 v[172:175], a[216:219], v[228:231], v[172:175]
 s_cmp_lg_u64 vcc, 0
 v_rcp_f32 v217, v217
 v_mfma_f32_16x16x32_bf16 v[172:175], a[212:215], v[224:227], v[172:175]
 s_cselect_b32 s34, 2, 0
 v_exp_f32 v168, v168
 v_mfma_f32_16x16x32_bf16 v[172:175], a[208:211], v[220:223], v[172:175]
 s_or_b32 s29, s29, s34
 v_exp_f32 v169, v169
 v_smfmac_f32_16x16x64_bf16 v[128:131], v[236:239], v[176:183], v138
 s_add_u32 s33, s25, 4096
 v_cvt_pk_bf16_f32 v176, v168, v169
 v_mfma_f32_16x16x32_bf16 v[0:3], v[180:183], a[224:227], v[0:3]
 s_add_u32 s32, s25, 32768
 v_exp_f32 v170, v170
 v_mfma_f32_16x16x32_bf16 v[4:7], v[180:183], a[228:231], v[4:7]
 v_exp_f32 v171, v171
 v_mfma_f32_16x16x32_bf16 v[8:11], v[180:183], a[232:235], v[8:11]
 v_exp_f32 v172, v172
 v_mfma_f32_16x16x32_bf16 v[12:15], v[180:183], a[236:239], v[12:15]
 v_exp_f32 v173, v173
 v_mfma_f32_16x16x32_bf16 v[16:19], v[180:183], a[240:243], v[16:19]
 v_exp_f32 v174, v174
 v_mfma_f32_16x16x32_bf16 v[20:23], v[180:183], a[244:247], v[20:23]
 v_exp_f32 v175, v175
 v_mfma_f32_16x16x32_bf16 v[24:27], v[180:183], a[248:251], v[24:27]
 ds_read_b128 a[224:227], v248 offset:40960
 v_cvt_pk_bf16_f32 v177, v170, v171
 v_cvt_pk_bf16_f32 v178, v172, v173
 v_mfma_f32_16x16x32_bf16 v[28:31], v[180:183], a[252:255], v[28:31]
 ds_read_b128 a[228:231], v248 offset:41472
 v_cvt_pk_bf16_f32 v179, v174, v175
 v_mfma_f32_16x16x32_bf16 v[160:163], a[192:195], a[0:3], v[148:151]
 ds_read_b128 a[252:255], v248 offset:44544
 ds_read_b128 a[232:235], v248 offset:41984
 v_mfma_f32_16x16x32_bf16 v[160:163], a[196:199], a[4:7], v[160:163]
 ds_read_b128 a[236:239], v248 offset:42496
 v_mov_b32_dpp v217, v217 row_shl:4 row_mask:0x2 bank_mask:0xf
 v_mfma_f32_16x16x32_bf16 v[160:163], a[200:203], a[8:11], v[160:163]
 ds_read_b128 a[196:199], v249 offset:49664
 ds_read_b128 a[240:243], v248 offset:43008
 v_mov_b32_dpp v217, v217 row_shl:8 row_mask:0x4 bank_mask:0xf
 v_mfma_f32_16x16x32_bf16 v[160:163], a[204:207], a[12:15], v[160:163]
 ds_read_b128 a[200:203], v249 offset:50176
 ds_read_b128 a[244:247], v248 offset:43520
 v_mfma_f32_16x16x32_bf16 v[164:167], a[220:223], a[12:15], v[148:151]
 ds_read_b128 a[248:251], v248 offset:44032
 v_mov_b32_dpp v217, v217 row_shl:12 row_mask:0x8 bank_mask:0xf
 v_mfma_f32_16x16x32_bf16 v[164:167], a[216:219], a[8:11], v[164:167]
 ds_read_b128 a[220:223], v249 offset:52736
 v_mul_f32_dpp v32, v217, v32 row_newbcast:0 row_mask:0xf bank_mask:0xf
 v_mfma_f32_16x16x32_bf16 v[164:167], a[212:215], a[4:7], v[164:167]
 ds_read_b128 a[192:195], v249 offset:49152
 v_mul_f32_dpp v36, v217, v36 row_newbcast:0 row_mask:0xf bank_mask:0xf
 v_cvt_pk_bf16_f32 v240, v32, v36
 v_mfma_f32_16x16x32_bf16 v[164:167], a[208:211], a[0:3], v[164:167]
 s_waitcnt lgkmcnt(8)
 v_mul_f32_dpp v40, v217, v40 row_newbcast:0 row_mask:0xf bank_mask:0xf
 v_mul_f32_dpp v44, v217, v44 row_newbcast:0 row_mask:0xf bank_mask:0xf
 v_mfma_f32_16x16x32_bf16 v[184:187], v[176:179], a[224:227], v[184:187]
 v_cvt_pk_bf16_f32 v241, v40, v44
 v_mul_f32_dpp v48, v217, v48 row_newbcast:0 row_mask:0xf bank_mask:0xf
 v_mfma_f32_16x16x32_bf16 v[188:191], v[176:179], a[228:231], v[188:191]
 ds_read_b128 a[204:207], v249 offset:50688
 v_mul_f32_dpp v52, v217, v52 row_newbcast:0 row_mask:0xf bank_mask:0xf
 v_cvt_pk_bf16_f32 v242, v48, v52
 v_mfma_f32_16x16x32_bf16 v[192:195], v[176:179], a[232:235], v[192:195]
 s_waitcnt lgkmcnt(4)
 v_mul_f32_dpp v56, v217, v56 row_newbcast:0 row_mask:0xf bank_mask:0xf
 v_mul_f32_dpp v60, v217, v60 row_newbcast:0 row_mask:0xf bank_mask:0xf
 v_mfma_f32_16x16x32_bf16 v[196:199], v[176:179], a[236:239], v[196:199]
 ds_read_b128 a[216:219], v249 offset:52224
 v_cvt_pk_bf16_f32 v243, v56, v60
 v_mfma_f32_16x16x32_bf16 v[200:203], v[176:179], a[240:243], v[200:203]
 buffer_store_dwordx4 v[240:243], v244, s[20:23], s33 offen offset:0 sc1
 v_mfma_f32_16x16x32_bf16 v[204:207], v[176:179], a[244:247], v[204:207]
 s_waitcnt lgkmcnt(2)
 v_exp_f32 v161, v161
 v_mfma_f32_16x16x32_bf16 v[208:211], v[176:179], a[248:251], v[208:211]
 v_exp_f32 v162, v162
 v_mfma_f32_16x16x32_bf16 v[212:215], v[176:179], a[252:255], v[212:215]
 s_waitcnt vmcnt(9)
 v_exp_f32 v163, v163
 v_mfma_f32_16x16x32_bf16 v[252:255], a[192:195], a[16:19], 0
 ds_read_b128 a[212:215], v249 offset:51712
 v_exp_f32 v164, v164
 v_mfma_f32_16x16x32_bf16 v[252:255], a[196:199], a[20:23], v[252:255]
 ds_read_b128 a[208:211], v249 offset:51200
 v_exp_f32 v165, v165
 v_mfma_f32_16x16x32_bf16 v[252:255], a[200:203], a[24:27], v[252:255]
 s_waitcnt lgkmcnt(2)
 v_exp_f32 v166, v166
 v_mfma_f32_16x16x32_bf16 v[252:255], a[204:207], a[28:31], v[252:255]
 v_exp_f32 v160, v160
 v_mfma_f32_16x16x32_bf16 v[168:171], a[192:195], v[220:223], v[144:147]
 v_exp_f32 v167, v167
 v_mfma_f32_16x16x32_bf16 v[168:171], a[196:199], v[224:227], v[168:171]
 v_cvt_pk_bf16_f32 v180, v160, v161
 v_cvt_pk_bf16_f32 v181, v162, v163
 v_mfma_f32_16x16x32_bf16 v[168:171], a[200:203], v[228:231], v[168:171]
 v_cvt_pk_bf16_f32 v182, v164, v165
 v_mul_f32_dpp v33, v217, v33 row_newbcast:1 row_mask:0xf bank_mask:0xf
 v_mfma_f32_16x16x32_bf16 v[168:171], a[204:207], v[232:235], v[168:171]
 v_cvt_pk_bf16_f32 v183, v166, v167
 v_mul_f32_dpp v37, v217, v37 row_newbcast:1 row_mask:0xf bank_mask:0xf
 v_mfma_f32_16x16x32_bf16 v[172:175], a[220:223], v[232:235], v[144:147]
 v_cvt_pk_bf16_f32 v240, v33, v37
 v_mul_f32_dpp v41, v217, v41 row_newbcast:1 row_mask:0xf bank_mask:0xf
 v_mfma_f32_16x16x32_bf16 v[172:175], a[216:219], v[228:231], v[172:175]
 s_waitcnt lgkmcnt(0)
 v_mul_f32_dpp v45, v217, v45 row_newbcast:1 row_mask:0xf bank_mask:0xf
 v_cvt_pk_bf16_f32 v241, v41, v45
 v_mfma_f32_16x16x32_bf16 v[172:175], a[212:215], v[224:227], v[172:175]
 v_mul_f32_dpp v49, v217, v49 row_newbcast:1 row_mask:0xf bank_mask:0xf
 v_mul_f32_dpp v53, v217, v53 row_newbcast:1 row_mask:0xf bank_mask:0xf
 v_mfma_f32_16x16x32_bf16 v[172:175], a[208:211], v[220:223], v[172:175]
 v_cvt_pk_bf16_f32 v242, v49, v53
 v_mul_f32_dpp v57, v217, v57 row_newbcast:1 row_mask:0xf bank_mask:0xf
 v_smfmac_f32_16x16x64_bf16 v[128:131], v[236:239], v[176:183], v138
 v_mul_f32_dpp v61, v217, v61 row_newbcast:1 row_mask:0xf bank_mask:0xf
 v_mfma_f32_16x16x32_bf16 v[0:3], v[180:183], a[224:227], v[0:3]
 v_cvt_pk_bf16_f32 v243, v57, v61
 v_max3_f32 v246, v252, v253, v254
 v_mfma_f32_16x16x32_bf16 v[4:7], v[180:183], a[228:231], v[4:7]
 buffer_store_dwordx4 v[240:243], v244, s[20:23], s33 offen offset:1024 sc1
 v_mfma_f32_16x16x32_bf16 v[8:11], v[180:183], a[232:235], v[8:11]
 v_exp_f32 v168, v168
 v_mfma_f32_16x16x32_bf16 v[12:15], v[180:183], a[236:239], v[12:15]
 v_exp_f32 v169, v169
 v_mfma_f32_16x16x32_bf16 v[16:19], v[180:183], a[240:243], v[16:19]
 v_exp_f32 v175, v175
 v_mfma_f32_16x16x32_bf16 v[20:23], v[180:183], a[244:247], v[20:23]
 ds_read_b128 a[224:227], v248 offset:49152
 v_cvt_pk_bf16_f32 v176, v168, v169
 v_mfma_f32_16x16x32_bf16 v[24:27], v[180:183], a[248:251], v[24:27]
 v_exp_f32 v170, v170
 v_mfma_f32_16x16x32_bf16 v[28:31], v[180:183], a[252:255], v[28:31]
 ds_read_b128 a[228:231], v248 offset:49664
 v_exp_f32 v171, v171
 v_mfma_f32_16x16x32_bf16 v[160:163], a[192:195], a[0:3], v[148:151]
 ds_read_b128 a[232:235], v248 offset:50176
 v_exp_f32 v172, v172
 v_mfma_f32_16x16x32_bf16 v[160:163], a[196:199], a[4:7], v[160:163]
 ds_read_b128 a[236:239], v248 offset:50688
 v_exp_f32 v173, v173
 v_mfma_f32_16x16x32_bf16 v[160:163], a[200:203], a[8:11], v[160:163]
 ds_read_b128 a[240:243], v248 offset:51200
 v_cvt_pk_bf16_f32 v177, v170, v171
 v_cvt_pk_bf16_f32 v178, v172, v173
 v_mfma_f32_16x16x32_bf16 v[160:163], a[204:207], a[12:15], v[160:163]
 ds_read_b128 a[244:247], v248 offset:51712
 v_exp_f32 v174, v174
 v_mfma_f32_16x16x32_bf16 v[164:167], a[220:223], a[12:15], v[148:151]
 ds_read_b128 a[248:251], v248 offset:52224
 v_cvt_pk_bf16_f32 v179, v174, v175
 v_max_f32 v246, v246, v255
 v_mfma_f32_16x16x32_bf16 v[164:167], a[216:219], a[8:11], v[164:167]
 ds_read_b128 a[252:255], v248 offset:52736
 v_mov_b32 v247, v246
 v_mfma_f32_16x16x32_bf16 v[164:167], a[212:215], a[4:7], v[164:167]
 v_exp_f32 v160, v160
 v_mfma_f32_16x16x32_bf16 v[164:167], a[208:211], a[0:3], v[164:167]
 s_waitcnt lgkmcnt(5)
 v_permlane16_swap_b32 v246, v247
 v_max_f32 v246, v246, v247
 v_mfma_f32_16x16x32_bf16 v[184:187], v[176:179], a[224:227], v[184:187]
 ds_read_b128 a[192:195], v249 offset:57344
 v_mov_b32 v247, v246
 v_mfma_f32_16x16x32_bf16 v[188:191], v[176:179], a[228:231], v[188:191]
 v_exp_f32 v161, v161
 v_mfma_f32_16x16x32_bf16 v[192:195], v[176:179], a[232:235], v[192:195]
 s_waitcnt lgkmcnt(3)
 v_permlane32_swap_b32 v246, v247
 v_min_f32 v246, -v246, -v247
 v_mfma_f32_16x16x32_bf16 v[196:199], v[176:179], a[236:239], v[196:199]
 v_mov_b32 v152, v246
 v_mov_b32 v153, v246
 v_mfma_f32_16x16x32_bf16 v[200:203], v[176:179], a[240:243], v[200:203]
 v_mov_b32 v154, v246
 v_mov_b32 v155, v246
 v_mfma_f32_16x16x32_bf16 v[204:207], v[176:179], a[244:247], v[204:207]
 s_waitcnt lgkmcnt(1)
 v_exp_f32 v162, v162
 v_mfma_f32_16x16x32_bf16 v[208:211], v[176:179], a[248:251], v[208:211]
 v_exp_f32 v163, v163
 v_mfma_f32_16x16x32_bf16 v[212:215], v[176:179], a[252:255], v[212:215]
 v_cvt_pk_bf16_f32 v180, v160, v161
 v_cvt_pk_bf16_f32 v181, v162, v163
 v_mfma_f32_16x16x32_bf16 v[172:175], a[220:223], a[28:31], v[152:155]
 ds_read_b128 a[196:199], v249 offset:57856
 v_mul_f32_dpp v34, v217, v34 row_newbcast:2 row_mask:0xf bank_mask:0xf
 v_exp_f32 v164, v164
 v_exp_f32 v165, v165
 v_exp_f32 v166, v166
 v_exp_f32 v167, v167
 v_mfma_f32_16x16x32_bf16 v[172:175], a[216:219], a[24:27], v[172:175]
 ds_read_b128 a[200:203], v249 offset:58368
 v_mul_f32_dpp v38, v217, v38 row_newbcast:2 row_mask:0xf bank_mask:0xf
 v_cvt_pk_bf16_f32 v182, v164, v165
 v_cvt_pk_bf16_f32 v183, v166, v167
 v_mfma_f32_16x16x32_bf16 v[172:175], a[212:215], a[20:23], v[172:175]
 v_cvt_pk_bf16_f32 v240, v34, v38
 v_mul_f32_dpp v42, v217, v42 row_newbcast:2 row_mask:0xf bank_mask:0xf
 v_mfma_f32_16x16x32_bf16 v[172:175], a[208:211], a[16:19], v[172:175]
 v_mul_f32_dpp v46, v217, v46 row_newbcast:2 row_mask:0xf bank_mask:0xf
 v_cvt_pk_bf16_f32 v241, v42, v46
 v_smfmac_f32_16x16x64_bf16 v[128:131], v[236:239], v[176:183], v138
 v_mul_f32_dpp v50, v217, v50 row_newbcast:2 row_mask:0xf bank_mask:0xf
 v_mfma_f32_16x16x32_bf16 v[0:3], v[180:183], a[224:227], v[0:3]
 v_mul_f32_dpp v54, v217, v54 row_newbcast:2 row_mask:0xf bank_mask:0xf
 v_cvt_pk_bf16_f32 v242, v50, v54
 v_mfma_f32_16x16x32_bf16 v[4:7], v[180:183], a[228:231], v[4:7]
 ds_read_b128 a[204:207], v249 offset:58880
 v_mul_f32_dpp v58, v217, v58 row_newbcast:2 row_mask:0xf bank_mask:0xf
 v_mul_f32_dpp v62, v217, v62 row_newbcast:2 row_mask:0xf bank_mask:0xf
 v_cvt_pk_bf16_f32 v243, v58, v62
 v_mfma_f32_16x16x32_bf16 v[8:11], v[180:183], a[232:235], v[8:11]
 buffer_store_dwordx4 v[240:243], v244, s[20:23], s33 offen offset:2048 sc1
 ds_read_b128 a[220:223], v249 offset:60928
 v_mfma_f32_16x16x32_bf16 v[12:15], v[180:183], a[236:239], v[12:15]
 ds_read_b128 a[216:219], v249 offset:60416
 v_add_f32 v252, v252, v246
 v_add_f32 v253, v253, v246
 v_mfma_f32_16x16x32_bf16 v[16:19], v[180:183], a[240:243], v[16:19]
 ds_read_b128 a[212:215], v249 offset:59904
 v_add_f32 v254, v254, v246
 v_add_f32 v255, v255, v246
 v_mfma_f32_16x16x32_bf16 v[20:23], v[180:183], a[244:247], v[20:23]
 ds_read_b128 a[208:211], v249 offset:59392
 v_exp_f32 v252, v252
 v_mfma_f32_16x16x32_bf16 v[24:27], v[180:183], a[248:251], v[24:27]
 v_exp_f32 v253, v253
 v_mfma_f32_16x16x32_bf16 v[28:31], v[180:183], a[252:255], v[28:31]
 s_waitcnt lgkmcnt(5)
 v_exp_f32 v254, v254
 v_mfma_f32_16x16x32_bf16 v[160:163], a[192:195], v[220:223], v[144:147]
 v_exp_f32 v255, v255
 v_mfma_f32_16x16x32_bf16 v[160:163], a[196:199], v[224:227], v[160:163]
 v_exp_f32 v172, v172
 v_mfma_f32_16x16x32_bf16 v[160:163], a[200:203], v[228:231], v[160:163]
 s_waitcnt lgkmcnt(2)
 v_exp_f32 v173, v173
 v_mfma_f32_16x16x32_bf16 v[160:163], a[204:207], v[232:235], v[160:163]
 v_exp_f32 v174, v174
 v_mfma_f32_16x16x32_bf16 v[164:167], a[220:223], v[232:235], v[144:147]
 v_exp_f32 v175, v175
 v_mfma_f32_16x16x32_bf16 v[164:167], a[216:219], v[228:231], v[164:167]
 s_waitcnt lgkmcnt(0)
 buffer_load_dwordx4 a[48:51], v245, s[8:11], s32 offen offset:0
 v_mov_b32 v132, 0
 v_mov_b32 v133, 0
 v_add_f32 v219, v134, v135
 v_mov_b32 v134, 0
 v_mov_b32 v135, 0
 v_cvt_pk_bf16_f32 v176, v252, v253
 v_cvt_pk_bf16_f32 v177, v254, v255
 v_cvt_pk_bf16_f32 v178, v172, v173
 v_cvt_pk_bf16_f32 v179, v174, v175
 v_mfma_f32_16x16x32_bf16 v[164:167], a[212:215], v[224:227], v[164:167]
 v_mul_f32_dpp v35, v217, v35 row_newbcast:3 row_mask:0xf bank_mask:0xf
 v_mul_f32_dpp v39, v217, v39 row_newbcast:3 row_mask:0xf bank_mask:0xf
 v_mfma_f32_16x16x32_bf16 v[164:167], a[208:211], v[220:223], v[164:167]
 v_cvt_pk_bf16_f32 v240, v35, v39
 v_mul_f32_dpp v43, v217, v43 row_newbcast:3 row_mask:0xf bank_mask:0xf
 v_mfma_f32_16x16x32_bf16 v[132:135], v[140:143], v[176:179], v[132:135]
 v_mul_f32_dpp v47, v217, v47 row_newbcast:3 row_mask:0xf bank_mask:0xf
 v_cvt_pk_bf16_f32 v241, v43, v47
 v_mfma_f32_16x16x32_bf16 v[32:35], v[176:179], a[224:227], 0
 buffer_load_dwordx4 a[52:55], v245, s[8:11], s32 offen offset:64
 v_mfma_f32_16x16x32_bf16 v[36:39], v[176:179], a[228:231], 0
 v_mul_f32_dpp v51, v217, v51 row_newbcast:3 row_mask:0xf bank_mask:0xf
 v_mul_f32_dpp v55, v217, v55 row_newbcast:3 row_mask:0xf bank_mask:0xf
 v_mfma_f32_16x16x32_bf16 v[40:43], v[176:179], a[232:235], 0
 v_cvt_pk_bf16_f32 v242, v51, v55
 v_mul_f32_dpp v59, v217, v59 row_newbcast:3 row_mask:0xf bank_mask:0xf
 v_mfma_f32_16x16x32_bf16 v[44:47], v[176:179], a[236:239], 0
 v_mul_f32_dpp v63, v217, v63 row_newbcast:3 row_mask:0xf bank_mask:0xf
 v_cvt_pk_bf16_f32 v243, v59, v63
 v_mfma_f32_16x16x32_bf16 v[48:51], v[176:179], a[240:243], 0
 buffer_store_dwordx4 v[240:243], v244, s[20:23], s33 offen offset:3072 sc1
 v_mfma_f32_16x16x32_bf16 v[52:55], v[176:179], a[244:247], 0
 buffer_load_dwordx4 a[56:59], v245, s[8:11], s32 offen offset:128
 v_mfma_f32_16x16x32_bf16 v[56:59], v[176:179], a[248:251], 0
 ds_read_b128 a[224:227], v248 offset:57344
 ds_read_b128 a[228:231], v248 offset:57856
 v_mfma_f32_16x16x32_bf16 v[60:63], v[176:179], a[252:255], 0
 ds_read_b128 a[232:235], v248 offset:58368
 ds_read_b128 a[236:239], v248 offset:58880
 v_mfma_f32_16x16x32_bf16 v[168:171], a[192:195], a[0:3], v[148:151]
 v_exp_f32 v160, v160
 v_mfma_f32_16x16x32_bf16 v[168:171], a[196:199], a[4:7], v[168:171]
 buffer_load_dwordx4 a[60:63], v245, s[8:11], s32 offen offset:192
 v_mfma_f32_16x16x32_bf16 v[168:171], a[200:203], a[8:11], v[168:171]
 ds_read_b128 a[240:243], v248 offset:59392
 v_exp_f32 v161, v161
 v_mfma_f32_16x16x32_bf16 v[168:171], a[204:207], a[12:15], v[168:171]
 ds_read_b128 a[244:247], v248 offset:59904
 v_exp_f32 v162, v162
 v_mfma_f32_16x16x32_bf16 v[172:175], a[220:223], a[12:15], v[148:151]
 ds_read_b128 a[248:251], v248 offset:60416
 v_exp_f32 v163, v163
 v_exp_f32 v164, v164
 v_exp_f32 v165, v165
 v_exp_f32 v166, v166
 v_exp_f32 v167, v167
 v_mfma_f32_16x16x32_bf16 v[172:175], a[216:219], a[8:11], v[172:175]
 ds_read_b128 a[252:255], v248 offset:60928
 v_cvt_pk_bf16_f32 v176, v160, v161
 v_cvt_pk_bf16_f32 v177, v162, v163
 v_cvt_pk_bf16_f32 v178, v164, v165
 v_cvt_pk_bf16_f32 v179, v166, v167
 v_mfma_f32_16x16x32_bf16 v[172:175], a[212:215], a[4:7], v[172:175]
 v_exp_f32 v168, v168
 v_mfma_f32_16x16x32_bf16 v[172:175], a[208:211], a[0:3], v[172:175]
 s_waitcnt lgkmcnt(4)
 v_exp_f32 v169, v169
 v_mfma_f32_16x16x32_bf16 v[184:187], v[176:179], a[224:227], v[184:187]
 v_exp_f32 v170, v170
 v_mfma_f32_16x16x32_bf16 v[188:191], v[176:179], a[228:231], v[188:191]
 v_exp_f32 v171, v171
 v_mfma_f32_16x16x32_bf16 v[192:195], v[176:179], a[232:235], v[192:195]
 v_cvt_pk_bf16_f32 v180, v168, v169
 v_cvt_pk_bf16_f32 v181, v170, v171
 v_mfma_f32_16x16x32_bf16 v[196:199], v[176:179], a[236:239], v[196:199]
 s_waitcnt lgkmcnt(1)
 v_exp_f32 v172, v172
 v_mfma_f32_16x16x32_bf16 v[200:203], v[176:179], a[240:243], v[200:203]
 v_exp_f32 v173, v173
 v_mfma_f32_16x16x32_bf16 v[204:207], v[176:179], a[244:247], v[204:207]
 v_exp_f32 v174, v174
 v_mfma_f32_16x16x32_bf16 v[208:211], v[176:179], a[248:251], v[208:211]
 s_waitcnt lgkmcnt(0)
 v_exp_f32 v175, v175
 v_mfma_f32_16x16x32_bf16 v[212:215], v[176:179], a[252:255], v[212:215]
 v_cvt_pk_bf16_f32 v182, v172, v173
 v_cvt_pk_bf16_f32 v183, v174, v175
 v_mfma_f32_16x16x32_bf16 v[160:163], a[192:195], a[16:19], v[152:155]
 ds_read_b128 a[192:195], v250 offset:0
 v_cmp_nge_f32 vcc, s28, v218
 v_mfma_f32_16x16x32_bf16 v[160:163], a[196:199], a[20:23], v[160:163]
 s_cmp_lg_u64 vcc, 0
 v_rcp_f32 v218, v218
 v_mfma_f32_16x16x32_bf16 v[160:163], a[200:203], a[24:27], v[160:163]
 s_cselect_b32 s34, 4, 0
 ds_read_b128 a[196:199], v250 offset:512
 ds_read_b128 a[200:203], v250 offset:1024
 v_mfma_f32_16x16x32_bf16 v[160:163], a[204:207], a[28:31], v[160:163]
 s_or_b32 s29, s29, s34
 ds_read_b128 a[204:207], v250 offset:1536
 v_mov_b32_dpp v218, v218 row_shl:4 row_mask:0x2 bank_mask:0xf
 v_mfma_f32_16x16x32_bf16 v[164:167], a[220:223], a[28:31], v[152:155]
 s_add_u32 s33, s25, 8192
 ds_read_b128 a[220:223], v250 offset:3584
 v_mov_b32_dpp v218, v218 row_shl:8 row_mask:0x4 bank_mask:0xf
 v_mfma_f32_16x16x32_bf16 v[164:167], a[216:219], a[24:27], v[164:167]
 ds_read_b128 a[216:219], v250 offset:3072
 v_mov_b32_dpp v218, v218 row_shl:12 row_mask:0x8 bank_mask:0xf
 v_mfma_f32_16x16x32_bf16 v[164:167], a[212:215], a[20:23], v[164:167]
 ds_read_b128 a[212:215], v250 offset:2560
 v_mul_f32_dpp v64, v218, v64 row_newbcast:0 row_mask:0xf bank_mask:0xf
 v_mfma_f32_16x16x32_bf16 v[164:167], a[208:211], a[16:19], v[164:167]
 ds_read_b128 a[208:211], v250 offset:2048
 v_mul_f32_dpp v68, v218, v68 row_newbcast:0 row_mask:0xf bank_mask:0xf
 v_smfmac_f32_16x16x64_bf16 v[128:131], v[236:239], v[176:183], v138
 v_cvt_pk_bf16_f32 v240, v64, v68
 v_mfma_f32_16x16x32_bf16 v[0:3], v[180:183], a[224:227], v[0:3]
 v_exp_f32 v160, v160
 v_mfma_f32_16x16x32_bf16 v[4:7], v[180:183], a[228:231], v[4:7]
 v_exp_f32 v161, v161
 v_mfma_f32_16x16x32_bf16 v[8:11], v[180:183], a[232:235], v[8:11]
 v_exp_f32 v162, v162
 v_mfma_f32_16x16x32_bf16 v[12:15], v[180:183], a[236:239], v[12:15]
 v_exp_f32 v163, v163
 v_mfma_f32_16x16x32_bf16 v[16:19], v[180:183], a[240:243], v[16:19]
 v_exp_f32 v164, v164
 v_mfma_f32_16x16x32_bf16 v[20:23], v[180:183], a[244:247], v[20:23]
 v_exp_f32 v165, v165
 v_mfma_f32_16x16x32_bf16 v[24:27], v[180:183], a[248:251], v[24:27]
 v_exp_f32 v166, v166
 v_mfma_f32_16x16x32_bf16 v[28:31], v[180:183], a[252:255], v[28:31]
 s_waitcnt lgkmcnt(0)
 v_exp_f32 v167, v167
 v_mfma_f32_16x16x32_bf16 v[168:171], a[192:195], v[220:223], v[144:147]
 v_cvt_pk_bf16_f32 v176, v160, v161
 v_cvt_pk_bf16_f32 v177, v162, v163
 v_mfma_f32_16x16x32_bf16 v[168:171], a[196:199], v[224:227], v[168:171]
 v_cvt_pk_bf16_f32 v178, v164, v165
 v_cvt_pk_bf16_f32 v179, v166, v167
 v_mfma_f32_16x16x32_bf16 v[168:171], a[200:203], v[228:231], v[168:171]
 v_mul_f32_dpp v72, v218, v72 row_newbcast:0 row_mask:0xf bank_mask:0xf
 v_mul_f32_dpp v76, v218, v76 row_newbcast:0 row_mask:0xf bank_mask:0xf
 v_mfma_f32_16x16x32_bf16 v[168:171], a[204:207], v[232:235], v[168:171]
 v_cvt_pk_bf16_f32 v241, v72, v76
 v_mul_f32_dpp v80, v218, v80 row_newbcast:0 row_mask:0xf bank_mask:0xf
 v_mfma_f32_16x16x32_bf16 v[172:175], a[220:223], v[232:235], v[144:147]
 v_mul_f32_dpp v84, v218, v84 row_newbcast:0 row_mask:0xf bank_mask:0xf
 v_cvt_pk_bf16_f32 v242, v80, v84
 v_mfma_f32_16x16x32_bf16 v[172:175], a[216:219], v[228:231], v[172:175]
 v_mul_f32_dpp v88, v218, v88 row_newbcast:0 row_mask:0xf bank_mask:0xf
 v_mul_f32_dpp v92, v218, v92 row_newbcast:0 row_mask:0xf bank_mask:0xf
 v_mfma_f32_16x16x32_bf16 v[172:175], a[212:215], v[224:227], v[172:175]
 v_exp_f32 v168, v168
 v_mfma_f32_16x16x32_bf16 v[172:175], a[208:211], v[220:223], v[172:175]
 v_exp_f32 v169, v169
 v_mfma_f32_16x16x32_bf16 v[132:135], v[140:143], v[176:179], v[132:135]
L_pg5:
 s_cbranch_execz L_pg9
 v_exp_f32 v170, v170
 v_mfma_f32_16x16x32_bf16 v[32:35], v[176:179], a[224:227], v[32:35]
 ds_read_b128 a[224:227], v249 offset:0
 v_cvt_pk_bf16_f32 v243, v88, v92
 v_mfma_f32_16x16x32_bf16 v[36:39], v[176:179], a[228:231], v[36:39]
 buffer_store_dwordx4 v[240:243], v244, s[20:23], s33 offen offset:0 sc1
 v_mfma_f32_16x16x32_bf16 v[40:43], v[176:179], a[232:235], v[40:43]
 ds_read_b128 a[228:231], v249 offset:512
 ds_read_b128 a[232:235], v249 offset:1024
 v_mfma_f32_16x16x32_bf16 v[44:47], v[176:179], a[236:239], v[44:47]
 v_exp_f32 v171, v171
 v_mfma_f32_16x16x32_bf16 v[48:51], v[176:179], a[240:243], v[48:51]
 v_exp_f32 v172, v172
 v_mfma_f32_16x16x32_bf16 v[52:55], v[176:179], a[244:247], v[52:55]
 v_exp_f32 v173, v173
 v_mfma_f32_16x16x32_bf16 v[56:59], v[176:179], a[248:251], v[56:59]
 v_exp_f32 v174, v174
 v_mfma_f32_16x16x32_bf16 v[60:63], v[176:179], a[252:255], v[60:63]
 ds_read_b128 a[236:239], v249 offset:1536
 ds_read_b128 a[240:243], v249 offset:2048
 v_mfma_f32_16x16x32_bf16 v[160:163], a[192:195], a[0:3], v[148:151]
 v_exp_f32 v175, v175
 v_mfma_f32_16x16x32_bf16 v[160:163], a[196:199], a[4:7], v[160:163]
 ds_read_b128 a[244:247], v249 offset:2560
 v_cvt_pk_bf16_f32 v176, v168, v169
 v_mfma_f32_16x16x32_bf16 v[160:163], a[200:203], a[8:11], v[160:163]
 ds_read_b128 a[248:251], v249 offset:3072
 v_cvt_pk_bf16_f32 v177, v170, v171
 v_mfma_f32_16x16x32_bf16 v[160:163], a[204:207], a[12:15], v[160:163]
 v_cvt_pk_bf16_f32 v178, v172, v173
 v_cvt_pk_bf16_f32 v179, v174, v175
 v_mfma_f32_16x16x32_bf16 v[164:167], a[220:223], a[12:15], v[148:151]
 ds_read_b128 a[252:255], v249 offset:3584
 v_mul_f32_dpp v65, v218, v65 row_newbcast:1 row_mask:0xf bank_mask:0xf
 v_mfma_f32_16x16x32_bf16 v[164:167], a[216:219], a[8:11], v[164:167]
 v_mul_f32_dpp v69, v218, v69 row_newbcast:1 row_mask:0xf bank_mask:0xf
 v_cvt_pk_bf16_f32 v240, v65, v69
 v_mfma_f32_16x16x32_bf16 v[164:167], a[212:215], a[4:7], v[164:167]
 v_exp_f32 v160, v160
 v_mfma_f32_16x16x32_bf16 v[164:167], a[208:211], a[0:3], v[164:167]
 s_waitcnt lgkmcnt(3)
 v_exp_f32 v161, v161
 v_mfma_f32_16x16x32_bf16 v[184:187], v[176:179], a[224:227], v[184:187]
 v_exp_f32 v162, v162
 v_mfma_f32_16x16x32_bf16 v[188:191], v[176:179], a[228:231], v[188:191]
 v_exp_f32 v163, v163
 v_mfma_f32_16x16x32_bf16 v[192:195], v[176:179], a[232:235], v[192:195]
 v_cvt_pk_bf16_f32 v180, v160, v161
 v_cvt_pk_bf16_f32 v181, v162, v163
 v_mfma_f32_16x16x32_bf16 v[196:199], v[176:179], a[236:239], v[196:199]
 v_exp_f32 v164, v164
 v_mfma_f32_16x16x32_bf16 v[200:203], v[176:179], a[240:243], v[200:203]
 s_waitcnt lgkmcnt(0)
 v_exp_f32 v165, v165
 v_mfma_f32_16x16x32_bf16 v[204:207], v[176:179], a[244:247], v[204:207]
 v_exp_f32 v166, v166
 v_mfma_f32_16x16x32_bf16 v[208:211], v[176:179], a[248:251], v[208:211]
 v_exp_f32 v167, v167
 v_mfma_f32_16x16x32_bf16 v[212:215], v[176:179], a[252:255], v[212:215]
 v_cvt_pk_bf16_f32 v182, v164, v165
 v_cvt_pk_bf16_f32 v183, v166, v167
 v_mfma_f32_16x16x32_bf16 v[168:171], a[192:195], a[16:19], v[152:155]
 ds_read_b128 a[192:195], v250 offset:8192
 v_mul_f32_dpp v73, v218, v73 row_newbcast:1 row_mask:0xf bank_mask:0xf
 v_mfma_f32_16x16x32_bf16 v[168:171], a[196:199], a[20:23], v[168:171]
 ds_read_b128 a[196:199], v250 offset:8704
 v_mul_f32_dpp v77, v218, v77 row_newbcast:1 row_mask:0xf bank_mask:0xf
 v_mfma_f32_16x16x32_bf16 v[168:171], a[200:203], a[24:27], v[168:171]
 ds_read_b128 a[200:203], v250 offset:9216
 v_cvt_pk_bf16_f32 v241, v73, v77
 v_mfma_f32_16x16x32_bf16 v[168:171], a[204:207], a[28:31], v[168:171]
 ds_read_b128 a[204:207], v250 offset:9728
 v_mul_f32_dpp v81, v218, v81 row_newbcast:1 row_mask:0xf bank_mask:0xf
 v_mfma_f32_16x16x32_bf16 v[172:175], a[220:223], a[28:31], v[152:155]
 ds_read_b128 a[220:223], v250 offset:11776
 v_mul_f32_dpp v85, v218, v85 row_newbcast:1 row_mask:0xf bank_mask:0xf
 v_mfma_f32_16x16x32_bf16 v[172:175], a[216:219], a[24:27], v[172:175]
 ds_read_b128 a[216:219], v250 offset:11264
 v_cvt_pk_bf16_f32 v242, v81, v85
 v_mfma_f32_16x16x32_bf16 v[172:175], a[212:215], a[20:23], v[172:175]
 v_exp_f32 v168, v168
 v_mfma_f32_16x16x32_bf16 v[172:175], a[208:211], a[16:19], v[172:175]
 v_exp_f32 v169, v169
 v_smfmac_f32_16x16x64_bf16 v[128:131], v[236:239], v[176:183], v138
 ds_read_b128 a[212:215], v250 offset:10752
 v_mfma_f32_16x16x32_bf16 v[0:3], v[180:183], a[224:227], v[0:3]
 v_exp_f32 v170, v170
 v_mfma_f32_16x16x32_bf16 v[4:7], v[180:183], a[228:231], v[4:7]
 v_exp_f32 v171, v171
 v_mfma_f32_16x16x32_bf16 v[8:11], v[180:183], a[232:235], v[8:11]
 v_exp_f32 v172, v172
 v_mfma_f32_16x16x32_bf16 v[12:15], v[180:183], a[236:239], v[12:15]
 v_exp_f32 v173, v173
 v_mfma_f32_16x16x32_bf16 v[16:19], v[180:183], a[240:243], v[16:19]
 v_exp_f32 v174, v174
 v_mfma_f32_16x16x32_bf16 v[20:23], v[180:183], a[244:247], v[20:23]
 ds_read_b128 a[208:211], v250 offset:10240
 v_exp_f32 v175, v175
 v_mfma_f32_16x16x32_bf16 v[24:27], v[180:183], a[248:251], v[24:27]
 v_cvt_pk_bf16_f32 v176, v168, v169
 v_cvt_pk_bf16_f32 v177, v170, v171
 v_mfma_f32_16x16x32_bf16 v[28:31], v[180:183], a[252:255], v[28:31]
 s_waitcnt lgkmcnt(1)
 v_cvt_pk_bf16_f32 v178, v172, v173
 v_cvt_pk_bf16_f32 v179, v174, v175
 v_mfma_f32_16x16x32_bf16 v[160:163], a[192:195], v[220:223], v[144:147]
 v_mul_f32_dpp v89, v218, v89 row_newbcast:1 row_mask:0xf bank_mask:0xf
 v_mul_f32_dpp v93, v218, v93 row_newbcast:1 row_mask:0xf bank_mask:0xf
 v_mfma_f32_16x16x32_bf16 v[160:163], a[196:199], v[224:227], v[160:163]
 v_cvt_pk_bf16_f32 v243, v89, v93
 v_mul_f32_dpp v66, v218, v66 row_newbcast:2 row_mask:0xf bank_mask:0xf
 v_mfma_f32_16x16x32_bf16 v[160:163], a[200:203], v[228:231], v[160:163]
 buffer_store_dwordx4 v[240:243], v244, s[20:23], s33 offen offset:1024 sc1
 v_mfma_f32_16x16x32_bf16 v[160:163], a[204:207], v[232:235], v[160:163]
 v_mul_f32_dpp v70, v218, v70 row_newbcast:2 row_mask:0xf bank_mask:0xf
 v_cvt_pk_bf16_f32 v240, v66, v70
 v_mfma_f32_16x16x32_bf16 v[164:167], a[220:223], v[232:235], v[144:147]
 v_mul_f32_dpp v74, v218, v74 row_newbcast:2 row_mask:0xf bank_mask:0xf
 v_mul_f32_dpp v78, v218, v78 row_newbcast:2 row_mask:0xf bank_mask:0xf
 v_mfma_f32_16x16x32_bf16 v[164:167], a[216:219], v[228:231], v[164:167]
 v_cvt_pk_bf16_f32 v241, v74, v78
 v_mul_f32_dpp v82, v218, v82 row_newbcast:2 row_mask:0xf bank_mask:0xf
 v_mfma_f32_16x16x32_bf16 v[164:167], a[212:215], v[224:227], v[164:167]
 s_waitcnt lgkmcnt(0)
 v_exp_f32 v160, v160
 v_mfma_f32_16x16x32_bf16 v[164:167], a[208:211], v[220:223], v[164:167]
 v_exp_f32 v161, v161
 v_mfma_f32_16x16x32_bf16 v[132:135], v[140:143], v[176:179], v[132:135]
 v_exp_f32 v162, v162
 v_mfma_f32_16x16x32_bf16 v[32:35], v[176:179], a[224:227], v[32:35]
 v_exp_f32 v163, v163
 v_mfma_f32_16x16x32_bf16 v[36:39], v[176:179], a[228:231], v[36:39]
 ds_read_b128 a[224:227], v249 offset:8192
 ds_read_b128 a[228:231], v249 offset:8704
 v_mfma_f32_16x16x32_bf16 v[40:43], v[176:179], a[232:235], v[40:43]
 v_exp_f32 v164, v164
 v_mfma_f32_16x16x32_bf16 v[44:47], v[176:179], a[236:239], v[44:47]
 v_exp_f32 v165, v165
 v_mfma_f32_16x16x32_bf16 v[48:51], v[176:179], a[240:243], v[48:51]
 ds_read_b128 a[240:243], v249 offset:10240
 ds_read_b128 a[232:235], v249 offset:9216
 v_mfma_f32_16x16x32_bf16 v[52:55], v[176:179], a[244:247], v[52:55]
 ds_read_b128 a[244:247], v249 offset:10752
 ds_read_b128 a[236:239], v249 offset:9728
 v_mfma_f32_16x16x32_bf16 v[56:59], v[176:179], a[248:251], v[56:59]
 v_exp_f32 v166, v166
 v_mfma_f32_16x16x32_bf16 v[60:63], v[176:179], a[252:255], v[60:63]
 s_waitcnt vmcnt(12)
 v_exp_f32 v167, v167
 v_mfma_f32_16x16x32_bf16 v[252:255], a[192:195], a[32:35], 0
 ds_read_b128 a[248:251], v249 offset:11264
 v_cvt_pk_bf16_f32 v176, v160, v161
 v_mfma_f32_16x16x32_bf16 v[252:255], a[196:199], a[36:39], v[252:255]
 v_cvt_pk_bf16_f32 v177, v162, v163
 v_cvt_pk_bf16_f32 v178, v164, v165
 v_mfma_f32_16x16x32_bf16 v[252:255], a[200:203], a[40:43], v[252:255]
 ds_read_b128 a[252:255], v249 offset:11776
 v_cvt_pk_bf16_f32 v179, v166, v167
 v_mfma_f32_16x16x32_bf16 v[252:255], a[204:207], a[44:47], v[252:255]
 v_mul_f32_dpp v86, v218, v86 row_newbcast:2 row_mask:0xf bank_mask:0xf
 v_cvt_pk_bf16_f32 v242, v82, v86
 v_mfma_f32_16x16x32_bf16 v[168:171], a[192:195], a[0:3], v[148:151]
 v_mul_f32_dpp v90, v218, v90 row_newbcast:2 row_mask:0xf bank_mask:0xf
 v_mul_f32_dpp v94, v218, v94 row_newbcast:2 row_mask:0xf bank_mask:0xf
 v_mfma_f32_16x16x32_bf16 v[168:171], a[196:199], a[4:7], v[168:171]
 v_cvt_pk_bf16_f32 v243, v90, v94
 v_mul_f32_dpp v67, v218, v67 row_newbcast:3 row_mask:0xf bank_mask:0xf
 v_mfma_f32_16x16x32_bf16 v[168:171], a[200:203], a[8:11], v[168:171]
 buffer_store_dwordx4 v[240:243], v244, s[20:23], s33 offen offset:2048 sc1
 v_mfma_f32_16x16x32_bf16 v[168:171], a[204:207], a[12:15], v[168:171]
 v_max3_f32 v246, v252, v253, v254
 v_max_f32 v246, v246, v255
 v_mfma_f32_16x16x32_bf16 v[172:175], a[220:223], a[12:15], v[148:151]
 v_mov_b32 v247, v246
 v_mul_f32_dpp v71, v218, v71 row_newbcast:3 row_mask:0xf bank_mask:0xf
 v_mfma_f32_16x16x32_bf16 v[172:175], a[216:219], a[8:11], v[172:175]
 v_permlane16_swap_b32 v246, v247
 v_max_f32 v246, v246, v247
 v_mfma_f32_16x16x32_bf16 v[172:175], a[212:215], a[4:7], v[172:175]
 v_exp_f32 v171, v171
 v_mfma_f32_16x16x32_bf16 v[172:175], a[208:211], a[0:3], v[172:175]
 s_waitcnt lgkmcnt(0)
 v_exp_f32 v168, v168
 v_mfma_f32_16x16x32_bf16 v[184:187], v[176:179], a[224:227], v[184:187]
 v_exp_f32 v169, v169
 v_mfma_f32_16x16x32_bf16 v[188:191], v[176:179], a[228:231], v[188:191]
 v_exp_f32 v170, v170
 v_mfma_f32_16x16x32_bf16 v[192:195], v[176:179], a[232:235], v[192:195]
 v_cvt_pk_bf16_f32 v180, v168, v169
 v_cvt_pk_bf16_f32 v181, v170, v171
 v_mfma_f32_16x16x32_bf16 v[196:199], v[176:179], a[236:239], v[196:199]
 v_exp_f32 v172, v172
 v_mfma_f32_16x16x32_bf16 v[200:203], v[176:179], a[240:243], v[200:203]
 v_exp_f32 v173, v173
 v_mfma_f32_16x16x32_bf16 v[204:207], v[176:179], a[244:247], v[204:207]
 v_cvt_pk_bf16_f32 v182, v172, v173
 v_mov_b32 v247, v246
 v_mfma_f32_16x16x32_bf16 v[208:211], v[176:179], a[248:251], v[208:211]
 v_exp_f32 v174, v174
 v_mfma_f32_16x16x32_bf16 v[212:215], v[176:179], a[252:255], v[212:215]
 v_exp_f32 v175, v175
 v_mfma_f32_16x16x32_bf16 v[160:163], a[192:195], a[16:19], v[152:155]
 v_cvt_pk_bf16_f32 v183, v174, v175
 v_permlane32_swap_b32 v246, v247
 v_mfma_f32_16x16x32_bf16 v[160:163], a[196:199], a[20:23], v[160:163]
 v_min_f32 v246, -v246, -v247
 v_mov_b32 v156, v246
 v_mfma_f32_16x16x32_bf16 v[160:163], a[200:203], a[24:27], v[160:163]
 v_mov_b32 v157, v246
 v_mov_b32 v158, v246
 v_mfma_f32_16x16x32_bf16 v[160:163], a[204:207], a[28:31], v[160:163]
 ds_read_b128 a[192:195], v250 offset:16384
 v_mov_b32 v159, v246
 v_mfma_f32_16x16x32_bf16 v[164:167], a[220:223], a[28:31], v[152:155]
 ds_read_b128 a[196:199], v250 offset:16896
 ds_read_b128 a[200:203], v250 offset:17408
 v_mfma_f32_16x16x32_bf16 v[164:167], a[216:219], a[24:27], v[164:167]
 ds_read_b128 a[204:207], v250 offset:17920
 v_add_f32 v252, v252, v246
 v_mfma_f32_16x16x32_bf16 v[164:167], a[212:215], a[20:23], v[164:167]
 v_exp_f32 v161, v161
 v_mfma_f32_16x16x32_bf16 v[164:167], a[208:211], a[16:19], v[164:167]
 v_exp_f32 v162, v162
 v_smfmac_f32_16x16x64_bf16 v[128:131], v[236:239], v[176:183], v138
 v_add_f32 v253, v253, v246
 v_mfma_f32_16x16x32_bf16 v[0:3], v[180:183], a[224:227], v[0:3]
 v_exp_f32 v160, v160
 v_mfma_f32_16x16x32_bf16 v[4:7], v[180:183], a[228:231], v[4:7]
 v_exp_f32 v163, v163
 v_mfma_f32_16x16x32_bf16 v[8:11], v[180:183], a[232:235], v[8:11]
 v_cvt_pk_bf16_f32 v176, v160, v161
 v_cvt_pk_bf16_f32 v177, v162, v163
 v_mfma_f32_16x16x32_bf16 v[12:15], v[180:183], a[236:239], v[12:15]
 v_exp_f32 v164, v164
 v_mfma_f32_16x16x32_bf16 v[16:19], v[180:183], a[240:243], v[16:19]
 v_exp_f32 v165, v165
 v_mfma_f32_16x16x32_bf16 v[20:23], v[180:183], a[244:247], v[20:23]
 v_exp_f32 v166, v166
 v_mfma_f32_16x16x32_bf16 v[24:27], v[180:183], a[248:251], v[24:27]
 v_exp_f32 v167, v167
 v_mfma_f32_16x16x32_bf16 v[28:31], v[180:183], a[252:255], v[28:31]
 v_cvt_pk_bf16_f32 v178, v164, v165
 v_cvt_pk_bf16_f32 v179, v166, v167
 v_mfma_f32_16x16x32_bf16 v[172:175], a[220:223], a[44:47], v[156:159]
 ds_read_b128 a[220:223], v250 offset:19968
 v_add_f32 v254, v254, v246
 v_mfma_f32_16x16x32_bf16 v[172:175], a[216:219], a[40:43], v[172:175]
 ds_read_b128 a[216:219], v250 offset:19456
 v_add_f32 v255, v255, v246
 v_mfma_f32_16x16x32_bf16 v[172:175], a[212:215], a[36:39], v[172:175]
 ds_read_b128 a[212:215], v250 offset:18944
 v_cvt_pk_bf16_f32 v240, v67, v71
 v_mfma_f32_16x16x32_bf16 v[172:175], a[208:211], a[32:35], v[172:175]
 v_exp_f32 v252, v252
 v_mfma_f32_16x16x32_bf16 v[32:35], v[176:179], a[224:227], v[32:35]
 v_exp_f32 v253, v253
 v_mfma_f32_16x16x32_bf16 v[36:39], v[176:179], a[228:231], v[36:39]
 v_exp_f32 v254, v254
 v_mfma_f32_16x16x32_bf16 v[40:43], v[176:179], a[232:235], v[40:43]
 v_exp_f32 v255, v255
 v_mfma_f32_16x16x32_bf16 v[44:47], v[176:179], a[236:239], v[44:47]
 v_exp_f32 v172, v172
 v_mfma_f32_16x16x32_bf16 v[48:51], v[176:179], a[240:243], v[48:51]
 ds_read_b128 a[208:211], v250 offset:18432
 v_cvt_pk_bf16_f32 v180, v252, v253
 v_mfma_f32_16x16x32_bf16 v[52:55], v[176:179], a[244:247], v[52:55]
 v_exp_f32 v173, v173
 v_mfma_f32_16x16x32_bf16 v[56:59], v[176:179], a[248:251], v[56:59]
 v_exp_f32 v174, v174
 v_mfma_f32_16x16x32_bf16 v[60:63], v[176:179], a[252:255], v[60:63]
 s_waitcnt lgkmcnt(1)
 v_exp_f32 v175, v175
 v_mfma_f32_16x16x32_bf16 v[160:163], a[192:195], v[220:223], v[144:147]
 v_cvt_pk_bf16_f32 v181, v254, v255
 v_cvt_pk_bf16_f32 v182, v172, v173
 v_mfma_f32_16x16x32_bf16 v[160:163], a[196:199], v[224:227], v[160:163]
 v_cvt_pk_bf16_f32 v183, v174, v175
 v_mul_f32_dpp v75, v218, v75 row_newbcast:3 row_mask:0xf bank_mask:0xf
 v_mfma_f32_16x16x32_bf16 v[160:163], a[200:203], v[228:231], v[160:163]
 v_mul_f32_dpp v79, v218, v79 row_newbcast:3 row_mask:0xf bank_mask:0xf
 v_cvt_pk_bf16_f32 v241, v75, v79
 v_mfma_f32_16x16x32_bf16 v[160:163], a[204:207], v[232:235], v[160:163]
 v_mul_f32_dpp v83, v218, v83 row_newbcast:3 row_mask:0xf bank_mask:0xf
 v_mul_f32_dpp v87, v218, v87 row_newbcast:3 row_mask:0xf bank_mask:0xf
 v_mfma_f32_16x16x32_bf16 v[164:167], a[220:223], v[232:235], v[144:147]
 v_cvt_pk_bf16_f32 v242, v83, v87
 v_mul_f32_dpp v91, v218, v91 row_newbcast:3 row_mask:0xf bank_mask:0xf
 v_mfma_f32_16x16x32_bf16 v[164:167], a[216:219], v[228:231], v[164:167]
 v_mul_f32_dpp v95, v218, v95 row_newbcast:3 row_mask:0xf bank_mask:0xf
 v_cvt_pk_bf16_f32 v243, v91, v95
 v_mfma_f32_16x16x32_bf16 v[164:167], a[212:215], v[224:227], v[164:167]
 s_waitcnt lgkmcnt(0)
 buffer_store_dwordx4 v[240:243], v244, s[20:23], s33 offen offset:3072 sc1
 v_mfma_f32_16x16x32_bf16 v[164:167], a[208:211], v[220:223], v[164:167]
 v_exp_f32 v160, v160
 v_smfmac_f32_16x16x64_bf16 v[132:135], v[236:239], v[176:183], v138
 v_cmp_nge_f32 vcc, s28, v219
 v_mfma_f32_16x16x32_bf16 v[64:67], v[180:183], a[224:227], 0
 s_cmp_lg_u64 vcc, 0
 v_exp_f32 v161, v161
 v_mfma_f32_16x16x32_bf16 v[68:71], v[180:183], a[228:231], 0
 s_cselect_b32 s34, 8, 0
 ds_read_b128 a[224:227], v249 offset:16384
 ds_read_b128 a[228:231], v249 offset:16896
 v_mfma_f32_16x16x32_bf16 v[72:75], v[180:183], a[232:235], 0
 s_or_b32 s29, s29, s34
 ds_read_b128 a[232:235], v249 offset:17408
 v_cvt_pk_bf16_f32 v176, v160, v161
 v_mfma_f32_16x16x32_bf16 v[76:79], v[180:183], a[236:239], 0
 s_add_u32 s33, s25, 12288
 v_exp_f32 v162, v162
 v_mfma_f32_16x16x32_bf16 v[80:83], v[180:183], a[240:243], 0
 s_add_u32 s32, s25, 36864
 v_exp_f32 v163, v163
 v_mfma_f32_16x16x32_bf16 v[84:87], v[180:183], a[244:247], 0
 v_exp_f32 v164, v164
 v_mfma_f32_16x16x32_bf16 v[88:91], v[180:183], a[248:251], 0
 v_exp_f32 v165, v165
 v_mfma_f32_16x16x32_bf16 v[92:95], v[180:183], a[252:255], 0
 v_exp_f32 v166, v166
 v_mfma_f32_16x16x32_bf16 v[168:171], a[192:195], a[0:3], v[148:151]
 ds_read_b128 a[236:239], v249 offset:17920
 ds_read_b128 a[240:243], v249 offset:18432
 v_mfma_f32_16x16x32_bf16 v[168:171], a[196:199], a[4:7], v[168:171]
 v_exp_f32 v167, v167
 v_mfma_f32_16x16x32_bf16 v[168:171], a[200:203], a[8:11], v[168:171]
 ds_read_b128 a[244:247], v249 offset:18944
 ds_read_b128 a[248:251], v249 offset:19456
 v_mfma_f32_16x16x32_bf16 v[168:171], a[204:207], a[12:15], v[168:171]
 v_cvt_pk_bf16_f32 v177, v162, v163
 v_cvt_pk_bf16_f32 v178, v164, v165
 v_mfma_f32_16x16x32_bf16 v[172:175], a[220:223], a[12:15], v[148:151]
 ds_read_b128 a[252:255], v249 offset:19968
 v_cvt_pk_bf16_f32 v179, v166, v167
 v_mfma_f32_16x16x32_bf16 v[172:175], a[216:219], a[8:11], v[172:175]
 v_rcp_f32 v219, v219
 v_mfma_f32_16x16x32_bf16 v[172:175], a[212:215], a[4:7], v[172:175]
 v_exp_f32 v168, v168
 v_mfma_f32_16x16x32_bf16 v[172:175], a[208:211], a[0:3], v[172:175]
 s_waitcnt lgkmcnt(3)
 v_exp_f32 v169, v169
 v_mfma_f32_16x16x32_bf16 v[184:187], v[176:179], a[224:227], v[184:187]
 v_exp_f32 v170, v170
 v_mfma_f32_16x16x32_bf16 v[188:191], v[176:179], a[228:231], v[188:191]
 v_exp_f32 v171, v171
 v_mfma_f32_16x16x32_bf16 v[192:195], v[176:179], a[232:235], v[192:195]
 v_cvt_pk_bf16_f32 v180, v168, v169
 v_cvt_pk_bf16_f32 v181, v170, v171
 v_mfma_f32_16x16x32_bf16 v[196:199], v[176:179], a[236:239], v[196:199]
 v_exp_f32 v172, v172
 v_mfma_f32_16x16x32_bf16 v[200:203], v[176:179], a[240:243], v[200:203]
 s_waitcnt lgkmcnt(0)
 v_exp_f32 v173, v173
 v_mfma_f32_16x16x32_bf16 v[204:207], v[176:179], a[244:247], v[204:207]
 v_exp_f32 v174, v174
 v_mfma_f32_16x16x32_bf16 v[208:211], v[176:179], a[248:251], v[208:211]
 v_exp_f32 v175, v175
 v_mfma_f32_16x16x32_bf16 v[212:215], v[176:179], a[252:255], v[212:215]
 v_cvt_pk_bf16_f32 v182, v172, v173
 v_cvt_pk_bf16_f32 v183, v174, v175
 v_mfma_f32_16x16x32_bf16 v[160:163], a[192:195], a[16:19], v[152:155]
 v_mov_b32_dpp v219, v219 row_shl:4 row_mask:0x2 bank_mask:0xf
 s_nop 0
 v_mfma_f32_16x16x32_bf16 v[160:163], a[196:199], a[20:23], v[160:163]
 v_mov_b32_dpp v219, v219 row_shl:8 row_mask:0x4 bank_mask:0xf
 s_nop 0
 v_mfma_f32_16x16x32_bf16 v[160:163], a[200:203], a[24:27], v[160:163]
 v_mov_b32_dpp v219, v219 row_shl:12 row_mask:0x8 bank_mask:0xf
 s_nop 0
 v_mfma_f32_16x16x32_bf16 v[160:163], a[204:207], a[28:31], v[160:163]
 v_mul_f32_dpp v96, v219, v96 row_newbcast:0 row_mask:0xf bank_mask:0xf
 v_mul_f32_dpp v100, v219, v100 row_newbcast:0 row_mask:0xf bank_mask:0xf
 v_mfma_f32_16x16x32_bf16 v[164:167], a[220:223], a[28:31], v[152:155]
 v_cvt_pk_bf16_f32 v240, v96, v100
 v_mul_f32_dpp v104, v219, v104 row_newbcast:0 row_mask:0xf bank_mask:0xf
 v_mfma_f32_16x16x32_bf16 v[164:167], a[216:219], a[24:27], v[164:167]
 v_mul_f32_dpp v108, v219, v108 row_newbcast:0 row_mask:0xf bank_mask:0xf
 v_cvt_pk_bf16_f32 v241, v104, v108
 v_mfma_f32_16x16x32_bf16 v[164:167], a[212:215], a[20:23], v[164:167]
 v_exp_f32 v160, v160
 v_mfma_f32_16x16x32_bf16 v[164:167], a[208:211], a[16:19], v[164:167]
 v_exp_f32 v161, v161
 v_smfmac_f32_16x16x64_bf16 v[128:131], v[236:239], v[176:183], v138
 v_cvt_pk_bf16_f32 v176, v160, v161
 v_mfma_f32_16x16x32_bf16 v[0:3], v[180:183], a[224:227], v[0:3]
 v_exp_f32 v162, v162
 v_mfma_f32_16x16x32_bf16 v[4:7], v[180:183], a[228:231], v[4:7]
 v_exp_f32 v163, v163
 v_mfma_f32_16x16x32_bf16 v[8:11], v[180:183], a[232:235], v[8:11]
 v_exp_f32 v164, v164
 v_mfma_f32_16x16x32_bf16 v[12:15], v[180:183], a[236:239], v[12:15]
 v_exp_f32 v165, v165
 v_mfma_f32_16x16x32_bf16 v[16:19], v[180:183], a[240:243], v[16:19]
 v_exp_f32 v166, v166
 v_mfma_f32_16x16x32_bf16 v[20:23], v[180:183], a[244:247], v[20:23]
 v_exp_f32 v167, v167
 v_mfma_f32_16x16x32_bf16 v[24:27], v[180:183], a[248:251], v[24:27]
 v_cvt_pk_bf16_f32 v177, v162, v163
 v_cvt_pk_bf16_f32 v178, v164, v165
 v_mfma_f32_16x16x32_bf16 v[28:31], v[180:183], a[252:255], v[28:31]
 v_cvt_pk_bf16_f32 v179, v166, v167
 v_mul_f32_dpp v112, v219, v112 row_newbcast:0 row_mask:0xf bank_mask:0xf
 v_mfma_f32_16x16x32_bf16 v[168:171], a[192:195], a[32:35], v[156:159]
 ds_read_b128 a[192:195], v250 offset:24576
 v_mul_f32_dpp v116, v219, v116 row_newbcast:0 row_mask:0xf bank_mask:0xf
 v_mfma_f32_16x16x32_bf16 v[168:171], a[196:199], a[36:39], v[168:171]
 ds_read_b128 a[196:199], v250 offset:25088
 v_cvt_pk_bf16_f32 v242, v112, v116
 v_mfma_f32_16x16x32_bf16 v[168:171], a[200:203], a[40:43], v[168:171]
 ds_read_b128 a[200:203], v250 offset:25600
 v_mul_f32_dpp v120, v219, v120 row_newbcast:0 row_mask:0xf bank_mask:0xf
 v_mfma_f32_16x16x32_bf16 v[168:171], a[204:207], a[44:47], v[168:171]
 ds_read_b128 a[204:207], v250 offset:26112
 v_mul_f32_dpp v124, v219, v124 row_newbcast:0 row_mask:0xf bank_mask:0xf
 v_mfma_f32_16x16x32_bf16 v[172:175], a[220:223], a[44:47], v[156:159]
 ds_read_b128 a[220:223], v250 offset:28160
 v_cvt_pk_bf16_f32 v243, v120, v124
 v_mfma_f32_16x16x32_bf16 v[172:175], a[216:219], a[40:43], v[172:175]
 buffer_store_dwordx4 v[240:243], v244, s[20:23], s33 offen offset:0 sc1
 v_mfma_f32_16x16x32_bf16 v[172:175], a[212:215], a[36:39], v[172:175]
 ds_read_b128 a[216:219], v250 offset:27648
 ds_read_b128 a[212:215], v250 offset:27136
 v_mfma_f32_16x16x32_bf16 v[172:175], a[208:211], a[32:35], v[172:175]
 ds_read_b128 a[208:211], v250 offset:26624
 v_mul_f32_dpp v97, v219, v97 row_newbcast:1 row_mask:0xf bank_mask:0xf
 v_mfma_f32_16x16x32_bf16 v[32:35], v[176:179], a[224:227], v[32:35]
 v_exp_f32 v168, v168
 v_mfma_f32_16x16x32_bf16 v[36:39], v[176:179], a[228:231], v[36:39]
 v_exp_f32 v169, v169
 v_mfma_f32_16x16x32_bf16 v[40:43], v[176:179], a[232:235], v[40:43]
 v_exp_f32 v170, v170
 v_mfma_f32_16x16x32_bf16 v[44:47], v[176:179], a[236:239], v[44:47]
 v_exp_f32 v171, v171
 v_mfma_f32_16x16x32_bf16 v[48:51], v[176:179], a[240:243], v[48:51]
 v_exp_f32 v172, v172
 v_mfma_f32_16x16x32_bf16 v[52:55], v[176:179], a[244:247], v[52:55]
 v_exp_f32 v173, v173
 v_mfma_f32_16x16x32_bf16 v[56:59], v[176:179], a[248:251], v[56:59]
 v_exp_f32 v174, v174
 v_mfma_f32_16x16x32_bf16 v[60:63], v[176:179], a[252:255], v[60:63]
 s_waitcnt lgkmcnt(0)
 v_exp_f32 v175, v175
 v_mfma_f32_16x16x32_bf16 v[160:163], a[192:195], v[220:223], v[144:147]
 v_cvt_pk_bf16_f32 v180, v168, v169
 v_cvt_pk_bf16_f32 v181, v170, v171
 v_mfma_f32_16x16x32_bf16 v[160:163], a[196:199], v[224:227], v[160:163]
 v_cvt_pk_bf16_f32 v182, v172, v173
 v_cvt_pk_bf16_f32 v183, v174, v175
 v_mfma_f32_16x16x32_bf16 v[160:163], a[200:203], v[228:231], v[160:163]
 v_mul_f32_dpp v101, v219, v101 row_newbcast:1 row_mask:0xf bank_mask:0xf
 v_cvt_pk_bf16_f32 v240, v97, v101
 v_mfma_f32_16x16x32_bf16 v[160:163], a[204:207], v[232:235], v[160:163]
 v_mul_f32_dpp v105, v219, v105 row_newbcast:1 row_mask:0xf bank_mask:0xf
 v_mul_f32_dpp v109, v219, v109 row_newbcast:1 row_mask:0xf bank_mask:0xf
 v_mfma_f32_16x16x32_bf16 v[164:167], a[220:223], v[232:235], v[144:147]
 buffer_load_dwordx4 v[232:235], v245, s[8:11], s32 offen offset:192
 v_mfma_f32_16x16x32_bf16 v[164:167], a[216:219], v[228:231], v[164:167]
 v_cvt_pk_bf16_f32 v241, v105, v109
 v_mul_f32_dpp v113, v219, v113 row_newbcast:1 row_mask:0xf bank_mask:0xf
 v_mfma_f32_16x16x32_bf16 v[164:167], a[212:215], v[224:227], v[164:167]
 v_exp_f32 v160, v160
 v_mfma_f32_16x16x32_bf16 v[164:167], a[208:211], v[220:223], v[164:167]
 v_exp_f32 v161, v161
 v_smfmac_f32_16x16x64_bf16 v[132:135], v[236:239], v[176:183], v138
 v_cvt_pk_bf16_f32 v176, v160, v161
 v_mfma_f32_16x16x32_bf16 v[64:67], v[180:183], a[224:227], v[64:67]
 buffer_load_dwordx4 v[220:223], v245, s[8:11], s32 offen offset:0
 v_mfma_f32_16x16x32_bf16 v[68:71], v[180:183], a[228:231], v[68:71]
 v_exp_f32 v162, v162
 v_mfma_f32_16x16x32_bf16 v[72:75], v[180:183], a[232:235], v[72:75]
 v_exp_f32 v163, v163
 v_mfma_f32_16x16x32_bf16 v[76:79], v[180:183], a[236:239], v[76:79]
 v_exp_f32 v164, v164
 v_mfma_f32_16x16x32_bf16 v[80:83], v[180:183], a[240:243], v[80:83]
 buffer_load_dwordx4 v[224:227], v245, s[8:11], s32 offen offset:64
 v_mfma_f32_16x16x32_bf16 v[84:87], v[180:183], a[244:247], v[84:87]
 v_exp_f32 v165, v165
 v_mfma_f32_16x16x32_bf16 v[88:91], v[180:183], a[248:251], v[88:91]
 ds_read_b128 a[224:227], v249 offset:24576
 v_exp_f32 v166, v166
 v_mfma_f32_16x16x32_bf16 v[92:95], v[180:183], a[252:255], v[92:95]
 ds_read_b128 a[228:231], v249 offset:25088
 v_exp_f32 v167, v167
 v_mfma_f32_16x16x32_bf16 v[168:171], a[192:195], a[0:3], v[148:151]
 buffer_load_dwordx4 v[228:231], v245, s[8:11], s32 offen offset:128
 ds_read_b128 a[232:235], v249 offset:25600
 v_mfma_f32_16x16x32_bf16 v[168:171], a[196:199], a[4:7], v[168:171]
 ds_read_b128 a[248:251], v249 offset:27648
 ds_read_b128 a[236:239], v249 offset:26112
 v_cvt_pk_bf16_f32 v177, v162, v163
 v_mfma_f32_16x16x32_bf16 v[168:171], a[200:203], a[8:11], v[168:171]
 ds_read_b128 a[240:243], v249 offset:26624
 v_cvt_pk_bf16_f32 v178, v164, v165
 v_cvt_pk_bf16_f32 v179, v166, v167
 v_mfma_f32_16x16x32_bf16 v[168:171], a[204:207], a[12:15], v[168:171]
 ds_read_b128 a[244:247], v249 offset:27136
 ds_read_b128 a[252:255], v249 offset:28160
 v_mfma_f32_16x16x32_bf16 v[172:175], a[220:223], a[12:15], v[148:151]
 v_mul_f32_dpp v117, v219, v117 row_newbcast:1 row_mask:0xf bank_mask:0xf
 v_cvt_pk_bf16_f32 v242, v113, v117
 v_mfma_f32_16x16x32_bf16 v[172:175], a[216:219], a[8:11], v[172:175]
 v_mul_f32_dpp v121, v219, v121 row_newbcast:1 row_mask:0xf bank_mask:0xf
 v_mul_f32_dpp v125, v219, v125 row_newbcast:1 row_mask:0xf bank_mask:0xf
 v_mfma_f32_16x16x32_bf16 v[172:175], a[212:215], a[4:7], v[172:175]
 v_exp_f32 v168, v168
 v_mfma_f32_16x16x32_bf16 v[172:175], a[208:211], a[0:3], v[172:175]
 s_waitcnt lgkmcnt(5)
 v_exp_f32 v169, v169
 v_mfma_f32_16x16x32_bf16 v[184:187], v[176:179], a[224:227], v[184:187]
 v_exp_f32 v170, v170
 v_mfma_f32_16x16x32_bf16 v[188:191], v[176:179], a[228:231], v[188:191]
 v_exp_f32 v171, v171
 v_mfma_f32_16x16x32_bf16 v[192:195], v[176:179], a[232:235], v[192:195]
 s_waitcnt lgkmcnt(0)
 v_cvt_pk_bf16_f32 v180, v168, v169
 v_cvt_pk_bf16_f32 v181, v170, v171
 v_mfma_f32_16x16x32_bf16 v[196:199], v[176:179], a[236:239], v[196:199]
 v_exp_f32 v172, v172
 v_mfma_f32_16x16x32_bf16 v[200:203], v[176:179], a[240:243], v[200:203]
 v_exp_f32 v173, v173
 v_mfma_f32_16x16x32_bf16 v[204:207], v[176:179], a[244:247], v[204:207]
 v_exp_f32 v174, v174
 v_mfma_f32_16x16x32_bf16 v[208:211], v[176:179], a[248:251], v[208:211]
 v_exp_f32 v175, v175
 v_mfma_f32_16x16x32_bf16 v[212:215], v[176:179], a[252:255], v[212:215]
 s_waitcnt vmcnt(12)
 v_cvt_pk_bf16_f32 v182, v172, v173
 v_cvt_pk_bf16_f32 v183, v174, v175
 v_mfma_f32_16x16x32_bf16 v[252:255], a[64:67], a[48:51], 0
 v_cvt_pk_bf16_f32 v243, v121, v125
 v_mul_f32_dpp v98, v219, v98 row_newbcast:2 row_mask:0xf bank_mask:0xf
 v_mfma_f32_16x16x32_bf16 v[252:255], a[68:71], a[52:55], v[252:255]
 s_waitcnt vmcnt(9)
 buffer_store_dwordx4 v[240:243], v244, s[20:23], s33 offen offset:1024 sc1
 v_mfma_f32_16x16x32_bf16 v[252:255], a[72:75], a[56:59], v[252:255]
 v_mul_f32_dpp v102, v219, v102 row_newbcast:2 row_mask:0xf bank_mask:0xf
 v_cvt_pk_bf16_f32 v240, v98, v102
 v_mfma_f32_16x16x32_bf16 v[252:255], a[76:79], a[60:63], v[252:255]
 v_mul_f32_dpp v106, v219, v106 row_newbcast:2 row_mask:0xf bank_mask:0xf
 v_mul_f32_dpp v110, v219, v110 row_newbcast:2 row_mask:0xf bank_mask:0xf
 v_mfma_f32_16x16x32_bf16 v[160:163], a[192:195], a[16:19], v[152:155]
 v_cvt_pk_bf16_f32 v241, v106, v110
 v_mul_f32_dpp v114, v219, v114 row_newbcast:2 row_mask:0xf bank_mask:0xf
 v_mfma_f32_16x16x32_bf16 v[160:163], a[196:199], a[20:23], v[160:163]
 v_mul_f32_dpp v118, v219, v118 row_newbcast:2 row_mask:0xf bank_mask:0xf
 v_cvt_pk_bf16_f32 v242, v114, v118
 v_mfma_f32_16x16x32_bf16 v[160:163], a[200:203], a[24:27], v[160:163]
 v_max3_f32 v246, v252, v253, v254
 v_max_f32 v246, v246, v255
 v_mfma_f32_16x16x32_bf16 v[160:163], a[204:207], a[28:31], v[160:163]
 v_mov_b32 v247, v246
 v_mul_f32_dpp v122, v219, v122 row_newbcast:2 row_mask:0xf bank_mask:0xf
 v_mfma_f32_16x16x32_bf16 v[164:167], a[220:223], a[28:31], v[152:155]
 v_permlane16_swap_b32 v246, v247
 v_max_f32 v246, v246, v247
 v_mfma_f32_16x16x32_bf16 v[164:167], a[216:219], a[24:27], v[164:167]
 v_mov_b32 v247, v246
 v_mul_f32_dpp v126, v219, v126 row_newbcast:2 row_mask:0xf bank_mask:0xf
 v_mfma_f32_16x16x32_bf16 v[164:167], a[212:215], a[20:23], v[164:167]
 v_exp_f32 v160, v160
 v_mfma_f32_16x16x32_bf16 v[164:167], a[208:211], a[16:19], v[164:167]
 v_exp_f32 v161, v161
 v_smfmac_f32_16x16x64_bf16 v[128:131], v[236:239], v[176:183], v138
 v_cvt_pk_bf16_f32 v176, v160, v161
 v_mfma_f32_16x16x32_bf16 v[0:3], v[180:183], a[224:227], v[0:3]
 v_exp_f32 v162, v162
 v_mfma_f32_16x16x32_bf16 v[4:7], v[180:183], a[228:231], v[4:7]
 v_exp_f32 v163, v163
 v_mfma_f32_16x16x32_bf16 v[8:11], v[180:183], a[232:235], v[8:11]
 v_exp_f32 v166, v166
 v_mfma_f32_16x16x32_bf16 v[12:15], v[180:183], a[236:239], v[12:15]
 v_exp_f32 v167, v167
 v_mfma_f32_16x16x32_bf16 v[16:19], v[180:183], a[240:243], v[16:19]
 v_cvt_pk_bf16_f32 v177, v162, v163
 v_cvt_pk_bf16_f32 v179, v166, v167
 v_mfma_f32_16x16x32_bf16 v[20:23], v[180:183], a[244:247], v[20:23]
 v_exp_f32 v164, v164
 v_mfma_f32_16x16x32_bf16 v[24:27], v[180:183], a[248:251], v[24:27]
 v_exp_f32 v165, v165
 v_mfma_f32_16x16x32_bf16 v[28:31], v[180:183], a[252:255], v[28:31]
 v_cvt_pk_bf16_f32 v178, v164, v165
 v_permlane32_swap_b32 v246, v247
 v_mfma_f32_16x16x32_bf16 v[168:171], a[192:195], a[32:35], v[156:159]
 v_min_f32 v246, -v246, -v247
 v_mov_b32 v144, v246
 v_mfma_f32_16x16x32_bf16 v[168:171], a[196:199], a[36:39], v[168:171]
 v_mov_b32 v145, v246
 v_mov_b32 v146, v246
 v_mfma_f32_16x16x32_bf16 v[168:171], a[200:203], a[40:43], v[168:171]
L_pg6:
 s_cbranch_execz L_pg10
 v_mov_b32 v147, v246
 v_cvt_pk_bf16_f32 v243, v122, v126
 v_mfma_f32_16x16x32_bf16 v[168:171], a[204:207], a[44:47], v[168:171]
 buffer_store_dwordx4 v[240:243], v244, s[20:23], s33 offen offset:2048 sc1
 v_mfma_f32_16x16x32_bf16 v[172:175], a[220:223], a[44:47], v[156:159]
 v_add_f32 v252, v252, v246
 v_add_f32 v253, v253, v246
 v_mfma_f32_16x16x32_bf16 v[172:175], a[216:219], a[40:43], v[172:175]
 v_add_f32 v254, v254, v246
 v_add_f32 v255, v255, v246
 v_mfma_f32_16x16x32_bf16 v[172:175], a[212:215], a[36:39], v[172:175]
 v_exp_f32 v170, v170
 v_mfma_f32_16x16x32_bf16 v[172:175], a[208:211], a[32:35], v[172:175]
 v_exp_f32 v168, v168
 v_mfma_f32_16x16x32_bf16 v[32:35], v[176:179], a[224:227], v[32:35]
 v_exp_f32 v169, v169
 v_mfma_f32_16x16x32_bf16 v[36:39], v[176:179], a[228:231], v[36:39]
 v_exp_f32 v171, v171
 v_mfma_f32_16x16x32_bf16 v[40:43], v[176:179], a[232:235], v[40:43]
 v_cvt_pk_bf16_f32 v180, v168, v169
 v_cvt_pk_bf16_f32 v181, v170, v171
 v_mfma_f32_16x16x32_bf16 v[44:47], v[176:179], a[236:239], v[44:47]
 v_exp_f32 v174, v174
 v_mfma_f32_16x16x32_bf16 v[48:51], v[176:179], a[240:243], v[48:51]
 v_exp_f32 v175, v175
 v_mfma_f32_16x16x32_bf16 v[52:55], v[176:179], a[244:247], v[52:55]
 v_cvt_pk_bf16_f32 v183, v174, v175
 v_mul_f32_dpp v99, v219, v99 row_newbcast:3 row_mask:0xf bank_mask:0xf
 v_mfma_f32_16x16x32_bf16 v[56:59], v[176:179], a[248:251], v[56:59]
 v_exp_f32 v172, v172
 v_mfma_f32_16x16x32_bf16 v[60:63], v[176:179], a[252:255], v[60:63]
 v_exp_f32 v173, v173
 v_mfma_f32_16x16x32_bf16 v[164:167], a[92:95], a[60:63], v[144:147]
 v_cvt_pk_bf16_f32 v182, v172, v173
 v_mul_f32_dpp v103, v219, v103 row_newbcast:3 row_mask:0xf bank_mask:0xf
 v_mfma_f32_16x16x32_bf16 v[164:167], a[88:91], a[56:59], v[164:167]
 v_exp_f32 v252, v252
 v_mfma_f32_16x16x32_bf16 v[164:167], a[84:87], a[52:55], v[164:167]
 v_exp_f32 v253, v253
 v_mfma_f32_16x16x32_bf16 v[164:167], a[80:83], a[48:51], v[164:167]
 v_exp_f32 v254, v254
 v_smfmac_f32_16x16x64_bf16 v[132:135], v[236:239], v[176:183], v138
 v_cvt_pk_bf16_f32 v176, v252, v253
 v_mfma_f32_16x16x32_bf16 v[64:67], v[180:183], a[224:227], v[64:67]
 v_exp_f32 v255, v255
 v_mfma_f32_16x16x32_bf16 v[68:71], v[180:183], a[228:231], v[68:71]
 ds_read_b128 a[224:227], v248 offset:0
 v_cvt_pk_bf16_f32 v177, v254, v255
 v_mfma_f32_16x16x32_bf16 v[72:75], v[180:183], a[232:235], v[72:75]
 v_exp_f32 v164, v164
 v_mfma_f32_16x16x32_bf16 v[76:79], v[180:183], a[236:239], v[76:79]
 v_exp_f32 v165, v165
 v_mfma_f32_16x16x32_bf16 v[80:83], v[180:183], a[240:243], v[80:83]
 v_exp_f32 v166, v166
 v_mfma_f32_16x16x32_bf16 v[84:87], v[180:183], a[244:247], v[84:87]
 v_exp_f32 v167, v167
 v_mfma_f32_16x16x32_bf16 v[88:91], v[180:183], a[248:251], v[88:91]
 v_cvt_pk_bf16_f32 v178, v164, v165
 v_cvt_pk_bf16_f32 v179, v166, v167
 v_mfma_f32_16x16x32_bf16 v[92:95], v[180:183], a[252:255], v[92:95]
 ds_read_b128 a[228:231], v248 offset:512
 ds_read_b128 a[232:235], v248 offset:1024
 v_mfma_f32_16x16x32_bf16 v[168:171], a[64:67], a[0:3], v[148:151]
 v_cvt_pk_bf16_f32 v240, v99, v103
 v_mul_f32_dpp v107, v219, v107 row_newbcast:3 row_mask:0xf bank_mask:0xf
 v_mfma_f32_16x16x32_bf16 v[168:171], a[68:71], a[4:7], v[168:171]
 ds_read_b128 a[236:239], v248 offset:1536
 v_mul_f32_dpp v111, v219, v111 row_newbcast:3 row_mask:0xf bank_mask:0xf
 v_mfma_f32_16x16x32_bf16 v[168:171], a[72:75], a[8:11], v[168:171]
 ds_read_b128 a[240:243], v248 offset:2048
 v_cvt_pk_bf16_f32 v241, v107, v111
 v_mfma_f32_16x16x32_bf16 v[168:171], a[76:79], a[12:15], v[168:171]
 ds_read_b128 a[244:247], v248 offset:2560
 v_mul_f32_dpp v115, v219, v115 row_newbcast:3 row_mask:0xf bank_mask:0xf
 v_mul_f32_dpp v119, v219, v119 row_newbcast:3 row_mask:0xf bank_mask:0xf
 v_mfma_f32_16x16x32_bf16 v[172:175], a[92:95], a[12:15], v[148:151]
 ds_read_b128 a[248:251], v248 offset:3072
 v_cvt_pk_bf16_f32 v242, v115, v119
 v_mul_f32_dpp v123, v219, v123 row_newbcast:3 row_mask:0xf bank_mask:0xf
 v_mfma_f32_16x16x32_bf16 v[172:175], a[88:91], a[8:11], v[172:175]
 ds_read_b128 a[252:255], v248 offset:3584
 v_mul_f32_dpp v127, v219, v127 row_newbcast:3 row_mask:0xf bank_mask:0xf
 v_cvt_pk_bf16_f32 v243, v123, v127
 v_mfma_f32_16x16x32_bf16 v[172:175], a[84:87], a[4:7], v[172:175]
 buffer_store_dwordx4 v[240:243], v244, s[20:23], s33 offen offset:3072 sc1
 v_mfma_f32_16x16x32_bf16 v[172:175], a[80:83], a[0:3], v[172:175]
 s_waitcnt lgkmcnt(5)
 v_exp_f32 v168, v168
 v_mfma_f32_16x16x32_bf16 v[96:99], v[176:179], a[224:227], 0
 v_exp_f32 v169, v169
 v_mfma_f32_16x16x32_bf16 v[100:103], v[176:179], a[228:231], 0
 v_exp_f32 v170, v170
 v_mfma_f32_16x16x32_bf16 v[104:107], v[176:179], a[232:235], 0
 s_waitcnt lgkmcnt(2)
 v_exp_f32 v171, v171
 v_mfma_f32_16x16x32_bf16 v[108:111], v[176:179], a[236:239], 0
 v_exp_f32 v172, v172
 v_mfma_f32_16x16x32_bf16 v[112:115], v[176:179], a[240:243], 0
 v_exp_f32 v173, v173
 v_mfma_f32_16x16x32_bf16 v[116:119], v[176:179], a[244:247], 0
 s_waitcnt lgkmcnt(0)
 v_exp_f32 v174, v174
 v_mfma_f32_16x16x32_bf16 v[120:123], v[176:179], a[248:251], 0
 v_exp_f32 v175, v175
 v_mfma_f32_16x16x32_bf16 v[124:127], v[176:179], a[252:255], 0
 v_add_f32 v216, v128, v129
 v_mov_b32 v128, 0
 v_mfma_f32_16x16x32_bf16 v[160:163], a[64:67], a[16:19], v[152:155]
 v_mov_b32 v129, 0
 v_cvt_pk_bf16_f32 v180, v168, v169
 v_mfma_f32_16x16x32_bf16 v[160:163], a[68:71], a[20:23], v[160:163]
 v_cvt_pk_bf16_f32 v181, v170, v171
 v_cvt_pk_bf16_f32 v182, v172, v173
 v_mfma_f32_16x16x32_bf16 v[160:163], a[72:75], a[24:27], v[160:163]
 v_cvt_pk_bf16_f32 v183, v174, v175
 v_cmp_nge_f32 vcc, s28, v216
 v_mfma_f32_16x16x32_bf16 v[160:163], a[76:79], a[28:31], v[160:163]
 s_cmp_lg_u64 vcc, 0
 v_rcp_f32 v216, v216
 v_mfma_f32_16x16x32_bf16 v[164:167], a[92:95], a[28:31], v[152:155]
 s_cselect_b32 s34, 16, 0
 s_or_b32 s29, s29, s34
 v_mov_b32_dpp v216, v216 row_shl:4 row_mask:0x2 bank_mask:0xf
 v_mfma_f32_16x16x32_bf16 v[164:167], a[88:91], a[24:27], v[164:167]
 s_add_u32 s33, s25, 16384
 v_exp_f32 v160, v160
 v_mfma_f32_16x16x32_bf16 v[164:167], a[84:87], a[20:23], v[164:167]
 s_add_u32 s32, s25, 40960
 v_exp_f32 v161, v161
 v_mfma_f32_16x16x32_bf16 v[164:167], a[80:83], a[16:19], v[164:167]
 v_exp_f32 v162, v162
 v_smfmac_f32_16x16x64_bf16 v[128:131], v[236:239], v[176:183], v138
 v_cvt_pk_bf16_f32 v176, v160, v161
 v_mfma_f32_16x16x32_bf16 v[0:3], v[180:183], a[224:227], v[0:3]
 v_exp_f32 v163, v163
 v_mfma_f32_16x16x32_bf16 v[4:7], v[180:183], a[228:231], v[4:7]
 v_cvt_pk_bf16_f32 v177, v162, v163
 v_mov_b32_dpp v216, v216 row_shl:8 row_mask:0x4 bank_mask:0xf
 v_mfma_f32_16x16x32_bf16 v[8:11], v[180:183], a[232:235], v[8:11]
 v_exp_f32 v164, v164
 v_mfma_f32_16x16x32_bf16 v[12:15], v[180:183], a[236:239], v[12:15]
 v_exp_f32 v165, v165
 v_mfma_f32_16x16x32_bf16 v[16:19], v[180:183], a[240:243], v[16:19]
 v_exp_f32 v166, v166
 v_mfma_f32_16x16x32_bf16 v[20:23], v[180:183], a[244:247], v[20:23]
 v_exp_f32 v167, v167
 v_mfma_f32_16x16x32_bf16 v[24:27], v[180:183], a[248:251], v[24:27]
 v_cvt_pk_bf16_f32 v178, v164, v165
 v_cvt_pk_bf16_f32 v179, v166, v167
 v_mfma_f32_16x16x32_bf16 v[28:31], v[180:183], a[252:255], v[28:31]
 ds_read_b128 a[192:195], v249 offset:32768
 v_mov_b32_dpp v216, v216 row_shl:12 row_mask:0x8 bank_mask:0xf
 v_mfma_f32_16x16x32_bf16 v[168:171], a[64:67], a[32:35], v[156:159]
 ds_read_b128 a[196:199], v249 offset:33280
 v_mul_f32_dpp v184, v216, v184 row_newbcast:0 row_mask:0xf bank_mask:0xf
 v_mfma_f32_16x16x32_bf16 v[168:171], a[68:71], a[36:39], v[168:171]
 v_mul_f32_dpp v188, v216, v188 row_newbcast:0 row_mask:0xf bank_mask:0xf
 v_cvt_pk_bf16_f32 v240, v184, v188
 v_mfma_f32_16x16x32_bf16 v[168:171], a[72:75], a[40:43], v[168:171]
 v_mul_f32_dpp v192, v216, v192 row_newbcast:0 row_mask:0xf bank_mask:0xf
 v_mul_f32_dpp v196, v216, v196 row_newbcast:0 row_mask:0xf bank_mask:0xf
 v_mfma_f32_16x16x32_bf16 v[168:171], a[76:79], a[44:47], v[168:171]
 v_cvt_pk_bf16_f32 v241, v192, v196
 v_mul_f32_dpp v200, v216, v200 row_newbcast:0 row_mask:0xf bank_mask:0xf
 v_mfma_f32_16x16x32_bf16 v[172:175], a[92:95], a[44:47], v[156:159]
 v_mul_f32_dpp v204, v216, v204 row_newbcast:0 row_mask:0xf bank_mask:0xf
 v_cvt_pk_bf16_f32 v242, v200, v204
 v_mfma_f32_16x16x32_bf16 v[172:175], a[88:91], a[40:43], v[172:175]
 v_mul_f32_dpp v208, v216, v208 row_newbcast:0 row_mask:0xf bank_mask:0xf
 v_mul_f32_dpp v212, v216, v212 row_newbcast:0 row_mask:0xf bank_mask:0xf
 v_mfma_f32_16x16x32_bf16 v[172:175], a[84:87], a[36:39], v[172:175]
 v_exp_f32 v168, v168
 v_mfma_f32_16x16x32_bf16 v[172:175], a[80:83], a[32:35], v[172:175]
 v_exp_f32 v169, v169
 v_mfma_f32_16x16x32_bf16 v[32:35], v[176:179], a[224:227], v[32:35]
 v_exp_f32 v170, v170
 v_mfma_f32_16x16x32_bf16 v[36:39], v[176:179], a[228:231], v[36:39]
 v_exp_f32 v171, v171
 v_mfma_f32_16x16x32_bf16 v[40:43], v[176:179], a[232:235], v[40:43]
 v_cvt_pk_bf16_f32 v180, v168, v169
 v_cvt_pk_bf16_f32 v181, v170, v171
 v_mfma_f32_16x16x32_bf16 v[44:47], v[176:179], a[236:239], v[44:47]
 v_exp_f32 v172, v172
 v_mfma_f32_16x16x32_bf16 v[48:51], v[176:179], a[240:243], v[48:51]
 v_exp_f32 v173, v173
 v_mfma_f32_16x16x32_bf16 v[52:55], v[176:179], a[244:247], v[52:55]
 v_exp_f32 v174, v174
 v_mfma_f32_16x16x32_bf16 v[56:59], v[176:179], a[248:251], v[56:59]
 v_exp_f32 v175, v175
 v_mfma_f32_16x16x32_bf16 v[60:63], v[176:179], a[252:255], v[60:63]
 v_cvt_pk_bf16_f32 v182, v172, v173
 v_cvt_pk_bf16_f32 v183, v174, v175
 v_mfma_f32_16x16x32_bf16 v[160:163], a[96:99], a[48:51], v[144:147]
 v_cvt_pk_bf16_f32 v243, v208, v212
 v_mul_f32_dpp v185, v216, v185 row_newbcast:1 row_mask:0xf bank_mask:0xf
 v_mfma_f32_16x16x32_bf16 v[160:163], a[100:103], a[52:55], v[160:163]
 buffer_store_dwordx4 v[240:243], v244, s[20:23], s33 offen offset:0 sc1
 v_mfma_f32_16x16x32_bf16 v[160:163], a[104:107], a[56:59], v[160:163]
 v_mul_f32_dpp v189, v216, v189 row_newbcast:1 row_mask:0xf bank_mask:0xf
 v_cvt_pk_bf16_f32 v240, v185, v189
 v_mfma_f32_16x16x32_bf16 v[160:163], a[108:111], a[60:63], v[160:163]
 v_mul_f32_dpp v193, v216, v193 row_newbcast:1 row_mask:0xf bank_mask:0xf
 v_mul_f32_dpp v197, v216, v197 row_newbcast:1 row_mask:0xf bank_mask:0xf
 v_mfma_f32_16x16x32_bf16 v[164:167], a[124:127], a[60:63], v[144:147]
 v_cvt_pk_bf16_f32 v241, v193, v197
 v_mul_f32_dpp v201, v216, v201 row_newbcast:1 row_mask:0xf bank_mask:0xf
 v_mfma_f32_16x16x32_bf16 v[164:167], a[120:123], a[56:59], v[164:167]
 v_mul_f32_dpp v205, v216, v205 row_newbcast:1 row_mask:0xf bank_mask:0xf
 v_cvt_pk_bf16_f32 v242, v201, v205
 v_mfma_f32_16x16x32_bf16 v[164:167], a[116:119], a[52:55], v[164:167]
 v_exp_f32 v160, v160
 v_mfma_f32_16x16x32_bf16 v[164:167], a[112:115], a[48:51], v[164:167]
 v_exp_f32 v161, v161
 v_smfmac_f32_16x16x64_bf16 v[132:135], v[236:239], v[176:183], v138
 v_cvt_pk_bf16_f32 v176, v160, v161
 v_mfma_f32_16x16x32_bf16 v[64:67], v[180:183], a[224:227], v[64:67]
 ds_read_b128 a[224:227], v248 offset:8192
 v_mul_f32_dpp v209, v216, v209 row_newbcast:1 row_mask:0xf bank_mask:0xf
 v_mfma_f32_16x16x32_bf16 v[68:71], v[180:183], a[228:231], v[68:71]
 ds_read_b128 a[228:231], v248 offset:8704
 v_mul_f32_dpp v213, v216, v213 row_newbcast:1 row_mask:0xf bank_mask:0xf
 v_mfma_f32_16x16x32_bf16 v[72:75], v[180:183], a[232:235], v[72:75]
 ds_read_b128 a[232:235], v248 offset:9216
 v_cvt_pk_bf16_f32 v243, v209, v213
 v_mfma_f32_16x16x32_bf16 v[76:79], v[180:183], a[236:239], v[76:79]
 buffer_store_dwordx4 v[240:243], v244, s[20:23], s33 offen offset:1024 sc1
 v_mfma_f32_16x16x32_bf16 v[80:83], v[180:183], a[240:243], v[80:83]
 v_exp_f32 v162, v162
 v_mfma_f32_16x16x32_bf16 v[84:87], v[180:183], a[244:247], v[84:87]
 v_exp_f32 v163, v163
 v_mfma_f32_16x16x32_bf16 v[88:91], v[180:183], a[248:251], v[88:91]
 v_exp_f32 v164, v164
 v_mfma_f32_16x16x32_bf16 v[92:95], v[180:183], a[252:255], v[92:95]
 v_exp_f32 v165, v165
 v_mfma_f32_16x16x32_bf16 v[168:171], a[96:99], a[0:3], v[148:151]
 v_exp_f32 v166, v166
 v_mfma_f32_16x16x32_bf16 v[168:171], a[100:103], a[4:7], v[168:171]
 ds_read_b128 a[236:239], v248 offset:9728
 ds_read_b128 a[240:243], v248 offset:10240
 v_mfma_f32_16x16x32_bf16 v[168:171], a[104:107], a[8:11], v[168:171]
 v_exp_f32 v167, v167
 v_mfma_f32_16x16x32_bf16 v[168:171], a[108:111], a[12:15], v[168:171]
 ds_read_b128 a[244:247], v248 offset:10752
 ds_read_b128 a[248:251], v248 offset:11264
 v_mfma_f32_16x16x32_bf16 v[172:175], a[124:127], a[12:15], v[148:151]
 v_cvt_pk_bf16_f32 v177, v162, v163
 v_cvt_pk_bf16_f32 v178, v164, v165
 v_mfma_f32_16x16x32_bf16 v[172:175], a[120:123], a[8:11], v[172:175]
 ds_read_b128 a[252:255], v248 offset:11776
 v_cvt_pk_bf16_f32 v179, v166, v167
 v_mfma_f32_16x16x32_bf16 v[172:175], a[116:119], a[4:7], v[172:175]
 v_exp_f32 v168, v168
 v_mfma_f32_16x16x32_bf16 v[172:175], a[112:115], a[0:3], v[172:175]
 s_waitcnt lgkmcnt(5)
 v_exp_f32 v169, v169
 v_mfma_f32_16x16x32_bf16 v[96:99], v[176:179], a[224:227], v[96:99]
 v_exp_f32 v170, v170
 v_mfma_f32_16x16x32_bf16 v[100:103], v[176:179], a[228:231], v[100:103]
 v_exp_f32 v171, v171
 v_mfma_f32_16x16x32_bf16 v[104:107], v[176:179], a[232:235], v[104:107]
 s_waitcnt lgkmcnt(1)
 v_cvt_pk_bf16_f32 v180, v168, v169
 v_cvt_pk_bf16_f32 v181, v170, v171
 v_mfma_f32_16x16x32_bf16 v[108:111], v[176:179], a[236:239], v[108:111]
 v_exp_f32 v172, v172
 v_mfma_f32_16x16x32_bf16 v[112:115], v[176:179], a[240:243], v[112:115]
 v_exp_f32 v173, v173
 v_mfma_f32_16x16x32_bf16 v[116:119], v[176:179], a[244:247], v[116:119]
 v_exp_f32 v174, v174
 v_mfma_f32_16x16x32_bf16 v[120:123], v[176:179], a[248:251], v[120:123]
 s_waitcnt lgkmcnt(0)
 v_exp_f32 v175, v175
 v_mfma_f32_16x16x32_bf16 v[124:127], v[176:179], a[252:255], v[124:127]
 v_cvt_pk_bf16_f32 v182, v172, v173
 v_cvt_pk_bf16_f32 v183, v174, v175
 v_mfma_f32_16x16x32_bf16 v[160:163], a[96:99], a[16:19], v[152:155]
 v_mul_f32_dpp v186, v216, v186 row_newbcast:2 row_mask:0xf bank_mask:0xf
 v_mul_f32_dpp v190, v216, v190 row_newbcast:2 row_mask:0xf bank_mask:0xf
 v_mfma_f32_16x16x32_bf16 v[160:163], a[100:103], a[20:23], v[160:163]
 v_cvt_pk_bf16_f32 v240, v186, v190
 v_mul_f32_dpp v194, v216, v194 row_newbcast:2 row_mask:0xf bank_mask:0xf
 v_mfma_f32_16x16x32_bf16 v[160:163], a[104:107], a[24:27], v[160:163]
 v_mul_f32_dpp v198, v216, v198 row_newbcast:2 row_mask:0xf bank_mask:0xf
 v_cvt_pk_bf16_f32 v241, v194, v198
 v_mfma_f32_16x16x32_bf16 v[160:163], a[108:111], a[28:31], v[160:163]
 v_mul_f32_dpp v202, v216, v202 row_newbcast:2 row_mask:0xf bank_mask:0xf
 v_mul_f32_dpp v206, v216, v206 row_newbcast:2 row_mask:0xf bank_mask:0xf
 v_mfma_f32_16x16x32_bf16 v[164:167], a[124:127], a[28:31], v[152:155]
 v_cvt_pk_bf16_f32 v242, v202, v206
 v_mul_f32_dpp v210, v216, v210 row_newbcast:2 row_mask:0xf bank_mask:0xf
 v_mfma_f32_16x16x32_bf16 v[164:167], a[120:123], a[24:27], v[164:167]
 v_mul_f32_dpp v214, v216, v214 row_newbcast:2 row_mask:0xf bank_mask:0xf
 v_cvt_pk_bf16_f32 v243, v210, v214
 v_mfma_f32_16x16x32_bf16 v[164:167], a[116:119], a[20:23], v[164:167]
 v_exp_f32 v160, v160
 v_mfma_f32_16x16x32_bf16 v[164:167], a[112:115], a[16:19], v[164:167]
 v_exp_f32 v161, v161
 v_smfmac_f32_16x16x64_bf16 v[128:131], v[236:239], v[176:183], v138
 v_cvt_pk_bf16_f32 v176, v160, v161
 v_mfma_f32_16x16x32_bf16 v[0:3], v[180:183], a[224:227], v[0:3]
 buffer_store_dwordx4 v[240:243], v244, s[20:23], s33 offen offset:2048 sc1
 v_mfma_f32_16x16x32_bf16 v[4:7], v[180:183], a[228:231], v[4:7]
 v_exp_f32 v162, v162
 v_mfma_f32_16x16x32_bf16 v[8:11], v[180:183], a[232:235], v[8:11]
 v_exp_f32 v163, v163
 v_mfma_f32_16x16x32_bf16 v[12:15], v[180:183], a[236:239], v[12:15]
 v_exp_f32 v164, v164
 v_mfma_f32_16x16x32_bf16 v[16:19], v[180:183], a[240:243], v[16:19]
 v_exp_f32 v165, v165
 v_mfma_f32_16x16x32_bf16 v[20:23], v[180:183], a[244:247], v[20:23]
 v_exp_f32 v166, v166
 v_mfma_f32_16x16x32_bf16 v[24:27], v[180:183], a[248:251], v[24:27]
 v_exp_f32 v167, v167
 v_mfma_f32_16x16x32_bf16 v[28:31], v[180:183], a[252:255], v[28:31]
 v_cvt_pk_bf16_f32 v177, v162, v163
 v_cvt_pk_bf16_f32 v178, v164, v165
 v_mfma_f32_16x16x32_bf16 v[168:171], a[96:99], a[32:35], v[156:159]
 v_cvt_pk_bf16_f32 v179, v166, v167
 v_mul_f32_dpp v187, v216, v187 row_newbcast:3 row_mask:0xf bank_mask:0xf
 v_mfma_f32_16x16x32_bf16 v[168:171], a[100:103], a[36:39], v[168:171]
 v_mul_f32_dpp v191, v216, v191 row_newbcast:3 row_mask:0xf bank_mask:0xf
 v_cvt_pk_bf16_f32 v240, v187, v191
 v_mfma_f32_16x16x32_bf16 v[168:171], a[104:107], a[40:43], v[168:171]
 v_mul_f32_dpp v195, v216, v195 row_newbcast:3 row_mask:0xf bank_mask:0xf
 v_mul_f32_dpp v199, v216, v199 row_newbcast:3 row_mask:0xf bank_mask:0xf
 v_mfma_f32_16x16x32_bf16 v[168:171], a[108:111], a[44:47], v[168:171]
 v_cvt_pk_bf16_f32 v241, v195, v199
 v_mul_f32_dpp v203, v216, v203 row_newbcast:3 row_mask:0xf bank_mask:0xf
 v_mfma_f32_16x16x32_bf16 v[172:175], a[124:127], a[44:47], v[156:159]
 v_mul_f32_dpp v207, v216, v207 row_newbcast:3 row_mask:0xf bank_mask:0xf
 v_cvt_pk_bf16_f32 v242, v203, v207
 v_mfma_f32_16x16x32_bf16 v[172:175], a[120:123], a[40:43], v[172:175]
 v_mul_f32_dpp v211, v216, v211 row_newbcast:3 row_mask:0xf bank_mask:0xf
 v_mul_f32_dpp v215, v216, v215 row_newbcast:3 row_mask:0xf bank_mask:0xf
 v_mfma_f32_16x16x32_bf16 v[172:175], a[116:119], a[36:39], v[172:175]
 v_exp_f32 v168, v168
 v_mfma_f32_16x16x32_bf16 v[172:175], a[112:115], a[32:35], v[172:175]
 v_exp_f32 v169, v169
 v_mfma_f32_16x16x32_bf16 v[32:35], v[176:179], a[224:227], v[32:35]
 v_exp_f32 v170, v170
 v_mfma_f32_16x16x32_bf16 v[36:39], v[176:179], a[228:231], v[36:39]
 v_exp_f32 v171, v171
 v_mfma_f32_16x16x32_bf16 v[40:43], v[176:179], a[232:235], v[40:43]
 v_cvt_pk_bf16_f32 v180, v168, v169
 v_cvt_pk_bf16_f32 v181, v170, v171
 v_mfma_f32_16x16x32_bf16 v[44:47], v[176:179], a[236:239], v[44:47]
 v_exp_f32 v172, v172
 v_mfma_f32_16x16x32_bf16 v[48:51], v[176:179], a[240:243], v[48:51]
 v_exp_f32 v173, v173
 v_mfma_f32_16x16x32_bf16 v[52:55], v[176:179], a[244:247], v[52:55]
 v_exp_f32 v174, v174
 v_mfma_f32_16x16x32_bf16 v[56:59], v[176:179], a[248:251], v[56:59]
 v_exp_f32 v175, v175
 v_mfma_f32_16x16x32_bf16 v[60:63], v[176:179], a[252:255], v[60:63]
 v_cvt_pk_bf16_f32 v182, v172, v173
 v_cvt_pk_bf16_f32 v183, v174, v175
 v_mfma_f32_16x16x32_bf16 v[160:163], a[128:131], a[48:51], v[144:147]
 ds_read_b128 a[200:203], v249 offset:33792
 v_cvt_pk_bf16_f32 v243, v211, v215
 v_mfma_f32_16x16x32_bf16 v[160:163], a[132:135], a[52:55], v[160:163]
 buffer_store_dwordx4 v[240:243], v244, s[20:23], s33 offen offset:3072 sc1
 v_mfma_f32_16x16x32_bf16 v[160:163], a[136:139], a[56:59], v[160:163]
 ds_read_b128 a[204:207], v249 offset:34304
 ds_read_b128 a[216:219], v249 offset:35840
 v_mfma_f32_16x16x32_bf16 v[160:163], a[140:143], a[60:63], v[160:163]
 ds_read_b128 a[220:223], v249 offset:36352
 ds_read_b128 a[208:211], v249 offset:34816
 v_mfma_f32_16x16x32_bf16 v[164:167], a[156:159], a[60:63], v[144:147]
 ds_read_b128 a[212:215], v249 offset:35328
 s_nop 0
 v_mfma_f32_16x16x32_bf16 v[164:167], a[152:155], a[56:59], v[164:167]
 s_nop 1
 v_mfma_f32_16x16x32_bf16 v[164:167], a[148:151], a[52:55], v[164:167]
 v_exp_f32 v160, v160
 v_mfma_f32_16x16x32_bf16 v[164:167], a[144:147], a[48:51], v[164:167]
 v_exp_f32 v161, v161
 v_smfmac_f32_16x16x64_bf16 v[132:135], v[236:239], v[176:183], v138
 v_cvt_pk_bf16_f32 v176, v160, v161
 v_mfma_f32_16x16x32_bf16 v[64:67], v[180:183], a[224:227], v[64:67]
 v_exp_f32 v162, v162
 v_mfma_f32_16x16x32_bf16 v[68:71], v[180:183], a[228:231], v[68:71]
 ds_read_b128 a[224:227], v248 offset:16384
 ds_read_b128 a[228:231], v248 offset:16896
 v_mfma_f32_16x16x32_bf16 v[72:75], v[180:183], a[232:235], v[72:75]
 v_exp_f32 v163, v163
 v_mfma_f32_16x16x32_bf16 v[76:79], v[180:183], a[236:239], v[76:79]
 ds_read_b128 a[232:235], v248 offset:17408
 ds_read_b128 a[236:239], v248 offset:17920
 v_mfma_f32_16x16x32_bf16 v[80:83], v[180:183], a[240:243], v[80:83]
 v_exp_f32 v164, v164
 v_mfma_f32_16x16x32_bf16 v[84:87], v[180:183], a[244:247], v[84:87]
 v_exp_f32 v165, v165
 v_mfma_f32_16x16x32_bf16 v[88:91], v[180:183], a[248:251], v[88:91]
 v_exp_f32 v166, v166
 v_mfma_f32_16x16x32_bf16 v[92:95], v[180:183], a[252:255], v[92:95]
 v_exp_f32 v167, v167
 v_mfma_f32_16x16x32_bf16 v[168:171], a[128:131], a[0:3], v[148:151]
 ds_read_b128 a[240:243], v248 offset:18432
 ds_read_b128 a[244:247], v248 offset:18944
 v_mfma_f32_16x16x32_bf16 v[168:171], a[132:135], a[4:7], v[168:171]
 ds_read_b128 a[248:251], v248 offset:19456
 v_cvt_pk_bf16_f32 v177, v162, v163
 v_mfma_f32_16x16x32_bf16 v[168:171], a[136:139], a[8:11], v[168:171]
 v_cvt_pk_bf16_f32 v178, v164, v165
 v_cvt_pk_bf16_f32 v179, v166, v167
 v_mfma_f32_16x16x32_bf16 v[168:171], a[140:143], a[12:15], v[168:171]
 ds_read_b128 a[252:255], v248 offset:19968
 s_nop 0
 v_mfma_f32_16x16x32_bf16 v[172:175], a[156:159], a[12:15], v[148:151]
 buffer_load_dwordx4 a[12:15], v245, s[8:11], s32 offen offset:192
 v_mfma_f32_16x16x32_bf16 v[172:175], a[152:155], a[8:11], v[172:175]
 s_nop 1
 v_mfma_f32_16x16x32_bf16 v[172:175], a[148:151], a[4:7], v[172:175]
 v_exp_f32 v168, v168
 v_mfma_f32_16x16x32_bf16 v[172:175], a[144:147], a[0:3], v[172:175]
 s_waitcnt lgkmcnt(2)
 v_exp_f32 v169, v169
 v_mfma_f32_16x16x32_bf16 v[96:99], v[176:179], a[224:227], v[96:99]
 buffer_load_dwordx4 a[0:3], v245, s[8:11], s32 offen offset:0
 v_mfma_f32_16x16x32_bf16 v[100:103], v[176:179], a[228:231], v[100:103]
 v_exp_f32 v170, v170
 v_mfma_f32_16x16x32_bf16 v[104:107], v[176:179], a[232:235], v[104:107]
 v_exp_f32 v171, v171
 v_mfma_f32_16x16x32_bf16 v[108:111], v[176:179], a[236:239], v[108:111]
 v_exp_f32 v172, v172
 v_mfma_f32_16x16x32_bf16 v[112:115], v[176:179], a[240:243], v[112:115]
 buffer_load_dwordx4 a[4:7], v245, s[8:11], s32 offen offset:64
 v_mfma_f32_16x16x32_bf16 v[116:119], v[176:179], a[244:247], v[116:119]
 s_waitcnt lgkmcnt(0)
 v_exp_f32 v173, v173
 v_mfma_f32_16x16x32_bf16 v[120:123], v[176:179], a[248:251], v[120:123]
 v_exp_f32 v174, v174
 v_mfma_f32_16x16x32_bf16 v[124:127], v[176:179], a[252:255], v[124:127]
 v_exp_f32 v175, v175
 v_mfma_f32_16x16x32_bf16 v[160:163], a[128:131], a[16:19], v[152:155]
 buffer_load_dwordx4 a[8:11], v245, s[8:11], s32 offen offset:128
 v_mfma_f32_16x16x32_bf16 v[160:163], a[132:135], a[20:23], v[160:163]
 v_cvt_pk_bf16_f32 v180, v168, v169
 v_cvt_pk_bf16_f32 v181, v170, v171
 v_mfma_f32_16x16x32_bf16 v[160:163], a[136:139], a[24:27], v[160:163]
 v_cvt_pk_bf16_f32 v182, v172, v173
 v_cvt_pk_bf16_f32 v183, v174, v175
 v_mfma_f32_16x16x32_bf16 v[160:163], a[140:143], a[28:31], v[160:163]
 s_nop 1
 v_mfma_f32_16x16x32_bf16 v[164:167], a[156:159], a[28:31], v[152:155]
 s_nop 1
 v_mfma_f32_16x16x32_bf16 v[164:167], a[152:155], a[24:27], v[164:167]
 s_nop 1
 v_mfma_f32_16x16x32_bf16 v[164:167], a[148:151], a[20:23], v[164:167]
 v_exp_f32 v160, v160
 v_mfma_f32_16x16x32_bf16 v[164:167], a[144:147], a[16:19], v[164:167]
 v_exp_f32 v161, v161
 v_smfmac_f32_16x16x64_bf16 v[128:131], v[236:239], v[176:183], v138
 v_cvt_pk_bf16_f32 v176, v160, v161
 v_mfma_f32_16x16x32_bf16 v[0:3], v[180:183], a[224:227], v[0:3]
 v_exp_f32 v162, v162
 v_mfma_f32_16x16x32_bf16 v[4:7], v[180:183], a[228:231], v[4:7]
 v_exp_f32 v163, v163
 v_mfma_f32_16x16x32_bf16 v[8:11], v[180:183], a[232:235], v[8:11]
 v_exp_f32 v164, v164
 v_mfma_f32_16x16x32_bf16 v[12:15], v[180:183], a[236:239], v[12:15]
 v_exp_f32 v165, v165
 v_mfma_f32_16x16x32_bf16 v[16:19], v[180:183], a[240:243], v[16:19]
 v_exp_f32 v166, v166
 v_mfma_f32_16x16x32_bf16 v[20:23], v[180:183], a[244:247], v[20:23]
 v_exp_f32 v167, v167
 v_mfma_f32_16x16x32_bf16 v[24:27], v[180:183], a[248:251], v[24:27]
 v_cvt_pk_bf16_f32 v177, v162, v163
 v_cvt_pk_bf16_f32 v178, v164, v165
 v_mfma_f32_16x16x32_bf16 v[28:31], v[180:183], a[252:255], v[28:31]
 s_waitcnt vmcnt(11)
 v_cvt_pk_bf16_f32 v179, v166, v167
 v_add_f32 v217, v130, v131
 v_mfma_f32_16x16x32_bf16 v[252:255], a[160:163], v[220:223], 0
 v_mov_b32 v130, 0
 v_mov_b32 v131, 0
 v_mfma_f32_16x16x32_bf16 v[252:255], a[164:167], v[224:227], v[252:255]
 v_cmp_nge_f32 vcc, s28, v217
 s_nop 0
 v_mfma_f32_16x16x32_bf16 v[252:255], a[168:171], v[228:231], v[252:255]
 s_cmp_lg_u64 vcc, 0
 v_rcp_f32 v217, v217
 v_mfma_f32_16x16x32_bf16 v[252:255], a[172:175], v[232:235], v[252:255]
 s_cselect_b32 s34, 32, 0
 s_or_b32 s29, s29, s34
 v_mov_b32_dpp v217, v217 row_shl:4 row_mask:0x2 bank_mask:0xf
 v_mfma_f32_16x16x32_bf16 v[168:171], a[128:131], a[32:35], v[156:159]
 s_add_u32 s33, s25, 20480
 s_add_u32 s32, s25, 45056
 v_mov_b32_dpp v217, v217 row_shl:8 row_mask:0x4 bank_mask:0xf
 v_mfma_f32_16x16x32_bf16 v[168:171], a[132:135], a[36:39], v[168:171]
 v_max3_f32 v246, v252, v253, v254
 v_max_f32 v246, v246, v255
 v_mfma_f32_16x16x32_bf16 v[168:171], a[136:139], a[40:43], v[168:171]
 v_mov_b32 v247, v246
 v_mov_b32_dpp v217, v217 row_shl:12 row_mask:0x8 bank_mask:0xf
 v_mfma_f32_16x16x32_bf16 v[168:171], a[140:143], a[44:47], v[168:171]
 v_permlane16_swap_b32 v246, v247
 v_max_f32 v246, v246, v247
 v_mfma_f32_16x16x32_bf16 v[172:175], a[156:159], a[44:47], v[156:159]
 v_mov_b32 v247, v246
 v_mul_f32_dpp v0, v217, v0 row_newbcast:0 row_mask:0xf bank_mask:0xf
 v_mfma_f32_16x16x32_bf16 v[172:175], a[152:155], a[40:43], v[172:175]
 v_permlane32_swap_b32 v246, v247
 v_min_f32 v246, -v246, -v247
 v_mfma_f32_16x16x32_bf16 v[172:175], a[148:151], a[36:39], v[172:175]
 v_exp_f32 v171, v171
 v_mfma_f32_16x16x32_bf16 v[172:175], a[144:147], a[32:35], v[172:175]
 v_exp_f32 v168, v168
 v_mfma_f32_16x16x32_bf16 v[32:35], v[176:179], a[224:227], v[32:35]
 v_exp_f32 v169, v169
 v_mfma_f32_16x16x32_bf16 v[36:39], v[176:179], a[228:231], v[36:39]
 v_exp_f32 v170, v170
 v_mfma_f32_16x16x32_bf16 v[40:43], v[176:179], a[232:235], v[40:43]
 v_cvt_pk_bf16_f32 v180, v168, v169
 v_cvt_pk_bf16_f32 v181, v170, v171
 v_mfma_f32_16x16x32_bf16 v[44:47], v[176:179], a[236:239], v[44:47]
 v_exp_f32 v172, v172
 v_mfma_f32_16x16x32_bf16 v[48:51], v[176:179], a[240:243], v[48:51]
 v_exp_f32 v173, v173
 v_mfma_f32_16x16x32_bf16 v[52:55], v[176:179], a[244:247], v[52:55]
 v_cvt_pk_bf16_f32 v182, v172, v173
 v_mov_b32 v148, v246
 v_mfma_f32_16x16x32_bf16 v[56:59], v[176:179], a[248:251], v[56:59]
 v_exp_f32 v174, v174
 v_mfma_f32_16x16x32_bf16 v[60:63], v[176:179], a[252:255], v[60:63]
 v_exp_f32 v175, v175
 v_mfma_f32_16x16x32_bf16 v[160:163], a[160:163], a[48:51], v[144:147]
 v_cvt_pk_bf16_f32 v183, v174, v175
 v_mov_b32 v149, v246
 v_mfma_f32_16x16x32_bf16 v[160:163], a[164:167], a[52:55], v[160:163]
 v_mov_b32 v150, v246
 v_mov_b32 v151, v246
 v_mfma_f32_16x16x32_bf16 v[160:163], a[168:171], a[56:59], v[160:163]
 v_add_f32 v252, v252, v246
 v_add_f32 v253, v253, v246
 v_mfma_f32_16x16x32_bf16 v[160:163], a[172:175], a[60:63], v[160:163]
 v_add_f32 v254, v254, v246
 v_add_f32 v255, v255, v246
 v_mfma_f32_16x16x32_bf16 v[164:167], a[188:191], a[60:63], v[144:147]
 v_exp_f32 v252, v252
 v_mfma_f32_16x16x32_bf16 v[164:167], a[184:187], a[56:59], v[164:167]
 v_exp_f32 v253, v253
 v_mfma_f32_16x16x32_bf16 v[164:167], a[180:183], a[52:55], v[164:167]
 v_exp_f32 v254, v254
 v_mfma_f32_16x16x32_bf16 v[164:167], a[176:179], a[48:51], v[164:167]
 v_exp_f32 v161, v161
 v_smfmac_f32_16x16x64_bf16 v[132:135], v[236:239], v[176:183], v138
 v_mul_f32_dpp v4, v217, v4 row_newbcast:0 row_mask:0xf bank_mask:0xf
 v_mfma_f32_16x16x32_bf16 v[64:67], v[180:183], a[224:227], v[64:67]
 v_exp_f32 v162, v162
 v_mfma_f32_16x16x32_bf16 v[68:71], v[180:183], a[228:231], v[68:71]
 v_exp_f32 v163, v163
 v_mfma_f32_16x16x32_bf16 v[72:75], v[180:183], a[232:235], v[72:75]
 ds_read_b128 a[224:227], v248 offset:24576
 v_exp_f32 v160, v160
 v_mfma_f32_16x16x32_bf16 v[76:79], v[180:183], a[236:239], v[76:79]
 ds_read_b128 a[228:231], v248 offset:25088
 v_cvt_pk_bf16_f32 v176, v160, v161
 v_cvt_pk_bf16_f32 v177, v162, v163
 v_mfma_f32_16x16x32_bf16 v[80:83], v[180:183], a[240:243], v[80:83]
 ds_read_b128 a[232:235], v248 offset:25600
 ds_read_b128 a[236:239], v248 offset:26112
 v_mfma_f32_16x16x32_bf16 v[84:87], v[180:183], a[244:247], v[84:87]
 ds_read_b128 a[240:243], v248 offset:26624
 ds_read_b128 a[244:247], v248 offset:27136
 v_mfma_f32_16x16x32_bf16 v[88:91], v[180:183], a[248:251], v[88:91]
 v_exp_f32 v164, v164
 v_mfma_f32_16x16x32_bf16 v[92:95], v[180:183], a[252:255], v[92:95]
 v_exp_f32 v165, v165
 v_mfma_f32_16x16x32_bf16 v[172:175], a[188:191], v[232:235], v[148:151]
 ds_read_b128 a[248:251], v248 offset:27648
 v_exp_f32 v166, v166
 v_exp_f32 v167, v167
 v_mfma_f32_16x16x32_bf16 v[172:175], a[184:187], v[228:231], v[172:175]
 ds_read_b128 a[252:255], v248 offset:28160
 v_cvt_pk_bf16_f32 v178, v164, v165
 v_cvt_pk_bf16_f32 v179, v166, v167
 v_mfma_f32_16x16x32_bf16 v[172:175], a[180:183], v[224:227], v[172:175]
 v_exp_f32 v255, v255
 v_mfma_f32_16x16x32_bf16 v[172:175], a[176:179], v[220:223], v[172:175]
 s_waitcnt lgkmcnt(4)
 v_cvt_pk_bf16_f32 v180, v252, v253
 v_cvt_pk_bf16_f32 v181, v254, v255
 v_mfma_f32_16x16x32_bf16 v[96:99], v[176:179], a[224:227], v[96:99]
 v_cvt_pk_bf16_f32 v240, v0, v4
 v_mul_f32_dpp v8, v217, v8 row_newbcast:0 row_mask:0xf bank_mask:0xf
 v_mfma_f32_16x16x32_bf16 v[100:103], v[176:179], a[228:231], v[100:103]
 v_mul_f32_dpp v12, v217, v12 row_newbcast:0 row_mask:0xf bank_mask:0xf
 v_cvt_pk_bf16_f32 v241, v8, v12
 v_mfma_f32_16x16x32_bf16 v[104:107], v[176:179], a[232:235], v[104:107]
 v_exp_f32 v172, v172
 v_mfma_f32_16x16x32_bf16 v[108:111], v[176:179], a[236:239], v[108:111]
 s_waitcnt lgkmcnt(1)
 v_exp_f32 v173, v173
 v_mfma_f32_16x16x32_bf16 v[112:115], v[176:179], a[240:243], v[112:115]
 v_exp_f32 v174, v174
 v_mfma_f32_16x16x32_bf16 v[116:119], v[176:179], a[244:247], v[116:119]
L_pg7:
 s_cbranch_execz L_pg11
 v_exp_f32 v175, v175
 v_mfma_f32_16x16x32_bf16 v[120:123], v[176:179], a[248:251], v[120:123]
 s_waitcnt lgkmcnt(0)
 v_cvt_pk_bf16_f32 v182, v172, v173
 v_cvt_pk_bf16_f32 v183, v174, v175
 v_mfma_f32_16x16x32_bf16 v[124:127], v[176:179], a[252:255], v[124:127]
 v_mul_f32_dpp v16, v217, v16 row_newbcast:0 row_mask:0xf bank_mask:0xf
 v_mul_f32_dpp v20, v217, v20 row_newbcast:0 row_mask:0xf bank_mask:0xf
 v_mfma_f32_16x16x32_bf16 v[160:163], a[160:163], a[16:19], v[152:155]
 v_cvt_pk_bf16_f32 v242, v16, v20
 v_mul_f32_dpp v24, v217, v24 row_newbcast:0 row_mask:0xf bank_mask:0xf
 v_mfma_f32_16x16x32_bf16 v[160:163], a[164:167], a[20:23], v[160:163]
 v_mul_f32_dpp v28, v217, v28 row_newbcast:0 row_mask:0xf bank_mask:0xf
 v_cvt_pk_bf16_f32 v243, v24, v28
 v_mfma_f32_16x16x32_bf16 v[160:163], a[168:171], a[24:27], v[160:163]
 buffer_store_dwordx4 v[240:243], v244, s[20:23], s33 offen offset:0 sc1
 v_mfma_f32_16x16x32_bf16 v[160:163], a[172:175], a[28:31], v[160:163]
 v_mul_f32_dpp v1, v217, v1 row_newbcast:1 row_mask:0xf bank_mask:0xf
 v_mul_f32_dpp v5, v217, v5 row_newbcast:1 row_mask:0xf bank_mask:0xf
 v_mfma_f32_16x16x32_bf16 v[164:167], a[188:191], a[28:31], v[152:155]
 v_cvt_pk_bf16_f32 v240, v1, v5
 v_mul_f32_dpp v9, v217, v9 row_newbcast:1 row_mask:0xf bank_mask:0xf
 v_mfma_f32_16x16x32_bf16 v[164:167], a[184:187], a[24:27], v[164:167]
 v_mul_f32_dpp v13, v217, v13 row_newbcast:1 row_mask:0xf bank_mask:0xf
 v_cvt_pk_bf16_f32 v241, v9, v13
 v_mfma_f32_16x16x32_bf16 v[164:167], a[180:183], a[20:23], v[164:167]
 v_exp_f32 v160, v160
 v_mfma_f32_16x16x32_bf16 v[164:167], a[176:179], a[16:19], v[164:167]
 v_exp_f32 v161, v161
 v_smfmac_f32_16x16x64_bf16 v[128:131], v[236:239], v[176:183], v138
 v_cvt_pk_bf16_f32 v176, v160, v161
 v_mfma_f32_16x16x32_bf16 v[184:187], v[180:183], a[224:227], 0
 v_exp_f32 v162, v162
 v_mfma_f32_16x16x32_bf16 v[188:191], v[180:183], a[228:231], 0
 v_exp_f32 v163, v163
 v_mfma_f32_16x16x32_bf16 v[192:195], v[180:183], a[232:235], 0
 v_exp_f32 v164, v164
 v_mfma_f32_16x16x32_bf16 v[196:199], v[180:183], a[236:239], 0
 v_exp_f32 v165, v165
 v_mfma_f32_16x16x32_bf16 v[200:203], v[180:183], a[240:243], 0
 v_exp_f32 v166, v166
 v_mfma_f32_16x16x32_bf16 v[204:207], v[180:183], a[244:247], 0
 v_exp_f32 v167, v167
 v_mfma_f32_16x16x32_bf16 v[208:211], v[180:183], a[248:251], 0
 v_cvt_pk_bf16_f32 v177, v162, v163
 v_cvt_pk_bf16_f32 v178, v164, v165
 v_mfma_f32_16x16x32_bf16 v[212:215], v[180:183], a[252:255], 0
 v_cvt_pk_bf16_f32 v179, v166, v167
 v_mul_f32_dpp v17, v217, v17 row_newbcast:1 row_mask:0xf bank_mask:0xf
 v_mfma_f32_16x16x32_bf16 v[168:171], a[160:163], a[32:35], v[156:159]
 v_mul_f32_dpp v21, v217, v21 row_newbcast:1 row_mask:0xf bank_mask:0xf
 v_cvt_pk_bf16_f32 v242, v17, v21
 v_mfma_f32_16x16x32_bf16 v[168:171], a[164:167], a[36:39], v[168:171]
 v_mul_f32_dpp v25, v217, v25 row_newbcast:1 row_mask:0xf bank_mask:0xf
 v_mul_f32_dpp v29, v217, v29 row_newbcast:1 row_mask:0xf bank_mask:0xf
 v_mfma_f32_16x16x32_bf16 v[168:171], a[168:171], a[40:43], v[168:171]
 v_cvt_pk_bf16_f32 v243, v25, v29
 v_mul_f32_dpp v2, v217, v2 row_newbcast:2 row_mask:0xf bank_mask:0xf
 v_mfma_f32_16x16x32_bf16 v[168:171], a[172:175], a[44:47], v[168:171]
 buffer_store_dwordx4 v[240:243], v244, s[20:23], s33 offen offset:1024 sc1
 v_mfma_f32_16x16x32_bf16 v[172:175], a[188:191], a[44:47], v[156:159]
 v_mul_f32_dpp v6, v217, v6 row_newbcast:2 row_mask:0xf bank_mask:0xf
 v_cvt_pk_bf16_f32 v240, v2, v6
 v_mfma_f32_16x16x32_bf16 v[172:175], a[184:187], a[40:43], v[172:175]
 v_mul_f32_dpp v10, v217, v10 row_newbcast:2 row_mask:0xf bank_mask:0xf
 v_mul_f32_dpp v14, v217, v14 row_newbcast:2 row_mask:0xf bank_mask:0xf
 v_mfma_f32_16x16x32_bf16 v[172:175], a[180:183], a[36:39], v[172:175]
 v_exp_f32 v168, v168
 v_mfma_f32_16x16x32_bf16 v[172:175], a[176:179], a[32:35], v[172:175]
 v_exp_f32 v169, v169
 v_mfma_f32_16x16x32_bf16 v[32:35], v[176:179], a[224:227], v[32:35]
 v_exp_f32 v170, v170
 v_mfma_f32_16x16x32_bf16 v[36:39], v[176:179], a[228:231], v[36:39]
 v_exp_f32 v171, v171
 v_mfma_f32_16x16x32_bf16 v[40:43], v[176:179], a[232:235], v[40:43]
 v_cvt_pk_bf16_f32 v180, v168, v169
 v_cvt_pk_bf16_f32 v181, v170, v171
 v_mfma_f32_16x16x32_bf16 v[44:47], v[176:179], a[236:239], v[44:47]
 v_exp_f32 v172, v172
 v_mfma_f32_16x16x32_bf16 v[48:51], v[176:179], a[240:243], v[48:51]
 v_exp_f32 v173, v173
 v_mfma_f32_16x16x32_bf16 v[52:55], v[176:179], a[244:247], v[52:55]
 v_exp_f32 v174, v174
 v_mfma_f32_16x16x32_bf16 v[56:59], v[176:179], a[248:251], v[56:59]
 v_exp_f32 v175, v175
 v_mfma_f32_16x16x32_bf16 v[60:63], v[176:179], a[252:255], v[60:63]
 v_cvt_pk_bf16_f32 v182, v172, v173
 v_cvt_pk_bf16_f32 v183, v174, v175
 v_mfma_f32_16x16x32_bf16 v[160:163], a[192:195], a[48:51], v[144:147]
 v_cvt_pk_bf16_f32 v241, v10, v14
 v_mul_f32_dpp v18, v217, v18 row_newbcast:2 row_mask:0xf bank_mask:0xf
 v_mfma_f32_16x16x32_bf16 v[160:163], a[196:199], a[52:55], v[160:163]
 v_mul_f32_dpp v22, v217, v22 row_newbcast:2 row_mask:0xf bank_mask:0xf
 v_cvt_pk_bf16_f32 v242, v18, v22
 v_mfma_f32_16x16x32_bf16 v[160:163], a[200:203], a[56:59], v[160:163]
 v_mul_f32_dpp v26, v217, v26 row_newbcast:2 row_mask:0xf bank_mask:0xf
 v_mul_f32_dpp v30, v217, v30 row_newbcast:2 row_mask:0xf bank_mask:0xf
 v_mfma_f32_16x16x32_bf16 v[160:163], a[204:207], a[60:63], v[160:163]
 v_cvt_pk_bf16_f32 v243, v26, v30
 v_mul_f32_dpp v3, v217, v3 row_newbcast:3 row_mask:0xf bank_mask:0xf
 v_mfma_f32_16x16x32_bf16 v[164:167], a[220:223], a[60:63], v[144:147]
 v_mul_f32_dpp v7, v217, v7 row_newbcast:3 row_mask:0xf bank_mask:0xf
 v_mul_f32_dpp v11, v217, v11 row_newbcast:3 row_mask:0xf bank_mask:0xf
 v_mfma_f32_16x16x32_bf16 v[164:167], a[216:219], a[56:59], v[164:167]
 v_mul_f32_dpp v15, v217, v15 row_newbcast:3 row_mask:0xf bank_mask:0xf
 v_mul_f32_dpp v19, v217, v19 row_newbcast:3 row_mask:0xf bank_mask:0xf
 v_mfma_f32_16x16x32_bf16 v[164:167], a[212:215], a[52:55], v[164:167]
 v_exp_f32 v160, v160
 v_mfma_f32_16x16x32_bf16 v[164:167], a[208:211], a[48:51], v[164:167]
 v_exp_f32 v161, v161
 v_smfmac_f32_16x16x64_bf16 v[132:135], v[236:239], v[176:183], v138
 v_cvt_pk_bf16_f32 v176, v160, v161
 v_mfma_f32_16x16x32_bf16 v[64:67], v[180:183], a[224:227], v[64:67]
 buffer_store_dwordx4 v[240:243], v244, s[20:23], s33 offen offset:2048 sc1
 v_mfma_f32_16x16x32_bf16 v[68:71], v[180:183], a[228:231], v[68:71]
 ds_read_b128 a[224:227], v248 offset:32768
 ds_read_b128 a[228:231], v248 offset:33280
 v_mfma_f32_16x16x32_bf16 v[72:75], v[180:183], a[232:235], v[72:75]
 ds_read_b128 a[232:235], v248 offset:33792
 v_cvt_pk_bf16_f32 v240, v3, v7
 v_mfma_f32_16x16x32_bf16 v[76:79], v[180:183], a[236:239], v[76:79]
 v_exp_f32 v162, v162
 v_mfma_f32_16x16x32_bf16 v[80:83], v[180:183], a[240:243], v[80:83]
 v_exp_f32 v163, v163
 v_mfma_f32_16x16x32_bf16 v[84:87], v[180:183], a[244:247], v[84:87]
 v_exp_f32 v164, v164
 v_mfma_f32_16x16x32_bf16 v[88:91], v[180:183], a[248:251], v[88:91]
 v_exp_f32 v165, v165
 v_mfma_f32_16x16x32_bf16 v[92:95], v[180:183], a[252:255], v[92:95]
 v_exp_f32 v166, v166
 v_mfma_f32_16x16x32_bf16 v[168:171], a[192:195], v[220:223], v[148:151]
 ds_read_b128 a[236:239], v248 offset:34304
 ds_read_b128 a[240:243], v248 offset:34816
 v_mfma_f32_16x16x32_bf16 v[168:171], a[196:199], v[224:227], v[168:171]
 v_exp_f32 v167, v167
 v_mfma_f32_16x16x32_bf16 v[168:171], a[200:203], v[228:231], v[168:171]
 ds_read_b128 a[244:247], v248 offset:35328
 ds_read_b128 a[248:251], v248 offset:35840
 v_mfma_f32_16x16x32_bf16 v[168:171], a[204:207], v[232:235], v[168:171]
 v_cvt_pk_bf16_f32 v177, v162, v163
 v_cvt_pk_bf16_f32 v178, v164, v165
 v_mfma_f32_16x16x32_bf16 v[172:175], a[220:223], v[232:235], v[148:151]
 ds_read_b128 a[252:255], v248 offset:36352
 v_cvt_pk_bf16_f32 v179, v166, v167
 v_mfma_f32_16x16x32_bf16 v[172:175], a[216:219], v[228:231], v[172:175]
 v_cvt_pk_bf16_f32 v241, v11, v15
 v_mul_f32_dpp v23, v217, v23 row_newbcast:3 row_mask:0xf bank_mask:0xf
 v_mfma_f32_16x16x32_bf16 v[172:175], a[212:215], v[224:227], v[172:175]
 v_exp_f32 v168, v168
 v_mfma_f32_16x16x32_bf16 v[172:175], a[208:211], v[220:223], v[172:175]
 s_waitcnt lgkmcnt(3)
 v_exp_f32 v169, v169
 v_mfma_f32_16x16x32_bf16 v[96:99], v[176:179], a[224:227], v[96:99]
 v_exp_f32 v170, v170
 v_mfma_f32_16x16x32_bf16 v[100:103], v[176:179], a[228:231], v[100:103]
 v_exp_f32 v171, v171
 v_mfma_f32_16x16x32_bf16 v[104:107], v[176:179], a[232:235], v[104:107]
 v_cvt_pk_bf16_f32 v180, v168, v169
 v_cvt_pk_bf16_f32 v181, v170, v171
 v_mfma_f32_16x16x32_bf16 v[108:111], v[176:179], a[236:239], v[108:111]
 v_exp_f32 v172, v172
 v_mfma_f32_16x16x32_bf16 v[112:115], v[176:179], a[240:243], v[112:115]
 s_waitcnt lgkmcnt(0)
 v_exp_f32 v173, v173
 v_mfma_f32_16x16x32_bf16 v[116:119], v[176:179], a[244:247], v[116:119]
 v_exp_f32 v174, v174
 v_mfma_f32_16x16x32_bf16 v[120:123], v[176:179], a[248:251], v[120:123]
 v_exp_f32 v175, v175
 v_mfma_f32_16x16x32_bf16 v[124:127], v[176:179], a[252:255], v[124:127]
 v_cvt_pk_bf16_f32 v182, v172, v173
 v_cvt_pk_bf16_f32 v183, v174, v175
 v_mfma_f32_16x16x32_bf16 v[160:163], a[192:195], a[16:19], v[152:155]
 v_cvt_pk_bf16_f32 v242, v19, v23
 v_mul_f32_dpp v27, v217, v27 row_newbcast:3 row_mask:0xf bank_mask:0xf
 v_mfma_f32_16x16x32_bf16 v[160:163], a[196:199], a[20:23], v[160:163]
 v_mul_f32_dpp v31, v217, v31 row_newbcast:3 row_mask:0xf bank_mask:0xf
 v_cvt_pk_bf16_f32 v243, v27, v31
 v_mfma_f32_16x16x32_bf16 v[160:163], a[200:203], a[24:27], v[160:163]
 buffer_store_dwordx4 v[240:243], v244, s[20:23], s33 offen offset:3072 sc1
 v_mfma_f32_16x16x32_bf16 v[160:163], a[204:207], a[28:31], v[160:163]
 s_nop 1
 v_mfma_f32_16x16x32_bf16 v[164:167], a[220:223], a[28:31], v[152:155]
 s_nop 1
 v_mfma_f32_16x16x32_bf16 v[164:167], a[216:219], a[24:27], v[164:167]
 s_nop 1
 v_mfma_f32_16x16x32_bf16 v[164:167], a[212:215], a[20:23], v[164:167]
 v_exp_f32 v160, v160
 v_mfma_f32_16x16x32_bf16 v[164:167], a[208:211], a[16:19], v[164:167]
 v_exp_f32 v161, v161
 v_smfmac_f32_16x16x64_bf16 v[128:131], v[236:239], v[176:183], v138
 v_cvt_pk_bf16_f32 v176, v160, v161
 v_mfma_f32_16x16x32_bf16 v[184:187], v[180:183], a[224:227], v[184:187]
 v_exp_f32 v162, v162
 v_mfma_f32_16x16x32_bf16 v[188:191], v[180:183], a[228:231], v[188:191]
 v_exp_f32 v163, v163
 v_mfma_f32_16x16x32_bf16 v[192:195], v[180:183], a[232:235], v[192:195]
 v_exp_f32 v164, v164
 v_mfma_f32_16x16x32_bf16 v[196:199], v[180:183], a[236:239], v[196:199]
 v_exp_f32 v165, v165
 v_mfma_f32_16x16x32_bf16 v[200:203], v[180:183], a[240:243], v[200:203]
 v_exp_f32 v166, v166
 v_mfma_f32_16x16x32_bf16 v[204:207], v[180:183], a[244:247], v[204:207]
 v_exp_f32 v167, v167
 v_mfma_f32_16x16x32_bf16 v[208:211], v[180:183], a[248:251], v[208:211]
 v_cvt_pk_bf16_f32 v177, v162, v163
 v_cvt_pk_bf16_f32 v178, v164, v165
 v_mfma_f32_16x16x32_bf16 v[212:215], v[180:183], a[252:255], v[212:215]
 v_cvt_pk_bf16_f32 v179, v166, v167
 v_mfma_f32_16x16x32_bf16 v[168:171], a[192:195], a[32:35], v[156:159]
 ds_read_b128 a[192:195], v249 offset:40960
 v_mfma_f32_16x16x32_bf16 v[168:171], a[196:199], a[36:39], v[168:171]
 ds_read_b128 a[196:199], v249 offset:41472
 v_mfma_f32_16x16x32_bf16 v[168:171], a[200:203], a[40:43], v[168:171]
 ds_read_b128 a[200:203], v249 offset:41984
 v_mfma_f32_16x16x32_bf16 v[168:171], a[204:207], a[44:47], v[168:171]
 ds_read_b128 a[204:207], v249 offset:42496
 s_nop 0
 v_mfma_f32_16x16x32_bf16 v[172:175], a[220:223], a[44:47], v[156:159]
 ds_read_b128 a[220:223], v249 offset:44544
 s_nop 0
 v_mfma_f32_16x16x32_bf16 v[172:175], a[216:219], a[40:43], v[172:175]
 ds_read_b128 a[216:219], v249 offset:44032
 s_nop 0
 v_mfma_f32_16x16x32_bf16 v[172:175], a[212:215], a[36:39], v[172:175]
 v_exp_f32 v168, v168
 v_mfma_f32_16x16x32_bf16 v[172:175], a[208:211], a[32:35], v[172:175]
 ds_read_b128 a[208:211], v249 offset:43008
 ds_read_b128 a[212:215], v249 offset:43520
 v_mfma_f32_16x16x32_bf16 v[32:35], v[176:179], a[224:227], v[32:35]
 v_exp_f32 v169, v169
 v_mfma_f32_16x16x32_bf16 v[36:39], v[176:179], a[228:231], v[36:39]
 v_exp_f32 v170, v170
 v_mfma_f32_16x16x32_bf16 v[40:43], v[176:179], a[232:235], v[40:43]
 v_exp_f32 v171, v171
 v_mfma_f32_16x16x32_bf16 v[44:47], v[176:179], a[236:239], v[44:47]
 v_exp_f32 v172, v172
 v_mfma_f32_16x16x32_bf16 v[48:51], v[176:179], a[240:243], v[48:51]
 v_exp_f32 v173, v173
 v_mfma_f32_16x16x32_bf16 v[52:55], v[176:179], a[244:247], v[52:55]
 v_exp_f32 v174, v174
 v_mfma_f32_16x16x32_bf16 v[56:59], v[176:179], a[248:251], v[56:59]
 v_exp_f32 v175, v175
 v_mfma_f32_16x16x32_bf16 v[60:63], v[176:179], a[252:255], v[60:63]
 s_waitcnt lgkmcnt(0)
 v_cvt_pk_bf16_f32 v180, v168, v169
 v_cvt_pk_bf16_f32 v181, v170, v171
 v_mfma_f32_16x16x32_bf16 v[160:163], a[192:195], a[48:51], v[144:147]
 v_cvt_pk_bf16_f32 v182, v172, v173
 v_cvt_pk_bf16_f32 v183, v174, v175
 v_mfma_f32_16x16x32_bf16 v[160:163], a[196:199], a[52:55], v[160:163]
 v_mfma_f32_16x16x32_bf16 v[160:163], a[200:203], a[56:59], v[160:163]
 v_mfma_f32_16x16x32_bf16 v[160:163], a[204:207], a[60:63], v[160:163]
 s_nop 1
 v_mfma_f32_16x16x32_bf16 v[164:167], a[220:223], a[60:63], v[144:147]
 s_nop 1
 v_mfma_f32_16x16x32_bf16 v[164:167], a[216:219], a[56:59], v[164:167]
 s_nop 1
 v_mfma_f32_16x16x32_bf16 v[164:167], a[212:215], a[52:55], v[164:167]
 v_exp_f32 v160, v160
 v_mfma_f32_16x16x32_bf16 v[164:167], a[208:211], a[48:51], v[164:167]
 v_exp_f32 v161, v161
 v_smfmac_f32_16x16x64_bf16 v[132:135], v[236:239], v[176:183], v138
 v_cvt_pk_bf16_f32 v176, v160, v161
 v_mfma_f32_16x16x32_bf16 v[64:67], v[180:183], a[224:227], v[64:67]
 v_exp_f32 v162, v162
 v_mfma_f32_16x16x32_bf16 v[68:71], v[180:183], a[228:231], v[68:71]
 ds_read_b128 a[224:227], v248 offset:40960
 ds_read_b128 a[228:231], v248 offset:41472
 v_mfma_f32_16x16x32_bf16 v[72:75], v[180:183], a[232:235], v[72:75]
 v_exp_f32 v163, v163
 v_mfma_f32_16x16x32_bf16 v[76:79], v[180:183], a[236:239], v[76:79]
 ds_read_b128 a[232:235], v248 offset:41984
 ds_read_b128 a[236:239], v248 offset:42496
 v_mfma_f32_16x16x32_bf16 v[80:83], v[180:183], a[240:243], v[80:83]
 v_exp_f32 v164, v164
 v_mfma_f32_16x16x32_bf16 v[84:87], v[180:183], a[244:247], v[84:87]
 v_exp_f32 v165, v165
 v_mfma_f32_16x16x32_bf16 v[88:91], v[180:183], a[248:251], v[88:91]
 v_exp_f32 v166, v166
 v_mfma_f32_16x16x32_bf16 v[92:95], v[180:183], a[252:255], v[92:95]
 v_exp_f32 v167, v167
 v_mfma_f32_16x16x32_bf16 v[168:171], a[192:195], v[220:223], v[148:151]
 ds_read_b128 a[240:243], v248 offset:43008
 ds_read_b128 a[244:247], v248 offset:43520
 v_mfma_f32_16x16x32_bf16 v[168:171], a[196:199], v[224:227], v[168:171]
 ds_read_b128 a[248:251], v248 offset:44032
 v_cvt_pk_bf16_f32 v177, v162, v163
 v_mfma_f32_16x16x32_bf16 v[168:171], a[200:203], v[228:231], v[168:171]
 v_cvt_pk_bf16_f32 v178, v164, v165
 v_cvt_pk_bf16_f32 v179, v166, v167
 v_mfma_f32_16x16x32_bf16 v[168:171], a[204:207], v[232:235], v[168:171]
 ds_read_b128 a[252:255], v248 offset:44544
 s_nop 0
 v_mfma_f32_16x16x32_bf16 v[172:175], a[220:223], v[232:235], v[148:151]
 s_nop 1
 v_mfma_f32_16x16x32_bf16 v[172:175], a[216:219], v[228:231], v[172:175]
 s_nop 1
 v_mfma_f32_16x16x32_bf16 v[172:175], a[212:215], v[224:227], v[172:175]
 v_exp_f32 v168, v168
 v_mfma_f32_16x16x32_bf16 v[172:175], a[208:211], v[220:223], v[172:175]
 s_waitcnt lgkmcnt(2)
 v_exp_f32 v169, v169
 v_mfma_f32_16x16x32_bf16 v[96:99], v[176:179], a[224:227], v[96:99]
 v_exp_f32 v170, v170
 v_mfma_f32_16x16x32_bf16 v[100:103], v[176:179], a[228:231], v[100:103]
 v_exp_f32 v171, v171
 v_mfma_f32_16x16x32_bf16 v[104:107], v[176:179], a[232:235], v[104:107]
 v_cvt_pk_bf16_f32 v180, v168, v169
 v_cvt_pk_bf16_f32 v181, v170, v171
 v_mfma_f32_16x16x32_bf16 v[108:111], v[176:179], a[236:239], v[108:111]
 v_exp_f32 v172, v172
 v_mfma_f32_16x16x32_bf16 v[112:115], v[176:179], a[240:243], v[112:115]
 v_exp_f32 v173, v173
 v_mfma_f32_16x16x32_bf16 v[116:119], v[176:179], a[244:247], v[116:119]
 s_waitcnt lgkmcnt(0)
 v_exp_f32 v174, v174
 v_mfma_f32_16x16x32_bf16 v[120:123], v[176:179], a[248:251], v[120:123]
 v_exp_f32 v175, v175
 v_mfma_f32_16x16x32_bf16 v[124:127], v[176:179], a[252:255], v[124:127]
 v_cvt_pk_bf16_f32 v182, v172, v173
 v_cvt_pk_bf16_f32 v183, v174, v175
 v_mfma_f32_16x16x32_bf16 v[160:163], a[192:195], a[16:19], v[152:155]
 v_mfma_f32_16x16x32_bf16 v[160:163], a[196:199], a[20:23], v[160:163]
 v_mfma_f32_16x16x32_bf16 v[160:163], a[200:203], a[24:27], v[160:163]
 v_mfma_f32_16x16x32_bf16 v[160:163], a[204:207], a[28:31], v[160:163]
 s_nop 1
 v_mfma_f32_16x16x32_bf16 v[164:167], a[220:223], a[28:31], v[152:155]
 buffer_load_dwordx4 a[28:31], v245, s[8:11], s32 offen offset:192
 v_mfma_f32_16x16x32_bf16 v[164:167], a[216:219], a[24:27], v[164:167]
 s_nop 1
 v_mfma_f32_16x16x32_bf16 v[164:167], a[212:215], a[20:23], v[164:167]
 v_exp_f32 v161, v161
 v_mfma_f32_16x16x32_bf16 v[164:167], a[208:211], a[16:19], v[164:167]
 v_exp_f32 v162, v162
 v_smfmac_f32_16x16x64_bf16 v[128:131], v[236:239], v[176:183], v138
 s_nop 0
 v_mfma_f32_16x16x32_bf16 v[184:187], v[180:183], a[224:227], v[184:187]
 buffer_load_dwordx4 a[16:19], v245, s[8:11], s32 offen offset:0
 v_mfma_f32_16x16x32_bf16 v[188:191], v[180:183], a[228:231], v[188:191]
 v_exp_f32 v163, v163
 v_mfma_f32_16x16x32_bf16 v[192:195], v[180:183], a[232:235], v[192:195]
 v_exp_f32 v164, v164
 v_mfma_f32_16x16x32_bf16 v[196:199], v[180:183], a[236:239], v[196:199]
 v_exp_f32 v165, v165
 v_mfma_f32_16x16x32_bf16 v[200:203], v[180:183], a[240:243], v[200:203]
 buffer_load_dwordx4 a[20:23], v245, s[8:11], s32 offen offset:64
 v_mfma_f32_16x16x32_bf16 v[204:207], v[180:183], a[244:247], v[204:207]
 v_exp_f32 v166, v166
 v_mfma_f32_16x16x32_bf16 v[208:211], v[180:183], a[248:251], v[208:211]
 v_exp_f32 v160, v160
 v_mfma_f32_16x16x32_bf16 v[212:215], v[180:183], a[252:255], v[212:215]
 v_exp_f32 v167, v167
 v_mfma_f32_16x16x32_bf16 v[168:171], a[192:195], a[32:35], v[156:159]
 buffer_load_dwordx4 a[24:27], v245, s[8:11], s32 offen offset:128
 v_mfma_f32_16x16x32_bf16 v[168:171], a[196:199], a[36:39], v[168:171]
 v_cvt_pk_bf16_f32 v176, v160, v161
 v_cvt_pk_bf16_f32 v177, v162, v163
 v_mfma_f32_16x16x32_bf16 v[168:171], a[200:203], a[40:43], v[168:171]
 v_cvt_pk_bf16_f32 v178, v164, v165
 v_cvt_pk_bf16_f32 v179, v166, v167
 v_mfma_f32_16x16x32_bf16 v[168:171], a[204:207], a[44:47], v[168:171]
 ds_read_b128 a[192:195], v249 offset:49152
 ds_read_b128 a[196:199], v249 offset:49664
 v_mfma_f32_16x16x32_bf16 v[172:175], a[220:223], a[44:47], v[156:159]
 ds_read_b128 a[204:207], v249 offset:50688
 ds_read_b128 a[200:203], v249 offset:50176
 v_mfma_f32_16x16x32_bf16 v[172:175], a[216:219], a[40:43], v[172:175]
 ds_read_b128 a[216:219], v249 offset:52224
 ds_read_b128 a[220:223], v249 offset:52736
 v_mfma_f32_16x16x32_bf16 v[172:175], a[212:215], a[36:39], v[172:175]
 v_exp_f32 v168, v168
 v_mfma_f32_16x16x32_bf16 v[172:175], a[208:211], a[32:35], v[172:175]
 ds_read_b128 a[208:211], v249 offset:51200
 ds_read_b128 a[212:215], v249 offset:51712
 v_mfma_f32_16x16x32_bf16 v[32:35], v[176:179], a[224:227], v[32:35]
 v_exp_f32 v169, v169
 v_mfma_f32_16x16x32_bf16 v[36:39], v[176:179], a[228:231], v[36:39]
 v_exp_f32 v170, v170
 v_mfma_f32_16x16x32_bf16 v[40:43], v[176:179], a[232:235], v[40:43]
 v_exp_f32 v171, v171
 v_mfma_f32_16x16x32_bf16 v[44:47], v[176:179], a[236:239], v[44:47]
 v_exp_f32 v172, v172
 v_mfma_f32_16x16x32_bf16 v[48:51], v[176:179], a[240:243], v[48:51]
 v_exp_f32 v173, v173
 v_mfma_f32_16x16x32_bf16 v[52:55], v[176:179], a[244:247], v[52:55]
 v_exp_f32 v174, v174
 v_mfma_f32_16x16x32_bf16 v[56:59], v[176:179], a[248:251], v[56:59]
 v_exp_f32 v175, v175
 v_mfma_f32_16x16x32_bf16 v[60:63], v[176:179], a[252:255], v[60:63]
 s_waitcnt vmcnt(8) lgkmcnt(0)
 v_cvt_pk_bf16_f32 v180, v168, v169
 v_cvt_pk_bf16_f32 v181, v170, v171
 v_mfma_f32_16x16x32_bf16 v[252:255], a[192:195], a[0:3], 0
 v_cvt_pk_bf16_f32 v182, v172, v173
 v_cvt_pk_bf16_f32 v183, v174, v175
 v_mfma_f32_16x16x32_bf16 v[252:255], a[196:199], a[4:7], v[252:255]
 v_mfma_f32_16x16x32_bf16 v[252:255], a[200:203], a[8:11], v[252:255]
 v_mfma_f32_16x16x32_bf16 v[252:255], a[204:207], a[12:15], v[252:255]
 s_nop 1
 v_mfma_f32_16x16x32_bf16 v[160:163], a[192:195], a[48:51], v[144:147]
 s_nop 1
 v_mfma_f32_16x16x32_bf16 v[160:163], a[196:199], a[52:55], v[160:163]
 s_nop 1
 v_mfma_f32_16x16x32_bf16 v[160:163], a[200:203], a[56:59], v[160:163]
 v_max3_f32 v246, v252, v253, v254
 v_max_f32 v246, v246, v255
 v_mfma_f32_16x16x32_bf16 v[160:163], a[204:207], a[60:63], v[160:163]
 v_mov_b32 v247, v246
 s_nop 0
 v_mfma_f32_16x16x32_bf16 v[164:167], a[220:223], a[60:63], v[144:147]
 v_permlane16_swap_b32 v246, v247
 v_max_f32 v246, v246, v247
 v_mfma_f32_16x16x32_bf16 v[164:167], a[216:219], a[56:59], v[164:167]
 v_mov_b32 v247, v246
 s_nop 0
 v_mfma_f32_16x16x32_bf16 v[164:167], a[212:215], a[52:55], v[164:167]
 v_exp_f32 v160, v160
 v_mfma_f32_16x16x32_bf16 v[164:167], a[208:211], a[48:51], v[164:167]
 v_exp_f32 v161, v161
 v_smfmac_f32_16x16x64_bf16 v[132:135], v[236:239], v[176:183], v138
 v_cvt_pk_bf16_f32 v176, v160, v161
 v_mfma_f32_16x16x32_bf16 v[64:67], v[180:183], a[224:227], v[64:67]
 v_exp_f32 v162, v162
 v_mfma_f32_16x16x32_bf16 v[68:71], v[180:183], a[228:231], v[68:71]
 v_exp_f32 v163, v163
 v_mfma_f32_16x16x32_bf16 v[72:75], v[180:183], a[232:235], v[72:75]
 v_exp_f32 v166, v166
 v_mfma_f32_16x16x32_bf16 v[76:79], v[180:183], a[236:239], v[76:79]
 v_exp_f32 v167, v167
 v_mfma_f32_16x16x32_bf16 v[80:83], v[180:183], a[240:243], v[80:83]
 v_exp_f32 v164, v164
 v_mfma_f32_16x16x32_bf16 v[84:87], v[180:183], a[244:247], v[84:87]
 v_exp_f32 v165, v165
 v_mfma_f32_16x16x32_bf16 v[88:91], v[180:183], a[248:251], v[88:91]
 ds_read_b128 a[224:227], v248 offset:49152
 v_cvt_pk_bf16_f32 v177, v162, v163
 v_cvt_pk_bf16_f32 v178, v164, v165
 v_mfma_f32_16x16x32_bf16 v[92:95], v[180:183], a[252:255], v[92:95]
 ds_read_b128 a[228:231], v248 offset:49664
 v_cvt_pk_bf16_f32 v179, v166, v167
 v_mfma_f32_16x16x32_bf16 v[168:171], a[192:195], v[220:223], v[148:151]
 ds_read_b128 a[232:235], v248 offset:50176
 ds_read_b128 a[252:255], v248 offset:52736
 v_mfma_f32_16x16x32_bf16 v[168:171], a[196:199], v[224:227], v[168:171]
 ds_read_b128 a[236:239], v248 offset:50688
 v_permlane32_swap_b32 v246, v247
 v_mfma_f32_16x16x32_bf16 v[168:171], a[200:203], v[228:231], v[168:171]
 ds_read_b128 a[240:243], v248 offset:51200
 v_min_f32 v246, -v246, -v247
 v_mfma_f32_16x16x32_bf16 v[168:171], a[204:207], v[232:235], v[168:171]
 ds_read_b128 a[244:247], v248 offset:51712
 v_mov_b32 v152, v246
 v_mov_b32 v153, v246
 v_mfma_f32_16x16x32_bf16 v[172:175], a[220:223], v[232:235], v[148:151]
 ds_read_b128 a[248:251], v248 offset:52224
 v_mov_b32 v154, v246
 v_mov_b32 v155, v246
 v_mfma_f32_16x16x32_bf16 v[172:175], a[216:219], v[228:231], v[172:175]
 v_exp_f32 v168, v168
 v_mfma_f32_16x16x32_bf16 v[172:175], a[212:215], v[224:227], v[172:175]
 v_exp_f32 v169, v169
 v_mfma_f32_16x16x32_bf16 v[172:175], a[208:211], v[220:223], v[172:175]
 s_waitcnt lgkmcnt(4)
 v_exp_f32 v170, v170
 v_mfma_f32_16x16x32_bf16 v[96:99], v[176:179], a[224:227], v[96:99]
 v_exp_f32 v171, v171
 v_mfma_f32_16x16x32_bf16 v[100:103], v[176:179], a[228:231], v[100:103]
 v_cvt_pk_bf16_f32 v180, v168, v169
 v_cvt_pk_bf16_f32 v181, v170, v171
 v_mfma_f32_16x16x32_bf16 v[104:107], v[176:179], a[232:235], v[104:107]
 s_waitcnt lgkmcnt(1)
 v_add_f32 v252, v252, v246
 v_add_f32 v253, v253, v246
 v_mfma_f32_16x16x32_bf16 v[108:111], v[176:179], a[236:239], v[108:111]
 v_add_f32 v254, v254, v246
 v_add_f32 v255, v255, v246
 v_mfma_f32_16x16x32_bf16 v[112:115], v[176:179], a[240:243], v[112:115]
 v_exp_f32 v172, v172
 v_mfma_f32_16x16x32_bf16 v[116:119], v[176:179], a[244:247], v[116:119]
 s_waitcnt lgkmcnt(0)
 v_exp_f32 v173, v173
 v_mfma_f32_16x16x32_bf16 v[120:123], v[176:179], a[248:251], v[120:123]
 v_exp_f32 v174, v174
 v_mfma_f32_16x16x32_bf16 v[124:127], v[176:179], a[252:255], v[124:127]
 v_exp_f32 v175, v175
 v_mfma_f32_16x16x32_bf16 v[164:167], a[220:223], a[12:15], v[152:155]
 v_exp_f32 v252, v252
 v_mfma_f32_16x16x32_bf16 v[164:167], a[216:219], a[8:11], v[164:167]
 v_cvt_pk_bf16_f32 v182, v172, v173
 v_cvt_pk_bf16_f32 v183, v174, v175
 v_mfma_f32_16x16x32_bf16 v[164:167], a[212:215], a[4:7], v[164:167]
 v_exp_f32 v253, v253
 v_mfma_f32_16x16x32_bf16 v[164:167], a[208:211], a[0:3], v[164:167]
 v_exp_f32 v254, v254
 v_smfmac_f32_16x16x64_bf16 v[128:131], v[236:239], v[176:183], v138
 v_cvt_pk_bf16_f32 v176, v252, v253
 v_mfma_f32_16x16x32_bf16 v[184:187], v[180:183], a[224:227], v[184:187]
 v_exp_f32 v255, v255
 v_mfma_f32_16x16x32_bf16 v[188:191], v[180:183], a[228:231], v[188:191]
 v_cvt_pk_bf16_f32 v177, v254, v255
 v_add_f32 v218, v132, v133
 v_mfma_f32_16x16x32_bf16 v[192:195], v[180:183], a[232:235], v[192:195]
 v_exp_f32 v164, v164
 v_mfma_f32_16x16x32_bf16 v[196:199], v[180:183], a[236:239], v[196:199]
 v_exp_f32 v165, v165
 v_mfma_f32_16x16x32_bf16 v[200:203], v[180:183], a[240:243], v[200:203]
 v_exp_f32 v166, v166
 v_mfma_f32_16x16x32_bf16 v[204:207], v[180:183], a[244:247], v[204:207]
 v_exp_f32 v167, v167
 v_mfma_f32_16x16x32_bf16 v[208:211], v[180:183], a[248:251], v[208:211]
 v_cvt_pk_bf16_f32 v178, v164, v165
 v_cvt_pk_bf16_f32 v179, v166, v167
 v_mfma_f32_16x16x32_bf16 v[212:215], v[180:183], a[252:255], v[212:215]
 v_mov_b32 v132, 0
 v_mov_b32 v133, 0
 v_mfma_f32_16x16x32_bf16 v[168:171], a[192:195], a[32:35], v[156:159]
 ds_read_b128 a[192:195], v249 offset:57344
 v_cmp_nge_f32 vcc, s28, v218
 v_mfma_f32_16x16x32_bf16 v[168:171], a[196:199], a[36:39], v[168:171]
 s_cmp_lg_u64 vcc, 0
 v_rcp_f32 v218, v218
 v_mfma_f32_16x16x32_bf16 v[168:171], a[200:203], a[40:43], v[168:171]
 s_cselect_b32 s34, 64, 0
 ds_read_b128 a[196:199], v249 offset:57856
 ds_read_b128 a[200:203], v249 offset:58368
 v_mfma_f32_16x16x32_bf16 v[168:171], a[204:207], a[44:47], v[168:171]
 s_or_b32 s29, s29, s34
 s_add_u32 s33, s25, 24576
 ds_read_b128 a[204:207], v249 offset:58880
 v_mfma_f32_16x16x32_bf16 v[172:175], a[220:223], a[44:47], v[156:159]
 s_add_u32 s32, s25, 49152
 ds_read_b128 a[220:223], v249 offset:60928
 v_mov_b32_dpp v218, v218 row_shl:4 row_mask:0x2 bank_mask:0xf
 v_mfma_f32_16x16x32_bf16 v[172:175], a[216:219], a[40:43], v[172:175]
 v_exp_f32 v168, v168
 v_mfma_f32_16x16x32_bf16 v[172:175], a[212:215], a[36:39], v[172:175]
 v_exp_f32 v169, v169
 v_mfma_f32_16x16x32_bf16 v[172:175], a[208:211], a[32:35], v[172:175]
 ds_read_b128 a[216:219], v249 offset:60416
 ds_read_b128 a[212:215], v249 offset:59904
 v_mfma_f32_16x16x32_bf16 v[0:3], v[176:179], a[224:227], 0
 v_exp_f32 v170, v170
 v_mfma_f32_16x16x32_bf16 v[4:7], v[176:179], a[228:231], 0
 v_exp_f32 v171, v171
 v_mfma_f32_16x16x32_bf16 v[8:11], v[176:179], a[232:235], 0
 ds_read_b128 a[208:211], v249 offset:59392
 v_cvt_pk_bf16_f32 v180, v168, v169
 v_mfma_f32_16x16x32_bf16 v[12:15], v[176:179], a[236:239], 0
 v_exp_f32 v172, v172
 v_mfma_f32_16x16x32_bf16 v[16:19], v[176:179], a[240:243], 0
 v_exp_f32 v173, v173
 v_mfma_f32_16x16x32_bf16 v[20:23], v[176:179], a[244:247], 0
 v_exp_f32 v174, v174
 v_mfma_f32_16x16x32_bf16 v[24:27], v[176:179], a[248:251], 0
 v_exp_f32 v175, v175
 v_mfma_f32_16x16x32_bf16 v[28:31], v[176:179], a[252:255], 0
 s_waitcnt lgkmcnt(1)
 v_cvt_pk_bf16_f32 v181, v170, v171
 v_cvt_pk_bf16_f32 v182, v172, v173
 v_mfma_f32_16x16x32_bf16 v[160:163], a[192:195], a[48:51], v[144:147]
 v_cvt_pk_bf16_f32 v183, v174, v175
 v_mov_b32_dpp v218, v218 row_shl:8 row_mask:0x4 bank_mask:0xf
 v_mfma_f32_16x16x32_bf16 v[160:163], a[196:199], a[52:55], v[160:163]
 s_nop 1
 v_mfma_f32_16x16x32_bf16 v[160:163], a[200:203], a[56:59], v[160:163]
 v_mov_b32_dpp v218, v218 row_shl:12 row_mask:0x8 bank_mask:0xf
 s_nop 0
 v_mfma_f32_16x16x32_bf16 v[160:163], a[204:207], a[60:63], v[160:163]
 v_mul_f32_dpp v32, v218, v32 row_newbcast:0 row_mask:0xf bank_mask:0xf
 v_mul_f32_dpp v36, v218, v36 row_newbcast:0 row_mask:0xf bank_mask:0xf
 v_mfma_f32_16x16x32_bf16 v[164:167], a[220:223], a[60:63], v[144:147]
 v_cvt_pk_bf16_f32 v240, v32, v36
 v_mul_f32_dpp v40, v218, v40 row_newbcast:0 row_mask:0xf bank_mask:0xf
 v_mfma_f32_16x16x32_bf16 v[164:167], a[216:219], a[56:59], v[164:167]
 v_mul_f32_dpp v44, v218, v44 row_newbcast:0 row_mask:0xf bank_mask:0xf
 v_cvt_pk_bf16_f32 v241, v40, v44
 v_mfma_f32_16x16x32_bf16 v[164:167], a[212:215], a[52:55], v[164:167]
 s_waitcnt lgkmcnt(0)
 v_exp_f32 v160, v160
 v_mfma_f32_16x16x32_bf16 v[164:167], a[208:211], a[48:51], v[164:167]
 v_exp_f32 v161, v161
 v_smfmac_f32_16x16x64_bf16 v[132:135], v[236:239], v[176:183], v138
 v_cvt_pk_bf16_f32 v176, v160, v161
 v_mfma_f32_16x16x32_bf16 v[64:67], v[180:183], a[224:227], v[64:67]
 ds_read_b128 a[224:227], v248 offset:57344
 v_mul_f32_dpp v48, v218, v48 row_newbcast:0 row_mask:0xf bank_mask:0xf
 v_mfma_f32_16x16x32_bf16 v[68:71], v[180:183], a[228:231], v[68:71]
 ds_read_b128 a[228:231], v248 offset:57856
 v_mul_f32_dpp v52, v218, v52 row_newbcast:0 row_mask:0xf bank_mask:0xf
 v_mfma_f32_16x16x32_bf16 v[72:75], v[180:183], a[232:235], v[72:75]
 ds_read_b128 a[232:235], v248 offset:58368
 v_cvt_pk_bf16_f32 v242, v48, v52
 v_mfma_f32_16x16x32_bf16 v[76:79], v[180:183], a[236:239], v[76:79]
 v_exp_f32 v162, v162
 v_mfma_f32_16x16x32_bf16 v[80:83], v[180:183], a[240:243], v[80:83]
 v_exp_f32 v163, v163
 v_mfma_f32_16x16x32_bf16 v[84:87], v[180:183], a[244:247], v[84:87]
 v_exp_f32 v164, v164
 v_mfma_f32_16x16x32_bf16 v[88:91], v[180:183], a[248:251], v[88:91]
L_pg8:
 s_cbranch_execz L_wb0
 v_exp_f32 v165, v165
 v_mfma_f32_16x16x32_bf16 v[92:95], v[180:183], a[252:255], v[92:95]
 v_exp_f32 v166, v166
 v_mfma_f32_16x16x32_bf16 v[168:171], a[192:195], v[220:223], v[148:151]
 ds_read_b128 a[236:239], v248 offset:58880
 ds_read_b128 a[240:243], v248 offset:59392
 v_mfma_f32_16x16x32_bf16 v[168:171], a[196:199], v[224:227], v[168:171]
 v_exp_f32 v167, v167
 v_mfma_f32_16x16x32_bf16 v[168:171], a[200:203], v[228:231], v[168:171]
 ds_read_b128 a[244:247], v248 offset:59904
 ds_read_b128 a[248:251], v248 offset:60416
 v_mfma_f32_16x16x32_bf16 v[168:171], a[204:207], v[232:235], v[168:171]
 v_cvt_pk_bf16_f32 v177, v162, v163
 v_cvt_pk_bf16_f32 v178, v164, v165
 v_mfma_f32_16x16x32_bf16 v[172:175], a[220:223], v[232:235], v[148:151]
 ds_read_b128 a[252:255], v248 offset:60928
 v_cvt_pk_bf16_f32 v179, v166, v167
 v_mfma_f32_16x16x32_bf16 v[172:175], a[216:219], v[228:231], v[172:175]
 v_mul_f32_dpp v56, v218, v56 row_newbcast:0 row_mask:0xf bank_mask:0xf
 v_mul_f32_dpp v60, v218, v60 row_newbcast:0 row_mask:0xf bank_mask:0xf
 v_mfma_f32_16x16x32_bf16 v[172:175], a[212:215], v[224:227], v[172:175]
 v_exp_f32 v168, v168
 v_mfma_f32_16x16x32_bf16 v[172:175], a[208:211], v[220:223], v[172:175]
 s_waitcnt lgkmcnt(3)
 v_exp_f32 v169, v169
 v_mfma_f32_16x16x32_bf16 v[96:99], v[176:179], a[224:227], v[96:99]
 v_exp_f32 v170, v170
 v_mfma_f32_16x16x32_bf16 v[100:103], v[176:179], a[228:231], v[100:103]
 v_exp_f32 v171, v171
 v_mfma_f32_16x16x32_bf16 v[104:107], v[176:179], a[232:235], v[104:107]
 v_cvt_pk_bf16_f32 v180, v168, v169
 v_cvt_pk_bf16_f32 v181, v170, v171
 v_mfma_f32_16x16x32_bf16 v[108:111], v[176:179], a[236:239], v[108:111]
 v_exp_f32 v172, v172
 v_mfma_f32_16x16x32_bf16 v[112:115], v[176:179], a[240:243], v[112:115]
 s_waitcnt lgkmcnt(0)
 v_exp_f32 v173, v173
 v_mfma_f32_16x16x32_bf16 v[116:119], v[176:179], a[244:247], v[116:119]
 v_exp_f32 v174, v174
 v_mfma_f32_16x16x32_bf16 v[120:123], v[176:179], a[248:251], v[120:123]
 v_exp_f32 v175, v175
 v_mfma_f32_16x16x32_bf16 v[124:127], v[176:179], a[252:255], v[124:127]
 v_cvt_pk_bf16_f32 v182, v172, v173
 v_cvt_pk_bf16_f32 v183, v174, v175
 v_mfma_f32_16x16x32_bf16 v[160:163], a[192:195], a[0:3], v[152:155]
 v_cvt_pk_bf16_f32 v243, v56, v60
 v_mul_f32_dpp v33, v218, v33 row_newbcast:1 row_mask:0xf bank_mask:0xf
 v_mfma_f32_16x16x32_bf16 v[160:163], a[196:199], a[4:7], v[160:163]
 buffer_store_dwordx4 v[240:243], v244, s[20:23], s33 offen offset:0 sc1
 v_mfma_f32_16x16x32_bf16 v[160:163], a[200:203], a[8:11], v[160:163]
 v_mul_f32_dpp v37, v218, v37 row_newbcast:1 row_mask:0xf bank_mask:0xf
 v_cvt_pk_bf16_f32 v240, v33, v37
 v_mfma_f32_16x16x32_bf16 v[160:163], a[204:207], a[12:15], v[160:163]
 v_mul_f32_dpp v41, v218, v41 row_newbcast:1 row_mask:0xf bank_mask:0xf
 v_mul_f32_dpp v45, v218, v45 row_newbcast:1 row_mask:0xf bank_mask:0xf
 v_mfma_f32_16x16x32_bf16 v[164:167], a[220:223], a[12:15], v[152:155]
 v_cvt_pk_bf16_f32 v241, v41, v45
 v_mul_f32_dpp v49, v218, v49 row_newbcast:1 row_mask:0xf bank_mask:0xf
 v_mfma_f32_16x16x32_bf16 v[164:167], a[216:219], a[8:11], v[164:167]
 v_mul_f32_dpp v53, v218, v53 row_newbcast:1 row_mask:0xf bank_mask:0xf
 v_cvt_pk_bf16_f32 v242, v49, v53
 v_mfma_f32_16x16x32_bf16 v[164:167], a[212:215], a[4:7], v[164:167]
 v_exp_f32 v160, v160
 v_mfma_f32_16x16x32_bf16 v[164:167], a[208:211], a[0:3], v[164:167]
 v_exp_f32 v161, v161
 v_smfmac_f32_16x16x64_bf16 v[128:131], v[236:239], v[176:183], v138
 v_cvt_pk_bf16_f32 v176, v160, v161
 v_mfma_f32_16x16x32_bf16 v[184:187], v[180:183], a[224:227], v[184:187]
 v_exp_f32 v162, v162
 v_mfma_f32_16x16x32_bf16 v[188:191], v[180:183], a[228:231], v[188:191]
 v_exp_f32 v163, v163
 v_mfma_f32_16x16x32_bf16 v[192:195], v[180:183], a[232:235], v[192:195]
 v_exp_f32 v164, v164
 v_mfma_f32_16x16x32_bf16 v[196:199], v[180:183], a[236:239], v[196:199]
 v_exp_f32 v165, v165
 v_mfma_f32_16x16x32_bf16 v[200:203], v[180:183], a[240:243], v[200:203]
 v_exp_f32 v166, v166
 v_mfma_f32_16x16x32_bf16 v[204:207], v[180:183], a[244:247], v[204:207]
 v_exp_f32 v167, v167
 v_mfma_f32_16x16x32_bf16 v[208:211], v[180:183], a[248:251], v[208:211]
 v_cvt_pk_bf16_f32 v177, v162, v163
 v_cvt_pk_bf16_f32 v178, v164, v165
 v_mfma_f32_16x16x32_bf16 v[212:215], v[180:183], a[252:255], v[212:215]
 v_cvt_pk_bf16_f32 v179, v166, v167
 v_mul_f32_dpp v57, v218, v57 row_newbcast:1 row_mask:0xf bank_mask:0xf
 v_mfma_f32_16x16x32_bf16 v[168:171], a[192:195], a[32:35], v[156:159]
 ds_read_b128 a[192:195], v250 offset:0
 v_mul_f32_dpp v61, v218, v61 row_newbcast:1 row_mask:0xf bank_mask:0xf
 v_mfma_f32_16x16x32_bf16 v[168:171], a[196:199], a[36:39], v[168:171]
 ds_read_b128 a[196:199], v250 offset:512
 v_cvt_pk_bf16_f32 v243, v57, v61
 v_mfma_f32_16x16x32_bf16 v[168:171], a[200:203], a[40:43], v[168:171]
 buffer_store_dwordx4 v[240:243], v244, s[20:23], s33 offen offset:1024 sc1
 v_mfma_f32_16x16x32_bf16 v[168:171], a[204:207], a[44:47], v[168:171]
 ds_read_b128 a[200:203], v250 offset:1024
 ds_read_b128 a[204:207], v250 offset:1536
 v_mfma_f32_16x16x32_bf16 v[172:175], a[220:223], a[44:47], v[156:159]
 ds_read_b128 a[220:223], v250 offset:3584
 v_mul_f32_dpp v34, v218, v34 row_newbcast:2 row_mask:0xf bank_mask:0xf
 v_mfma_f32_16x16x32_bf16 v[172:175], a[216:219], a[40:43], v[172:175]
 ds_read_b128 a[216:219], v250 offset:3072
 v_mul_f32_dpp v38, v218, v38 row_newbcast:2 row_mask:0xf bank_mask:0xf
 v_mfma_f32_16x16x32_bf16 v[172:175], a[212:215], a[36:39], v[172:175]
 ds_read_b128 a[212:215], v250 offset:2560
 v_cvt_pk_bf16_f32 v240, v34, v38
 v_mfma_f32_16x16x32_bf16 v[172:175], a[208:211], a[32:35], v[172:175]
 ds_read_b128 a[208:211], v250 offset:2048
 v_mul_f32_dpp v42, v218, v42 row_newbcast:2 row_mask:0xf bank_mask:0xf
 v_mfma_f32_16x16x32_bf16 v[0:3], v[176:179], a[224:227], v[0:3]
 v_exp_f32 v168, v168
 v_mfma_f32_16x16x32_bf16 v[4:7], v[176:179], a[228:231], v[4:7]
 v_exp_f32 v169, v169
 v_mfma_f32_16x16x32_bf16 v[8:11], v[176:179], a[232:235], v[8:11]
 v_exp_f32 v170, v170
 v_mfma_f32_16x16x32_bf16 v[12:15], v[176:179], a[236:239], v[12:15]
 v_exp_f32 v171, v171
 v_mfma_f32_16x16x32_bf16 v[16:19], v[176:179], a[240:243], v[16:19]
 v_exp_f32 v172, v172
 v_mfma_f32_16x16x32_bf16 v[20:23], v[176:179], a[244:247], v[20:23]
 v_exp_f32 v173, v173
 v_mfma_f32_16x16x32_bf16 v[24:27], v[176:179], a[248:251], v[24:27]
 v_exp_f32 v174, v174
 v_mfma_f32_16x16x32_bf16 v[28:31], v[176:179], a[252:255], v[28:31]
 s_waitcnt lgkmcnt(0)
 v_exp_f32 v175, v175
 v_mfma_f32_16x16x32_bf16 v[160:163], a[192:195], a[48:51], v[144:147]
 v_cvt_pk_bf16_f32 v180, v168, v169
 v_cvt_pk_bf16_f32 v181, v170, v171
 v_mfma_f32_16x16x32_bf16 v[160:163], a[196:199], a[52:55], v[160:163]
 v_cvt_pk_bf16_f32 v182, v172, v173
 v_cvt_pk_bf16_f32 v183, v174, v175
 v_mfma_f32_16x16x32_bf16 v[160:163], a[200:203], a[56:59], v[160:163]
 v_mul_f32_dpp v46, v218, v46 row_newbcast:2 row_mask:0xf bank_mask:0xf
 v_cvt_pk_bf16_f32 v241, v42, v46
 v_mfma_f32_16x16x32_bf16 v[160:163], a[204:207], a[60:63], v[160:163]
 v_mul_f32_dpp v50, v218, v50 row_newbcast:2 row_mask:0xf bank_mask:0xf
 v_mul_f32_dpp v54, v218, v54 row_newbcast:2 row_mask:0xf bank_mask:0xf
 v_mfma_f32_16x16x32_bf16 v[164:167], a[220:223], a[60:63], v[144:147]
 v_cvt_pk_bf16_f32 v242, v50, v54
 v_mul_f32_dpp v58, v218, v58 row_newbcast:2 row_mask:0xf bank_mask:0xf
 v_mfma_f32_16x16x32_bf16 v[164:167], a[216:219], a[56:59], v[164:167]
 v_mul_f32_dpp v62, v218, v62 row_newbcast:2 row_mask:0xf bank_mask:0xf
 v_cvt_pk_bf16_f32 v243, v58, v62
 v_mfma_f32_16x16x32_bf16 v[164:167], a[212:215], a[52:55], v[164:167]
 v_exp_f32 v160, v160
 v_mfma_f32_16x16x32_bf16 v[164:167], a[208:211], a[48:51], v[164:167]
 v_exp_f32 v161, v161
 v_smfmac_f32_16x16x64_bf16 v[132:135], v[236:239], v[176:183], v138
 v_cvt_pk_bf16_f32 v176, v160, v161
 v_mfma_f32_16x16x32_bf16 v[64:67], v[180:183], a[224:227], v[64:67]
 buffer_store_dwordx4 v[240:243], v244, s[20:23], s33 offen offset:2048 sc1
 v_mfma_f32_16x16x32_bf16 v[68:71], v[180:183], a[228:231], v[68:71]
 ds_read_b128 a[224:227], v249 offset:0
 ds_read_b128 a[228:231], v249 offset:512
 v_mfma_f32_16x16x32_bf16 v[72:75], v[180:183], a[232:235], v[72:75]
 ds_read_b128 a[232:235], v249 offset:1024
 v_mul_f32_dpp v35, v218, v35 row_newbcast:3 row_mask:0xf bank_mask:0xf
 v_mfma_f32_16x16x32_bf16 v[76:79], v[180:183], a[236:239], v[76:79]
 v_exp_f32 v162, v162
 v_mfma_f32_16x16x32_bf16 v[80:83], v[180:183], a[240:243], v[80:83]
 v_exp_f32 v163, v163
 v_mfma_f32_16x16x32_bf16 v[84:87], v[180:183], a[244:247], v[84:87]
 v_exp_f32 v164, v164
 v_mfma_f32_16x16x32_bf16 v[88:91], v[180:183], a[248:251], v[88:91]
 v_exp_f32 v165, v165
 v_mfma_f32_16x16x32_bf16 v[92:95], v[180:183], a[252:255], v[92:95]
 v_exp_f32 v166, v166
 v_mfma_f32_16x16x32_bf16 v[168:171], a[192:195], v[220:223], v[148:151]
 ds_read_b128 a[236:239], v249 offset:1536
 ds_read_b128 a[240:243], v249 offset:2048
 v_mfma_f32_16x16x32_bf16 v[168:171], a[196:199], v[224:227], v[168:171]
 v_exp_f32 v167, v167
 v_mfma_f32_16x16x32_bf16 v[168:171], a[200:203], v[228:231], v[168:171]
 ds_read_b128 a[244:247], v249 offset:2560
 ds_read_b128 a[248:251], v249 offset:3072
 v_mfma_f32_16x16x32_bf16 v[168:171], a[204:207], v[232:235], v[168:171]
 v_cvt_pk_bf16_f32 v177, v162, v163
 v_cvt_pk_bf16_f32 v178, v164, v165
 v_mfma_f32_16x16x32_bf16 v[172:175], a[220:223], v[232:235], v[148:151]
 ds_read_b128 a[252:255], v249 offset:3584
 v_cvt_pk_bf16_f32 v179, v166, v167
 v_mfma_f32_16x16x32_bf16 v[172:175], a[216:219], v[228:231], v[172:175]
 v_mul_f32_dpp v39, v218, v39 row_newbcast:3 row_mask:0xf bank_mask:0xf
 v_cvt_pk_bf16_f32 v240, v35, v39
 v_mfma_f32_16x16x32_bf16 v[172:175], a[212:215], v[224:227], v[172:175]
 v_exp_f32 v168, v168
 v_mfma_f32_16x16x32_bf16 v[172:175], a[208:211], v[220:223], v[172:175]
 s_waitcnt lgkmcnt(3)
 v_exp_f32 v169, v169
 v_mfma_f32_16x16x32_bf16 v[96:99], v[176:179], a[224:227], v[96:99]
 v_exp_f32 v170, v170
 v_mfma_f32_16x16x32_bf16 v[100:103], v[176:179], a[228:231], v[100:103]
 v_exp_f32 v171, v171
 v_mfma_f32_16x16x32_bf16 v[104:107], v[176:179], a[232:235], v[104:107]
 v_cvt_pk_bf16_f32 v180, v168, v169
 v_cvt_pk_bf16_f32 v181, v170, v171
 v_mfma_f32_16x16x32_bf16 v[108:111], v[176:179], a[236:239], v[108:111]
 v_exp_f32 v172, v172
 v_mfma_f32_16x16x32_bf16 v[112:115], v[176:179], a[240:243], v[112:115]
 s_waitcnt lgkmcnt(0)
 v_exp_f32 v173, v173
 v_mfma_f32_16x16x32_bf16 v[116:119], v[176:179], a[244:247], v[116:119]
 v_exp_f32 v174, v174
 v_mfma_f32_16x16x32_bf16 v[120:123], v[176:179], a[248:251], v[120:123]
 v_exp_f32 v175, v175
 v_mfma_f32_16x16x32_bf16 v[124:127], v[176:179], a[252:255], v[124:127]
 v_cvt_pk_bf16_f32 v182, v172, v173
 v_cvt_pk_bf16_f32 v183, v174, v175
 v_mfma_f32_16x16x32_bf16 v[160:163], a[192:195], a[0:3], v[152:155]
 v_mul_f32_dpp v43, v218, v43 row_newbcast:3 row_mask:0xf bank_mask:0xf
 v_mul_f32_dpp v47, v218, v47 row_newbcast:3 row_mask:0xf bank_mask:0xf
 v_mfma_f32_16x16x32_bf16 v[160:163], a[196:199], a[4:7], v[160:163]
 v_cvt_pk_bf16_f32 v241, v43, v47
 v_mul_f32_dpp v51, v218, v51 row_newbcast:3 row_mask:0xf bank_mask:0xf
 v_mfma_f32_16x16x32_bf16 v[160:163], a[200:203], a[8:11], v[160:163]
 v_mul_f32_dpp v55, v218, v55 row_newbcast:3 row_mask:0xf bank_mask:0xf
 v_cvt_pk_bf16_f32 v242, v51, v55
 v_mfma_f32_16x16x32_bf16 v[160:163], a[204:207], a[12:15], v[160:163]
 v_mul_f32_dpp v59, v218, v59 row_newbcast:3 row_mask:0xf bank_mask:0xf
 v_mul_f32_dpp v63, v218, v63 row_newbcast:3 row_mask:0xf bank_mask:0xf
 v_mfma_f32_16x16x32_bf16 v[164:167], a[220:223], a[12:15], v[152:155]
 v_cvt_pk_bf16_f32 v243, v59, v63
 s_nop 0
 v_mfma_f32_16x16x32_bf16 v[164:167], a[216:219], a[8:11], v[164:167]
 buffer_store_dwordx4 v[240:243], v244, s[20:23], s33 offen offset:3072 sc1
 v_mfma_f32_16x16x32_bf16 v[164:167], a[212:215], a[4:7], v[164:167]
 v_exp_f32 v160, v160
 v_mfma_f32_16x16x32_bf16 v[164:167], a[208:211], a[0:3], v[164:167]
 v_exp_f32 v161, v161
 v_smfmac_f32_16x16x64_bf16 v[128:131], v[236:239], v[176:183], v138
 v_cvt_pk_bf16_f32 v176, v160, v161
 v_mfma_f32_16x16x32_bf16 v[184:187], v[180:183], a[224:227], v[184:187]
 v_exp_f32 v162, v162
 v_mfma_f32_16x16x32_bf16 v[188:191], v[180:183], a[228:231], v[188:191]
 v_exp_f32 v163, v163
 v_mfma_f32_16x16x32_bf16 v[192:195], v[180:183], a[232:235], v[192:195]
 v_exp_f32 v164, v164
 v_mfma_f32_16x16x32_bf16 v[196:199], v[180:183], a[236:239], v[196:199]
 v_exp_f32 v165, v165
 v_mfma_f32_16x16x32_bf16 v[200:203], v[180:183], a[240:243], v[200:203]
 v_exp_f32 v166, v166
 v_mfma_f32_16x16x32_bf16 v[204:207], v[180:183], a[244:247], v[204:207]
 v_exp_f32 v167, v167
 v_mfma_f32_16x16x32_bf16 v[208:211], v[180:183], a[248:251], v[208:211]
 v_cvt_pk_bf16_f32 v177, v162, v163
 v_cvt_pk_bf16_f32 v178, v164, v165
 v_mfma_f32_16x16x32_bf16 v[212:215], v[180:183], a[252:255], v[212:215]
 v_cvt_pk_bf16_f32 v179, v166, v167
 v_mfma_f32_16x16x32_bf16 v[168:171], a[192:195], a[32:35], v[156:159]
 ds_read_b128 a[192:195], v250 offset:8192
 v_mfma_f32_16x16x32_bf16 v[168:171], a[196:199], a[36:39], v[168:171]
 ds_read_b128 a[196:199], v250 offset:8704
 v_mfma_f32_16x16x32_bf16 v[168:171], a[200:203], a[40:43], v[168:171]
 ds_read_b128 a[200:203], v250 offset:9216
 v_mfma_f32_16x16x32_bf16 v[168:171], a[204:207], a[44:47], v[168:171]
 ds_read_b128 a[204:207], v250 offset:9728
 s_nop 0
 v_mfma_f32_16x16x32_bf16 v[172:175], a[220:223], a[44:47], v[156:159]
 buffer_load_dwordx4 a[44:47], v245, s[8:11], s32 offen offset:192
 v_mfma_f32_16x16x32_bf16 v[172:175], a[216:219], a[40:43], v[172:175]
 ds_read_b128 a[220:223], v250 offset:11776
 ds_read_b128 a[216:219], v250 offset:11264
 v_mfma_f32_16x16x32_bf16 v[172:175], a[212:215], a[36:39], v[172:175]
 v_exp_f32 v168, v168
 v_mfma_f32_16x16x32_bf16 v[172:175], a[208:211], a[32:35], v[172:175]
 v_exp_f32 v169, v169
 v_mfma_f32_16x16x32_bf16 v[0:3], v[176:179], a[224:227], v[0:3]
 buffer_load_dwordx4 a[32:35], v245, s[8:11], s32 offen offset:0
 v_mfma_f32_16x16x32_bf16 v[4:7], v[176:179], a[228:231], v[4:7]
 v_exp_f32 v170, v170
 v_mfma_f32_16x16x32_bf16 v[8:11], v[176:179], a[232:235], v[8:11]
 v_exp_f32 v171, v171
 v_mfma_f32_16x16x32_bf16 v[12:15], v[176:179], a[236:239], v[12:15]
 v_exp_f32 v173, v173
 v_mfma_f32_16x16x32_bf16 v[16:19], v[176:179], a[240:243], v[16:19]
 buffer_load_dwordx4 a[36:39], v245, s[8:11], s32 offen offset:64
 ds_read_b128 a[212:215], v250 offset:10752
 v_mfma_f32_16x16x32_bf16 v[20:23], v[176:179], a[244:247], v[20:23]
 ds_read_b128 a[208:211], v250 offset:10240
 v_exp_f32 v174, v174
 v_mfma_f32_16x16x32_bf16 v[24:27], v[176:179], a[248:251], v[24:27]
 v_exp_f32 v175, v175
 v_mfma_f32_16x16x32_bf16 v[28:31], v[176:179], a[252:255], v[28:31]
 s_waitcnt lgkmcnt(2)
 v_cvt_pk_bf16_f32 v180, v168, v169
 v_cvt_pk_bf16_f32 v181, v170, v171
 v_mfma_f32_16x16x32_bf16 v[160:163], a[192:195], a[48:51], v[144:147]
 buffer_load_dwordx4 a[40:43], v245, s[8:11], s32 offen offset:128
 v_mfma_f32_16x16x32_bf16 v[160:163], a[196:199], a[52:55], v[160:163]
 v_exp_f32 v172, v172
 v_mfma_f32_16x16x32_bf16 v[160:163], a[200:203], a[56:59], v[160:163]
 v_cvt_pk_bf16_f32 v182, v172, v173
 v_cvt_pk_bf16_f32 v183, v174, v175
 v_mfma_f32_16x16x32_bf16 v[160:163], a[204:207], a[60:63], v[160:163]
 s_nop 1
 v_mfma_f32_16x16x32_bf16 v[164:167], a[220:223], a[60:63], v[144:147]
 s_nop 1
 v_mfma_f32_16x16x32_bf16 v[164:167], a[216:219], a[56:59], v[164:167]
 s_waitcnt lgkmcnt(0)
 s_nop 1
 v_mfma_f32_16x16x32_bf16 v[164:167], a[212:215], a[52:55], v[164:167]
 v_exp_f32 v160, v160
 v_mfma_f32_16x16x32_bf16 v[164:167], a[208:211], a[48:51], v[164:167]
 v_exp_f32 v161, v161
 v_smfmac_f32_16x16x64_bf16 v[132:135], v[236:239], v[176:183], v138
 v_cvt_pk_bf16_f32 v176, v160, v161
 v_mfma_f32_16x16x32_bf16 v[64:67], v[180:183], a[224:227], v[64:67]
 v_exp_f32 v162, v162
 v_mfma_f32_16x16x32_bf16 v[68:71], v[180:183], a[228:231], v[68:71]
 v_exp_f32 v163, v163
 v_mfma_f32_16x16x32_bf16 v[72:75], v[180:183], a[232:235], v[72:75]
 ds_read_b128 a[232:235], v249 offset:9216
 ds_read_b128 a[224:227], v249 offset:8192
 v_mfma_f32_16x16x32_bf16 v[76:79], v[180:183], a[236:239], v[76:79]
 ds_read_b128 a[236:239], v249 offset:9728
 ds_read_b128 a[228:231], v249 offset:8704
 v_mfma_f32_16x16x32_bf16 v[80:83], v[180:183], a[240:243], v[80:83]
 ds_read_b128 a[240:243], v249 offset:10240
 v_cvt_pk_bf16_f32 v177, v162, v163
 v_mfma_f32_16x16x32_bf16 v[84:87], v[180:183], a[244:247], v[84:87]
 ds_read_b128 a[244:247], v249 offset:10752
 v_add_f32 v219, v134, v135
 v_mfma_f32_16x16x32_bf16 v[88:91], v[180:183], a[248:251], v[88:91]
 v_exp_f32 v164, v164
 v_mfma_f32_16x16x32_bf16 v[92:95], v[180:183], a[252:255], v[92:95]
 s_waitcnt vmcnt(8)
 v_exp_f32 v165, v165
 v_mfma_f32_16x16x32_bf16 v[252:255], a[192:195], a[16:19], 0
 v_exp_f32 v166, v166
 v_mfma_f32_16x16x32_bf16 v[252:255], a[196:199], a[20:23], v[252:255]
 v_exp_f32 v167, v167
 v_mfma_f32_16x16x32_bf16 v[252:255], a[200:203], a[24:27], v[252:255]
 ds_read_b128 a[248:251], v249 offset:11264
 v_cvt_pk_bf16_f32 v178, v164, v165
 v_mfma_f32_16x16x32_bf16 v[252:255], a[204:207], a[28:31], v[252:255]
 ds_read_b128 a[252:255], v249 offset:11776
 v_cvt_pk_bf16_f32 v179, v166, v167
 v_mfma_f32_16x16x32_bf16 v[168:171], a[192:195], v[220:223], v[148:151]
 v_mov_b32 v134, 0
 v_mov_b32 v135, 0
 v_mfma_f32_16x16x32_bf16 v[168:171], a[196:199], v[224:227], v[168:171]
 v_cmp_nge_f32 vcc, s28, v219
 s_nop 0
 v_mfma_f32_16x16x32_bf16 v[168:171], a[200:203], v[228:231], v[168:171]
 s_cmp_lg_u64 vcc, 0
 v_max3_f32 v246, v252, v253, v254
 v_max_f32 v246, v246, v255
 v_mfma_f32_16x16x32_bf16 v[168:171], a[204:207], v[232:235], v[168:171]
 s_cselect_b32 s34, 128, 0
 v_rcp_f32 v219, v219
 v_mfma_f32_16x16x32_bf16 v[172:175], a[220:223], v[232:235], v[148:151]
 s_or_b32 s29, s29, s34
 v_mov_b32 v247, v246
 v_mov_b32_dpp v219, v219 row_shl:4 row_mask:0x2 bank_mask:0xf
 v_mfma_f32_16x16x32_bf16 v[172:175], a[216:219], v[228:231], v[172:175]
 s_add_u32 s33, s25, 28672
 v_permlane16_swap_b32 v246, v247
 v_max_f32 v246, v246, v247
 v_mfma_f32_16x16x32_bf16 v[172:175], a[212:215], v[224:227], v[172:175]
 s_add_u32 s32, s25, 53248
 v_exp_f32 v168, v168
 v_mfma_f32_16x16x32_bf16 v[172:175], a[208:211], v[220:223], v[172:175]
 s_waitcnt lgkmcnt(0)
 v_exp_f32 v169, v169
 v_mfma_f32_16x16x32_bf16 v[96:99], v[176:179], a[224:227], v[96:99]
 v_exp_f32 v170, v170
 v_mfma_f32_16x16x32_bf16 v[100:103], v[176:179], a[228:231], v[100:103]
 v_exp_f32 v171, v171
 v_mfma_f32_16x16x32_bf16 v[104:107], v[176:179], a[232:235], v[104:107]
 v_cvt_pk_bf16_f32 v180, v168, v169
 v_cvt_pk_bf16_f32 v181, v170, v171
 v_mfma_f32_16x16x32_bf16 v[108:111], v[176:179], a[236:239], v[108:111]
 v_exp_f32 v175, v175
 v_mfma_f32_16x16x32_bf16 v[112:115], v[176:179], a[240:243], v[112:115]
 v_exp_f32 v172, v172
 v_mfma_f32_16x16x32_bf16 v[116:119], v[176:179], a[244:247], v[116:119]
 v_exp_f32 v173, v173
 v_mfma_f32_16x16x32_bf16 v[120:123], v[176:179], a[248:251], v[120:123]
 v_cvt_pk_bf16_f32 v182, v172, v173
 v_mov_b32 v247, v246
 v_mfma_f32_16x16x32_bf16 v[124:127], v[176:179], a[252:255], v[124:127]
 v_exp_f32 v174, v174
 v_mfma_f32_16x16x32_bf16 v[160:163], a[192:195], a[0:3], v[152:155]
 v_cvt_pk_bf16_f32 v183, v174, v175
 v_permlane32_swap_b32 v246, v247
 v_mfma_f32_16x16x32_bf16 v[160:163], a[196:199], a[4:7], v[160:163]
 v_min_f32 v246, -v246, -v247
 v_mov_b32 v156, v246
 v_mfma_f32_16x16x32_bf16 v[160:163], a[200:203], a[8:11], v[160:163]
 v_mov_b32 v157, v246
 v_mov_b32 v158, v246
 v_mfma_f32_16x16x32_bf16 v[160:163], a[204:207], a[12:15], v[160:163]
 ds_read_b128 a[192:195], v250 offset:16384
 v_mov_b32 v159, v246
 v_mfma_f32_16x16x32_bf16 v[164:167], a[220:223], a[12:15], v[152:155]
 ds_read_b128 a[196:199], v250 offset:16896
 ds_read_b128 a[200:203], v250 offset:17408
 v_mfma_f32_16x16x32_bf16 v[164:167], a[216:219], a[8:11], v[164:167]
 ds_read_b128 a[204:207], v250 offset:17920
 v_add_f32 v252, v252, v246
 v_mfma_f32_16x16x32_bf16 v[164:167], a[212:215], a[4:7], v[164:167]
 v_exp_f32 v161, v161
 v_mfma_f32_16x16x32_bf16 v[164:167], a[208:211], a[0:3], v[164:167]
 v_exp_f32 v162, v162
 v_smfmac_f32_16x16x64_bf16 v[128:131], v[236:239], v[176:183], v138
 v_add_f32 v253, v253, v246
 v_mfma_f32_16x16x32_bf16 v[184:187], v[180:183], a[224:227], v[184:187]
 v_exp_f32 v163, v163
 v_mfma_f32_16x16x32_bf16 v[188:191], v[180:183], a[228:231], v[188:191]
 v_exp_f32 v160, v160
 v_mfma_f32_16x16x32_bf16 v[192:195], v[180:183], a[232:235], v[192:195]
 v_exp_f32 v164, v164
 v_mfma_f32_16x16x32_bf16 v[196:199], v[180:183], a[236:239], v[196:199]
 v_exp_f32 v165, v165
 v_mfma_f32_16x16x32_bf16 v[200:203], v[180:183], a[240:243], v[200:203]
 v_exp_f32 v166, v166
 v_mfma_f32_16x16x32_bf16 v[204:207], v[180:183], a[244:247], v[204:207]
 v_exp_f32 v167, v167
 v_mfma_f32_16x16x32_bf16 v[208:211], v[180:183], a[248:251], v[208:211]
 v_cvt_pk_bf16_f32 v176, v160, v161
 v_cvt_pk_bf16_f32 v177, v162, v163
 v_mfma_f32_16x16x32_bf16 v[212:215], v[180:183], a[252:255], v[212:215]
 v_cvt_pk_bf16_f32 v178, v164, v165
 v_cvt_pk_bf16_f32 v179, v166, v167
 v_mfma_f32_16x16x32_bf16 v[172:175], a[220:223], a[28:31], v[156:159]
 ds_read_b128 a[220:223], v250 offset:19968
 v_add_f32 v254, v254, v246
 v_mfma_f32_16x16x32_bf16 v[172:175], a[216:219], a[24:27], v[172:175]
 ds_read_b128 a[216:219], v250 offset:19456
 v_add_f32 v255, v255, v246
 v_mfma_f32_16x16x32_bf16 v[172:175], a[212:215], a[20:23], v[172:175]
 v_exp_f32 v252, v252
 v_mfma_f32_16x16x32_bf16 v[172:175], a[208:211], a[16:19], v[172:175]
 v_exp_f32 v253, v253
 v_mfma_f32_16x16x32_bf16 v[0:3], v[176:179], a[224:227], v[0:3]
 v_exp_f32 v254, v254
 v_mfma_f32_16x16x32_bf16 v[4:7], v[176:179], a[228:231], v[4:7]
 v_exp_f32 v255, v255
 v_mfma_f32_16x16x32_bf16 v[8:11], v[176:179], a[232:235], v[8:11]
 ds_read_b128 a[212:215], v250 offset:18944
 ds_read_b128 a[208:211], v250 offset:18432
 v_mfma_f32_16x16x32_bf16 v[12:15], v[176:179], a[236:239], v[12:15]
 v_exp_f32 v172, v172
 v_mfma_f32_16x16x32_bf16 v[16:19], v[176:179], a[240:243], v[16:19]
 v_exp_f32 v173, v173
 v_mfma_f32_16x16x32_bf16 v[20:23], v[176:179], a[244:247], v[20:23]
 v_exp_f32 v174, v174
 v_mfma_f32_16x16x32_bf16 v[24:27], v[176:179], a[248:251], v[24:27]
 v_exp_f32 v175, v175
 v_mfma_f32_16x16x32_bf16 v[28:31], v[176:179], a[252:255], v[28:31]
 s_waitcnt lgkmcnt(2)
 v_cvt_pk_bf16_f32 v180, v252, v253
 v_cvt_pk_bf16_f32 v181, v254, v255
 v_mfma_f32_16x16x32_bf16 v[160:163], a[192:195], a[48:51], v[144:147]
 v_cvt_pk_bf16_f32 v182, v172, v173
 v_cvt_pk_bf16_f32 v183, v174, v175
 v_mfma_f32_16x16x32_bf16 v[160:163], a[196:199], a[52:55], v[160:163]
 v_mov_b32_dpp v219, v219 row_shl:8 row_mask:0x4 bank_mask:0xf
 s_nop 0
 v_mfma_f32_16x16x32_bf16 v[160:163], a[200:203], a[56:59], v[160:163]
 v_mov_b32_dpp v219, v219 row_shl:12 row_mask:0x8 bank_mask:0xf
 s_nop 0
 v_mfma_f32_16x16x32_bf16 v[160:163], a[204:207], a[60:63], v[160:163]
 v_mul_f32_dpp v64, v219, v64 row_newbcast:0 row_mask:0xf bank_mask:0xf
 v_mul_f32_dpp v68, v219, v68 row_newbcast:0 row_mask:0xf bank_mask:0xf
 v_mfma_f32_16x16x32_bf16 v[164:167], a[220:223], a[60:63], v[144:147]
 v_cvt_pk_bf16_f32 v240, v64, v68
 v_mul_f32_dpp v72, v219, v72 row_newbcast:0 row_mask:0xf bank_mask:0xf
 v_mfma_f32_16x16x32_bf16 v[164:167], a[216:219], a[56:59], v[164:167]
 s_waitcnt lgkmcnt(0)
 v_mul_f32_dpp v76, v219, v76 row_newbcast:0 row_mask:0xf bank_mask:0xf
 v_cvt_pk_bf16_f32 v241, v72, v76
 v_mfma_f32_16x16x32_bf16 v[164:167], a[212:215], a[52:55], v[164:167]
 v_exp_f32 v160, v160
 v_mfma_f32_16x16x32_bf16 v[164:167], a[208:211], a[48:51], v[164:167]
 v_exp_f32 v161, v161
 v_smfmac_f32_16x16x64_bf16 v[132:135], v[236:239], v[176:183], v138
 v_cvt_pk_bf16_f32 v176, v160, v161
 v_mfma_f32_16x16x32_bf16 v[32:35], v[180:183], a[224:227], 0
 ds_read_b128 a[224:227], v249 offset:16384
 v_mul_f32_dpp v80, v219, v80 row_newbcast:0 row_mask:0xf bank_mask:0xf
 v_mfma_f32_16x16x32_bf16 v[36:39], v[180:183], a[228:231], 0
 ds_read_b128 a[228:231], v249 offset:16896
 v_mul_f32_dpp v84, v219, v84 row_newbcast:0 row_mask:0xf bank_mask:0xf
 v_mfma_f32_16x16x32_bf16 v[40:43], v[180:183], a[232:235], 0
 ds_read_b128 a[232:235], v249 offset:17408
 v_cvt_pk_bf16_f32 v242, v80, v84
 v_mfma_f32_16x16x32_bf16 v[44:47], v[180:183], a[236:239], 0
 v_exp_f32 v162, v162
 v_mfma_f32_16x16x32_bf16 v[48:51], v[180:183], a[240:243], 0
 v_exp_f32 v163, v163
 v_mfma_f32_16x16x32_bf16 v[52:55], v[180:183], a[244:247], 0
 v_exp_f32 v164, v164
 v_mfma_f32_16x16x32_bf16 v[56:59], v[180:183], a[248:251], 0
 v_exp_f32 v165, v165
 v_mfma_f32_16x16x32_bf16 v[60:63], v[180:183], a[252:255], 0
 v_exp_f32 v166, v166
 v_mfma_f32_16x16x32_bf16 v[168:171], a[192:195], v[220:223], v[148:151]
 ds_read_b128 a[236:239], v249 offset:17920
 ds_read_b128 a[240:243], v249 offset:18432
 v_mfma_f32_16x16x32_bf16 v[168:171], a[196:199], v[224:227], v[168:171]
 v_exp_f32 v167, v167
 v_mfma_f32_16x16x32_bf16 v[168:171], a[200:203], v[228:231], v[168:171]
 ds_read_b128 a[244:247], v249 offset:18944
 ds_read_b128 a[248:251], v249 offset:19456
 v_mfma_f32_16x16x32_bf16 v[168:171], a[204:207], v[232:235], v[168:171]
 v_cvt_pk_bf16_f32 v177, v162, v163
 v_cvt_pk_bf16_f32 v178, v164, v165
 v_mfma_f32_16x16x32_bf16 v[172:175], a[220:223], v[232:235], v[148:151]
 ds_read_b128 a[252:255], v249 offset:19968
 v_cvt_pk_bf16_f32 v179, v166, v167
 v_mfma_f32_16x16x32_bf16 v[172:175], a[216:219], v[228:231], v[172:175]
 v_mul_f32_dpp v88, v219, v88 row_newbcast:0 row_mask:0xf bank_mask:0xf
 v_mul_f32_dpp v92, v219, v92 row_newbcast:0 row_mask:0xf bank_mask:0xf
 v_mfma_f32_16x16x32_bf16 v[172:175], a[212:215], v[224:227], v[172:175]
 v_exp_f32 v168, v168
 v_mfma_f32_16x16x32_bf16 v[172:175], a[208:211], v[220:223], v[172:175]
 s_waitcnt lgkmcnt(3)
 v_exp_f32 v169, v169
 v_mfma_f32_16x16x32_bf16 v[96:99], v[176:179], a[224:227], v[96:99]
 v_exp_f32 v170, v170
 v_mfma_f32_16x16x32_bf16 v[100:103], v[176:179], a[228:231], v[100:103]
 v_exp_f32 v171, v171
 v_mfma_f32_16x16x32_bf16 v[104:107], v[176:179], a[232:235], v[104:107]
 v_cvt_pk_bf16_f32 v180, v168, v169
 v_cvt_pk_bf16_f32 v181, v170, v171
 v_mfma_f32_16x16x32_bf16 v[108:111], v[176:179], a[236:239], v[108:111]
 v_exp_f32 v172, v172
 v_mfma_f32_16x16x32_bf16 v[112:115], v[176:179], a[240:243], v[112:115]
 s_waitcnt lgkmcnt(0)
 v_exp_f32 v173, v173
 v_mfma_f32_16x16x32_bf16 v[116:119], v[176:179], a[244:247], v[116:119]
 v_exp_f32 v174, v174
 v_mfma_f32_16x16x32_bf16 v[120:123], v[176:179], a[248:251], v[120:123]
 v_exp_f32 v175, v175
 v_mfma_f32_16x16x32_bf16 v[124:127], v[176:179], a[252:255], v[124:127]
 v_cvt_pk_bf16_f32 v182, v172, v173
 v_cvt_pk_bf16_f32 v183, v174, v175
 v_mfma_f32_16x16x32_bf16 v[160:163], a[192:195], a[0:3], v[152:155]
 v_cvt_pk_bf16_f32 v243, v88, v92
 v_mul_f32_dpp v65, v219, v65 row_newbcast:1 row_mask:0xf bank_mask:0xf
 v_mfma_f32_16x16x32_bf16 v[160:163], a[196:199], a[4:7], v[160:163]
 buffer_store_dwordx4 v[240:243], v244, s[20:23], s33 offen offset:0 sc1
 v_mfma_f32_16x16x32_bf16 v[160:163], a[200:203], a[8:11], v[160:163]
 v_mul_f32_dpp v69, v219, v69 row_newbcast:1 row_mask:0xf bank_mask:0xf
 v_cvt_pk_bf16_f32 v240, v65, v69
 v_mfma_f32_16x16x32_bf16 v[160:163], a[204:207], a[12:15], v[160:163]
 v_mul_f32_dpp v73, v219, v73 row_newbcast:1 row_mask:0xf bank_mask:0xf
 v_mul_f32_dpp v77, v219, v77 row_newbcast:1 row_mask:0xf bank_mask:0xf
 v_mfma_f32_16x16x32_bf16 v[164:167], a[220:223], a[12:15], v[152:155]
 v_cvt_pk_bf16_f32 v241, v73, v77
 v_mul_f32_dpp v81, v219, v81 row_newbcast:1 row_mask:0xf bank_mask:0xf
 v_mfma_f32_16x16x32_bf16 v[164:167], a[216:219], a[8:11], v[164:167]
 v_mul_f32_dpp v85, v219, v85 row_newbcast:1 row_mask:0xf bank_mask:0xf
 v_cvt_pk_bf16_f32 v242, v81, v85
 v_mfma_f32_16x16x32_bf16 v[164:167], a[212:215], a[4:7], v[164:167]
 v_exp_f32 v160, v160
 v_mfma_f32_16x16x32_bf16 v[164:167], a[208:211], a[0:3], v[164:167]
 v_exp_f32 v161, v161
 v_smfmac_f32_16x16x64_bf16 v[128:131], v[236:239], v[176:183], v138
 v_cvt_pk_bf16_f32 v176, v160, v161
 v_mfma_f32_16x16x32_bf16 v[184:187], v[180:183], a[224:227], v[184:187]
 v_exp_f32 v162, v162
 v_mfma_f32_16x16x32_bf16 v[188:191], v[180:183], a[228:231], v[188:191]
 v_exp_f32 v163, v163
 v_mfma_f32_16x16x32_bf16 v[192:195], v[180:183], a[232:235], v[192:195]
 v_exp_f32 v164, v164
 v_mfma_f32_16x16x32_bf16 v[196:199], v[180:183], a[236:239], v[196:199]
 v_exp_f32 v165, v165
 v_mfma_f32_16x16x32_bf16 v[200:203], v[180:183], a[240:243], v[200:203]
 v_exp_f32 v166, v166
 v_mfma_f32_16x16x32_bf16 v[204:207], v[180:183], a[244:247], v[204:207]
 v_exp_f32 v167, v167
 v_mfma_f32_16x16x32_bf16 v[208:211], v[180:183], a[248:251], v[208:211]
 v_cvt_pk_bf16_f32 v177, v162, v163
 v_cvt_pk_bf16_f32 v178, v164, v165
 v_mfma_f32_16x16x32_bf16 v[212:215], v[180:183], a[252:255], v[212:215]
 v_cvt_pk_bf16_f32 v179, v166, v167
 v_mul_f32_dpp v89, v219, v89 row_newbcast:1 row_mask:0xf bank_mask:0xf
 v_mfma_f32_16x16x32_bf16 v[168:171], a[192:195], a[16:19], v[156:159]
 ds_read_b128 a[192:195], v250 offset:24576
 v_mul_f32_dpp v93, v219, v93 row_newbcast:1 row_mask:0xf bank_mask:0xf
 v_mfma_f32_16x16x32_bf16 v[168:171], a[196:199], a[20:23], v[168:171]
 ds_read_b128 a[196:199], v250 offset:25088
 v_cvt_pk_bf16_f32 v243, v89, v93
 v_mfma_f32_16x16x32_bf16 v[168:171], a[200:203], a[24:27], v[168:171]
 buffer_store_dwordx4 v[240:243], v244, s[20:23], s33 offen offset:1024 sc1
 v_mfma_f32_16x16x32_bf16 v[168:171], a[204:207], a[28:31], v[168:171]
 ds_read_b128 a[200:203], v250 offset:25600
 ds_read_b128 a[204:207], v250 offset:26112
 v_mfma_f32_16x16x32_bf16 v[172:175], a[220:223], a[28:31], v[156:159]
L_pg9:
 s_cbranch_execz L_wb0
 ds_read_b128 a[220:223], v250 offset:28160
 v_mul_f32_dpp v66, v219, v66 row_newbcast:2 row_mask:0xf bank_mask:0xf
 v_mfma_f32_16x16x32_bf16 v[172:175], a[216:219], a[24:27], v[172:175]
 ds_read_b128 a[216:219], v250 offset:27648
 v_mul_f32_dpp v70, v219, v70 row_newbcast:2 row_mask:0xf bank_mask:0xf
 v_mfma_f32_16x16x32_bf16 v[172:175], a[212:215], a[20:23], v[172:175]
 ds_read_b128 a[212:215], v250 offset:27136
 v_cvt_pk_bf16_f32 v240, v66, v70
 v_mfma_f32_16x16x32_bf16 v[172:175], a[208:211], a[16:19], v[172:175]
 s_mov_b64 exec, 0
 s_cmp_eq_u32 s24, 0
 s_cbranch_scc1 L_pg12
 s_cmp_eq_u32 s24, 1
 s_cbranch_scc1 L_pg13
 s_cmp_eq_u32 s24, 2
 s_cbranch_scc1 L_pg14
 s_branch L_pg15
L_wb1:
 s_mov_b64 exec, -1
 ds_read_b128 a[208:211], v250 offset:26624
 v_mul_f32_dpp v74, v219, v74 row_newbcast:2 row_mask:0xf bank_mask:0xf
 v_mfma_f32_16x16x32_bf16 v[0:3], v[176:179], a[224:227], v[0:3]
 v_exp_f32 v168, v168
 v_mfma_f32_16x16x32_bf16 v[4:7], v[176:179], a[228:231], v[4:7]
 v_exp_f32 v169, v169
 v_mfma_f32_16x16x32_bf16 v[8:11], v[176:179], a[232:235], v[8:11]
 v_exp_f32 v170, v170
 v_mfma_f32_16x16x32_bf16 v[12:15], v[176:179], a[236:239], v[12:15]
 v_exp_f32 v171, v171
 v_mfma_f32_16x16x32_bf16 v[16:19], v[176:179], a[240:243], v[16:19]
 v_exp_f32 v172, v172
 v_mfma_f32_16x16x32_bf16 v[20:23], v[176:179], a[244:247], v[20:23]
 v_exp_f32 v173, v173
 v_mfma_f32_16x16x32_bf16 v[24:27], v[176:179], a[248:251], v[24:27]
 v_exp_f32 v174, v174
 v_mfma_f32_16x16x32_bf16 v[28:31], v[176:179], a[252:255], v[28:31]
 s_waitcnt lgkmcnt(0)
 v_exp_f32 v175, v175
 v_mfma_f32_16x16x32_bf16 v[160:163], a[192:195], a[48:51], v[144:147]
 v_cvt_pk_bf16_f32 v180, v168, v169
 v_cvt_pk_bf16_f32 v181, v170, v171
 v_mfma_f32_16x16x32_bf16 v[160:163], a[196:199], a[52:55], v[160:163]
 v_cvt_pk_bf16_f32 v182, v172, v173
 v_cvt_pk_bf16_f32 v183, v174, v175
 v_mfma_f32_16x16x32_bf16 v[160:163], a[200:203], a[56:59], v[160:163]
 v_mul_f32_dpp v78, v219, v78 row_newbcast:2 row_mask:0xf bank_mask:0xf
 v_cvt_pk_bf16_f32 v241, v74, v78
 v_mfma_f32_16x16x32_bf16 v[160:163], a[204:207], a[60:63], v[160:163]
 v_mul_f32_dpp v82, v219, v82 row_newbcast:2 row_mask:0xf bank_mask:0xf
 v_mul_f32_dpp v86, v219, v86 row_newbcast:2 row_mask:0xf bank_mask:0xf
 v_mfma_f32_16x16x32_bf16 v[164:167], a[220:223], a[60:63], v[144:147]
 buffer_load_dwordx4 a[60:63], v245, s[8:11], s32 offen offset:192
 v_mfma_f32_16x16x32_bf16 v[164:167], a[216:219], a[56:59], v[164:167]
 v_cvt_pk_bf16_f32 v242, v82, v86
 v_mul_f32_dpp v90, v219, v90 row_newbcast:2 row_mask:0xf bank_mask:0xf
 v_mfma_f32_16x16x32_bf16 v[164:167], a[212:215], a[52:55], v[164:167]
 v_exp_f32 v160, v160
 v_mfma_f32_16x16x32_bf16 v[164:167], a[208:211], a[48:51], v[164:167]
 v_exp_f32 v161, v161
 v_smfmac_f32_16x16x64_bf16 v[132:135], v[236:239], v[176:183], v138
 v_cvt_pk_bf16_f32 v176, v160, v161
 v_mfma_f32_16x16x32_bf16 v[32:35], v[180:183], a[224:227], v[32:35]
 buffer_load_dwordx4 a[48:51], v245, s[8:11], s32 offen offset:0
 v_mfma_f32_16x16x32_bf16 v[36:39], v[180:183], a[228:231], v[36:39]
 v_exp_f32 v162, v162
 v_mfma_f32_16x16x32_bf16 v[40:43], v[180:183], a[232:235], v[40:43]
 v_exp_f32 v163, v163
 v_mfma_f32_16x16x32_bf16 v[44:47], v[180:183], a[236:239], v[44:47]
 v_exp_f32 v164, v164
 v_mfma_f32_16x16x32_bf16 v[48:51], v[180:183], a[240:243], v[48:51]
 buffer_load_dwordx4 a[52:55], v245, s[8:11], s32 offen offset:64
 v_mfma_f32_16x16x32_bf16 v[52:55], v[180:183], a[244:247], v[52:55]
 v_exp_f32 v165, v165
 v_mfma_f32_16x16x32_bf16 v[56:59], v[180:183], a[248:251], v[56:59]
 ds_read_b128 a[224:227], v249 offset:24576
 v_exp_f32 v166, v166
 v_mfma_f32_16x16x32_bf16 v[60:63], v[180:183], a[252:255], v[60:63]
 ds_read_b128 a[228:231], v249 offset:25088
 v_exp_f32 v167, v167
 v_mfma_f32_16x16x32_bf16 v[168:171], a[192:195], v[220:223], v[148:151]
 buffer_load_dwordx4 a[56:59], v245, s[8:11], s32 offen offset:128
 ds_read_b128 a[232:235], v249 offset:25600
 v_mfma_f32_16x16x32_bf16 v[168:171], a[196:199], v[224:227], v[168:171]
 ds_read_b128 a[248:251], v249 offset:27648
 ds_read_b128 a[236:239], v249 offset:26112
 v_cvt_pk_bf16_f32 v177, v162, v163
 v_mfma_f32_16x16x32_bf16 v[168:171], a[200:203], v[228:231], v[168:171]
 ds_read_b128 a[240:243], v249 offset:26624
 v_cvt_pk_bf16_f32 v178, v164, v165
 v_cvt_pk_bf16_f32 v179, v166, v167
 v_mfma_f32_16x16x32_bf16 v[168:171], a[204:207], v[232:235], v[168:171]
 ds_read_b128 a[244:247], v249 offset:27136
 ds_read_b128 a[252:255], v249 offset:28160
 v_mfma_f32_16x16x32_bf16 v[172:175], a[220:223], v[232:235], v[148:151]
 v_mul_f32_dpp v94, v219, v94 row_newbcast:2 row_mask:0xf bank_mask:0xf
 v_cvt_pk_bf16_f32 v243, v90, v94
 v_mfma_f32_16x16x32_bf16 v[172:175], a[216:219], v[228:231], v[172:175]
 buffer_store_dwordx4 v[240:243], v244, s[20:23], s33 offen offset:2048 sc1
 v_mfma_f32_16x16x32_bf16 v[172:175], a[212:215], v[224:227], v[172:175]
 v_exp_f32 v168, v168
 v_mfma_f32_16x16x32_bf16 v[172:175], a[208:211], v[220:223], v[172:175]
 s_waitcnt lgkmcnt(5)
 v_exp_f32 v169, v169
 v_mfma_f32_16x16x32_bf16 v[96:99], v[176:179], a[224:227], v[96:99]
 v_exp_f32 v170, v170
 v_mfma_f32_16x16x32_bf16 v[100:103], v[176:179], a[228:231], v[100:103]
 v_exp_f32 v171, v171
 v_mfma_f32_16x16x32_bf16 v[104:107], v[176:179], a[232:235], v[104:107]
 s_waitcnt lgkmcnt(0)
 v_cvt_pk_bf16_f32 v180, v168, v169
 v_cvt_pk_bf16_f32 v181, v170, v171
 v_mfma_f32_16x16x32_bf16 v[108:111], v[176:179], a[236:239], v[108:111]
 v_exp_f32 v172, v172
 v_mfma_f32_16x16x32_bf16 v[112:115], v[176:179], a[240:243], v[112:115]
 v_exp_f32 v173, v173
 v_mfma_f32_16x16x32_bf16 v[116:119], v[176:179], a[244:247], v[116:119]
 v_exp_f32 v174, v174
 v_mfma_f32_16x16x32_bf16 v[120:123], v[176:179], a[248:251], v[120:123]
 v_exp_f32 v175, v175
 v_mfma_f32_16x16x32_bf16 v[124:127], v[176:179], a[252:255], v[124:127]
 s_waitcnt vmcnt(7)
 v_cvt_pk_bf16_f32 v182, v172, v173
 v_cvt_pk_bf16_f32 v183, v174, v175
 v_mfma_f32_16x16x32_bf16 v[252:255], a[64:67], a[32:35], 0
 v_mul_f32_dpp v67, v219, v67 row_newbcast:3 row_mask:0xf bank_mask:0xf
 v_mul_f32_dpp v71, v219, v71 row_newbcast:3 row_mask:0xf bank_mask:0xf
 v_mfma_f32_16x16x32_bf16 v[252:255], a[68:71], a[36:39], v[252:255]
 v_cvt_pk_bf16_f32 v240, v67, v71
 v_mul_f32_dpp v75, v219, v75 row_newbcast:3 row_mask:0xf bank_mask:0xf
 v_mfma_f32_16x16x32_bf16 v[252:255], a[72:75], a[40:43], v[252:255]
 v_mul_f32_dpp v79, v219, v79 row_newbcast:3 row_mask:0xf bank_mask:0xf
 v_cvt_pk_bf16_f32 v241, v75, v79
 v_mfma_f32_16x16x32_bf16 v[252:255], a[76:79], a[44:47], v[252:255]
 v_mul_f32_dpp v83, v219, v83 row_newbcast:3 row_mask:0xf bank_mask:0xf
 v_mul_f32_dpp v87, v219, v87 row_newbcast:3 row_mask:0xf bank_mask:0xf
 v_mfma_f32_16x16x32_bf16 v[160:163], a[192:195], a[0:3], v[152:155]
 v_cvt_pk_bf16_f32 v242, v83, v87
 v_mul_f32_dpp v91, v219, v91 row_newbcast:3 row_mask:0xf bank_mask:0xf
 v_mfma_f32_16x16x32_bf16 v[160:163], a[196:199], a[4:7], v[160:163]
 v_mul_f32_dpp v95, v219, v95 row_newbcast:3 row_mask:0xf bank_mask:0xf
 v_cvt_pk_bf16_f32 v243, v91, v95
 v_mfma_f32_16x16x32_bf16 v[160:163], a[200:203], a[8:11], v[160:163]
 buffer_store_dwordx4 v[240:243], v244, s[20:23], s33 offen offset:3072 sc1
 v_mfma_f32_16x16x32_bf16 v[160:163], a[204:207], a[12:15], v[160:163]
 v_max3_f32 v246, v252, v253, v254
 v_max_f32 v246, v246, v255
 v_mfma_f32_16x16x32_bf16 v[164:167], a[220:223], a[12:15], v[152:155]
 v_mov_b32 v247, v246
 s_nop 0
 v_mfma_f32_16x16x32_bf16 v[164:167], a[216:219], a[8:11], v[164:167]
 v_permlane16_swap_b32 v246, v247
 v_max_f32 v246, v246, v247
 v_mfma_f32_16x16x32_bf16 v[164:167], a[212:215], a[4:7], v[164:167]
 v_exp_f32 v160, v160
 v_mfma_f32_16x16x32_bf16 v[164:167], a[208:211], a[0:3], v[164:167]
 v_exp_f32 v161, v161
 v_smfmac_f32_16x16x64_bf16 v[128:131], v[236:239], v[176:183], v138
 v_cvt_pk_bf16_f32 v176, v160, v161
 v_mfma_f32_16x16x32_bf16 v[184:187], v[180:183], a[224:227], v[184:187]
 v_exp_f32 v162, v162
 v_mfma_f32_16x16x32_bf16 v[188:191], v[180:183], a[228:231], v[188:191]
 v_exp_f32 v163, v163
 v_mfma_f32_16x16x32_bf16 v[192:195], v[180:183], a[232:235], v[192:195]
 v_exp_f32 v166, v166
 v_mfma_f32_16x16x32_bf16 v[196:199], v[180:183], a[236:239], v[196:199]
 v_exp_f32 v167, v167
 v_mfma_f32_16x16x32_bf16 v[200:203], v[180:183], a[240:243], v[200:203]
 v_cvt_pk_bf16_f32 v177, v162, v163
 v_cvt_pk_bf16_f32 v179, v166, v167
 v_mfma_f32_16x16x32_bf16 v[204:207], v[180:183], a[244:247], v[204:207]
 v_exp_f32 v164, v164
 v_mfma_f32_16x16x32_bf16 v[208:211], v[180:183], a[248:251], v[208:211]
 v_exp_f32 v165, v165
 v_mfma_f32_16x16x32_bf16 v[212:215], v[180:183], a[252:255], v[212:215]
 v_cvt_pk_bf16_f32 v178, v164, v165
 v_mov_b32 v247, v246
 v_mfma_f32_16x16x32_bf16 v[168:171], a[192:195], a[16:19], v[156:159]
 v_add_f32 v216, v128, v129
 v_permlane32_swap_b32 v246, v247
 v_mfma_f32_16x16x32_bf16 v[168:171], a[196:199], a[20:23], v[168:171]
 v_min_f32 v246, -v246, -v247
 v_mov_b32 v144, v246
 v_mfma_f32_16x16x32_bf16 v[168:171], a[200:203], a[24:27], v[168:171]
 v_mov_b32 v145, v246
 v_mov_b32 v146, v246
 v_mfma_f32_16x16x32_bf16 v[168:171], a[204:207], a[28:31], v[168:171]
 v_mov_b32 v147, v246
 v_add_f32 v252, v252, v246
 v_mfma_f32_16x16x32_bf16 v[172:175], a[220:223], a[28:31], v[156:159]
 v_add_f32 v253, v253, v246
 v_add_f32 v254, v254, v246
 v_mfma_f32_16x16x32_bf16 v[172:175], a[216:219], a[24:27], v[172:175]
 v_exp_f32 v252, v252
 v_mfma_f32_16x16x32_bf16 v[172:175], a[212:215], a[20:23], v[172:175]
 v_exp_f32 v170, v170
 v_mfma_f32_16x16x32_bf16 v[172:175], a[208:211], a[16:19], v[172:175]
 v_exp_f32 v168, v168
 v_mfma_f32_16x16x32_bf16 v[0:3], v[176:179], a[224:227], v[0:3]
 v_exp_f32 v169, v169
 v_mfma_f32_16x16x32_bf16 v[4:7], v[176:179], a[228:231], v[4:7]
 v_exp_f32 v171, v171
 v_mfma_f32_16x16x32_bf16 v[8:11], v[176:179], a[232:235], v[8:11]
 v_cvt_pk_bf16_f32 v180, v168, v169
 v_cvt_pk_bf16_f32 v181, v170, v171
 v_mfma_f32_16x16x32_bf16 v[12:15], v[176:179], a[236:239], v[12:15]
 v_exp_f32 v174, v174
 v_mfma_f32_16x16x32_bf16 v[16:19], v[176:179], a[240:243], v[16:19]
 v_exp_f32 v175, v175
 v_mfma_f32_16x16x32_bf16 v[20:23], v[176:179], a[244:247], v[20:23]
 v_cvt_pk_bf16_f32 v183, v174, v175
 v_add_f32 v255, v255, v246
 v_mfma_f32_16x16x32_bf16 v[24:27], v[176:179], a[248:251], v[24:27]
 v_exp_f32 v172, v172
 v_mfma_f32_16x16x32_bf16 v[28:31], v[176:179], a[252:255], v[28:31]
 v_exp_f32 v173, v173
 v_mfma_f32_16x16x32_bf16 v[164:167], a[92:95], a[44:47], v[144:147]
 v_cvt_pk_bf16_f32 v182, v172, v173
 v_mov_b32 v128, 0
 v_mfma_f32_16x16x32_bf16 v[164:167], a[88:91], a[40:43], v[164:167]
 v_exp_f32 v253, v253
 v_mfma_f32_16x16x32_bf16 v[164:167], a[84:87], a[36:39], v[164:167]
 v_exp_f32 v254, v254
 v_mfma_f32_16x16x32_bf16 v[164:167], a[80:83], a[32:35], v[164:167]
 v_exp_f32 v255, v255
 v_smfmac_f32_16x16x64_bf16 v[132:135], v[236:239], v[176:183], v138
 v_cvt_pk_bf16_f32 v176, v252, v253
 v_mfma_f32_16x16x32_bf16 v[32:35], v[180:183], a[224:227], v[32:35]
 ds_read_b128 a[224:227], v248 offset:0
 v_cvt_pk_bf16_f32 v177, v254, v255
 v_mfma_f32_16x16x32_bf16 v[36:39], v[180:183], a[228:231], v[36:39]
 ds_read_b128 a[228:231], v248 offset:512
 v_mov_b32 v129, 0
 v_mfma_f32_16x16x32_bf16 v[40:43], v[180:183], a[232:235], v[40:43]
 v_exp_f32 v164, v164
 v_mfma_f32_16x16x32_bf16 v[44:47], v[180:183], a[236:239], v[44:47]
 v_exp_f32 v165, v165
 v_mfma_f32_16x16x32_bf16 v[48:51], v[180:183], a[240:243], v[48:51]
 v_exp_f32 v166, v166
 v_mfma_f32_16x16x32_bf16 v[52:55], v[180:183], a[244:247], v[52:55]
 v_exp_f32 v167, v167
 v_mfma_f32_16x16x32_bf16 v[56:59], v[180:183], a[248:251], v[56:59]
 v_cvt_pk_bf16_f32 v178, v164, v165
 v_cvt_pk_bf16_f32 v179, v166, v167
 v_mfma_f32_16x16x32_bf16 v[60:63], v[180:183], a[252:255], v[60:63]
 ds_read_b128 a[232:235], v248 offset:1024
 ds_read_b128 a[236:239], v248 offset:1536
 v_mfma_f32_16x16x32_bf16 v[168:171], a[64:67], v[220:223], v[148:151]
 ds_read_b128 a[240:243], v248 offset:2048
 ds_read_b128 a[244:247], v248 offset:2560
 v_mfma_f32_16x16x32_bf16 v[168:171], a[68:71], v[224:227], v[168:171]
 ds_read_b128 a[248:251], v248 offset:3072
 ds_read_b128 a[252:255], v248 offset:3584
 v_mfma_f32_16x16x32_bf16 v[168:171], a[72:75], v[228:231], v[168:171]
 ds_read_b128 a[192:195], v249 offset:32768
 v_cmp_nge_f32 vcc, s28, v216
 v_mfma_f32_16x16x32_bf16 v[168:171], a[76:79], v[232:235], v[168:171]
 s_cmp_lg_u64 vcc, 0
 v_rcp_f32 v216, v216
 v_mfma_f32_16x16x32_bf16 v[172:175], a[92:95], v[232:235], v[148:151]
 s_cselect_b32 s34, 256, 0
 s_or_b32 s29, s29, s34
 v_mov_b32_dpp v216, v216 row_shl:4 row_mask:0x2 bank_mask:0xf
 v_mfma_f32_16x16x32_bf16 v[172:175], a[88:91], v[228:231], v[172:175]
 s_add_u32 s33, s25, 32768
 v_exp_f32 v168, v168
 v_mfma_f32_16x16x32_bf16 v[172:175], a[84:87], v[224:227], v[172:175]
 s_add_u32 s32, s25, 57344
 v_exp_f32 v169, v169
 v_mfma_f32_16x16x32_bf16 v[172:175], a[80:83], v[220:223], v[172:175]
 s_waitcnt lgkmcnt(3)
 v_exp_f32 v170, v170
 v_mfma_f32_16x16x32_bf16 v[64:67], v[176:179], a[224:227], 0
 v_exp_f32 v171, v171
 v_mfma_f32_16x16x32_bf16 v[68:71], v[176:179], a[228:231], 0
 v_cvt_pk_bf16_f32 v180, v168, v169
 v_cvt_pk_bf16_f32 v181, v170, v171
 v_mfma_f32_16x16x32_bf16 v[72:75], v[176:179], a[232:235], 0
 ds_read_b128 a[196:199], v249 offset:33280
 v_mov_b32_dpp v216, v216 row_shl:8 row_mask:0x4 bank_mask:0xf
 v_mfma_f32_16x16x32_bf16 v[76:79], v[176:179], a[236:239], 0
 v_exp_f32 v172, v172
 v_mfma_f32_16x16x32_bf16 v[80:83], v[176:179], a[240:243], 0
 v_exp_f32 v173, v173
 v_mfma_f32_16x16x32_bf16 v[84:87], v[176:179], a[244:247], 0
 s_waitcnt lgkmcnt(1)
 v_exp_f32 v174, v174
 v_mfma_f32_16x16x32_bf16 v[88:91], v[176:179], a[248:251], 0
 v_exp_f32 v175, v175
 v_mfma_f32_16x16x32_bf16 v[92:95], v[176:179], a[252:255], 0
 v_cvt_pk_bf16_f32 v182, v172, v173
 v_cvt_pk_bf16_f32 v183, v174, v175
 v_mfma_f32_16x16x32_bf16 v[160:163], a[64:67], a[0:3], v[152:155]
 ds_read_b128 a[200:203], v249 offset:33792
 v_mov_b32_dpp v216, v216 row_shl:12 row_mask:0x8 bank_mask:0xf
 v_mfma_f32_16x16x32_bf16 v[160:163], a[68:71], a[4:7], v[160:163]
 ds_read_b128 a[204:207], v249 offset:34304
 v_mul_f32_dpp v96, v216, v96 row_newbcast:0 row_mask:0xf bank_mask:0xf
 v_mfma_f32_16x16x32_bf16 v[160:163], a[72:75], a[8:11], v[160:163]
 v_mul_f32_dpp v100, v216, v100 row_newbcast:0 row_mask:0xf bank_mask:0xf
 v_cvt_pk_bf16_f32 v240, v96, v100
 v_mfma_f32_16x16x32_bf16 v[160:163], a[76:79], a[12:15], v[160:163]
 v_mul_f32_dpp v104, v216, v104 row_newbcast:0 row_mask:0xf bank_mask:0xf
 v_mul_f32_dpp v108, v216, v108 row_newbcast:0 row_mask:0xf bank_mask:0xf
 v_mfma_f32_16x16x32_bf16 v[164:167], a[92:95], a[12:15], v[152:155]
 v_cvt_pk_bf16_f32 v241, v104, v108
 v_mul_f32_dpp v112, v216, v112 row_newbcast:0 row_mask:0xf bank_mask:0xf
 v_mfma_f32_16x16x32_bf16 v[164:167], a[88:91], a[8:11], v[164:167]
 v_mul_f32_dpp v116, v216, v116 row_newbcast:0 row_mask:0xf bank_mask:0xf
 v_cvt_pk_bf16_f32 v242, v112, v116
 v_mfma_f32_16x16x32_bf16 v[164:167], a[84:87], a[4:7], v[164:167]
 v_exp_f32 v160, v160
 v_mfma_f32_16x16x32_bf16 v[164:167], a[80:83], a[0:3], v[164:167]
 v_exp_f32 v161, v161
 v_smfmac_f32_16x16x64_bf16 v[128:131], v[236:239], v[176:183], v138
 v_cvt_pk_bf16_f32 v176, v160, v161
 v_mfma_f32_16x16x32_bf16 v[184:187], v[180:183], a[224:227], v[184:187]
 v_exp_f32 v162, v162
 v_mfma_f32_16x16x32_bf16 v[188:191], v[180:183], a[228:231], v[188:191]
 v_exp_f32 v163, v163
 v_mfma_f32_16x16x32_bf16 v[192:195], v[180:183], a[232:235], v[192:195]
 v_exp_f32 v164, v164
 v_mfma_f32_16x16x32_bf16 v[196:199], v[180:183], a[236:239], v[196:199]
 v_exp_f32 v165, v165
 v_mfma_f32_16x16x32_bf16 v[200:203], v[180:183], a[240:243], v[200:203]
 v_exp_f32 v166, v166
 v_mfma_f32_16x16x32_bf16 v[204:207], v[180:183], a[244:247], v[204:207]
 v_exp_f32 v167, v167
 v_mfma_f32_16x16x32_bf16 v[208:211], v[180:183], a[248:251], v[208:211]
 v_cvt_pk_bf16_f32 v177, v162, v163
 v_cvt_pk_bf16_f32 v178, v164, v165
 v_mfma_f32_16x16x32_bf16 v[212:215], v[180:183], a[252:255], v[212:215]
 v_cvt_pk_bf16_f32 v179, v166, v167
 v_mul_f32_dpp v120, v216, v120 row_newbcast:0 row_mask:0xf bank_mask:0xf
 v_mfma_f32_16x16x32_bf16 v[168:171], a[64:67], a[16:19], v[156:159]
 v_mul_f32_dpp v124, v216, v124 row_newbcast:0 row_mask:0xf bank_mask:0xf
 v_cvt_pk_bf16_f32 v243, v120, v124
 v_mfma_f32_16x16x32_bf16 v[168:171], a[68:71], a[20:23], v[168:171]
 buffer_store_dwordx4 v[240:243], v244, s[20:23], s33 offen offset:0 sc1
 v_mfma_f32_16x16x32_bf16 v[168:171], a[72:75], a[24:27], v[168:171]
 v_mul_f32_dpp v97, v216, v97 row_newbcast:1 row_mask:0xf bank_mask:0xf
 v_mul_f32_dpp v101, v216, v101 row_newbcast:1 row_mask:0xf bank_mask:0xf
 v_mfma_f32_16x16x32_bf16 v[168:171], a[76:79], a[28:31], v[168:171]
 v_cvt_pk_bf16_f32 v240, v97, v101
 v_mul_f32_dpp v105, v216, v105 row_newbcast:1 row_mask:0xf bank_mask:0xf
 v_mfma_f32_16x16x32_bf16 v[172:175], a[92:95], a[28:31], v[156:159]
 v_mul_f32_dpp v109, v216, v109 row_newbcast:1 row_mask:0xf bank_mask:0xf
 v_cvt_pk_bf16_f32 v241, v105, v109
 v_mfma_f32_16x16x32_bf16 v[172:175], a[88:91], a[24:27], v[172:175]
 v_mul_f32_dpp v113, v216, v113 row_newbcast:1 row_mask:0xf bank_mask:0xf
 v_mul_f32_dpp v117, v216, v117 row_newbcast:1 row_mask:0xf bank_mask:0xf
 v_mfma_f32_16x16x32_bf16 v[172:175], a[84:87], a[20:23], v[172:175]
 v_exp_f32 v168, v168
 v_mfma_f32_16x16x32_bf16 v[172:175], a[80:83], a[16:19], v[172:175]
 v_exp_f32 v169, v169
 v_mfma_f32_16x16x32_bf16 v[0:3], v[176:179], a[224:227], v[0:3]
 v_exp_f32 v170, v170
 v_mfma_f32_16x16x32_bf16 v[4:7], v[176:179], a[228:231], v[4:7]
 v_exp_f32 v171, v171
 v_mfma_f32_16x16x32_bf16 v[8:11], v[176:179], a[232:235], v[8:11]
 v_cvt_pk_bf16_f32 v180, v168, v169
 v_cvt_pk_bf16_f32 v181, v170, v171
 v_mfma_f32_16x16x32_bf16 v[12:15], v[176:179], a[236:239], v[12:15]
 v_exp_f32 v172, v172
 v_mfma_f32_16x16x32_bf16 v[16:19], v[176:179], a[240:243], v[16:19]
 v_exp_f32 v173, v173
 v_mfma_f32_16x16x32_bf16 v[20:23], v[176:179], a[244:247], v[20:23]
 v_exp_f32 v174, v174
 v_mfma_f32_16x16x32_bf16 v[24:27], v[176:179], a[248:251], v[24:27]
 v_exp_f32 v175, v175
 v_mfma_f32_16x16x32_bf16 v[28:31], v[176:179], a[252:255], v[28:31]
 v_cvt_pk_bf16_f32 v182, v172, v173
 v_cvt_pk_bf16_f32 v183, v174, v175
 v_mfma_f32_16x16x32_bf16 v[160:163], a[96:99], a[32:35], v[144:147]
 v_cvt_pk_bf16_f32 v242, v113, v117
 v_mul_f32_dpp v121, v216, v121 row_newbcast:1 row_mask:0xf bank_mask:0xf
 v_mfma_f32_16x16x32_bf16 v[160:163], a[100:103], a[36:39], v[160:163]
 v_mul_f32_dpp v125, v216, v125 row_newbcast:1 row_mask:0xf bank_mask:0xf
 v_cvt_pk_bf16_f32 v243, v121, v125
 v_mfma_f32_16x16x32_bf16 v[160:163], a[104:107], a[40:43], v[160:163]
 buffer_store_dwordx4 v[240:243], v244, s[20:23], s33 offen offset:1024 sc1
 v_mfma_f32_16x16x32_bf16 v[160:163], a[108:111], a[44:47], v[160:163]
 v_mul_f32_dpp v98, v216, v98 row_newbcast:2 row_mask:0xf bank_mask:0xf
 v_mul_f32_dpp v102, v216, v102 row_newbcast:2 row_mask:0xf bank_mask:0xf
 v_mfma_f32_16x16x32_bf16 v[164:167], a[124:127], a[44:47], v[144:147]
 v_cvt_pk_bf16_f32 v240, v98, v102
 v_mul_f32_dpp v106, v216, v106 row_newbcast:2 row_mask:0xf bank_mask:0xf
 v_mfma_f32_16x16x32_bf16 v[164:167], a[120:123], a[40:43], v[164:167]
 v_mul_f32_dpp v110, v216, v110 row_newbcast:2 row_mask:0xf bank_mask:0xf
 v_cvt_pk_bf16_f32 v241, v106, v110
 v_mfma_f32_16x16x32_bf16 v[164:167], a[116:119], a[36:39], v[164:167]
 v_exp_f32 v160, v160
 v_mfma_f32_16x16x32_bf16 v[164:167], a[112:115], a[32:35], v[164:167]
 v_exp_f32 v161, v161
 v_smfmac_f32_16x16x64_bf16 v[132:135], v[236:239], v[176:183], v138
 v_cvt_pk_bf16_f32 v176, v160, v161
 v_mfma_f32_16x16x32_bf16 v[32:35], v[180:183], a[224:227], v[32:35]
 ds_read_b128 a[224:227], v248 offset:8192
 v_mul_f32_dpp v114, v216, v114 row_newbcast:2 row_mask:0xf bank_mask:0xf
 v_mfma_f32_16x16x32_bf16 v[36:39], v[180:183], a[228:231], v[36:39]
 ds_read_b128 a[228:231], v248 offset:8704
 v_mul_f32_dpp v118, v216, v118 row_newbcast:2 row_mask:0xf bank_mask:0xf
 v_mfma_f32_16x16x32_bf16 v[40:43], v[180:183], a[232:235], v[40:43]
 ds_read_b128 a[232:235], v248 offset:9216
 v_cvt_pk_bf16_f32 v242, v114, v118
 v_mfma_f32_16x16x32_bf16 v[44:47], v[180:183], a[236:239], v[44:47]
 v_exp_f32 v162, v162
 v_mfma_f32_16x16x32_bf16 v[48:51], v[180:183], a[240:243], v[48:51]
 v_exp_f32 v163, v163
 v_mfma_f32_16x16x32_bf16 v[52:55], v[180:183], a[244:247], v[52:55]
 v_exp_f32 v164, v164
 v_mfma_f32_16x16x32_bf16 v[56:59], v[180:183], a[248:251], v[56:59]
 v_exp_f32 v165, v165
 v_mfma_f32_16x16x32_bf16 v[60:63], v[180:183], a[252:255], v[60:63]
 v_exp_f32 v166, v166
 v_mfma_f32_16x16x32_bf16 v[168:171], a[96:99], v[220:223], v[148:151]
 ds_read_b128 a[236:239], v248 offset:9728
 ds_read_b128 a[240:243], v248 offset:10240
 v_mfma_f32_16x16x32_bf16 v[168:171], a[100:103], v[224:227], v[168:171]
 v_exp_f32 v167, v167
 v_mfma_f32_16x16x32_bf16 v[168:171], a[104:107], v[228:231], v[168:171]
 ds_read_b128 a[244:247], v248 offset:10752
 ds_read_b128 a[248:251], v248 offset:11264
 v_mfma_f32_16x16x32_bf16 v[168:171], a[108:111], v[232:235], v[168:171]
 v_cvt_pk_bf16_f32 v177, v162, v163
 v_cvt_pk_bf16_f32 v178, v164, v165
 v_mfma_f32_16x16x32_bf16 v[172:175], a[124:127], v[232:235], v[148:151]
 ds_read_b128 a[252:255], v248 offset:11776
 v_cvt_pk_bf16_f32 v179, v166, v167
 v_mfma_f32_16x16x32_bf16 v[172:175], a[120:123], v[228:231], v[172:175]
 v_mul_f32_dpp v122, v216, v122 row_newbcast:2 row_mask:0xf bank_mask:0xf
 v_mul_f32_dpp v126, v216, v126 row_newbcast:2 row_mask:0xf bank_mask:0xf
 v_mfma_f32_16x16x32_bf16 v[172:175], a[116:119], v[224:227], v[172:175]
 v_exp_f32 v168, v168
 v_mfma_f32_16x16x32_bf16 v[172:175], a[112:115], v[220:223], v[172:175]
 s_waitcnt lgkmcnt(3)
 v_exp_f32 v169, v169
 v_mfma_f32_16x16x32_bf16 v[64:67], v[176:179], a[224:227], v[64:67]
 v_exp_f32 v170, v170
 v_mfma_f32_16x16x32_bf16 v[68:71], v[176:179], a[228:231], v[68:71]
 v_exp_f32 v171, v171
 v_mfma_f32_16x16x32_bf16 v[72:75], v[176:179], a[232:235], v[72:75]
 v_cvt_pk_bf16_f32 v180, v168, v169
 v_cvt_pk_bf16_f32 v181, v170, v171
 v_mfma_f32_16x16x32_bf16 v[76:79], v[176:179], a[236:239], v[76:79]
 v_exp_f32 v172, v172
 v_mfma_f32_16x16x32_bf16 v[80:83], v[176:179], a[240:243], v[80:83]
 s_waitcnt lgkmcnt(0)
 v_exp_f32 v173, v173
 v_mfma_f32_16x16x32_bf16 v[84:87], v[176:179], a[244:247], v[84:87]
 v_exp_f32 v174, v174
 v_mfma_f32_16x16x32_bf16 v[88:91], v[176:179], a[248:251], v[88:91]
 v_exp_f32 v175, v175
 v_mfma_f32_16x16x32_bf16 v[92:95], v[176:179], a[252:255], v[92:95]
 v_cvt_pk_bf16_f32 v182, v172, v173
 v_cvt_pk_bf16_f32 v183, v174, v175
 v_mfma_f32_16x16x32_bf16 v[160:163], a[96:99], a[0:3], v[152:155]
 v_cvt_pk_bf16_f32 v243, v122, v126
 v_mul_f32_dpp v99, v216, v99 row_newbcast:3 row_mask:0xf bank_mask:0xf
 v_mfma_f32_16x16x32_bf16 v[160:163], a[100:103], a[4:7], v[160:163]
 buffer_store_dwordx4 v[240:243], v244, s[20:23], s33 offen offset:2048 sc1
 v_mfma_f32_16x16x32_bf16 v[160:163], a[104:107], a[8:11], v[160:163]
 v_mul_f32_dpp v103, v216, v103 row_newbcast:3 row_mask:0xf bank_mask:0xf
 v_cvt_pk_bf16_f32 v240, v99, v103
 v_mfma_f32_16x16x32_bf16 v[160:163], a[108:111], a[12:15], v[160:163]
 v_mul_f32_dpp v107, v216, v107 row_newbcast:3 row_mask:0xf bank_mask:0xf
 v_mul_f32_dpp v111, v216, v111 row_newbcast:3 row_mask:0xf bank_mask:0xf
 v_mfma_f32_16x16x32_bf16 v[164:167], a[124:127], a[12:15], v[152:155]
 v_cvt_pk_bf16_f32 v241, v107, v111
 v_mul_f32_dpp v115, v216, v115 row_newbcast:3 row_mask:0xf bank_mask:0xf
 v_mfma_f32_16x16x32_bf16 v[164:167], a[120:123], a[8:11], v[164:167]
 v_mul_f32_dpp v119, v216, v119 row_newbcast:3 row_mask:0xf bank_mask:0xf
 v_cvt_pk_bf16_f32 v242, v115, v119
 v_mfma_f32_16x16x32_bf16 v[164:167], a[116:119], a[4:7], v[164:167]
 v_exp_f32 v160, v160
 v_mfma_f32_16x16x32_bf16 v[164:167], a[112:115], a[0:3], v[164:167]
 v_exp_f32 v161, v161
 v_smfmac_f32_16x16x64_bf16 v[128:131], v[236:239], v[176:183], v138
 v_cvt_pk_bf16_f32 v176, v160, v161
 v_mfma_f32_16x16x32_bf16 v[184:187], v[180:183], a[224:227], v[184:187]
 v_exp_f32 v162, v162
 v_mfma_f32_16x16x32_bf16 v[188:191], v[180:183], a[228:231], v[188:191]
 v_exp_f32 v163, v163
 v_mfma_f32_16x16x32_bf16 v[192:195], v[180:183], a[232:235], v[192:195]
 v_exp_f32 v164, v164
 v_mfma_f32_16x16x32_bf16 v[196:199], v[180:183], a[236:239], v[196:199]
 v_exp_f32 v165, v165
 v_mfma_f32_16x16x32_bf16 v[200:203], v[180:183], a[240:243], v[200:203]
 v_exp_f32 v166, v166
 v_mfma_f32_16x16x32_bf16 v[204:207], v[180:183], a[244:247], v[204:207]
 v_exp_f32 v167, v167
 v_mfma_f32_16x16x32_bf16 v[208:211], v[180:183], a[248:251], v[208:211]
 v_cvt_pk_bf16_f32 v177, v162, v163
 v_cvt_pk_bf16_f32 v178, v164, v165
 v_mfma_f32_16x16x32_bf16 v[212:215], v[180:183], a[252:255], v[212:215]
 v_cvt_pk_bf16_f32 v179, v166, v167
 v_mul_f32_dpp v123, v216, v123 row_newbcast:3 row_mask:0xf bank_mask:0xf
 v_mfma_f32_16x16x32_bf16 v[168:171], a[96:99], a[16:19], v[156:159]
 v_mul_f32_dpp v127, v216, v127 row_newbcast:3 row_mask:0xf bank_mask:0xf
 v_cvt_pk_bf16_f32 v243, v123, v127
 v_mfma_f32_16x16x32_bf16 v[168:171], a[100:103], a[20:23], v[168:171]
 buffer_store_dwordx4 v[240:243], v244, s[20:23], s33 offen offset:3072 sc1
 v_mfma_f32_16x16x32_bf16 v[168:171], a[104:107], a[24:27], v[168:171]
 ds_read_b128 a[216:219], v249 offset:35840
 ds_read_b128 a[220:223], v249 offset:36352
 v_mfma_f32_16x16x32_bf16 v[168:171], a[108:111], a[28:31], v[168:171]
 ds_read_b128 a[208:211], v249 offset:34816
 ds_read_b128 a[212:215], v249 offset:35328
 v_mfma_f32_16x16x32_bf16 v[172:175], a[124:127], a[28:31], v[156:159]
 s_nop 1
 v_mfma_f32_16x16x32_bf16 v[172:175], a[120:123], a[24:27], v[172:175]
 s_nop 1
 v_mfma_f32_16x16x32_bf16 v[172:175], a[116:119], a[20:23], v[172:175]
 v_exp_f32 v168, v168
 v_mfma_f32_16x16x32_bf16 v[172:175], a[112:115], a[16:19], v[172:175]
 v_exp_f32 v169, v169
 v_mfma_f32_16x16x32_bf16 v[0:3], v[176:179], a[224:227], v[0:3]
 v_exp_f32 v170, v170
 v_mfma_f32_16x16x32_bf16 v[4:7], v[176:179], a[228:231], v[4:7]
 v_exp_f32 v171, v171
 v_mfma_f32_16x16x32_bf16 v[8:11], v[176:179], a[232:235], v[8:11]
 v_cvt_pk_bf16_f32 v180, v168, v169
 v_cvt_pk_bf16_f32 v181, v170, v171
 v_mfma_f32_16x16x32_bf16 v[12:15], v[176:179], a[236:239], v[12:15]
 v_exp_f32 v172, v172
 v_mfma_f32_16x16x32_bf16 v[16:19], v[176:179], a[240:243], v[16:19]
 v_exp_f32 v173, v173
 v_mfma_f32_16x16x32_bf16 v[20:23], v[176:179], a[244:247], v[20:23]
 v_exp_f32 v174, v174
 v_mfma_f32_16x16x32_bf16 v[24:27], v[176:179], a[248:251], v[24:27]
 v_exp_f32 v175, v175
 v_mfma_f32_16x16x32_bf16 v[28:31], v[176:179], a[252:255], v[28:31]
 v_cvt_pk_bf16_f32 v182, v172, v173
 v_cvt_pk_bf16_f32 v183, v174, v175
 v_mfma_f32_16x16x32_bf16 v[160:163], a[128:131], a[32:35], v[144:147]
 v_mfma_f32_16x16x32_bf16 v[160:163], a[132:135], a[36:39], v[160:163]
 v_mfma_f32_16x16x32_bf16 v[160:163], a[136:139], a[40:43], v[160:163]
 v_mfma_f32_16x16x32_bf16 v[160:163], a[140:143], a[44:47], v[160:163]
 s_nop 1
 v_mfma_f32_16x16x32_bf16 v[164:167], a[156:159], a[44:47], v[144:147]
 s_nop 1
 v_mfma_f32_16x16x32_bf16 v[164:167], a[152:155], a[40:43], v[164:167]
 s_nop 1
 v_mfma_f32_16x16x32_bf16 v[164:167], a[148:151], a[36:39], v[164:167]
 v_exp_f32 v160, v160
 v_mfma_f32_16x16x32_bf16 v[164:167], a[144:147], a[32:35], v[164:167]
 v_exp_f32 v161, v161
 v_smfmac_f32_16x16x64_bf16 v[132:135], v[236:239], v[176:183], v138
 v_cvt_pk_bf16_f32 v176, v160, v161
 v_mfma_f32_16x16x32_bf16 v[32:35], v[180:183], a[224:227], v[32:35]
 v_exp_f32 v162, v162
 v_mfma_f32_16x16x32_bf16 v[36:39], v[180:183], a[228:231], v[36:39]
 ds_read_b128 a[224:227], v248 offset:16384
 ds_read_b128 a[228:231], v248 offset:16896
 v_mfma_f32_16x16x32_bf16 v[40:43], v[180:183], a[232:235], v[40:43]
 v_exp_f32 v163, v163
 v_mfma_f32_16x16x32_bf16 v[44:47], v[180:183], a[236:239], v[44:47]
 ds_read_b128 a[232:235], v248 offset:17408
 ds_read_b128 a[236:239], v248 offset:17920
 v_mfma_f32_16x16x32_bf16 v[48:51], v[180:183], a[240:243], v[48:51]
 v_exp_f32 v164, v164
 v_mfma_f32_16x16x32_bf16 v[52:55], v[180:183], a[244:247], v[52:55]
 v_exp_f32 v165, v165
 v_mfma_f32_16x16x32_bf16 v[56:59], v[180:183], a[248:251], v[56:59]
 v_exp_f32 v166, v166
 v_mfma_f32_16x16x32_bf16 v[60:63], v[180:183], a[252:255], v[60:63]
 v_exp_f32 v167, v167
 v_mfma_f32_16x16x32_bf16 v[168:171], a[128:131], v[220:223], v[148:151]
 ds_read_b128 a[240:243], v248 offset:18432
 ds_read_b128 a[244:247], v248 offset:18944
 v_mfma_f32_16x16x32_bf16 v[168:171], a[132:135], v[224:227], v[168:171]
 ds_read_b128 a[248:251], v248 offset:19456
 v_cvt_pk_bf16_f32 v177, v162, v163
 v_mfma_f32_16x16x32_bf16 v[168:171], a[136:139], v[228:231], v[168:171]
 v_cvt_pk_bf16_f32 v178, v164, v165
 v_cvt_pk_bf16_f32 v179, v166, v167
 v_mfma_f32_16x16x32_bf16 v[168:171], a[140:143], v[232:235], v[168:171]
 ds_read_b128 a[252:255], v248 offset:19968
 s_nop 0
 v_mfma_f32_16x16x32_bf16 v[172:175], a[156:159], v[232:235], v[148:151]
 buffer_load_dwordx4 v[232:235], v245, s[8:11], s32 offen offset:192
 v_mfma_f32_16x16x32_bf16 v[172:175], a[152:155], v[228:231], v[172:175]
 s_nop 1
 v_mfma_f32_16x16x32_bf16 v[172:175], a[148:151], v[224:227], v[172:175]
 v_exp_f32 v168, v168
 v_mfma_f32_16x16x32_bf16 v[172:175], a[144:147], v[220:223], v[172:175]
 s_waitcnt lgkmcnt(2)
 v_exp_f32 v169, v169
 v_mfma_f32_16x16x32_bf16 v[64:67], v[176:179], a[224:227], v[64:67]
 buffer_load_dwordx4 v[220:223], v245, s[8:11], s32 offen offset:0
 v_mfma_f32_16x16x32_bf16 v[68:71], v[176:179], a[228:231], v[68:71]
 v_exp_f32 v170, v170
 v_mfma_f32_16x16x32_bf16 v[72:75], v[176:179], a[232:235], v[72:75]
L_pg10:
 s_cbranch_execz L_wb0
 v_exp_f32 v171, v171
 v_mfma_f32_16x16x32_bf16 v[76:79], v[176:179], a[236:239], v[76:79]
 v_exp_f32 v172, v172
 v_mfma_f32_16x16x32_bf16 v[80:83], v[176:179], a[240:243], v[80:83]
 buffer_load_dwordx4 v[224:227], v245, s[8:11], s32 offen offset:64
 v_mfma_f32_16x16x32_bf16 v[84:87], v[176:179], a[244:247], v[84:87]
 s_waitcnt lgkmcnt(0)
 v_exp_f32 v173, v173
 v_mfma_f32_16x16x32_bf16 v[88:91], v[176:179], a[248:251], v[88:91]
 v_exp_f32 v174, v174
 v_mfma_f32_16x16x32_bf16 v[92:95], v[176:179], a[252:255], v[92:95]
 v_exp_f32 v175, v175
 v_mfma_f32_16x16x32_bf16 v[160:163], a[128:131], a[0:3], v[152:155]
 buffer_load_dwordx4 v[228:231], v245, s[8:11], s32 offen offset:128
 v_mfma_f32_16x16x32_bf16 v[160:163], a[132:135], a[4:7], v[160:163]
 v_cvt_pk_bf16_f32 v180, v168, v169
 v_cvt_pk_bf16_f32 v181, v170, v171
 v_mfma_f32_16x16x32_bf16 v[160:163], a[136:139], a[8:11], v[160:163]
 v_cvt_pk_bf16_f32 v182, v172, v173
 v_cvt_pk_bf16_f32 v183, v174, v175
 v_mfma_f32_16x16x32_bf16 v[160:163], a[140:143], a[12:15], v[160:163]
 s_nop 1
 v_mfma_f32_16x16x32_bf16 v[164:167], a[156:159], a[12:15], v[152:155]
 s_nop 1
 v_mfma_f32_16x16x32_bf16 v[164:167], a[152:155], a[8:11], v[164:167]
 s_nop 1
 v_mfma_f32_16x16x32_bf16 v[164:167], a[148:151], a[4:7], v[164:167]
 v_exp_f32 v160, v160
 v_mfma_f32_16x16x32_bf16 v[164:167], a[144:147], a[0:3], v[164:167]
 v_exp_f32 v161, v161
 v_smfmac_f32_16x16x64_bf16 v[128:131], v[236:239], v[176:183], v138
 v_cvt_pk_bf16_f32 v176, v160, v161
 v_mfma_f32_16x16x32_bf16 v[184:187], v[180:183], a[224:227], v[184:187]
 v_exp_f32 v162, v162
 v_mfma_f32_16x16x32_bf16 v[188:191], v[180:183], a[228:231], v[188:191]
 v_exp_f32 v163, v163
 v_mfma_f32_16x16x32_bf16 v[192:195], v[180:183], a[232:235], v[192:195]
 v_exp_f32 v164, v164
 v_mfma_f32_16x16x32_bf16 v[196:199], v[180:183], a[236:239], v[196:199]
 v_exp_f32 v165, v165
 v_mfma_f32_16x16x32_bf16 v[200:203], v[180:183], a[240:243], v[200:203]
 v_exp_f32 v166, v166
 v_mfma_f32_16x16x32_bf16 v[204:207], v[180:183], a[244:247], v[204:207]
 v_exp_f32 v167, v167
 v_mfma_f32_16x16x32_bf16 v[208:211], v[180:183], a[248:251], v[208:211]
 v_cvt_pk_bf16_f32 v177, v162, v163
 v_cvt_pk_bf16_f32 v178, v164, v165
 v_mfma_f32_16x16x32_bf16 v[212:215], v[180:183], a[252:255], v[212:215]
 s_waitcnt vmcnt(10)
 v_cvt_pk_bf16_f32 v179, v166, v167
 v_add_f32 v217, v130, v131
 v_mfma_f32_16x16x32_bf16 v[252:255], a[160:163], a[48:51], 0
 v_mov_b32 v130, 0
 v_mov_b32 v131, 0
 v_mfma_f32_16x16x32_bf16 v[252:255], a[164:167], a[52:55], v[252:255]
 v_cmp_nge_f32 vcc, s28, v217
 s_nop 0
 v_mfma_f32_16x16x32_bf16 v[252:255], a[168:171], a[56:59], v[252:255]
 s_cmp_lg_u64 vcc, 0
 v_rcp_f32 v217, v217
 v_mfma_f32_16x16x32_bf16 v[252:255], a[172:175], a[60:63], v[252:255]
 s_cselect_b32 s34, 512, 0
 s_or_b32 s29, s29, s34
 v_mov_b32_dpp v217, v217 row_shl:4 row_mask:0x2 bank_mask:0xf
 v_mfma_f32_16x16x32_bf16 v[168:171], a[128:131], a[16:19], v[156:159]
 s_add_u32 s33, s25, 36864
 s_add_u32 s32, s25, 61440
 v_mov_b32_dpp v217, v217 row_shl:8 row_mask:0x4 bank_mask:0xf
 v_mfma_f32_16x16x32_bf16 v[168:171], a[132:135], a[20:23], v[168:171]
 v_max3_f32 v246, v252, v253, v254
 v_max_f32 v246, v246, v255
 v_mfma_f32_16x16x32_bf16 v[168:171], a[136:139], a[24:27], v[168:171]
 v_mov_b32 v247, v246
 v_mov_b32_dpp v217, v217 row_shl:12 row_mask:0x8 bank_mask:0xf
 v_mfma_f32_16x16x32_bf16 v[168:171], a[140:143], a[28:31], v[168:171]
 v_permlane16_swap_b32 v246, v247
 v_max_f32 v246, v246, v247
 v_mfma_f32_16x16x32_bf16 v[172:175], a[156:159], a[28:31], v[156:159]
 v_mov_b32 v247, v246
 v_mul_f32_dpp v184, v217, v184 row_newbcast:0 row_mask:0xf bank_mask:0xf
 v_mfma_f32_16x16x32_bf16 v[172:175], a[152:155], a[24:27], v[172:175]
 v_permlane32_swap_b32 v246, v247
 v_min_f32 v246, -v246, -v247
 v_mfma_f32_16x16x32_bf16 v[172:175], a[148:151], a[20:23], v[172:175]
 v_exp_f32 v171, v171
 v_mfma_f32_16x16x32_bf16 v[172:175], a[144:147], a[16:19], v[172:175]
 v_exp_f32 v168, v168
 v_mfma_f32_16x16x32_bf16 v[0:3], v[176:179], a[224:227], v[0:3]
 v_exp_f32 v169, v169
 v_mfma_f32_16x16x32_bf16 v[4:7], v[176:179], a[228:231], v[4:7]
 v_exp_f32 v170, v170
 v_mfma_f32_16x16x32_bf16 v[8:11], v[176:179], a[232:235], v[8:11]
 v_cvt_pk_bf16_f32 v180, v168, v169
 v_cvt_pk_bf16_f32 v181, v170, v171
 v_mfma_f32_16x16x32_bf16 v[12:15], v[176:179], a[236:239], v[12:15]
 v_exp_f32 v172, v172
 v_mfma_f32_16x16x32_bf16 v[16:19], v[176:179], a[240:243], v[16:19]
 v_exp_f32 v173, v173
 v_mfma_f32_16x16x32_bf16 v[20:23], v[176:179], a[244:247], v[20:23]
 v_cvt_pk_bf16_f32 v182, v172, v173
 v_mov_b32 v148, v246
 v_mfma_f32_16x16x32_bf16 v[24:27], v[176:179], a[248:251], v[24:27]
 v_exp_f32 v174, v174
 v_mfma_f32_16x16x32_bf16 v[28:31], v[176:179], a[252:255], v[28:31]
 v_exp_f32 v175, v175
 v_mfma_f32_16x16x32_bf16 v[160:163], a[160:163], a[32:35], v[144:147]
 v_cvt_pk_bf16_f32 v183, v174, v175
 v_mov_b32 v149, v246
 v_mfma_f32_16x16x32_bf16 v[160:163], a[164:167], a[36:39], v[160:163]
 v_mov_b32 v150, v246
 v_mov_b32 v151, v246
 v_mfma_f32_16x16x32_bf16 v[160:163], a[168:171], a[40:43], v[160:163]
 v_add_f32 v252, v252, v246
 v_add_f32 v253, v253, v246
 v_mfma_f32_16x16x32_bf16 v[160:163], a[172:175], a[44:47], v[160:163]
 v_add_f32 v254, v254, v246
 v_add_f32 v255, v255, v246
 v_mfma_f32_16x16x32_bf16 v[164:167], a[188:191], a[44:47], v[144:147]
 v_exp_f32 v252, v252
 v_mfma_f32_16x16x32_bf16 v[164:167], a[184:187], a[40:43], v[164:167]
 v_exp_f32 v253, v253
 v_mfma_f32_16x16x32_bf16 v[164:167], a[180:183], a[36:39], v[164:167]
 v_exp_f32 v254, v254
 v_mfma_f32_16x16x32_bf16 v[164:167], a[176:179], a[32:35], v[164:167]
 v_exp_f32 v161, v161
 v_smfmac_f32_16x16x64_bf16 v[132:135], v[236:239], v[176:183], v138
 v_mul_f32_dpp v188, v217, v188 row_newbcast:0 row_mask:0xf bank_mask:0xf
 v_mfma_f32_16x16x32_bf16 v[32:35], v[180:183], a[224:227], v[32:35]
 v_exp_f32 v162, v162
 v_mfma_f32_16x16x32_bf16 v[36:39], v[180:183], a[228:231], v[36:39]
 v_exp_f32 v163, v163
 v_mfma_f32_16x16x32_bf16 v[40:43], v[180:183], a[232:235], v[40:43]
 ds_read_b128 a[224:227], v248 offset:24576
 v_exp_f32 v160, v160
 v_mfma_f32_16x16x32_bf16 v[44:47], v[180:183], a[236:239], v[44:47]
 ds_read_b128 a[228:231], v248 offset:25088
 v_cvt_pk_bf16_f32 v176, v160, v161
 v_cvt_pk_bf16_f32 v177, v162, v163
 v_mfma_f32_16x16x32_bf16 v[48:51], v[180:183], a[240:243], v[48:51]
 ds_read_b128 a[232:235], v248 offset:25600
 ds_read_b128 a[236:239], v248 offset:26112
 v_mfma_f32_16x16x32_bf16 v[52:55], v[180:183], a[244:247], v[52:55]
 ds_read_b128 a[240:243], v248 offset:26624
 ds_read_b128 a[244:247], v248 offset:27136
 v_mfma_f32_16x16x32_bf16 v[56:59], v[180:183], a[248:251], v[56:59]
 v_exp_f32 v164, v164
 v_mfma_f32_16x16x32_bf16 v[60:63], v[180:183], a[252:255], v[60:63]
 v_exp_f32 v165, v165
 v_mfma_f32_16x16x32_bf16 v[172:175], a[188:191], a[60:63], v[148:151]
 ds_read_b128 a[248:251], v248 offset:27648
 v_exp_f32 v166, v166
 v_exp_f32 v167, v167
 v_mfma_f32_16x16x32_bf16 v[172:175], a[184:187], a[56:59], v[172:175]
 ds_read_b128 a[252:255], v248 offset:28160
 v_cvt_pk_bf16_f32 v178, v164, v165
 v_cvt_pk_bf16_f32 v179, v166, v167
 v_mfma_f32_16x16x32_bf16 v[172:175], a[180:183], a[52:55], v[172:175]
 v_exp_f32 v255, v255
 v_mfma_f32_16x16x32_bf16 v[172:175], a[176:179], a[48:51], v[172:175]
 s_waitcnt lgkmcnt(4)
 v_cvt_pk_bf16_f32 v180, v252, v253
 v_cvt_pk_bf16_f32 v181, v254, v255
 v_mfma_f32_16x16x32_bf16 v[64:67], v[176:179], a[224:227], v[64:67]
 v_cvt_pk_bf16_f32 v240, v184, v188
 v_mul_f32_dpp v192, v217, v192 row_newbcast:0 row_mask:0xf bank_mask:0xf
 v_mfma_f32_16x16x32_bf16 v[68:71], v[176:179], a[228:231], v[68:71]
 v_mul_f32_dpp v196, v217, v196 row_newbcast:0 row_mask:0xf bank_mask:0xf
 v_cvt_pk_bf16_f32 v241, v192, v196
 v_mfma_f32_16x16x32_bf16 v[72:75], v[176:179], a[232:235], v[72:75]
 v_exp_f32 v172, v172
 v_mfma_f32_16x16x32_bf16 v[76:79], v[176:179], a[236:239], v[76:79]
 s_waitcnt lgkmcnt(1)
 v_exp_f32 v173, v173
 v_mfma_f32_16x16x32_bf16 v[80:83], v[176:179], a[240:243], v[80:83]
 v_exp_f32 v174, v174
 v_mfma_f32_16x16x32_bf16 v[84:87], v[176:179], a[244:247], v[84:87]
 v_exp_f32 v175, v175
 v_mfma_f32_16x16x32_bf16 v[88:91], v[176:179], a[248:251], v[88:91]
 s_waitcnt lgkmcnt(0)
 v_cvt_pk_bf16_f32 v182, v172, v173
 v_cvt_pk_bf16_f32 v183, v174, v175
 v_mfma_f32_16x16x32_bf16 v[92:95], v[176:179], a[252:255], v[92:95]
 v_mul_f32_dpp v200, v217, v200 row_newbcast:0 row_mask:0xf bank_mask:0xf
 v_mul_f32_dpp v204, v217, v204 row_newbcast:0 row_mask:0xf bank_mask:0xf
 v_mfma_f32_16x16x32_bf16 v[160:163], a[160:163], a[0:3], v[152:155]
 v_cvt_pk_bf16_f32 v242, v200, v204
 v_mul_f32_dpp v208, v217, v208 row_newbcast:0 row_mask:0xf bank_mask:0xf
 v_mfma_f32_16x16x32_bf16 v[160:163], a[164:167], a[4:7], v[160:163]
 v_mul_f32_dpp v212, v217, v212 row_newbcast:0 row_mask:0xf bank_mask:0xf
 v_cvt_pk_bf16_f32 v243, v208, v212
 v_mfma_f32_16x16x32_bf16 v[160:163], a[168:171], a[8:11], v[160:163]
 buffer_store_dwordx4 v[240:243], v244, s[20:23], s33 offen offset:0 sc1
 v_mfma_f32_16x16x32_bf16 v[160:163], a[172:175], a[12:15], v[160:163]
 v_mul_f32_dpp v185, v217, v185 row_newbcast:1 row_mask:0xf bank_mask:0xf
 v_mul_f32_dpp v189, v217, v189 row_newbcast:1 row_mask:0xf bank_mask:0xf
 v_mfma_f32_16x16x32_bf16 v[164:167], a[188:191], a[12:15], v[152:155]
 v_cvt_pk_bf16_f32 v240, v185, v189
 v_mul_f32_dpp v193, v217, v193 row_newbcast:1 row_mask:0xf bank_mask:0xf
 v_mfma_f32_16x16x32_bf16 v[164:167], a[184:187], a[8:11], v[164:167]
 v_mul_f32_dpp v197, v217, v197 row_newbcast:1 row_mask:0xf bank_mask:0xf
 v_cvt_pk_bf16_f32 v241, v193, v197
 v_mfma_f32_16x16x32_bf16 v[164:167], a[180:183], a[4:7], v[164:167]
 v_exp_f32 v160, v160
 v_mfma_f32_16x16x32_bf16 v[164:167], a[176:179], a[0:3], v[164:167]
 v_exp_f32 v161, v161
 v_smfmac_f32_16x16x64_bf16 v[128:131], v[236:239], v[176:183], v138
 v_cvt_pk_bf16_f32 v176, v160, v161
 v_mfma_f32_16x16x32_bf16 v[96:99], v[180:183], a[224:227], 0
 v_exp_f32 v162, v162
 v_mfma_f32_16x16x32_bf16 v[100:103], v[180:183], a[228:231], 0
 v_exp_f32 v163, v163
 v_mfma_f32_16x16x32_bf16 v[104:107], v[180:183], a[232:235], 0
 v_exp_f32 v164, v164
 v_mfma_f32_16x16x32_bf16 v[108:111], v[180:183], a[236:239], 0
 v_exp_f32 v165, v165
 v_mfma_f32_16x16x32_bf16 v[112:115], v[180:183], a[240:243], 0
 v_exp_f32 v166, v166
 v_mfma_f32_16x16x32_bf16 v[116:119], v[180:183], a[244:247], 0
 v_exp_f32 v167, v167
 v_mfma_f32_16x16x32_bf16 v[120:123], v[180:183], a[248:251], 0
 v_cvt_pk_bf16_f32 v177, v162, v163
 v_cvt_pk_bf16_f32 v178, v164, v165
 v_mfma_f32_16x16x32_bf16 v[124:127], v[180:183], a[252:255], 0
 v_cvt_pk_bf16_f32 v179, v166, v167
 v_mul_f32_dpp v201, v217, v201 row_newbcast:1 row_mask:0xf bank_mask:0xf
 v_mfma_f32_16x16x32_bf16 v[168:171], a[160:163], a[16:19], v[156:159]
 v_mul_f32_dpp v205, v217, v205 row_newbcast:1 row_mask:0xf bank_mask:0xf
 v_cvt_pk_bf16_f32 v242, v201, v205
 v_mfma_f32_16x16x32_bf16 v[168:171], a[164:167], a[20:23], v[168:171]
 v_mul_f32_dpp v209, v217, v209 row_newbcast:1 row_mask:0xf bank_mask:0xf
 v_mul_f32_dpp v213, v217, v213 row_newbcast:1 row_mask:0xf bank_mask:0xf
 v_mfma_f32_16x16x32_bf16 v[168:171], a[168:171], a[24:27], v[168:171]
 v_cvt_pk_bf16_f32 v243, v209, v213
 v_mul_f32_dpp v186, v217, v186 row_newbcast:2 row_mask:0xf bank_mask:0xf
 v_mfma_f32_16x16x32_bf16 v[168:171], a[172:175], a[28:31], v[168:171]
 buffer_store_dwordx4 v[240:243], v244, s[20:23], s33 offen offset:1024 sc1
 v_mfma_f32_16x16x32_bf16 v[172:175], a[188:191], a[28:31], v[156:159]
 v_mul_f32_dpp v190, v217, v190 row_newbcast:2 row_mask:0xf bank_mask:0xf
 v_cvt_pk_bf16_f32 v240, v186, v190
 v_mfma_f32_16x16x32_bf16 v[172:175], a[184:187], a[24:27], v[172:175]
 v_mul_f32_dpp v194, v217, v194 row_newbcast:2 row_mask:0xf bank_mask:0xf
 v_mul_f32_dpp v198, v217, v198 row_newbcast:2 row_mask:0xf bank_mask:0xf
 v_mfma_f32_16x16x32_bf16 v[172:175], a[180:183], a[20:23], v[172:175]
 v_exp_f32 v168, v168
 v_mfma_f32_16x16x32_bf16 v[172:175], a[176:179], a[16:19], v[172:175]
 v_exp_f32 v169, v169
 v_mfma_f32_16x16x32_bf16 v[0:3], v[176:179], a[224:227], v[0:3]
 v_exp_f32 v170, v170
 v_mfma_f32_16x16x32_bf16 v[4:7], v[176:179], a[228:231], v[4:7]
 v_exp_f32 v171, v171
 v_mfma_f32_16x16x32_bf16 v[8:11], v[176:179], a[232:235], v[8:11]
 v_cvt_pk_bf16_f32 v180, v168, v169
 v_cvt_pk_bf16_f32 v181, v170, v171
 v_mfma_f32_16x16x32_bf16 v[12:15], v[176:179], a[236:239], v[12:15]
 v_exp_f32 v172, v172
 v_mfma_f32_16x16x32_bf16 v[16:19], v[176:179], a[240:243], v[16:19]
 v_exp_f32 v173, v173
 v_mfma_f32_16x16x32_bf16 v[20:23], v[176:179], a[244:247], v[20:23]
 v_exp_f32 v174, v174
 v_mfma_f32_16x16x32_bf16 v[24:27], v[176:179], a[248:251], v[24:27]
 v_exp_f32 v175, v175
 v_mfma_f32_16x16x32_bf16 v[28:31], v[176:179], a[252:255], v[28:31]
 v_cvt_pk_bf16_f32 v182, v172, v173
 v_cvt_pk_bf16_f32 v183, v174, v175
 v_mfma_f32_16x16x32_bf16 v[160:163], a[192:195], a[32:35], v[144:147]
 v_cvt_pk_bf16_f32 v241, v194, v198
 v_mul_f32_dpp v202, v217, v202 row_newbcast:2 row_mask:0xf bank_mask:0xf
 v_mfma_f32_16x16x32_bf16 v[160:163], a[196:199], a[36:39], v[160:163]
 v_mul_f32_dpp v206, v217, v206 row_newbcast:2 row_mask:0xf bank_mask:0xf
 v_cvt_pk_bf16_f32 v242, v202, v206
 v_mfma_f32_16x16x32_bf16 v[160:163], a[200:203], a[40:43], v[160:163]
 v_mul_f32_dpp v210, v217, v210 row_newbcast:2 row_mask:0xf bank_mask:0xf
 v_mul_f32_dpp v214, v217, v214 row_newbcast:2 row_mask:0xf bank_mask:0xf
 v_mfma_f32_16x16x32_bf16 v[160:163], a[204:207], a[44:47], v[160:163]
 v_cvt_pk_bf16_f32 v243, v210, v214
 v_mul_f32_dpp v187, v217, v187 row_newbcast:3 row_mask:0xf bank_mask:0xf
 v_mfma_f32_16x16x32_bf16 v[164:167], a[220:223], a[44:47], v[144:147]
 v_mul_f32_dpp v191, v217, v191 row_newbcast:3 row_mask:0xf bank_mask:0xf
 v_mul_f32_dpp v195, v217, v195 row_newbcast:3 row_mask:0xf bank_mask:0xf
 v_mfma_f32_16x16x32_bf16 v[164:167], a[216:219], a[40:43], v[164:167]
 v_mul_f32_dpp v199, v217, v199 row_newbcast:3 row_mask:0xf bank_mask:0xf
 v_mul_f32_dpp v203, v217, v203 row_newbcast:3 row_mask:0xf bank_mask:0xf
 v_mfma_f32_16x16x32_bf16 v[164:167], a[212:215], a[36:39], v[164:167]
 v_exp_f32 v160, v160
 v_mfma_f32_16x16x32_bf16 v[164:167], a[208:211], a[32:35], v[164:167]
 v_exp_f32 v161, v161
 v_smfmac_f32_16x16x64_bf16 v[132:135], v[236:239], v[176:183], v138
 v_cvt_pk_bf16_f32 v176, v160, v161
 v_mfma_f32_16x16x32_bf16 v[32:35], v[180:183], a[224:227], v[32:35]
 buffer_store_dwordx4 v[240:243], v244, s[20:23], s33 offen offset:2048 sc1
 v_mfma_f32_16x16x32_bf16 v[36:39], v[180:183], a[228:231], v[36:39]
 ds_read_b128 a[224:227], v248 offset:32768
 ds_read_b128 a[228:231], v248 offset:33280
 v_mfma_f32_16x16x32_bf16 v[40:43], v[180:183], a[232:235], v[40:43]
 ds_read_b128 a[232:235], v248 offset:33792
 v_cvt_pk_bf16_f32 v240, v187, v191
 v_mfma_f32_16x16x32_bf16 v[44:47], v[180:183], a[236:239], v[44:47]
 v_exp_f32 v162, v162
 v_mfma_f32_16x16x32_bf16 v[48:51], v[180:183], a[240:243], v[48:51]
 v_exp_f32 v163, v163
 v_mfma_f32_16x16x32_bf16 v[52:55], v[180:183], a[244:247], v[52:55]
 v_exp_f32 v164, v164
 v_mfma_f32_16x16x32_bf16 v[56:59], v[180:183], a[248:251], v[56:59]
 v_exp_f32 v165, v165
 v_mfma_f32_16x16x32_bf16 v[60:63], v[180:183], a[252:255], v[60:63]
 v_exp_f32 v166, v166
 v_mfma_f32_16x16x32_bf16 v[168:171], a[192:195], a[48:51], v[148:151]
 ds_read_b128 a[236:239], v248 offset:34304
 ds_read_b128 a[240:243], v248 offset:34816
 v_mfma_f32_16x16x32_bf16 v[168:171], a[196:199], a[52:55], v[168:171]
 v_exp_f32 v167, v167
 v_mfma_f32_16x16x32_bf16 v[168:171], a[200:203], a[56:59], v[168:171]
 ds_read_b128 a[244:247], v248 offset:35328
 ds_read_b128 a[248:251], v248 offset:35840
 v_mfma_f32_16x16x32_bf16 v[168:171], a[204:207], a[60:63], v[168:171]
 v_cvt_pk_bf16_f32 v177, v162, v163
 v_cvt_pk_bf16_f32 v178, v164, v165
 v_mfma_f32_16x16x32_bf16 v[172:175], a[220:223], a[60:63], v[148:151]
 ds_read_b128 a[252:255], v248 offset:36352
 v_cvt_pk_bf16_f32 v179, v166, v167
 v_mfma_f32_16x16x32_bf16 v[172:175], a[216:219], a[56:59], v[172:175]
 v_cvt_pk_bf16_f32 v241, v195, v199
 v_mul_f32_dpp v207, v217, v207 row_newbcast:3 row_mask:0xf bank_mask:0xf
 v_mfma_f32_16x16x32_bf16 v[172:175], a[212:215], a[52:55], v[172:175]
 v_exp_f32 v168, v168
 v_mfma_f32_16x16x32_bf16 v[172:175], a[208:211], a[48:51], v[172:175]
 s_waitcnt lgkmcnt(3)
 v_exp_f32 v169, v169
 v_mfma_f32_16x16x32_bf16 v[64:67], v[176:179], a[224:227], v[64:67]
 v_exp_f32 v170, v170
 v_mfma_f32_16x16x32_bf16 v[68:71], v[176:179], a[228:231], v[68:71]
 v_exp_f32 v171, v171
 v_mfma_f32_16x16x32_bf16 v[72:75], v[176:179], a[232:235], v[72:75]
 v_cvt_pk_bf16_f32 v180, v168, v169
 v_cvt_pk_bf16_f32 v181, v170, v171
 v_mfma_f32_16x16x32_bf16 v[76:79], v[176:179], a[236:239], v[76:79]
 v_exp_f32 v172, v172
 v_mfma_f32_16x16x32_bf16 v[80:83], v[176:179], a[240:243], v[80:83]
 s_waitcnt lgkmcnt(0)
 v_exp_f32 v173, v173
 v_mfma_f32_16x16x32_bf16 v[84:87], v[176:179], a[244:247], v[84:87]
 v_exp_f32 v174, v174
 v_mfma_f32_16x16x32_bf16 v[88:91], v[176:179], a[248:251], v[88:91]
 v_exp_f32 v175, v175
 v_mfma_f32_16x16x32_bf16 v[92:95], v[176:179], a[252:255], v[92:95]
 v_cvt_pk_bf16_f32 v182, v172, v173
 v_cvt_pk_bf16_f32 v183, v174, v175
 v_mfma_f32_16x16x32_bf16 v[160:163], a[192:195], a[0:3], v[152:155]
 v_cvt_pk_bf16_f32 v242, v203, v207
 v_mul_f32_dpp v211, v217, v211 row_newbcast:3 row_mask:0xf bank_mask:0xf
 v_mfma_f32_16x16x32_bf16 v[160:163], a[196:199], a[4:7], v[160:163]
 v_mul_f32_dpp v215, v217, v215 row_newbcast:3 row_mask:0xf bank_mask:0xf
 v_cvt_pk_bf16_f32 v243, v211, v215
 v_mfma_f32_16x16x32_bf16 v[160:163], a[200:203], a[8:11], v[160:163]
 buffer_store_dwordx4 v[240:243], v244, s[20:23], s33 offen offset:3072 sc1
 v_mfma_f32_16x16x32_bf16 v[160:163], a[204:207], a[12:15], v[160:163]
 s_nop 1
 v_mfma_f32_16x16x32_bf16 v[164:167], a[220:223], a[12:15], v[152:155]
 s_nop 1
 v_mfma_f32_16x16x32_bf16 v[164:167], a[216:219], a[8:11], v[164:167]
 s_nop 1
 v_mfma_f32_16x16x32_bf16 v[164:167], a[212:215], a[4:7], v[164:167]
 v_exp_f32 v160, v160
 v_mfma_f32_16x16x32_bf16 v[164:167], a[208:211], a[0:3], v[164:167]
 v_exp_f32 v161, v161
 v_smfmac_f32_16x16x64_bf16 v[128:131], v[236:239], v[176:183], v138
 v_cvt_pk_bf16_f32 v176, v160, v161
 v_mfma_f32_16x16x32_bf16 v[96:99], v[180:183], a[224:227], v[96:99]
 v_exp_f32 v162, v162
 v_mfma_f32_16x16x32_bf16 v[100:103], v[180:183], a[228:231], v[100:103]
 v_exp_f32 v163, v163
 v_mfma_f32_16x16x32_bf16 v[104:107], v[180:183], a[232:235], v[104:107]
 v_exp_f32 v164, v164
 v_mfma_f32_16x16x32_bf16 v[108:111], v[180:183], a[236:239], v[108:111]
 v_exp_f32 v165, v165
 v_mfma_f32_16x16x32_bf16 v[112:115], v[180:183], a[240:243], v[112:115]
 v_exp_f32 v166, v166
 v_mfma_f32_16x16x32_bf16 v[116:119], v[180:183], a[244:247], v[116:119]
 v_exp_f32 v167, v167
 v_mfma_f32_16x16x32_bf16 v[120:123], v[180:183], a[248:251], v[120:123]
 v_cvt_pk_bf16_f32 v177, v162, v163
 v_cvt_pk_bf16_f32 v178, v164, v165
 v_mfma_f32_16x16x32_bf16 v[124:127], v[180:183], a[252:255], v[124:127]
 v_cvt_pk_bf16_f32 v179, v166, v167
 v_mfma_f32_16x16x32_bf16 v[168:171], a[192:195], a[16:19], v[156:159]
 ds_read_b128 a[192:195], v249 offset:40960
 v_mfma_f32_16x16x32_bf16 v[168:171], a[196:199], a[20:23], v[168:171]
 ds_read_b128 a[196:199], v249 offset:41472
 v_mfma_f32_16x16x32_bf16 v[168:171], a[200:203], a[24:27], v[168:171]
 ds_read_b128 a[200:203], v249 offset:41984
 v_mfma_f32_16x16x32_bf16 v[168:171], a[204:207], a[28:31], v[168:171]
 ds_read_b128 a[204:207], v249 offset:42496
 s_nop 0
 v_mfma_f32_16x16x32_bf16 v[172:175], a[220:223], a[28:31], v[156:159]
 ds_read_b128 a[220:223], v249 offset:44544
 s_nop 0
 v_mfma_f32_16x16x32_bf16 v[172:175], a[216:219], a[24:27], v[172:175]
 ds_read_b128 a[216:219], v249 offset:44032
 s_nop 0
 v_mfma_f32_16x16x32_bf16 v[172:175], a[212:215], a[20:23], v[172:175]
 v_exp_f32 v168, v168
 v_mfma_f32_16x16x32_bf16 v[172:175], a[208:211], a[16:19], v[172:175]
 ds_read_b128 a[208:211], v249 offset:43008
 ds_read_b128 a[212:215], v249 offset:43520
 v_mfma_f32_16x16x32_bf16 v[0:3], v[176:179], a[224:227], v[0:3]
 v_exp_f32 v169, v169
 v_mfma_f32_16x16x32_bf16 v[4:7], v[176:179], a[228:231], v[4:7]
 v_exp_f32 v170, v170
 v_mfma_f32_16x16x32_bf16 v[8:11], v[176:179], a[232:235], v[8:11]
 v_exp_f32 v171, v171
 v_mfma_f32_16x16x32_bf16 v[12:15], v[176:179], a[236:239], v[12:15]
 v_exp_f32 v172, v172
 v_mfma_f32_16x16x32_bf16 v[16:19], v[176:179], a[240:243], v[16:19]
 v_exp_f32 v173, v173
 v_mfma_f32_16x16x32_bf16 v[20:23], v[176:179], a[244:247], v[20:23]
 v_exp_f32 v174, v174
 v_mfma_f32_16x16x32_bf16 v[24:27], v[176:179], a[248:251], v[24:27]
 v_exp_f32 v175, v175
 v_mfma_f32_16x16x32_bf16 v[28:31], v[176:179], a[252:255], v[28:31]
 s_waitcnt lgkmcnt(0)
 v_cvt_pk_bf16_f32 v180, v168, v169
 v_cvt_pk_bf16_f32 v181, v170, v171
 v_mfma_f32_16x16x32_bf16 v[160:163], a[192:195], a[32:35], v[144:147]
 v_cvt_pk_bf16_f32 v182, v172, v173
 v_cvt_pk_bf16_f32 v183, v174, v175
 v_mfma_f32_16x16x32_bf16 v[160:163], a[196:199], a[36:39], v[160:163]
 v_mfma_f32_16x16x32_bf16 v[160:163], a[200:203], a[40:43], v[160:163]
 v_mfma_f32_16x16x32_bf16 v[160:163], a[204:207], a[44:47], v[160:163]
 s_nop 1
 v_mfma_f32_16x16x32_bf16 v[164:167], a[220:223], a[44:47], v[144:147]
 s_nop 1
 v_mfma_f32_16x16x32_bf16 v[164:167], a[216:219], a[40:43], v[164:167]
 s_nop 1
 v_mfma_f32_16x16x32_bf16 v[164:167], a[212:215], a[36:39], v[164:167]
 v_exp_f32 v160, v160
 v_mfma_f32_16x16x32_bf16 v[164:167], a[208:211], a[32:35], v[164:167]
 v_exp_f32 v161, v161
 v_smfmac_f32_16x16x64_bf16 v[132:135], v[236:239], v[176:183], v138
 v_cvt_pk_bf16_f32 v176, v160, v161
 v_mfma_f32_16x16x32_bf16 v[32:35], v[180:183], a[224:227], v[32:35]
 v_exp_f32 v162, v162
 v_mfma_f32_16x16x32_bf16 v[36:39], v[180:183], a[228:231], v[36:39]
 ds_read_b128 a[224:227], v248 offset:40960
 ds_read_b128 a[228:231], v248 offset:41472
 v_mfma_f32_16x16x32_bf16 v[40:43], v[180:183], a[232:235], v[40:43]
 v_exp_f32 v163, v163
 v_mfma_f32_16x16x32_bf16 v[44:47], v[180:183], a[236:239], v[44:47]
 ds_read_b128 a[232:235], v248 offset:41984
 ds_read_b128 a[236:239], v248 offset:42496
 v_mfma_f32_16x16x32_bf16 v[48:51], v[180:183], a[240:243], v[48:51]
 v_exp_f32 v164, v164
 v_mfma_f32_16x16x32_bf16 v[52:55], v[180:183], a[244:247], v[52:55]
 v_exp_f32 v165, v165
 v_mfma_f32_16x16x32_bf16 v[56:59], v[180:183], a[248:251], v[56:59]
 v_exp_f32 v166, v166
 v_mfma_f32_16x16x32_bf16 v[60:63], v[180:183], a[252:255], v[60:63]
 v_exp_f32 v167, v167
 v_mfma_f32_16x16x32_bf16 v[168:171], a[192:195], a[48:51], v[148:151]
 ds_read_b128 a[240:243], v248 offset:43008
 ds_read_b128 a[244:247], v248 offset:43520
 v_mfma_f32_16x16x32_bf16 v[168:171], a[196:199], a[52:55], v[168:171]
 ds_read_b128 a[248:251], v248 offset:44032
 v_cvt_pk_bf16_f32 v177, v162, v163
 v_mfma_f32_16x16x32_bf16 v[168:171], a[200:203], a[56:59], v[168:171]
 v_cvt_pk_bf16_f32 v178, v164, v165
 v_cvt_pk_bf16_f32 v179, v166, v167
 v_mfma_f32_16x16x32_bf16 v[168:171], a[204:207], a[60:63], v[168:171]
 ds_read_b128 a[252:255], v248 offset:44544
 s_nop 0
 v_mfma_f32_16x16x32_bf16 v[172:175], a[220:223], a[60:63], v[148:151]
 s_nop 1
 v_mfma_f32_16x16x32_bf16 v[172:175], a[216:219], a[56:59], v[172:175]
 s_nop 1
 v_mfma_f32_16x16x32_bf16 v[172:175], a[212:215], a[52:55], v[172:175]
 v_exp_f32 v168, v168
 v_mfma_f32_16x16x32_bf16 v[172:175], a[208:211], a[48:51], v[172:175]
 s_waitcnt lgkmcnt(2)
 v_exp_f32 v169, v169
 v_mfma_f32_16x16x32_bf16 v[64:67], v[176:179], a[224:227], v[64:67]
 v_exp_f32 v170, v170
 v_mfma_f32_16x16x32_bf16 v[68:71], v[176:179], a[228:231], v[68:71]
 v_exp_f32 v171, v171
 v_mfma_f32_16x16x32_bf16 v[72:75], v[176:179], a[232:235], v[72:75]
 v_cvt_pk_bf16_f32 v180, v168, v169
 v_cvt_pk_bf16_f32 v181, v170, v171
 v_mfma_f32_16x16x32_bf16 v[76:79], v[176:179], a[236:239], v[76:79]
 v_exp_f32 v172, v172
 v_mfma_f32_16x16x32_bf16 v[80:83], v[176:179], a[240:243], v[80:83]
 v_exp_f32 v173, v173
 v_mfma_f32_16x16x32_bf16 v[84:87], v[176:179], a[244:247], v[84:87]
 s_waitcnt lgkmcnt(0)
 v_exp_f32 v174, v174
 v_mfma_f32_16x16x32_bf16 v[88:91], v[176:179], a[248:251], v[88:91]
 v_exp_f32 v175, v175
 v_mfma_f32_16x16x32_bf16 v[92:95], v[176:179], a[252:255], v[92:95]
 v_cvt_pk_bf16_f32 v182, v172, v173
 v_cvt_pk_bf16_f32 v183, v174, v175
 v_mfma_f32_16x16x32_bf16 v[160:163], a[192:195], a[0:3], v[152:155]
 v_mfma_f32_16x16x32_bf16 v[160:163], a[196:199], a[4:7], v[160:163]
 v_mfma_f32_16x16x32_bf16 v[160:163], a[200:203], a[8:11], v[160:163]
 v_mfma_f32_16x16x32_bf16 v[160:163], a[204:207], a[12:15], v[160:163]
 s_nop 1
 v_mfma_f32_16x16x32_bf16 v[164:167], a[220:223], a[12:15], v[152:155]
 buffer_load_dwordx4 a[12:15], v245, s[8:11], s32 offen offset:192
 v_mfma_f32_16x16x32_bf16 v[164:167], a[216:219], a[8:11], v[164:167]
 s_nop 1
 v_mfma_f32_16x16x32_bf16 v[164:167], a[212:215], a[4:7], v[164:167]
 v_exp_f32 v161, v161
 v_mfma_f32_16x16x32_bf16 v[164:167], a[208:211], a[0:3], v[164:167]
 v_exp_f32 v162, v162
 v_smfmac_f32_16x16x64_bf16 v[128:131], v[236:239], v[176:183], v138
 s_nop 0
 v_mfma_f32_16x16x32_bf16 v[96:99], v[180:183], a[224:227], v[96:99]
 buffer_load_dwordx4 a[0:3], v245, s[8:11], s32 offen offset:0
 v_mfma_f32_16x16x32_bf16 v[100:103], v[180:183], a[228:231], v[100:103]
 v_exp_f32 v163, v163
 v_mfma_f32_16x16x32_bf16 v[104:107], v[180:183], a[232:235], v[104:107]
 v_exp_f32 v164, v164
 v_mfma_f32_16x16x32_bf16 v[108:111], v[180:183], a[236:239], v[108:111]
 v_exp_f32 v165, v165
 v_mfma_f32_16x16x32_bf16 v[112:115], v[180:183], a[240:243], v[112:115]
 buffer_load_dwordx4 a[4:7], v245, s[8:11], s32 offen offset:64
 v_mfma_f32_16x16x32_bf16 v[116:119], v[180:183], a[244:247], v[116:119]
 v_exp_f32 v166, v166
 v_mfma_f32_16x16x32_bf16 v[120:123], v[180:183], a[248:251], v[120:123]
 v_exp_f32 v160, v160
 v_mfma_f32_16x16x32_bf16 v[124:127], v[180:183], a[252:255], v[124:127]
 v_exp_f32 v167, v167
 v_mfma_f32_16x16x32_bf16 v[168:171], a[192:195], a[16:19], v[156:159]
 buffer_load_dwordx4 a[8:11], v245, s[8:11], s32 offen offset:128
 v_mfma_f32_16x16x32_bf16 v[168:171], a[196:199], a[20:23], v[168:171]
 v_cvt_pk_bf16_f32 v176, v160, v161
 v_cvt_pk_bf16_f32 v177, v162, v163
 v_mfma_f32_16x16x32_bf16 v[168:171], a[200:203], a[24:27], v[168:171]
 v_cvt_pk_bf16_f32 v178, v164, v165
 v_cvt_pk_bf16_f32 v179, v166, v167
 v_mfma_f32_16x16x32_bf16 v[168:171], a[204:207], a[28:31], v[168:171]
 ds_read_b128 a[192:195], v249 offset:49152
 ds_read_b128 a[196:199], v249 offset:49664
 v_mfma_f32_16x16x32_bf16 v[172:175], a[220:223], a[28:31], v[156:159]
 ds_read_b128 a[204:207], v249 offset:50688
 ds_read_b128 a[200:203], v249 offset:50176
 v_mfma_f32_16x16x32_bf16 v[172:175], a[216:219], a[24:27], v[172:175]
 ds_read_b128 a[216:219], v249 offset:52224
 ds_read_b128 a[220:223], v249 offset:52736
 v_mfma_f32_16x16x32_bf16 v[172:175], a[212:215], a[20:23], v[172:175]
 v_exp_f32 v168, v168
 v_mfma_f32_16x16x32_bf16 v[172:175], a[208:211], a[16:19], v[172:175]
 ds_read_b128 a[208:211], v249 offset:51200
 ds_read_b128 a[212:215], v249 offset:51712
 v_mfma_f32_16x16x32_bf16 v[0:3], v[176:179], a[224:227], v[0:3]
 v_exp_f32 v169, v169
 v_mfma_f32_16x16x32_bf16 v[4:7], v[176:179], a[228:231], v[4:7]
 v_exp_f32 v170, v170
 v_mfma_f32_16x16x32_bf16 v[8:11], v[176:179], a[232:235], v[8:11]
 v_exp_f32 v171, v171
 v_mfma_f32_16x16x32_bf16 v[12:15], v[176:179], a[236:239], v[12:15]
 v_exp_f32 v172, v172
 v_mfma_f32_16x16x32_bf16 v[16:19], v[176:179], a[240:243], v[16:19]
 v_exp_f32 v173, v173
 v_mfma_f32_16x16x32_bf16 v[20:23], v[176:179], a[244:247], v[20:23]
 v_exp_f32 v174, v174
 v_mfma_f32_16x16x32_bf16 v[24:27], v[176:179], a[248:251], v[24:27]
 v_exp_f32 v175, v175
 v_mfma_f32_16x16x32_bf16 v[28:31], v[176:179], a[252:255], v[28:31]
 s_waitcnt vmcnt(8) lgkmcnt(0)
 v_cvt_pk_bf16_f32 v180, v168, v169
 v_cvt_pk_bf16_f32 v181, v170, v171
 v_mfma_f32_16x16x32_bf16 v[252:255], a[192:195], v[220:223], 0
 v_cvt_pk_bf16_f32 v182, v172, v173
 v_cvt_pk_bf16_f32 v183, v174, v175
 v_mfma_f32_16x16x32_bf16 v[252:255], a[196:199], v[224:227], v[252:255]
 v_mfma_f32_16x16x32_bf16 v[252:255], a[200:203], v[228:231], v[252:255]
 v_mfma_f32_16x16x32_bf16 v[252:255], a[204:207], v[232:235], v[252:255]
 s_nop 1
 v_mfma_f32_16x16x32_bf16 v[160:163], a[192:195], a[32:35], v[144:147]
 s_nop 1
 v_mfma_f32_16x16x32_bf16 v[160:163], a[196:199], a[36:39], v[160:163]
 s_nop 1
 v_mfma_f32_16x16x32_bf16 v[160:163], a[200:203], a[40:43], v[160:163]
 v_max3_f32 v246, v252, v253, v254
 v_max_f32 v246, v246, v255
 v_mfma_f32_16x16x32_bf16 v[160:163], a[204:207], a[44:47], v[160:163]
 v_mov_b32 v247, v246
 s_nop 0
 v_mfma_f32_16x16x32_bf16 v[164:167], a[220:223], a[44:47], v[144:147]
 v_permlane16_swap_b32 v246, v247
 v_max_f32 v246, v246, v247
 v_mfma_f32_16x16x32_bf16 v[164:167], a[216:219], a[40:43], v[164:167]
 v_mov_b32 v247, v246
 s_nop 0
 v_mfma_f32_16x16x32_bf16 v[164:167], a[212:215], a[36:39], v[164:167]
 v_exp_f32 v160, v160
 v_mfma_f32_16x16x32_bf16 v[164:167], a[208:211], a[32:35], v[164:167]
 v_exp_f32 v161, v161
 v_smfmac_f32_16x16x64_bf16 v[132:135], v[236:239], v[176:183], v138
 v_cvt_pk_bf16_f32 v176, v160, v161
 v_mfma_f32_16x16x32_bf16 v[32:35], v[180:183], a[224:227], v[32:35]
 v_exp_f32 v162, v162
 v_mfma_f32_16x16x32_bf16 v[36:39], v[180:183], a[228:231], v[36:39]
 v_exp_f32 v163, v163
 v_mfma_f32_16x16x32_bf16 v[40:43], v[180:183], a[232:235], v[40:43]
L_pg11:
 s_cbranch_execz L_wb0
 v_exp_f32 v166, v166
 v_mfma_f32_16x16x32_bf16 v[44:47], v[180:183], a[236:239], v[44:47]
 v_exp_f32 v167, v167
 v_mfma_f32_16x16x32_bf16 v[48:51], v[180:183], a[240:243], v[48:51]
 v_exp_f32 v164, v164
 v_mfma_f32_16x16x32_bf16 v[52:55], v[180:183], a[244:247], v[52:55]
 v_exp_f32 v165, v165
 v_mfma_f32_16x16x32_bf16 v[56:59], v[180:183], a[248:251], v[56:59]
 ds_read_b128 a[224:227], v248 offset:49152
 v_cvt_pk_bf16_f32 v177, v162, v163
 v_cvt_pk_bf16_f32 v178, v164, v165
 v_mfma_f32_16x16x32_bf16 v[60:63], v[180:183], a[252:255], v[60:63]
 ds_read_b128 a[228:231], v248 offset:49664
 v_cvt_pk_bf16_f32 v179, v166, v167
 v_mfma_f32_16x16x32_bf16 v[168:171], a[192:195], a[48:51], v[148:151]
 ds_read_b128 a[232:235], v248 offset:50176
 ds_read_b128 a[252:255], v248 offset:52736
 v_mfma_f32_16x16x32_bf16 v[168:171], a[196:199], a[52:55], v[168:171]
 ds_read_b128 a[236:239], v248 offset:50688
 v_permlane32_swap_b32 v246, v247
 v_mfma_f32_16x16x32_bf16 v[168:171], a[200:203], a[56:59], v[168:171]
 ds_read_b128 a[240:243], v248 offset:51200
 v_min_f32 v246, -v246, -v247
 v_mfma_f32_16x16x32_bf16 v[168:171], a[204:207], a[60:63], v[168:171]
 ds_read_b128 a[244:247], v248 offset:51712
 v_mov_b32 v152, v246
 v_mov_b32 v153, v246
 v_mfma_f32_16x16x32_bf16 v[172:175], a[220:223], a[60:63], v[148:151]
 ds_read_b128 a[248:251], v248 offset:52224
 v_mov_b32 v154, v246
 v_mov_b32 v155, v246
 v_mfma_f32_16x16x32_bf16 v[172:175], a[216:219], a[56:59], v[172:175]
 v_exp_f32 v168, v168
 v_mfma_f32_16x16x32_bf16 v[172:175], a[212:215], a[52:55], v[172:175]
 v_exp_f32 v169, v169
 v_mfma_f32_16x16x32_bf16 v[172:175], a[208:211], a[48:51], v[172:175]
 s_waitcnt lgkmcnt(4)
 v_exp_f32 v170, v170
 v_mfma_f32_16x16x32_bf16 v[64:67], v[176:179], a[224:227], v[64:67]
 v_exp_f32 v171, v171
 v_mfma_f32_16x16x32_bf16 v[68:71], v[176:179], a[228:231], v[68:71]
 v_cvt_pk_bf16_f32 v180, v168, v169
 v_cvt_pk_bf16_f32 v181, v170, v171
 v_mfma_f32_16x16x32_bf16 v[72:75], v[176:179], a[232:235], v[72:75]
 s_waitcnt lgkmcnt(1)
 v_add_f32 v252, v252, v246
 v_add_f32 v253, v253, v246
 v_mfma_f32_16x16x32_bf16 v[76:79], v[176:179], a[236:239], v[76:79]
 v_add_f32 v254, v254, v246
 v_add_f32 v255, v255, v246
 v_mfma_f32_16x16x32_bf16 v[80:83], v[176:179], a[240:243], v[80:83]
 v_exp_f32 v172, v172
 v_mfma_f32_16x16x32_bf16 v[84:87], v[176:179], a[244:247], v[84:87]
 s_waitcnt lgkmcnt(0)
 v_exp_f32 v173, v173
 v_mfma_f32_16x16x32_bf16 v[88:91], v[176:179], a[248:251], v[88:91]
 v_exp_f32 v174, v174
 v_mfma_f32_16x16x32_bf16 v[92:95], v[176:179], a[252:255], v[92:95]
 v_exp_f32 v175, v175
 v_mfma_f32_16x16x32_bf16 v[164:167], a[220:223], v[232:235], v[152:155]
 v_exp_f32 v252, v252
 v_mfma_f32_16x16x32_bf16 v[164:167], a[216:219], v[228:231], v[164:167]
 v_cvt_pk_bf16_f32 v182, v172, v173
 v_cvt_pk_bf16_f32 v183, v174, v175
 v_mfma_f32_16x16x32_bf16 v[164:167], a[212:215], v[224:227], v[164:167]
 v_exp_f32 v253, v253
 v_mfma_f32_16x16x32_bf16 v[164:167], a[208:211], v[220:223], v[164:167]
 v_exp_f32 v254, v254
 v_smfmac_f32_16x16x64_bf16 v[128:131], v[236:239], v[176:183], v138
 v_cvt_pk_bf16_f32 v176, v252, v253
 v_mfma_f32_16x16x32_bf16 v[96:99], v[180:183], a[224:227], v[96:99]
 v_exp_f32 v255, v255
 v_mfma_f32_16x16x32_bf16 v[100:103], v[180:183], a[228:231], v[100:103]
 v_cvt_pk_bf16_f32 v177, v254, v255
 v_add_f32 v218, v132, v133
 v_mfma_f32_16x16x32_bf16 v[104:107], v[180:183], a[232:235], v[104:107]
 v_exp_f32 v164, v164
 v_mfma_f32_16x16x32_bf16 v[108:111], v[180:183], a[236:239], v[108:111]
 v_exp_f32 v165, v165
 v_mfma_f32_16x16x32_bf16 v[112:115], v[180:183], a[240:243], v[112:115]
 v_exp_f32 v166, v166
 v_mfma_f32_16x16x32_bf16 v[116:119], v[180:183], a[244:247], v[116:119]
 v_exp_f32 v167, v167
 v_mfma_f32_16x16x32_bf16 v[120:123], v[180:183], a[248:251], v[120:123]
 v_cvt_pk_bf16_f32 v178, v164, v165
 v_cvt_pk_bf16_f32 v179, v166, v167
 v_mfma_f32_16x16x32_bf16 v[124:127], v[180:183], a[252:255], v[124:127]
 v_mov_b32 v132, 0
 v_mov_b32 v133, 0
 v_mfma_f32_16x16x32_bf16 v[168:171], a[192:195], a[16:19], v[156:159]
 ds_read_b128 a[192:195], v249 offset:57344
 v_cmp_nge_f32 vcc, s28, v218
 v_mfma_f32_16x16x32_bf16 v[168:171], a[196:199], a[20:23], v[168:171]
 s_cmp_lg_u64 vcc, 0
 v_rcp_f32 v218, v218
 v_mfma_f32_16x16x32_bf16 v[168:171], a[200:203], a[24:27], v[168:171]
 s_cselect_b32 s34, 1024, 0
 ds_read_b128 a[196:199], v249 offset:57856
 ds_read_b128 a[200:203], v249 offset:58368
 v_mfma_f32_16x16x32_bf16 v[168:171], a[204:207], a[28:31], v[168:171]
 s_or_b32 s29, s29, s34
 s_add_u32 s33, s25, 40960
 ds_read_b128 a[204:207], v249 offset:58880
 v_mfma_f32_16x16x32_bf16 v[172:175], a[220:223], a[28:31], v[156:159]
 s_add_u32 s32, s25, 65536
 ds_read_b128 a[220:223], v249 offset:60928
 v_mov_b32_dpp v218, v218 row_shl:4 row_mask:0x2 bank_mask:0xf
 v_mfma_f32_16x16x32_bf16 v[172:175], a[216:219], a[24:27], v[172:175]
 v_exp_f32 v168, v168
 v_mfma_f32_16x16x32_bf16 v[172:175], a[212:215], a[20:23], v[172:175]
 v_exp_f32 v169, v169
 v_mfma_f32_16x16x32_bf16 v[172:175], a[208:211], a[16:19], v[172:175]
 ds_read_b128 a[216:219], v249 offset:60416
 ds_read_b128 a[212:215], v249 offset:59904
 v_mfma_f32_16x16x32_bf16 v[184:187], v[176:179], a[224:227], 0
 v_exp_f32 v170, v170
 v_mfma_f32_16x16x32_bf16 v[188:191], v[176:179], a[228:231], 0
 v_exp_f32 v171, v171
 v_mfma_f32_16x16x32_bf16 v[192:195], v[176:179], a[232:235], 0
 ds_read_b128 a[208:211], v249 offset:59392
 v_cvt_pk_bf16_f32 v180, v168, v169
 v_mfma_f32_16x16x32_bf16 v[196:199], v[176:179], a[236:239], 0
 v_exp_f32 v172, v172
 v_mfma_f32_16x16x32_bf16 v[200:203], v[176:179], a[240:243], 0
 v_exp_f32 v173, v173
 v_mfma_f32_16x16x32_bf16 v[204:207], v[176:179], a[244:247], 0
 v_exp_f32 v174, v174
 v_mfma_f32_16x16x32_bf16 v[208:211], v[176:179], a[248:251], 0
 v_exp_f32 v175, v175
 v_mfma_f32_16x16x32_bf16 v[212:215], v[176:179], a[252:255], 0
 s_waitcnt lgkmcnt(1)
 v_cvt_pk_bf16_f32 v181, v170, v171
 v_cvt_pk_bf16_f32 v182, v172, v173
 v_mfma_f32_16x16x32_bf16 v[160:163], a[192:195], a[32:35], v[144:147]
 v_cvt_pk_bf16_f32 v183, v174, v175
 v_mov_b32_dpp v218, v218 row_shl:8 row_mask:0x4 bank_mask:0xf
 v_mfma_f32_16x16x32_bf16 v[160:163], a[196:199], a[36:39], v[160:163]
 s_nop 1
 v_mfma_f32_16x16x32_bf16 v[160:163], a[200:203], a[40:43], v[160:163]
 v_mov_b32_dpp v218, v218 row_shl:12 row_mask:0x8 bank_mask:0xf
 s_nop 0
 v_mfma_f32_16x16x32_bf16 v[160:163], a[204:207], a[44:47], v[160:163]
 v_mul_f32_dpp v0, v218, v0 row_newbcast:0 row_mask:0xf bank_mask:0xf
 v_mul_f32_dpp v4, v218, v4 row_newbcast:0 row_mask:0xf bank_mask:0xf
 v_mfma_f32_16x16x32_bf16 v[164:167], a[220:223], a[44:47], v[144:147]
 v_cvt_pk_bf16_f32 v240, v0, v4
 v_mul_f32_dpp v8, v218, v8 row_newbcast:0 row_mask:0xf bank_mask:0xf
 v_mfma_f32_16x16x32_bf16 v[164:167], a[216:219], a[40:43], v[164:167]
 v_mul_f32_dpp v12, v218, v12 row_newbcast:0 row_mask:0xf bank_mask:0xf
 v_cvt_pk_bf16_f32 v241, v8, v12
 v_mfma_f32_16x16x32_bf16 v[164:167], a[212:215], a[36:39], v[164:167]
 s_waitcnt lgkmcnt(0)
 v_exp_f32 v160, v160
 v_mfma_f32_16x16x32_bf16 v[164:167], a[208:211], a[32:35], v[164:167]
 v_exp_f32 v161, v161
 v_smfmac_f32_16x16x64_bf16 v[132:135], v[236:239], v[176:183], v138
 v_cvt_pk_bf16_f32 v176, v160, v161
 v_mfma_f32_16x16x32_bf16 v[32:35], v[180:183], a[224:227], v[32:35]
 ds_read_b128 a[224:227], v248 offset:57344
 v_mul_f32_dpp v16, v218, v16 row_newbcast:0 row_mask:0xf bank_mask:0xf
 v_mfma_f32_16x16x32_bf16 v[36:39], v[180:183], a[228:231], v[36:39]
 ds_read_b128 a[228:231], v248 offset:57856
 v_mul_f32_dpp v20, v218, v20 row_newbcast:0 row_mask:0xf bank_mask:0xf
 v_mfma_f32_16x16x32_bf16 v[40:43], v[180:183], a[232:235], v[40:43]
 ds_read_b128 a[232:235], v248 offset:58368
 v_cvt_pk_bf16_f32 v242, v16, v20
 v_mfma_f32_16x16x32_bf16 v[44:47], v[180:183], a[236:239], v[44:47]
 v_exp_f32 v162, v162
 v_mfma_f32_16x16x32_bf16 v[48:51], v[180:183], a[240:243], v[48:51]
 v_exp_f32 v163, v163
 v_mfma_f32_16x16x32_bf16 v[52:55], v[180:183], a[244:247], v[52:55]
 v_exp_f32 v164, v164
 v_mfma_f32_16x16x32_bf16 v[56:59], v[180:183], a[248:251], v[56:59]
 v_exp_f32 v165, v165
 v_mfma_f32_16x16x32_bf16 v[60:63], v[180:183], a[252:255], v[60:63]
 v_exp_f32 v166, v166
 v_mfma_f32_16x16x32_bf16 v[168:171], a[192:195], a[48:51], v[148:151]
 ds_read_b128 a[236:239], v248 offset:58880
 ds_read_b128 a[240:243], v248 offset:59392
 v_mfma_f32_16x16x32_bf16 v[168:171], a[196:199], a[52:55], v[168:171]
 v_exp_f32 v167, v167
 v_mfma_f32_16x16x32_bf16 v[168:171], a[200:203], a[56:59], v[168:171]
 ds_read_b128 a[244:247], v248 offset:59904
 ds_read_b128 a[248:251], v248 offset:60416
 v_mfma_f32_16x16x32_bf16 v[168:171], a[204:207], a[60:63], v[168:171]
 v_cvt_pk_bf16_f32 v177, v162, v163
 v_cvt_pk_bf16_f32 v178, v164, v165
 v_mfma_f32_16x16x32_bf16 v[172:175], a[220:223], a[60:63], v[148:151]
 ds_read_b128 a[252:255], v248 offset:60928
 v_cvt_pk_bf16_f32 v179, v166, v167
 v_mfma_f32_16x16x32_bf16 v[172:175], a[216:219], a[56:59], v[172:175]
 v_mul_f32_dpp v24, v218, v24 row_newbcast:0 row_mask:0xf bank_mask:0xf
 v_mul_f32_dpp v28, v218, v28 row_newbcast:0 row_mask:0xf bank_mask:0xf
 v_mfma_f32_16x16x32_bf16 v[172:175], a[212:215], a[52:55], v[172:175]
 v_exp_f32 v168, v168
 v_mfma_f32_16x16x32_bf16 v[172:175], a[208:211], a[48:51], v[172:175]
 s_waitcnt lgkmcnt(3)
 v_exp_f32 v169, v169
 v_mfma_f32_16x16x32_bf16 v[64:67], v[176:179], a[224:227], v[64:67]
 v_exp_f32 v170, v170
 v_mfma_f32_16x16x32_bf16 v[68:71], v[176:179], a[228:231], v[68:71]
 v_exp_f32 v171, v171
 v_mfma_f32_16x16x32_bf16 v[72:75], v[176:179], a[232:235], v[72:75]
 v_cvt_pk_bf16_f32 v180, v168, v169
 v_cvt_pk_bf16_f32 v181, v170, v171
 v_mfma_f32_16x16x32_bf16 v[76:79], v[176:179], a[236:239], v[76:79]
 v_exp_f32 v172, v172
 v_mfma_f32_16x16x32_bf16 v[80:83], v[176:179], a[240:243], v[80:83]
 s_waitcnt lgkmcnt(0)
 v_exp_f32 v173, v173
 v_mfma_f32_16x16x32_bf16 v[84:87], v[176:179], a[244:247], v[84:87]
 v_exp_f32 v174, v174
 v_mfma_f32_16x16x32_bf16 v[88:91], v[176:179], a[248:251], v[88:91]
 v_exp_f32 v175, v175
 v_mfma_f32_16x16x32_bf16 v[92:95], v[176:179], a[252:255], v[92:95]
 v_cvt_pk_bf16_f32 v182, v172, v173
 v_cvt_pk_bf16_f32 v183, v174, v175
 v_mfma_f32_16x16x32_bf16 v[160:163], a[192:195], v[220:223], v[152:155]
 v_cvt_pk_bf16_f32 v243, v24, v28
 v_mul_f32_dpp v1, v218, v1 row_newbcast:1 row_mask:0xf bank_mask:0xf
 v_mfma_f32_16x16x32_bf16 v[160:163], a[196:199], v[224:227], v[160:163]
 buffer_store_dwordx4 v[240:243], v244, s[20:23], s33 offen offset:0 sc1
 v_mfma_f32_16x16x32_bf16 v[160:163], a[200:203], v[228:231], v[160:163]
 v_mul_f32_dpp v5, v218, v5 row_newbcast:1 row_mask:0xf bank_mask:0xf
 v_cvt_pk_bf16_f32 v240, v1, v5
 v_mfma_f32_16x16x32_bf16 v[160:163], a[204:207], v[232:235], v[160:163]
 v_mul_f32_dpp v9, v218, v9 row_newbcast:1 row_mask:0xf bank_mask:0xf
 v_mul_f32_dpp v13, v218, v13 row_newbcast:1 row_mask:0xf bank_mask:0xf
 v_mfma_f32_16x16x32_bf16 v[164:167], a[220:223], v[232:235], v[152:155]
 v_cvt_pk_bf16_f32 v241, v9, v13
 v_mul_f32_dpp v17, v218, v17 row_newbcast:1 row_mask:0xf bank_mask:0xf
 v_mfma_f32_16x16x32_bf16 v[164:167], a[216:219], v[228:231], v[164:167]
 v_mul_f32_dpp v21, v218, v21 row_newbcast:1 row_mask:0xf bank_mask:0xf
 v_cvt_pk_bf16_f32 v242, v17, v21
 v_mfma_f32_16x16x32_bf16 v[164:167], a[212:215], v[224:227], v[164:167]
 v_exp_f32 v160, v160
 v_mfma_f32_16x16x32_bf16 v[164:167], a[208:211], v[220:223], v[164:167]
 v_exp_f32 v161, v161
 v_smfmac_f32_16x16x64_bf16 v[128:131], v[236:239], v[176:183], v138
 v_cvt_pk_bf16_f32 v176, v160, v161
 v_mfma_f32_16x16x32_bf16 v[96:99], v[180:183], a[224:227], v[96:99]
 v_exp_f32 v162, v162
 v_mfma_f32_16x16x32_bf16 v[100:103], v[180:183], a[228:231], v[100:103]
 v_exp_f32 v163, v163
 v_mfma_f32_16x16x32_bf16 v[104:107], v[180:183], a[232:235], v[104:107]
 v_exp_f32 v164, v164
 v_mfma_f32_16x16x32_bf16 v[108:111], v[180:183], a[236:239], v[108:111]
 v_exp_f32 v165, v165
 v_mfma_f32_16x16x32_bf16 v[112:115], v[180:183], a[240:243], v[112:115]
 v_exp_f32 v166, v166
 v_mfma_f32_16x16x32_bf16 v[116:119], v[180:183], a[244:247], v[116:119]
 v_exp_f32 v167, v167
 v_mfma_f32_16x16x32_bf16 v[120:123], v[180:183], a[248:251], v[120:123]
 v_cvt_pk_bf16_f32 v177, v162, v163
 v_cvt_pk_bf16_f32 v178, v164, v165
 v_mfma_f32_16x16x32_bf16 v[124:127], v[180:183], a[252:255], v[124:127]
 v_cvt_pk_bf16_f32 v179, v166, v167
 v_mul_f32_dpp v25, v218, v25 row_newbcast:1 row_mask:0xf bank_mask:0xf
 v_mfma_f32_16x16x32_bf16 v[168:171], a[192:195], a[16:19], v[156:159]
 ds_read_b128 a[192:195], v250 offset:0
 v_mul_f32_dpp v29, v218, v29 row_newbcast:1 row_mask:0xf bank_mask:0xf
 v_mfma_f32_16x16x32_bf16 v[168:171], a[196:199], a[20:23], v[168:171]
 ds_read_b128 a[196:199], v250 offset:512
 v_cvt_pk_bf16_f32 v243, v25, v29
 v_mfma_f32_16x16x32_bf16 v[168:171], a[200:203], a[24:27], v[168:171]
 buffer_store_dwordx4 v[240:243], v244, s[20:23], s33 offen offset:1024 sc1
 v_mfma_f32_16x16x32_bf16 v[168:171], a[204:207], a[28:31], v[168:171]
 ds_read_b128 a[200:203], v250 offset:1024
 ds_read_b128 a[204:207], v250 offset:1536
 v_mfma_f32_16x16x32_bf16 v[172:175], a[220:223], a[28:31], v[156:159]
 ds_read_b128 a[220:223], v250 offset:3584
 v_mul_f32_dpp v2, v218, v2 row_newbcast:2 row_mask:0xf bank_mask:0xf
 v_mfma_f32_16x16x32_bf16 v[172:175], a[216:219], a[24:27], v[172:175]
 ds_read_b128 a[216:219], v250 offset:3072
 v_mul_f32_dpp v6, v218, v6 row_newbcast:2 row_mask:0xf bank_mask:0xf
 v_mfma_f32_16x16x32_bf16 v[172:175], a[212:215], a[20:23], v[172:175]
 ds_read_b128 a[212:215], v250 offset:2560
 v_cvt_pk_bf16_f32 v240, v2, v6
 v_mfma_f32_16x16x32_bf16 v[172:175], a[208:211], a[16:19], v[172:175]
 ds_read_b128 a[208:211], v250 offset:2048
 v_mul_f32_dpp v10, v218, v10 row_newbcast:2 row_mask:0xf bank_mask:0xf
 v_mfma_f32_16x16x32_bf16 v[184:187], v[176:179], a[224:227], v[184:187]
 v_exp_f32 v168, v168
 v_mfma_f32_16x16x32_bf16 v[188:191], v[176:179], a[228:231], v[188:191]
 v_exp_f32 v169, v169
 v_mfma_f32_16x16x32_bf16 v[192:195], v[176:179], a[232:235], v[192:195]
 v_exp_f32 v170, v170
 v_mfma_f32_16x16x32_bf16 v[196:199], v[176:179], a[236:239], v[196:199]
 v_exp_f32 v171, v171
 v_mfma_f32_16x16x32_bf16 v[200:203], v[176:179], a[240:243], v[200:203]
 v_exp_f32 v172, v172
 v_mfma_f32_16x16x32_bf16 v[204:207], v[176:179], a[244:247], v[204:207]
 v_exp_f32 v173, v173
 v_mfma_f32_16x16x32_bf16 v[208:211], v[176:179], a[248:251], v[208:211]
 v_exp_f32 v174, v174
 v_mfma_f32_16x16x32_bf16 v[212:215], v[176:179], a[252:255], v[212:215]
 s_waitcnt lgkmcnt(0)
 v_exp_f32 v175, v175
 v_mfma_f32_16x16x32_bf16 v[160:163], a[192:195], a[32:35], v[144:147]
 v_cvt_pk_bf16_f32 v180, v168, v169
 v_cvt_pk_bf16_f32 v181, v170, v171
 v_mfma_f32_16x16x32_bf16 v[160:163], a[196:199], a[36:39], v[160:163]
 v_cvt_pk_bf16_f32 v182, v172, v173
 v_cvt_pk_bf16_f32 v183, v174, v175
 v_mfma_f32_16x16x32_bf16 v[160:163], a[200:203], a[40:43], v[160:163]
 v_mul_f32_dpp v14, v218, v14 row_newbcast:2 row_mask:0xf bank_mask:0xf
 v_cvt_pk_bf16_f32 v241, v10, v14
 v_mfma_f32_16x16x32_bf16 v[160:163], a[204:207], a[44:47], v[160:163]
 v_mul_f32_dpp v18, v218, v18 row_newbcast:2 row_mask:0xf bank_mask:0xf
 v_mul_f32_dpp v22, v218, v22 row_newbcast:2 row_mask:0xf bank_mask:0xf
 v_mfma_f32_16x16x32_bf16 v[164:167], a[220:223], a[44:47], v[144:147]
 v_cvt_pk_bf16_f32 v242, v18, v22
 v_mul_f32_dpp v26, v218, v26 row_newbcast:2 row_mask:0xf bank_mask:0xf
 v_mfma_f32_16x16x32_bf16 v[164:167], a[216:219], a[40:43], v[164:167]
 v_mul_f32_dpp v30, v218, v30 row_newbcast:2 row_mask:0xf bank_mask:0xf
 v_cvt_pk_bf16_f32 v243, v26, v30
 v_mfma_f32_16x16x32_bf16 v[164:167], a[212:215], a[36:39], v[164:167]
 v_exp_f32 v160, v160
 v_mfma_f32_16x16x32_bf16 v[164:167], a[208:211], a[32:35], v[164:167]
 v_exp_f32 v161, v161
 v_smfmac_f32_16x16x64_bf16 v[132:135], v[236:239], v[176:183], v138
 v_cvt_pk_bf16_f32 v176, v160, v161
 v_mfma_f32_16x16x32_bf16 v[32:35], v[180:183], a[224:227], v[32:35]
 buffer_store_dwordx4 v[240:243], v244, s[20:23], s33 offen offset:2048 sc1
 v_mfma_f32_16x16x32_bf16 v[36:39], v[180:183], a[228:231], v[36:39]
 ds_read_b128 a[224:227], v249 offset:0
 ds_read_b128 a[228:231], v249 offset:512
 v_mfma_f32_16x16x32_bf16 v[40:43], v[180:183], a[232:235], v[40:43]
 ds_read_b128 a[232:235], v249 offset:1024
 v_mul_f32_dpp v3, v218, v3 row_newbcast:3 row_mask:0xf bank_mask:0xf
 v_mfma_f32_16x16x32_bf16 v[44:47], v[180:183], a[236:239], v[44:47]
 v_exp_f32 v162, v162
 v_mfma_f32_16x16x32_bf16 v[48:51], v[180:183], a[240:243], v[48:51]
 v_exp_f32 v163, v163
 v_mfma_f32_16x16x32_bf16 v[52:55], v[180:183], a[244:247], v[52:55]
 v_exp_f32 v164, v164
 v_mfma_f32_16x16x32_bf16 v[56:59], v[180:183], a[248:251], v[56:59]
 v_exp_f32 v165, v165
 v_mfma_f32_16x16x32_bf16 v[60:63], v[180:183], a[252:255], v[60:63]
 v_exp_f32 v166, v166
 v_mfma_f32_16x16x32_bf16 v[168:171], a[192:195], a[48:51], v[148:151]
 ds_read_b128 a[236:239], v249 offset:1536
 ds_read_b128 a[240:243], v249 offset:2048
 v_mfma_f32_16x16x32_bf16 v[168:171], a[196:199], a[52:55], v[168:171]
 v_exp_f32 v167, v167
 v_mfma_f32_16x16x32_bf16 v[168:171], a[200:203], a[56:59], v[168:171]
 ds_read_b128 a[244:247], v249 offset:2560
 ds_read_b128 a[248:251], v249 offset:3072
 v_mfma_f32_16x16x32_bf16 v[168:171], a[204:207], a[60:63], v[168:171]
 v_cvt_pk_bf16_f32 v177, v162, v163
 v_cvt_pk_bf16_f32 v178, v164, v165
 v_mfma_f32_16x16x32_bf16 v[172:175], a[220:223], a[60:63], v[148:151]
 ds_read_b128 a[252:255], v249 offset:3584
 v_cvt_pk_bf16_f32 v179, v166, v167
 v_mfma_f32_16x16x32_bf16 v[172:175], a[216:219], a[56:59], v[172:175]
 v_mul_f32_dpp v7, v218, v7 row_newbcast:3 row_mask:0xf bank_mask:0xf
 v_cvt_pk_bf16_f32 v240, v3, v7
 v_mfma_f32_16x16x32_bf16 v[172:175], a[212:215], a[52:55], v[172:175]
 v_exp_f32 v168, v168
 v_mfma_f32_16x16x32_bf16 v[172:175], a[208:211], a[48:51], v[172:175]
 s_waitcnt lgkmcnt(3)
 v_exp_f32 v169, v169
 v_mfma_f32_16x16x32_bf16 v[64:67], v[176:179], a[224:227], v[64:67]
 v_exp_f32 v170, v170
 v_mfma_f32_16x16x32_bf16 v[68:71], v[176:179], a[228:231], v[68:71]
 v_exp_f32 v171, v171
 v_mfma_f32_16x16x32_bf16 v[72:75], v[176:179], a[232:235], v[72:75]
 v_cvt_pk_bf16_f32 v180, v168, v169
 v_cvt_pk_bf16_f32 v181, v170, v171
 v_mfma_f32_16x16x32_bf16 v[76:79], v[176:179], a[236:239], v[76:79]
 v_exp_f32 v172, v172
 v_mfma_f32_16x16x32_bf16 v[80:83], v[176:179], a[240:243], v[80:83]
 s_waitcnt lgkmcnt(0)
 v_exp_f32 v173, v173
 v_mfma_f32_16x16x32_bf16 v[84:87], v[176:179], a[244:247], v[84:87]
 v_exp_f32 v174, v174
 v_mfma_f32_16x16x32_bf16 v[88:91], v[176:179], a[248:251], v[88:91]
 v_exp_f32 v175, v175
 v_mfma_f32_16x16x32_bf16 v[92:95], v[176:179], a[252:255], v[92:95]
 v_cvt_pk_bf16_f32 v182, v172, v173
 v_cvt_pk_bf16_f32 v183, v174, v175
 v_mfma_f32_16x16x32_bf16 v[160:163], a[192:195], v[220:223], v[152:155]
 v_mul_f32_dpp v11, v218, v11 row_newbcast:3 row_mask:0xf bank_mask:0xf
 v_mul_f32_dpp v15, v218, v15 row_newbcast:3 row_mask:0xf bank_mask:0xf
 v_mfma_f32_16x16x32_bf16 v[160:163], a[196:199], v[224:227], v[160:163]
 v_cvt_pk_bf16_f32 v241, v11, v15
 v_mul_f32_dpp v19, v218, v19 row_newbcast:3 row_mask:0xf bank_mask:0xf
 v_mfma_f32_16x16x32_bf16 v[160:163], a[200:203], v[228:231], v[160:163]
 v_mul_f32_dpp v23, v218, v23 row_newbcast:3 row_mask:0xf bank_mask:0xf
 v_cvt_pk_bf16_f32 v242, v19, v23
 v_mfma_f32_16x16x32_bf16 v[160:163], a[204:207], v[232:235], v[160:163]
 v_mul_f32_dpp v27, v218, v27 row_newbcast:3 row_mask:0xf bank_mask:0xf
 v_mul_f32_dpp v31, v218, v31 row_newbcast:3 row_mask:0xf bank_mask:0xf
 v_mfma_f32_16x16x32_bf16 v[164:167], a[220:223], v[232:235], v[152:155]
 v_cvt_pk_bf16_f32 v243, v27, v31
 s_nop 0
 v_mfma_f32_16x16x32_bf16 v[164:167], a[216:219], v[228:231], v[164:167]
 buffer_store_dwordx4 v[240:243], v244, s[20:23], s33 offen offset:3072 sc1
 v_mfma_f32_16x16x32_bf16 v[164:167], a[212:215], v[224:227], v[164:167]
 v_exp_f32 v160, v160
 v_mfma_f32_16x16x32_bf16 v[164:167], a[208:211], v[220:223], v[164:167]
 v_exp_f32 v161, v161
 v_smfmac_f32_16x16x64_bf16 v[128:131], v[236:239], v[176:183], v138
 v_cvt_pk_bf16_f32 v176, v160, v161
 v_mfma_f32_16x16x32_bf16 v[96:99], v[180:183], a[224:227], v[96:99]
 v_exp_f32 v162, v162
 v_mfma_f32_16x16x32_bf16 v[100:103], v[180:183], a[228:231], v[100:103]
 v_exp_f32 v163, v163
 v_mfma_f32_16x16x32_bf16 v[104:107], v[180:183], a[232:235], v[104:107]
 v_exp_f32 v164, v164
 v_mfma_f32_16x16x32_bf16 v[108:111], v[180:183], a[236:239], v[108:111]
 v_exp_f32 v165, v165
 v_mfma_f32_16x16x32_bf16 v[112:115], v[180:183], a[240:243], v[112:115]
 v_exp_f32 v166, v166
 v_mfma_f32_16x16x32_bf16 v[116:119], v[180:183], a[244:247], v[116:119]
 v_exp_f32 v167, v167
 v_mfma_f32_16x16x32_bf16 v[120:123], v[180:183], a[248:251], v[120:123]
 v_cvt_pk_bf16_f32 v177, v162, v163
 v_cvt_pk_bf16_f32 v178, v164, v165
 v_mfma_f32_16x16x32_bf16 v[124:127], v[180:183], a[252:255], v[124:127]
 v_cvt_pk_bf16_f32 v179, v166, v167
 v_mfma_f32_16x16x32_bf16 v[168:171], a[192:195], a[16:19], v[156:159]
 ds_read_b128 a[192:195], v250 offset:8192
 v_mfma_f32_16x16x32_bf16 v[168:171], a[196:199], a[20:23], v[168:171]
 ds_read_b128 a[196:199], v250 offset:8704
 v_mfma_f32_16x16x32_bf16 v[168:171], a[200:203], a[24:27], v[168:171]
 ds_read_b128 a[200:203], v250 offset:9216
 v_mfma_f32_16x16x32_bf16 v[168:171], a[204:207], a[28:31], v[168:171]
 ds_read_b128 a[204:207], v250 offset:9728
 s_nop 0
 v_mfma_f32_16x16x32_bf16 v[172:175], a[220:223], a[28:31], v[156:159]
 buffer_load_dwordx4 a[28:31], v245, s[8:11], s32 offen offset:192
 v_mfma_f32_16x16x32_bf16 v[172:175], a[216:219], a[24:27], v[172:175]
 ds_read_b128 a[220:223], v250 offset:11776
 ds_read_b128 a[216:219], v250 offset:11264
 v_mfma_f32_16x16x32_bf16 v[172:175], a[212:215], a[20:23], v[172:175]
 v_exp_f32 v168, v168
 v_mfma_f32_16x16x32_bf16 v[172:175], a[208:211], a[16:19], v[172:175]
 v_exp_f32 v169, v169
 v_mfma_f32_16x16x32_bf16 v[184:187], v[176:179], a[224:227], v[184:187]
 buffer_load_dwordx4 a[16:19], v245, s[8:11], s32 offen offset:0
 v_mfma_f32_16x16x32_bf16 v[188:191], v[176:179], a[228:231], v[188:191]
 v_exp_f32 v170, v170
 v_mfma_f32_16x16x32_bf16 v[192:195], v[176:179], a[232:235], v[192:195]
 v_exp_f32 v171, v171
 v_mfma_f32_16x16x32_bf16 v[196:199], v[176:179], a[236:239], v[196:199]
 v_exp_f32 v173, v173
 v_mfma_f32_16x16x32_bf16 v[200:203], v[176:179], a[240:243], v[200:203]
 buffer_load_dwordx4 a[20:23], v245, s[8:11], s32 offen offset:64
 ds_read_b128 a[212:215], v250 offset:10752
 v_mfma_f32_16x16x32_bf16 v[204:207], v[176:179], a[244:247], v[204:207]
 ds_read_b128 a[208:211], v250 offset:10240
 v_exp_f32 v174, v174
 v_mfma_f32_16x16x32_bf16 v[208:211], v[176:179], a[248:251], v[208:211]
 v_exp_f32 v175, v175
 v_mfma_f32_16x16x32_bf16 v[212:215], v[176:179], a[252:255], v[212:215]
 s_waitcnt lgkmcnt(2)
 v_cvt_pk_bf16_f32 v180, v168, v169
 v_cvt_pk_bf16_f32 v181, v170, v171
 v_mfma_f32_16x16x32_bf16 v[160:163], a[192:195], a[32:35], v[144:147]
 buffer_load_dwordx4 a[24:27], v245, s[8:11], s32 offen offset:128
 v_mfma_f32_16x16x32_bf16 v[160:163], a[196:199], a[36:39], v[160:163]
 v_exp_f32 v172, v172
 v_mfma_f32_16x16x32_bf16 v[160:163], a[200:203], a[40:43], v[160:163]
 v_cvt_pk_bf16_f32 v182, v172, v173
 v_cvt_pk_bf16_f32 v183, v174, v175
 v_mfma_f32_16x16x32_bf16 v[160:163], a[204:207], a[44:47], v[160:163]
 s_nop 1
 v_mfma_f32_16x16x32_bf16 v[164:167], a[220:223], a[44:47], v[144:147]
 s_nop 1
 v_mfma_f32_16x16x32_bf16 v[164:167], a[216:219], a[40:43], v[164:167]
 s_waitcnt lgkmcnt(0)
 s_nop 1
 v_mfma_f32_16x16x32_bf16 v[164:167], a[212:215], a[36:39], v[164:167]
 v_exp_f32 v160, v160
 v_mfma_f32_16x16x32_bf16 v[164:167], a[208:211], a[32:35], v[164:167]
 v_exp_f32 v161, v161
 v_smfmac_f32_16x16x64_bf16 v[132:135], v[236:239], v[176:183], v138
 v_cvt_pk_bf16_f32 v176, v160, v161
 v_mfma_f32_16x16x32_bf16 v[32:35], v[180:183], a[224:227], v[32:35]
 v_exp_f32 v162, v162
 v_mfma_f32_16x16x32_bf16 v[36:39], v[180:183], a[228:231], v[36:39]
 v_exp_f32 v163, v163
 v_mfma_f32_16x16x32_bf16 v[40:43], v[180:183], a[232:235], v[40:43]
 ds_read_b128 a[232:235], v249 offset:9216
 ds_read_b128 a[224:227], v249 offset:8192
 v_mfma_f32_16x16x32_bf16 v[44:47], v[180:183], a[236:239], v[44:47]
 ds_read_b128 a[236:239], v249 offset:9728
 ds_read_b128 a[228:231], v249 offset:8704
 v_mfma_f32_16x16x32_bf16 v[48:51], v[180:183], a[240:243], v[48:51]
 ds_read_b128 a[240:243], v249 offset:10240
 v_cvt_pk_bf16_f32 v177, v162, v163
 v_mfma_f32_16x16x32_bf16 v[52:55], v[180:183], a[244:247], v[52:55]
 ds_read_b128 a[244:247], v249 offset:10752
 v_add_f32 v219, v134, v135
 v_mfma_f32_16x16x32_bf16 v[56:59], v[180:183], a[248:251], v[56:59]
 v_exp_f32 v164, v164
 v_mfma_f32_16x16x32_bf16 v[60:63], v[180:183], a[252:255], v[60:63]
 s_waitcnt vmcnt(8)
 v_exp_f32 v165, v165
 v_mfma_f32_16x16x32_bf16 v[252:255], a[192:195], a[0:3], 0
 v_exp_f32 v166, v166
 v_mfma_f32_16x16x32_bf16 v[252:255], a[196:199], a[4:7], v[252:255]
 v_exp_f32 v167, v167
 v_mfma_f32_16x16x32_bf16 v[252:255], a[200:203], a[8:11], v[252:255]
 ds_read_b128 a[248:251], v249 offset:11264
 v_cvt_pk_bf16_f32 v178, v164, v165
 v_mfma_f32_16x16x32_bf16 v[252:255], a[204:207], a[12:15], v[252:255]
 ds_read_b128 a[252:255], v249 offset:11776
 v_cvt_pk_bf16_f32 v179, v166, v167
 v_mfma_f32_16x16x32_bf16 v[168:171], a[192:195], a[48:51], v[148:151]
 v_mov_b32 v134, 0
 v_mov_b32 v135, 0
 v_mfma_f32_16x16x32_bf16 v[168:171], a[196:199], a[52:55], v[168:171]
 v_cmp_nge_f32 vcc, s28, v219
 s_nop 0
 v_mfma_f32_16x16x32_bf16 v[168:171], a[200:203], a[56:59], v[168:171]
 s_cmp_lg_u64 vcc, 0
 v_max3_f32 v246, v252, v253, v254
 v_max_f32 v246, v246, v255
 v_mfma_f32_16x16x32_bf16 v[168:171], a[204:207], a[60:63], v[168:171]
 s_cselect_b32 s34, 2048, 0
 v_rcp_f32 v219, v219
 v_mfma_f32_16x16x32_bf16 v[172:175], a[220:223], a[60:63], v[148:151]
 s_or_b32 s29, s29, s34
 v_mov_b32 v247, v246
 v_mov_b32_dpp v219, v219 row_shl:4 row_mask:0x2 bank_mask:0xf
 v_mfma_f32_16x16x32_bf16 v[172:175], a[216:219], a[56:59], v[172:175]
 s_add_u32 s33, s25, 45056
 v_permlane16_swap_b32 v246, v247
 v_max_f32 v246, v246, v247
 v_mfma_f32_16x16x32_bf16 v[172:175], a[212:215], a[52:55], v[172:175]
 s_add_u32 s32, s25, 69632
 v_exp_f32 v168, v168
 v_mfma_f32_16x16x32_bf16 v[172:175], a[208:211], a[48:51], v[172:175]
 s_waitcnt lgkmcnt(0)
 v_exp_f32 v169, v169
 v_mfma_f32_16x16x32_bf16 v[64:67], v[176:179], a[224:227], v[64:67]
 v_exp_f32 v170, v170
 v_mfma_f32_16x16x32_bf16 v[68:71], v[176:179], a[228:231], v[68:71]
 v_exp_f32 v171, v171
 v_mfma_f32_16x16x32_bf16 v[72:75], v[176:179], a[232:235], v[72:75]
 v_cvt_pk_bf16_f32 v180, v168, v169
 v_cvt_pk_bf16_f32 v181, v170, v171
 v_mfma_f32_16x16x32_bf16 v[76:79], v[176:179], a[236:239], v[76:79]
 v_exp_f32 v175, v175
 v_mfma_f32_16x16x32_bf16 v[80:83], v[176:179], a[240:243], v[80:83]
 v_exp_f32 v172, v172
 v_mfma_f32_16x16x32_bf16 v[84:87], v[176:179], a[244:247], v[84:87]
 v_exp_f32 v173, v173
 v_mfma_f32_16x16x32_bf16 v[88:91], v[176:179], a[248:251], v[88:91]
 v_cvt_pk_bf16_f32 v182, v172, v173
 v_mov_b32 v247, v246
 v_mfma_f32_16x16x32_bf16 v[92:95], v[176:179], a[252:255], v[92:95]
 v_exp_f32 v174, v174
 v_mfma_f32_16x16x32_bf16 v[160:163], a[192:195], v[220:223], v[152:155]
 v_cvt_pk_bf16_f32 v183, v174, v175
 v_permlane32_swap_b32 v246, v247
 v_mfma_f32_16x16x32_bf16 v[160:163], a[196:199], v[224:227], v[160:163]
 v_min_f32 v246, -v246, -v247
 v_mov_b32 v156, v246
 v_mfma_f32_16x16x32_bf16 v[160:163], a[200:203], v[228:231], v[160:163]
 v_mov_b32 v157, v246
 v_mov_b32 v158, v246
 v_mfma_f32_16x16x32_bf16 v[160:163], a[204:207], v[232:235], v[160:163]
 ds_read_b128 a[192:195], v250 offset:16384
 v_mov_b32 v159, v246
 v_mfma_f32_16x16x32_bf16 v[164:167], a[220:223], v[232:235], v[152:155]
 ds_read_b128 a[196:199], v250 offset:16896
 ds_read_b128 a[200:203], v250 offset:17408
 v_mfma_f32_16x16x32_bf16 v[164:167], a[216:219], v[228:231], v[164:167]
 ds_read_b128 a[204:207], v250 offset:17920
 v_add_f32 v252, v252, v246
 v_mfma_f32_16x16x32_bf16 v[164:167], a[212:215], v[224:227], v[164:167]
 v_exp_f32 v161, v161
 v_mfma_f32_16x16x32_bf16 v[164:167], a[208:211], v[220:223], v[164:167]
 v_exp_f32 v162, v162
 v_smfmac_f32_16x16x64_bf16 v[128:131], v[236:239], v[176:183], v138
 v_add_f32 v253, v253, v246
 v_mfma_f32_16x16x32_bf16 v[96:99], v[180:183], a[224:227], v[96:99]
 v_exp_f32 v163, v163
 v_mfma_f32_16x16x32_bf16 v[100:103], v[180:183], a[228:231], v[100:103]
 v_exp_f32 v160, v160
 v_mfma_f32_16x16x32_bf16 v[104:107], v[180:183], a[232:235], v[104:107]
 v_exp_f32 v164, v164
 v_mfma_f32_16x16x32_bf16 v[108:111], v[180:183], a[236:239], v[108:111]
 v_exp_f32 v165, v165
 v_mfma_f32_16x16x32_bf16 v[112:115], v[180:183], a[240:243], v[112:115]
 v_exp_f32 v166, v166
 v_mfma_f32_16x16x32_bf16 v[116:119], v[180:183], a[244:247], v[116:119]
 v_exp_f32 v167, v167
 v_mfma_f32_16x16x32_bf16 v[120:123], v[180:183], a[248:251], v[120:123]
 v_cvt_pk_bf16_f32 v176, v160, v161
 v_cvt_pk_bf16_f32 v177, v162, v163
 v_mfma_f32_16x16x32_bf16 v[124:127], v[180:183], a[252:255], v[124:127]
 v_cvt_pk_bf16_f32 v178, v164, v165
 v_cvt_pk_bf16_f32 v179, v166, v167
 v_mfma_f32_16x16x32_bf16 v[172:175], a[220:223], a[12:15], v[156:159]
L_pg12:
 s_cbranch_execz L_pg16
 ds_read_b128 a[220:223], v250 offset:19968
 v_add_f32 v254, v254, v246
 v_mfma_f32_16x16x32_bf16 v[172:175], a[216:219], a[8:11], v[172:175]
 ds_read_b128 a[216:219], v250 offset:19456
 v_add_f32 v255, v255, v246
 v_mfma_f32_16x16x32_bf16 v[172:175], a[212:215], a[4:7], v[172:175]
 v_exp_f32 v252, v252
 v_mfma_f32_16x16x32_bf16 v[172:175], a[208:211], a[0:3], v[172:175]
 v_exp_f32 v253, v253
 v_mfma_f32_16x16x32_bf16 v[184:187], v[176:179], a[224:227], v[184:187]
 v_exp_f32 v254, v254
 v_mfma_f32_16x16x32_bf16 v[188:191], v[176:179], a[228:231], v[188:191]
 v_exp_f32 v255, v255
 v_mfma_f32_16x16x32_bf16 v[192:195], v[176:179], a[232:235], v[192:195]
 ds_read_b128 a[212:215], v250 offset:18944
 ds_read_b128 a[208:211], v250 offset:18432
 v_mfma_f32_16x16x32_bf16 v[196:199], v[176:179], a[236:239], v[196:199]
 v_exp_f32 v172, v172
 v_mfma_f32_16x16x32_bf16 v[200:203], v[176:179], a[240:243], v[200:203]
 v_exp_f32 v173, v173
 v_mfma_f32_16x16x32_bf16 v[204:207], v[176:179], a[244:247], v[204:207]
 v_exp_f32 v174, v174
 v_mfma_f32_16x16x32_bf16 v[208:211], v[176:179], a[248:251], v[208:211]
 v_exp_f32 v175, v175
 v_mfma_f32_16x16x32_bf16 v[212:215], v[176:179], a[252:255], v[212:215]
 s_waitcnt lgkmcnt(2)
 v_cvt_pk_bf16_f32 v180, v252, v253
 v_cvt_pk_bf16_f32 v181, v254, v255
 v_mfma_f32_16x16x32_bf16 v[160:163], a[192:195], a[32:35], v[144:147]
 v_cvt_pk_bf16_f32 v182, v172, v173
 v_cvt_pk_bf16_f32 v183, v174, v175
 v_mfma_f32_16x16x32_bf16 v[160:163], a[196:199], a[36:39], v[160:163]
 v_mov_b32_dpp v219, v219 row_shl:8 row_mask:0x4 bank_mask:0xf
 s_nop 0
 v_mfma_f32_16x16x32_bf16 v[160:163], a[200:203], a[40:43], v[160:163]
 v_mov_b32_dpp v219, v219 row_shl:12 row_mask:0x8 bank_mask:0xf
 s_nop 0
 v_mfma_f32_16x16x32_bf16 v[160:163], a[204:207], a[44:47], v[160:163]
 v_mul_f32_dpp v32, v219, v32 row_newbcast:0 row_mask:0xf bank_mask:0xf
 v_mul_f32_dpp v36, v219, v36 row_newbcast:0 row_mask:0xf bank_mask:0xf
 v_mfma_f32_16x16x32_bf16 v[164:167], a[220:223], a[44:47], v[144:147]
 v_cvt_pk_bf16_f32 v240, v32, v36
 v_mul_f32_dpp v40, v219, v40 row_newbcast:0 row_mask:0xf bank_mask:0xf
 v_mfma_f32_16x16x32_bf16 v[164:167], a[216:219], a[40:43], v[164:167]
 s_waitcnt lgkmcnt(0)
 v_mul_f32_dpp v44, v219, v44 row_newbcast:0 row_mask:0xf bank_mask:0xf
 v_cvt_pk_bf16_f32 v241, v40, v44
 v_mfma_f32_16x16x32_bf16 v[164:167], a[212:215], a[36:39], v[164:167]
 v_exp_f32 v160, v160
 v_mfma_f32_16x16x32_bf16 v[164:167], a[208:211], a[32:35], v[164:167]
 v_exp_f32 v161, v161
 v_smfmac_f32_16x16x64_bf16 v[132:135], v[236:239], v[176:183], v138
 v_cvt_pk_bf16_f32 v176, v160, v161
 v_mfma_f32_16x16x32_bf16 v[0:3], v[180:183], a[224:227], 0
 ds_read_b128 a[224:227], v249 offset:16384
 v_mul_f32_dpp v48, v219, v48 row_newbcast:0 row_mask:0xf bank_mask:0xf
 v_mfma_f32_16x16x32_bf16 v[4:7], v[180:183], a[228:231], 0
 ds_read_b128 a[228:231], v249 offset:16896
 v_mul_f32_dpp v52, v219, v52 row_newbcast:0 row_mask:0xf bank_mask:0xf
 v_mfma_f32_16x16x32_bf16 v[8:11], v[180:183], a[232:235], 0
 ds_read_b128 a[232:235], v249 offset:17408
 v_cvt_pk_bf16_f32 v242, v48, v52
 v_mfma_f32_16x16x32_bf16 v[12:15], v[180:183], a[236:239], 0
 v_exp_f32 v162, v162
 v_mfma_f32_16x16x32_bf16 v[16:19], v[180:183], a[240:243], 0
 v_exp_f32 v163, v163
 v_mfma_f32_16x16x32_bf16 v[20:23], v[180:183], a[244:247], 0
 v_exp_f32 v164, v164
 v_mfma_f32_16x16x32_bf16 v[24:27], v[180:183], a[248:251], 0
 v_exp_f32 v165, v165
 v_mfma_f32_16x16x32_bf16 v[28:31], v[180:183], a[252:255], 0
 v_exp_f32 v166, v166
 v_mfma_f32_16x16x32_bf16 v[168:171], a[192:195], a[48:51], v[148:151]
 ds_read_b128 a[236:239], v249 offset:17920
 ds_read_b128 a[240:243], v249 offset:18432
 v_mfma_f32_16x16x32_bf16 v[168:171], a[196:199], a[52:55], v[168:171]
 v_exp_f32 v167, v167
 v_mfma_f32_16x16x32_bf16 v[168:171], a[200:203], a[56:59], v[168:171]
 ds_read_b128 a[244:247], v249 offset:18944
 ds_read_b128 a[248:251], v249 offset:19456
 v_mfma_f32_16x16x32_bf16 v[168:171], a[204:207], a[60:63], v[168:171]
 v_cvt_pk_bf16_f32 v177, v162, v163
 v_cvt_pk_bf16_f32 v178, v164, v165
 v_mfma_f32_16x16x32_bf16 v[172:175], a[220:223], a[60:63], v[148:151]
 ds_read_b128 a[252:255], v249 offset:19968
 v_cvt_pk_bf16_f32 v179, v166, v167
 v_mfma_f32_16x16x32_bf16 v[172:175], a[216:219], a[56:59], v[172:175]
 v_mul_f32_dpp v56, v219, v56 row_newbcast:0 row_mask:0xf bank_mask:0xf
 v_mul_f32_dpp v60, v219, v60 row_newbcast:0 row_mask:0xf bank_mask:0xf
 v_mfma_f32_16x16x32_bf16 v[172:175], a[212:215], a[52:55], v[172:175]
 v_exp_f32 v168, v168
 v_mfma_f32_16x16x32_bf16 v[172:175], a[208:211], a[48:51], v[172:175]
 s_waitcnt lgkmcnt(3)
 v_exp_f32 v169, v169
 v_mfma_f32_16x16x32_bf16 v[64:67], v[176:179], a[224:227], v[64:67]
 v_exp_f32 v170, v170
 v_mfma_f32_16x16x32_bf16 v[68:71], v[176:179], a[228:231], v[68:71]
 v_exp_f32 v171, v171
 v_mfma_f32_16x16x32_bf16 v[72:75], v[176:179], a[232:235], v[72:75]
 v_cvt_pk_bf16_f32 v180, v168, v169
 v_cvt_pk_bf16_f32 v181, v170, v171
 v_mfma_f32_16x16x32_bf16 v[76:79], v[176:179], a[236:239], v[76:79]
 v_exp_f32 v172, v172
 v_mfma_f32_16x16x32_bf16 v[80:83], v[176:179], a[240:243], v[80:83]
 s_waitcnt lgkmcnt(0)
 v_exp_f32 v173, v173
 v_mfma_f32_16x16x32_bf16 v[84:87], v[176:179], a[244:247], v[84:87]
 v_exp_f32 v174, v174
 v_mfma_f32_16x16x32_bf16 v[88:91], v[176:179], a[248:251], v[88:91]
 v_exp_f32 v175, v175
 v_mfma_f32_16x16x32_bf16 v[92:95], v[176:179], a[252:255], v[92:95]
 v_cvt_pk_bf16_f32 v182, v172, v173
 v_cvt_pk_bf16_f32 v183, v174, v175
 v_mfma_f32_16x16x32_bf16 v[160:163], a[192:195], v[220:223], v[152:155]
 v_cvt_pk_bf16_f32 v243, v56, v60
 v_mul_f32_dpp v33, v219, v33 row_newbcast:1 row_mask:0xf bank_mask:0xf
 v_mfma_f32_16x16x32_bf16 v[160:163], a[196:199], v[224:227], v[160:163]
 buffer_store_dwordx4 v[240:243], v244, s[20:23], s33 offen offset:0 sc1
 v_mfma_f32_16x16x32_bf16 v[160:163], a[200:203], v[228:231], v[160:163]
 v_mul_f32_dpp v37, v219, v37 row_newbcast:1 row_mask:0xf bank_mask:0xf
 v_cvt_pk_bf16_f32 v240, v33, v37
 v_mfma_f32_16x16x32_bf16 v[160:163], a[204:207], v[232:235], v[160:163]
 v_mul_f32_dpp v41, v219, v41 row_newbcast:1 row_mask:0xf bank_mask:0xf
 v_mul_f32_dpp v45, v219, v45 row_newbcast:1 row_mask:0xf bank_mask:0xf
 v_mfma_f32_16x16x32_bf16 v[164:167], a[220:223], v[232:235], v[152:155]
 v_cvt_pk_bf16_f32 v241, v41, v45
 v_mul_f32_dpp v49, v219, v49 row_newbcast:1 row_mask:0xf bank_mask:0xf
 v_mfma_f32_16x16x32_bf16 v[164:167], a[216:219], v[228:231], v[164:167]
 v_mul_f32_dpp v53, v219, v53 row_newbcast:1 row_mask:0xf bank_mask:0xf
 v_cvt_pk_bf16_f32 v242, v49, v53
 v_mfma_f32_16x16x32_bf16 v[164:167], a[212:215], v[224:227], v[164:167]
 v_exp_f32 v160, v160
 v_mfma_f32_16x16x32_bf16 v[164:167], a[208:211], v[220:223], v[164:167]
 v_exp_f32 v161, v161
 v_smfmac_f32_16x16x64_bf16 v[128:131], v[236:239], v[176:183], v138
 v_cvt_pk_bf16_f32 v176, v160, v161
 v_mfma_f32_16x16x32_bf16 v[96:99], v[180:183], a[224:227], v[96:99]
 v_exp_f32 v162, v162
 v_mfma_f32_16x16x32_bf16 v[100:103], v[180:183], a[228:231], v[100:103]
 v_exp_f32 v163, v163
 v_mfma_f32_16x16x32_bf16 v[104:107], v[180:183], a[232:235], v[104:107]
 v_exp_f32 v164, v164
 v_mfma_f32_16x16x32_bf16 v[108:111], v[180:183], a[236:239], v[108:111]
 v_exp_f32 v165, v165
 v_mfma_f32_16x16x32_bf16 v[112:115], v[180:183], a[240:243], v[112:115]
 v_exp_f32 v166, v166
 v_mfma_f32_16x16x32_bf16 v[116:119], v[180:183], a[244:247], v[116:119]
 v_exp_f32 v167, v167
 v_mfma_f32_16x16x32_bf16 v[120:123], v[180:183], a[248:251], v[120:123]
 v_cvt_pk_bf16_f32 v177, v162, v163
 v_cvt_pk_bf16_f32 v178, v164, v165
 v_mfma_f32_16x16x32_bf16 v[124:127], v[180:183], a[252:255], v[124:127]
 v_cvt_pk_bf16_f32 v179, v166, v167
 v_mul_f32_dpp v57, v219, v57 row_newbcast:1 row_mask:0xf bank_mask:0xf
 v_mfma_f32_16x16x32_bf16 v[168:171], a[192:195], a[0:3], v[156:159]
 ds_read_b128 a[192:195], v250 offset:24576
 v_mul_f32_dpp v61, v219, v61 row_newbcast:1 row_mask:0xf bank_mask:0xf
 v_mfma_f32_16x16x32_bf16 v[168:171], a[196:199], a[4:7], v[168:171]
 ds_read_b128 a[196:199], v250 offset:25088
 v_cvt_pk_bf16_f32 v243, v57, v61
 v_mfma_f32_16x16x32_bf16 v[168:171], a[200:203], a[8:11], v[168:171]
 buffer_store_dwordx4 v[240:243], v244, s[20:23], s33 offen offset:1024 sc1
 v_mfma_f32_16x16x32_bf16 v[168:171], a[204:207], a[12:15], v[168:171]
 ds_read_b128 a[200:203], v250 offset:25600
 ds_read_b128 a[204:207], v250 offset:26112
 v_mfma_f32_16x16x32_bf16 v[172:175], a[220:223], a[12:15], v[156:159]
 ds_read_b128 a[220:223], v250 offset:28160
 v_mul_f32_dpp v34, v219, v34 row_newbcast:2 row_mask:0xf bank_mask:0xf
 v_mfma_f32_16x16x32_bf16 v[172:175], a[216:219], a[8:11], v[172:175]
 ds_read_b128 a[216:219], v250 offset:27648
 v_mul_f32_dpp v38, v219, v38 row_newbcast:2 row_mask:0xf bank_mask:0xf
 v_mfma_f32_16x16x32_bf16 v[172:175], a[212:215], a[4:7], v[172:175]
 ds_read_b128 a[212:215], v250 offset:27136
 v_cvt_pk_bf16_f32 v240, v34, v38
 v_mfma_f32_16x16x32_bf16 v[172:175], a[208:211], a[0:3], v[172:175]
 ds_read_b128 a[208:211], v250 offset:26624
 v_mul_f32_dpp v42, v219, v42 row_newbcast:2 row_mask:0xf bank_mask:0xf
 v_mfma_f32_16x16x32_bf16 v[184:187], v[176:179], a[224:227], v[184:187]
 v_exp_f32 v168, v168
 v_mfma_f32_16x16x32_bf16 v[188:191], v[176:179], a[228:231], v[188:191]
 v_exp_f32 v169, v169
 v_mfma_f32_16x16x32_bf16 v[192:195], v[176:179], a[232:235], v[192:195]
 v_exp_f32 v170, v170
 v_mfma_f32_16x16x32_bf16 v[196:199], v[176:179], a[236:239], v[196:199]
 v_exp_f32 v171, v171
 v_mfma_f32_16x16x32_bf16 v[200:203], v[176:179], a[240:243], v[200:203]
 v_exp_f32 v172, v172
 v_mfma_f32_16x16x32_bf16 v[204:207], v[176:179], a[244:247], v[204:207]
 v_exp_f32 v173, v173
 v_mfma_f32_16x16x32_bf16 v[208:211], v[176:179], a[248:251], v[208:211]
 v_exp_f32 v174, v174
 v_mfma_f32_16x16x32_bf16 v[212:215], v[176:179], a[252:255], v[212:215]
 s_waitcnt lgkmcnt(0)
 v_exp_f32 v175, v175
 v_mfma_f32_16x16x32_bf16 v[160:163], a[192:195], a[32:35], v[144:147]
 v_cvt_pk_bf16_f32 v180, v168, v169
 v_cvt_pk_bf16_f32 v181, v170, v171
 v_mfma_f32_16x16x32_bf16 v[160:163], a[196:199], a[36:39], v[160:163]
 v_cvt_pk_bf16_f32 v182, v172, v173
 v_cvt_pk_bf16_f32 v183, v174, v175
 v_mfma_f32_16x16x32_bf16 v[160:163], a[200:203], a[40:43], v[160:163]
 v_mul_f32_dpp v46, v219, v46 row_newbcast:2 row_mask:0xf bank_mask:0xf
 v_cvt_pk_bf16_f32 v241, v42, v46
 v_mfma_f32_16x16x32_bf16 v[160:163], a[204:207], a[44:47], v[160:163]
 v_mul_f32_dpp v50, v219, v50 row_newbcast:2 row_mask:0xf bank_mask:0xf
 v_mul_f32_dpp v54, v219, v54 row_newbcast:2 row_mask:0xf bank_mask:0xf
 v_mfma_f32_16x16x32_bf16 v[164:167], a[220:223], a[44:47], v[144:147]
 buffer_load_dwordx4 a[44:47], v245, s[8:11], s32 offen offset:192
 v_mfma_f32_16x16x32_bf16 v[164:167], a[216:219], a[40:43], v[164:167]
 v_cvt_pk_bf16_f32 v242, v50, v54
 v_mul_f32_dpp v58, v219, v58 row_newbcast:2 row_mask:0xf bank_mask:0xf
 v_mfma_f32_16x16x32_bf16 v[164:167], a[212:215], a[36:39], v[164:167]
 v_exp_f32 v160, v160
 v_mfma_f32_16x16x32_bf16 v[164:167], a[208:211], a[32:35], v[164:167]
 v_exp_f32 v161, v161
 v_smfmac_f32_16x16x64_bf16 v[132:135], v[236:239], v[176:183], v138
 v_cvt_pk_bf16_f32 v176, v160, v161
 v_mfma_f32_16x16x32_bf16 v[0:3], v[180:183], a[224:227], v[0:3]
 buffer_load_dwordx4 a[32:35], v245, s[8:11], s32 offen offset:0
 v_mfma_f32_16x16x32_bf16 v[4:7], v[180:183], a[228:231], v[4:7]
 v_exp_f32 v162, v162
 v_mfma_f32_16x16x32_bf16 v[8:11], v[180:183], a[232:235], v[8:11]
 v_exp_f32 v163, v163
 v_mfma_f32_16x16x32_bf16 v[12:15], v[180:183], a[236:239], v[12:15]
 v_exp_f32 v164, v164
 v_mfma_f32_16x16x32_bf16 v[16:19], v[180:183], a[240:243], v[16:19]
 buffer_load_dwordx4 a[36:39], v245, s[8:11], s32 offen offset:64
 v_mfma_f32_16x16x32_bf16 v[20:23], v[180:183], a[244:247], v[20:23]
 v_exp_f32 v165, v165
 v_mfma_f32_16x16x32_bf16 v[24:27], v[180:183], a[248:251], v[24:27]
 ds_read_b128 a[224:227], v249 offset:24576
 v_exp_f32 v166, v166
 v_mfma_f32_16x16x32_bf16 v[28:31], v[180:183], a[252:255], v[28:31]
 ds_read_b128 a[228:231], v249 offset:25088
 v_exp_f32 v167, v167
 v_mfma_f32_16x16x32_bf16 v[168:171], a[192:195], a[48:51], v[148:151]
 buffer_load_dwordx4 a[40:43], v245, s[8:11], s32 offen offset:128
 ds_read_b128 a[232:235], v249 offset:25600
 v_mfma_f32_16x16x32_bf16 v[168:171], a[196:199], a[52:55], v[168:171]
 ds_read_b128 a[248:251], v249 offset:27648
 ds_read_b128 a[236:239], v249 offset:26112
 v_cvt_pk_bf16_f32 v177, v162, v163
 v_mfma_f32_16x16x32_bf16 v[168:171], a[200:203], a[56:59], v[168:171]
 ds_read_b128 a[240:243], v249 offset:26624
 v_cvt_pk_bf16_f32 v178, v164, v165
 v_cvt_pk_bf16_f32 v179, v166, v167
 v_mfma_f32_16x16x32_bf16 v[168:171], a[204:207], a[60:63], v[168:171]
 ds_read_b128 a[244:247], v249 offset:27136
 ds_read_b128 a[252:255], v249 offset:28160
 v_mfma_f32_16x16x32_bf16 v[172:175], a[220:223], a[60:63], v[148:151]
 v_mul_f32_dpp v62, v219, v62 row_newbcast:2 row_mask:0xf bank_mask:0xf
 v_cvt_pk_bf16_f32 v243, v58, v62
 v_mfma_f32_16x16x32_bf16 v[172:175], a[216:219], a[56:59], v[172:175]
 buffer_store_dwordx4 v[240:243], v244, s[20:23], s33 offen offset:2048 sc1
 v_mfma_f32_16x16x32_bf16 v[172:175], a[212:215], a[52:55], v[172:175]
 v_exp_f32 v168, v168
 v_mfma_f32_16x16x32_bf16 v[172:175], a[208:211], a[48:51], v[172:175]
 s_waitcnt lgkmcnt(5)
 v_exp_f32 v169, v169
 v_mfma_f32_16x16x32_bf16 v[64:67], v[176:179], a[224:227], v[64:67]
 v_exp_f32 v170, v170
 v_mfma_f32_16x16x32_bf16 v[68:71], v[176:179], a[228:231], v[68:71]
 v_exp_f32 v171, v171
 v_mfma_f32_16x16x32_bf16 v[72:75], v[176:179], a[232:235], v[72:75]
 s_waitcnt lgkmcnt(0)
 v_cvt_pk_bf16_f32 v180, v168, v169
 v_cvt_pk_bf16_f32 v181, v170, v171
 v_mfma_f32_16x16x32_bf16 v[76:79], v[176:179], a[236:239], v[76:79]
 v_exp_f32 v172, v172
 v_mfma_f32_16x16x32_bf16 v[80:83], v[176:179], a[240:243], v[80:83]
 v_exp_f32 v173, v173
 v_mfma_f32_16x16x32_bf16 v[84:87], v[176:179], a[244:247], v[84:87]
 v_exp_f32 v174, v174
 v_mfma_f32_16x16x32_bf16 v[88:91], v[176:179], a[248:251], v[88:91]
 v_exp_f32 v175, v175
 v_mfma_f32_16x16x32_bf16 v[92:95], v[176:179], a[252:255], v[92:95]
 s_waitcnt vmcnt(7)
 v_cvt_pk_bf16_f32 v182, v172, v173
 v_cvt_pk_bf16_f32 v183, v174, v175
 v_mfma_f32_16x16x32_bf16 v[252:255], a[64:67], a[16:19], 0
 v_mul_f32_dpp v35, v219, v35 row_newbcast:3 row_mask:0xf bank_mask:0xf
 v_mul_f32_dpp v39, v219, v39 row_newbcast:3 row_mask:0xf bank_mask:0xf
 v_mfma_f32_16x16x32_bf16 v[252:255], a[68:71], a[20:23], v[252:255]
 v_cvt_pk_bf16_f32 v240, v35, v39
 v_mul_f32_dpp v43, v219, v43 row_newbcast:3 row_mask:0xf bank_mask:0xf
 v_mfma_f32_16x16x32_bf16 v[252:255], a[72:75], a[24:27], v[252:255]
 v_mul_f32_dpp v47, v219, v47 row_newbcast:3 row_mask:0xf bank_mask:0xf
 v_cvt_pk_bf16_f32 v241, v43, v47
 v_mfma_f32_16x16x32_bf16 v[252:255], a[76:79], a[28:31], v[252:255]
 v_mul_f32_dpp v51, v219, v51 row_newbcast:3 row_mask:0xf bank_mask:0xf
 v_mul_f32_dpp v55, v219, v55 row_newbcast:3 row_mask:0xf bank_mask:0xf
 v_mfma_f32_16x16x32_bf16 v[160:163], a[192:195], v[220:223], v[152:155]
 v_cvt_pk_bf16_f32 v242, v51, v55
 v_mul_f32_dpp v59, v219, v59 row_newbcast:3 row_mask:0xf bank_mask:0xf
 v_mfma_f32_16x16x32_bf16 v[160:163], a[196:199], v[224:227], v[160:163]
 v_mul_f32_dpp v63, v219, v63 row_newbcast:3 row_mask:0xf bank_mask:0xf
 v_cvt_pk_bf16_f32 v243, v59, v63
 v_mfma_f32_16x16x32_bf16 v[160:163], a[200:203], v[228:231], v[160:163]
 buffer_store_dwordx4 v[240:243], v244, s[20:23], s33 offen offset:3072 sc1
 v_mfma_f32_16x16x32_bf16 v[160:163], a[204:207], v[232:235], v[160:163]
 v_max3_f32 v246, v252, v253, v254
 v_max_f32 v246, v246, v255
 v_mfma_f32_16x16x32_bf16 v[164:167], a[220:223], v[232:235], v[152:155]
 v_mov_b32 v247, v246
 s_nop 0
 v_mfma_f32_16x16x32_bf16 v[164:167], a[216:219], v[228:231], v[164:167]
 v_permlane16_swap_b32 v246, v247
 v_max_f32 v246, v246, v247
 v_mfma_f32_16x16x32_bf16 v[164:167], a[212:215], v[224:227], v[164:167]
 v_exp_f32 v160, v160
 v_mfma_f32_16x16x32_bf16 v[164:167], a[208:211], v[220:223], v[164:167]
 v_exp_f32 v161, v161
 v_smfmac_f32_16x16x64_bf16 v[128:131], v[236:239], v[176:183], v138
 v_cvt_pk_bf16_f32 v176, v160, v161
 v_mfma_f32_16x16x32_bf16 v[96:99], v[180:183], a[224:227], v[96:99]
 v_exp_f32 v162, v162
 v_mfma_f32_16x16x32_bf16 v[100:103], v[180:183], a[228:231], v[100:103]
 v_exp_f32 v163, v163
 v_mfma_f32_16x16x32_bf16 v[104:107], v[180:183], a[232:235], v[104:107]
 v_exp_f32 v166, v166
 v_mfma_f32_16x16x32_bf16 v[108:111], v[180:183], a[236:239], v[108:111]
 v_exp_f32 v167, v167
 v_mfma_f32_16x16x32_bf16 v[112:115], v[180:183], a[240:243], v[112:115]
 v_cvt_pk_bf16_f32 v177, v162, v163
 v_cvt_pk_bf16_f32 v179, v166, v167
 v_mfma_f32_16x16x32_bf16 v[116:119], v[180:183], a[244:247], v[116:119]
 v_exp_f32 v164, v164
 v_mfma_f32_16x16x32_bf16 v[120:123], v[180:183], a[248:251], v[120:123]
 v_exp_f32 v165, v165
 v_mfma_f32_16x16x32_bf16 v[124:127], v[180:183], a[252:255], v[124:127]
 v_cvt_pk_bf16_f32 v178, v164, v165
 v_mov_b32 v247, v246
 v_mfma_f32_16x16x32_bf16 v[168:171], a[192:195], a[0:3], v[156:159]
 v_add_f32 v216, v128, v129
 v_permlane32_swap_b32 v246, v247
 v_mfma_f32_16x16x32_bf16 v[168:171], a[196:199], a[4:7], v[168:171]
 v_min_f32 v246, -v246, -v247
 v_mov_b32 v144, v246
 v_mfma_f32_16x16x32_bf16 v[168:171], a[200:203], a[8:11], v[168:171]
 v_mov_b32 v145, v246
 v_mov_b32 v146, v246
 v_mfma_f32_16x16x32_bf16 v[168:171], a[204:207], a[12:15], v[168:171]
 v_mov_b32 v147, v246
 v_add_f32 v252, v252, v246
 v_mfma_f32_16x16x32_bf16 v[172:175], a[220:223], a[12:15], v[156:159]
 v_add_f32 v253, v253, v246
 v_add_f32 v254, v254, v246
 v_mfma_f32_16x16x32_bf16 v[172:175], a[216:219], a[8:11], v[172:175]
 v_exp_f32 v252, v252
 v_mfma_f32_16x16x32_bf16 v[172:175], a[212:215], a[4:7], v[172:175]
 v_exp_f32 v170, v170
 v_mfma_f32_16x16x32_bf16 v[172:175], a[208:211], a[0:3], v[172:175]
 v_exp_f32 v168, v168
 v_mfma_f32_16x16x32_bf16 v[184:187], v[176:179], a[224:227], v[184:187]
 v_exp_f32 v169, v169
 v_mfma_f32_16x16x32_bf16 v[188:191], v[176:179], a[228:231], v[188:191]
 v_exp_f32 v171, v171
 v_mfma_f32_16x16x32_bf16 v[192:195], v[176:179], a[232:235], v[192:195]
 v_cvt_pk_bf16_f32 v180, v168, v169
 v_cvt_pk_bf16_f32 v181, v170, v171
 v_mfma_f32_16x16x32_bf16 v[196:199], v[176:179], a[236:239], v[196:199]
 v_exp_f32 v174, v174
 v_mfma_f32_16x16x32_bf16 v[200:203], v[176:179], a[240:243], v[200:203]
 v_exp_f32 v175, v175
 v_mfma_f32_16x16x32_bf16 v[204:207], v[176:179], a[244:247], v[204:207]
 v_cvt_pk_bf16_f32 v183, v174, v175
 v_add_f32 v255, v255, v246
 v_mfma_f32_16x16x32_bf16 v[208:211], v[176:179], a[248:251], v[208:211]
 v_exp_f32 v172, v172
 v_mfma_f32_16x16x32_bf16 v[212:215], v[176:179], a[252:255], v[212:215]
 v_exp_f32 v173, v173
 v_mfma_f32_16x16x32_bf16 v[164:167], a[92:95], a[28:31], v[144:147]
 v_cvt_pk_bf16_f32 v182, v172, v173
 v_mov_b32 v128, 0
 v_mfma_f32_16x16x32_bf16 v[164:167], a[88:91], a[24:27], v[164:167]
 v_exp_f32 v253, v253
 v_mfma_f32_16x16x32_bf16 v[164:167], a[84:87], a[20:23], v[164:167]
 v_exp_f32 v254, v254
 v_mfma_f32_16x16x32_bf16 v[164:167], a[80:83], a[16:19], v[164:167]
 v_exp_f32 v255, v255
 v_smfmac_f32_16x16x64_bf16 v[132:135], v[236:239], v[176:183], v138
 v_cvt_pk_bf16_f32 v176, v252, v253
 v_mfma_f32_16x16x32_bf16 v[0:3], v[180:183], a[224:227], v[0:3]
 ds_read_b128 a[224:227], v248 offset:0
 v_cvt_pk_bf16_f32 v177, v254, v255
 v_mfma_f32_16x16x32_bf16 v[4:7], v[180:183], a[228:231], v[4:7]
 ds_read_b128 a[228:231], v248 offset:512
 v_mov_b32 v129, 0
 v_mfma_f32_16x16x32_bf16 v[8:11], v[180:183], a[232:235], v[8:11]
 v_exp_f32 v164, v164
 v_mfma_f32_16x16x32_bf16 v[12:15], v[180:183], a[236:239], v[12:15]
 v_exp_f32 v165, v165
 v_mfma_f32_16x16x32_bf16 v[16:19], v[180:183], a[240:243], v[16:19]
 v_exp_f32 v166, v166
 v_mfma_f32_16x16x32_bf16 v[20:23], v[180:183], a[244:247], v[20:23]
 v_exp_f32 v167, v167
 v_mfma_f32_16x16x32_bf16 v[24:27], v[180:183], a[248:251], v[24:27]
 v_cvt_pk_bf16_f32 v178, v164, v165
 v_cvt_pk_bf16_f32 v179, v166, v167
 v_mfma_f32_16x16x32_bf16 v[28:31], v[180:183], a[252:255], v[28:31]
 ds_read_b128 a[232:235], v248 offset:1024
 ds_read_b128 a[236:239], v248 offset:1536
 v_mfma_f32_16x16x32_bf16 v[168:171], a[64:67], a[48:51], v[148:151]
 ds_read_b128 a[240:243], v248 offset:2048
 ds_read_b128 a[244:247], v248 offset:2560
 v_mfma_f32_16x16x32_bf16 v[168:171], a[68:71], a[52:55], v[168:171]
 ds_read_b128 a[248:251], v248 offset:3072
 ds_read_b128 a[252:255], v248 offset:3584
 v_mfma_f32_16x16x32_bf16 v[168:171], a[72:75], a[56:59], v[168:171]
 ds_read_b128 a[192:195], v249 offset:32768
 v_cmp_nge_f32 vcc, s28, v216
 v_mfma_f32_16x16x32_bf16 v[168:171], a[76:79], a[60:63], v[168:171]
 s_cmp_lg_u64 vcc, 0
 v_rcp_f32 v216, v216
 v_mfma_f32_16x16x32_bf16 v[172:175], a[92:95], a[60:63], v[148:151]
 s_cselect_b32 s34, 4096, 0
 s_or_b32 s29, s29, s34
 v_mov_b32_dpp v216, v216 row_shl:4 row_mask:0x2 bank_mask:0xf
 v_mfma_f32_16x16x32_bf16 v[172:175], a[88:91], a[56:59], v[172:175]
 s_add_u32 s33, s25, 49152
 v_exp_f32 v168, v168
 v_mfma_f32_16x16x32_bf16 v[172:175], a[84:87], a[52:55], v[172:175]
 s_add_u32 s32, s25, 73728
 v_exp_f32 v169, v169
 v_mfma_f32_16x16x32_bf16 v[172:175], a[80:83], a[48:51], v[172:175]
 s_waitcnt lgkmcnt(3)
 v_exp_f32 v170, v170
 v_mfma_f32_16x16x32_bf16 v[32:35], v[176:179], a[224:227], 0
 v_exp_f32 v171, v171
 v_mfma_f32_16x16x32_bf16 v[36:39], v[176:179], a[228:231], 0
 v_cvt_pk_bf16_f32 v180, v168, v169
 v_cvt_pk_bf16_f32 v181, v170, v171
 v_mfma_f32_16x16x32_bf16 v[40:43], v[176:179], a[232:235], 0
 ds_read_b128 a[196:199], v249 offset:33280
 v_mov_b32_dpp v216, v216 row_shl:8 row_mask:0x4 bank_mask:0xf
 v_mfma_f32_16x16x32_bf16 v[44:47], v[176:179], a[236:239], 0
 v_exp_f32 v172, v172
 v_mfma_f32_16x16x32_bf16 v[48:51], v[176:179], a[240:243], 0
 v_exp_f32 v173, v173
 v_mfma_f32_16x16x32_bf16 v[52:55], v[176:179], a[244:247], 0
 s_waitcnt lgkmcnt(1)
 v_exp_f32 v174, v174
 v_mfma_f32_16x16x32_bf16 v[56:59], v[176:179], a[248:251], 0
 v_exp_f32 v175, v175
 v_mfma_f32_16x16x32_bf16 v[60:63], v[176:179], a[252:255], 0
 v_cvt_pk_bf16_f32 v182, v172, v173
 v_cvt_pk_bf16_f32 v183, v174, v175
 v_mfma_f32_16x16x32_bf16 v[160:163], a[64:67], v[220:223], v[152:155]
 ds_read_b128 a[200:203], v249 offset:33792
 v_mov_b32_dpp v216, v216 row_shl:12 row_mask:0x8 bank_mask:0xf
 v_mfma_f32_16x16x32_bf16 v[160:163], a[68:71], v[224:227], v[160:163]
 ds_read_b128 a[204:207], v249 offset:34304
 v_mul_f32_dpp v64, v216, v64 row_newbcast:0 row_mask:0xf bank_mask:0xf
 v_mfma_f32_16x16x32_bf16 v[160:163], a[72:75], v[228:231], v[160:163]
 v_mul_f32_dpp v68, v216, v68 row_newbcast:0 row_mask:0xf bank_mask:0xf
 v_cvt_pk_bf16_f32 v240, v64, v68
 v_mfma_f32_16x16x32_bf16 v[160:163], a[76:79], v[232:235], v[160:163]
 v_mul_f32_dpp v72, v216, v72 row_newbcast:0 row_mask:0xf bank_mask:0xf
 v_mul_f32_dpp v76, v216, v76 row_newbcast:0 row_mask:0xf bank_mask:0xf
 v_mfma_f32_16x16x32_bf16 v[164:167], a[92:95], v[232:235], v[152:155]
 v_cvt_pk_bf16_f32 v241, v72, v76
 v_mul_f32_dpp v80, v216, v80 row_newbcast:0 row_mask:0xf bank_mask:0xf
 v_mfma_f32_16x16x32_bf16 v[164:167], a[88:91], v[228:231], v[164:167]
 v_mul_f32_dpp v84, v216, v84 row_newbcast:0 row_mask:0xf bank_mask:0xf
 v_cvt_pk_bf16_f32 v242, v80, v84
 v_mfma_f32_16x16x32_bf16 v[164:167], a[84:87], v[224:227], v[164:167]
 v_exp_f32 v160, v160
 v_mfma_f32_16x16x32_bf16 v[164:167], a[80:83], v[220:223], v[164:167]
 v_exp_f32 v161, v161
 v_smfmac_f32_16x16x64_bf16 v[128:131], v[236:239], v[176:183], v138
 v_cvt_pk_bf16_f32 v176, v160, v161
 v_mfma_f32_16x16x32_bf16 v[96:99], v[180:183], a[224:227], v[96:99]
 v_exp_f32 v162, v162
 v_mfma_f32_16x16x32_bf16 v[100:103], v[180:183], a[228:231], v[100:103]
 v_exp_f32 v163, v163
 v_mfma_f32_16x16x32_bf16 v[104:107], v[180:183], a[232:235], v[104:107]
 v_exp_f32 v164, v164
 v_mfma_f32_16x16x32_bf16 v[108:111], v[180:183], a[236:239], v[108:111]
 v_exp_f32 v165, v165
 v_mfma_f32_16x16x32_bf16 v[112:115], v[180:183], a[240:243], v[112:115]
 v_exp_f32 v166, v166
 v_mfma_f32_16x16x32_bf16 v[116:119], v[180:183], a[244:247], v[116:119]
 v_exp_f32 v167, v167
 v_mfma_f32_16x16x32_bf16 v[120:123], v[180:183], a[248:251], v[120:123]
 v_cvt_pk_bf16_f32 v177, v162, v163
 v_cvt_pk_bf16_f32 v178, v164, v165
 v_mfma_f32_16x16x32_bf16 v[124:127], v[180:183], a[252:255], v[124:127]
 v_cvt_pk_bf16_f32 v179, v166, v167
 v_mul_f32_dpp v88, v216, v88 row_newbcast:0 row_mask:0xf bank_mask:0xf
 v_mfma_f32_16x16x32_bf16 v[168:171], a[64:67], a[0:3], v[156:159]
 v_mul_f32_dpp v92, v216, v92 row_newbcast:0 row_mask:0xf bank_mask:0xf
 v_cvt_pk_bf16_f32 v243, v88, v92
 v_mfma_f32_16x16x32_bf16 v[168:171], a[68:71], a[4:7], v[168:171]
 buffer_store_dwordx4 v[240:243], v244, s[20:23], s33 offen offset:0 sc1
 v_mfma_f32_16x16x32_bf16 v[168:171], a[72:75], a[8:11], v[168:171]
 v_mul_f32_dpp v65, v216, v65 row_newbcast:1 row_mask:0xf bank_mask:0xf
 v_mul_f32_dpp v69, v216, v69 row_newbcast:1 row_mask:0xf bank_mask:0xf
 v_mfma_f32_16x16x32_bf16 v[168:171], a[76:79], a[12:15], v[168:171]
 v_cvt_pk_bf16_f32 v240, v65, v69
 v_mul_f32_dpp v73, v216, v73 row_newbcast:1 row_mask:0xf bank_mask:0xf
 v_mfma_f32_16x16x32_bf16 v[172:175], a[92:95], a[12:15], v[156:159]
 v_mul_f32_dpp v77, v216, v77 row_newbcast:1 row_mask:0xf bank_mask:0xf
 v_cvt_pk_bf16_f32 v241, v73, v77
 v_mfma_f32_16x16x32_bf16 v[172:175], a[88:91], a[8:11], v[172:175]
 v_mul_f32_dpp v81, v216, v81 row_newbcast:1 row_mask:0xf bank_mask:0xf
 v_mul_f32_dpp v85, v216, v85 row_newbcast:1 row_mask:0xf bank_mask:0xf
 v_mfma_f32_16x16x32_bf16 v[172:175], a[84:87], a[4:7], v[172:175]
 v_exp_f32 v168, v168
 v_mfma_f32_16x16x32_bf16 v[172:175], a[80:83], a[0:3], v[172:175]
 v_exp_f32 v169, v169
 v_mfma_f32_16x16x32_bf16 v[184:187], v[176:179], a[224:227], v[184:187]
 v_exp_f32 v170, v170
 v_mfma_f32_16x16x32_bf16 v[188:191], v[176:179], a[228:231], v[188:191]
 v_exp_f32 v171, v171
 v_mfma_f32_16x16x32_bf16 v[192:195], v[176:179], a[232:235], v[192:195]
 v_cvt_pk_bf16_f32 v180, v168, v169
 v_cvt_pk_bf16_f32 v181, v170, v171
 v_mfma_f32_16x16x32_bf16 v[196:199], v[176:179], a[236:239], v[196:199]
 v_exp_f32 v172, v172
 v_mfma_f32_16x16x32_bf16 v[200:203], v[176:179], a[240:243], v[200:203]
 v_exp_f32 v173, v173
 v_mfma_f32_16x16x32_bf16 v[204:207], v[176:179], a[244:247], v[204:207]
 v_exp_f32 v174, v174
 v_mfma_f32_16x16x32_bf16 v[208:211], v[176:179], a[248:251], v[208:211]
 v_exp_f32 v175, v175
 v_mfma_f32_16x16x32_bf16 v[212:215], v[176:179], a[252:255], v[212:215]
 v_cvt_pk_bf16_f32 v182, v172, v173
 v_cvt_pk_bf16_f32 v183, v174, v175
 v_mfma_f32_16x16x32_bf16 v[160:163], a[96:99], a[16:19], v[144:147]
 v_cvt_pk_bf16_f32 v242, v81, v85
 v_mul_f32_dpp v89, v216, v89 row_newbcast:1 row_mask:0xf bank_mask:0xf
 v_mfma_f32_16x16x32_bf16 v[160:163], a[100:103], a[20:23], v[160:163]
 v_mul_f32_dpp v93, v216, v93 row_newbcast:1 row_mask:0xf bank_mask:0xf
 v_cvt_pk_bf16_f32 v243, v89, v93
 v_mfma_f32_16x16x32_bf16 v[160:163], a[104:107], a[24:27], v[160:163]
 buffer_store_dwordx4 v[240:243], v244, s[20:23], s33 offen offset:1024 sc1
 v_mfma_f32_16x16x32_bf16 v[160:163], a[108:111], a[28:31], v[160:163]
 v_mul_f32_dpp v66, v216, v66 row_newbcast:2 row_mask:0xf bank_mask:0xf
 v_mul_f32_dpp v70, v216, v70 row_newbcast:2 row_mask:0xf bank_mask:0xf
 v_mfma_f32_16x16x32_bf16 v[164:167], a[124:127], a[28:31], v[144:147]
 v_cvt_pk_bf16_f32 v240, v66, v70
 v_mul_f32_dpp v74, v216, v74 row_newbcast:2 row_mask:0xf bank_mask:0xf
 v_mfma_f32_16x16x32_bf16 v[164:167], a[120:123], a[24:27], v[164:167]
 v_mul_f32_dpp v78, v216, v78 row_newbcast:2 row_mask:0xf bank_mask:0xf
 v_cvt_pk_bf16_f32 v241, v74, v78
 v_mfma_f32_16x16x32_bf16 v[164:167], a[116:119], a[20:23], v[164:167]
 v_exp_f32 v160, v160
 v_mfma_f32_16x16x32_bf16 v[164:167], a[112:115], a[16:19], v[164:167]
 v_exp_f32 v161, v161
 v_smfmac_f32_16x16x64_bf16 v[132:135], v[236:239], v[176:183], v138
 v_cvt_pk_bf16_f32 v176, v160, v161
 v_mfma_f32_16x16x32_bf16 v[0:3], v[180:183], a[224:227], v[0:3]
 ds_read_b128 a[224:227], v248 offset:8192
 v_mul_f32_dpp v82, v216, v82 row_newbcast:2 row_mask:0xf bank_mask:0xf
 v_mfma_f32_16x16x32_bf16 v[4:7], v[180:183], a[228:231], v[4:7]
 ds_read_b128 a[228:231], v248 offset:8704
 v_mul_f32_dpp v86, v216, v86 row_newbcast:2 row_mask:0xf bank_mask:0xf
 v_mfma_f32_16x16x32_bf16 v[8:11], v[180:183], a[232:235], v[8:11]
 ds_read_b128 a[232:235], v248 offset:9216
 v_cvt_pk_bf16_f32 v242, v82, v86
 v_mfma_f32_16x16x32_bf16 v[12:15], v[180:183], a[236:239], v[12:15]
 v_exp_f32 v162, v162
 v_mfma_f32_16x16x32_bf16 v[16:19], v[180:183], a[240:243], v[16:19]
 v_exp_f32 v163, v163
 v_mfma_f32_16x16x32_bf16 v[20:23], v[180:183], a[244:247], v[20:23]
 v_exp_f32 v164, v164
 v_mfma_f32_16x16x32_bf16 v[24:27], v[180:183], a[248:251], v[24:27]
 v_exp_f32 v165, v165
 v_mfma_f32_16x16x32_bf16 v[28:31], v[180:183], a[252:255], v[28:31]
 v_exp_f32 v166, v166
 v_mfma_f32_16x16x32_bf16 v[168:171], a[96:99], a[48:51], v[148:151]
 ds_read_b128 a[236:239], v248 offset:9728
 ds_read_b128 a[240:243], v248 offset:10240
 v_mfma_f32_16x16x32_bf16 v[168:171], a[100:103], a[52:55], v[168:171]
 v_exp_f32 v167, v167
 v_mfma_f32_16x16x32_bf16 v[168:171], a[104:107], a[56:59], v[168:171]
 ds_read_b128 a[244:247], v248 offset:10752
 ds_read_b128 a[248:251], v248 offset:11264
 v_mfma_f32_16x16x32_bf16 v[168:171], a[108:111], a[60:63], v[168:171]
 v_cvt_pk_bf16_f32 v177, v162, v163
 v_cvt_pk_bf16_f32 v178, v164, v165
 v_mfma_f32_16x16x32_bf16 v[172:175], a[124:127], a[60:63], v[148:151]
 ds_read_b128 a[252:255], v248 offset:11776
 v_cvt_pk_bf16_f32 v179, v166, v167
 v_mfma_f32_16x16x32_bf16 v[172:175], a[120:123], a[56:59], v[172:175]
 v_mul_f32_dpp v90, v216, v90 row_newbcast:2 row_mask:0xf bank_mask:0xf
 v_mul_f32_dpp v94, v216, v94 row_newbcast:2 row_mask:0xf bank_mask:0xf
 v_mfma_f32_16x16x32_bf16 v[172:175], a[116:119], a[52:55], v[172:175]
L_pg13:
 s_cbranch_execz L_pg17
 v_exp_f32 v168, v168
 v_mfma_f32_16x16x32_bf16 v[172:175], a[112:115], a[48:51], v[172:175]
 s_waitcnt lgkmcnt(3)
 v_exp_f32 v169, v169
 v_mfma_f32_16x16x32_bf16 v[32:35], v[176:179], a[224:227], v[32:35]
 v_exp_f32 v170, v170
 v_mfma_f32_16x16x32_bf16 v[36:39], v[176:179], a[228:231], v[36:39]
 v_exp_f32 v171, v171
 v_mfma_f32_16x16x32_bf16 v[40:43], v[176:179], a[232:235], v[40:43]
 v_cvt_pk_bf16_f32 v180, v168, v169
 v_cvt_pk_bf16_f32 v181, v170, v171
 v_mfma_f32_16x16x32_bf16 v[44:47], v[176:179], a[236:239], v[44:47]
 v_exp_f32 v172, v172
 v_mfma_f32_16x16x32_bf16 v[48:51], v[176:179], a[240:243], v[48:51]
 s_waitcnt lgkmcnt(0)
 v_exp_f32 v173, v173
 v_mfma_f32_16x16x32_bf16 v[52:55], v[176:179], a[244:247], v[52:55]
 v_exp_f32 v174, v174
 v_mfma_f32_16x16x32_bf16 v[56:59], v[176:179], a[248:251], v[56:59]
 v_exp_f32 v175, v175
 v_mfma_f32_16x16x32_bf16 v[60:63], v[176:179], a[252:255], v[60:63]
 v_cvt_pk_bf16_f32 v182, v172, v173
 v_cvt_pk_bf16_f32 v183, v174, v175
 v_mfma_f32_16x16x32_bf16 v[160:163], a[96:99], v[220:223], v[152:155]
 v_cvt_pk_bf16_f32 v243, v90, v94
 v_mul_f32_dpp v67, v216, v67 row_newbcast:3 row_mask:0xf bank_mask:0xf
 v_mfma_f32_16x16x32_bf16 v[160:163], a[100:103], v[224:227], v[160:163]
 buffer_store_dwordx4 v[240:243], v244, s[20:23], s33 offen offset:2048 sc1
 v_mfma_f32_16x16x32_bf16 v[160:163], a[104:107], v[228:231], v[160:163]
 v_mul_f32_dpp v71, v216, v71 row_newbcast:3 row_mask:0xf bank_mask:0xf
 v_cvt_pk_bf16_f32 v240, v67, v71
 v_mfma_f32_16x16x32_bf16 v[160:163], a[108:111], v[232:235], v[160:163]
 v_mul_f32_dpp v75, v216, v75 row_newbcast:3 row_mask:0xf bank_mask:0xf
 v_mul_f32_dpp v79, v216, v79 row_newbcast:3 row_mask:0xf bank_mask:0xf
 v_mfma_f32_16x16x32_bf16 v[164:167], a[124:127], v[232:235], v[152:155]
 v_cvt_pk_bf16_f32 v241, v75, v79
 v_mul_f32_dpp v83, v216, v83 row_newbcast:3 row_mask:0xf bank_mask:0xf
 v_mfma_f32_16x16x32_bf16 v[164:167], a[120:123], v[228:231], v[164:167]
 v_mul_f32_dpp v87, v216, v87 row_newbcast:3 row_mask:0xf bank_mask:0xf
 v_cvt_pk_bf16_f32 v242, v83, v87
 v_mfma_f32_16x16x32_bf16 v[164:167], a[116:119], v[224:227], v[164:167]
 v_exp_f32 v160, v160
 v_mfma_f32_16x16x32_bf16 v[164:167], a[112:115], v[220:223], v[164:167]
 v_exp_f32 v161, v161
 v_smfmac_f32_16x16x64_bf16 v[128:131], v[236:239], v[176:183], v138
 v_cvt_pk_bf16_f32 v176, v160, v161
 v_mfma_f32_16x16x32_bf16 v[96:99], v[180:183], a[224:227], v[96:99]
 v_exp_f32 v162, v162
 v_mfma_f32_16x16x32_bf16 v[100:103], v[180:183], a[228:231], v[100:103]
 v_exp_f32 v163, v163
 v_mfma_f32_16x16x32_bf16 v[104:107], v[180:183], a[232:235], v[104:107]
 v_exp_f32 v164, v164
 v_mfma_f32_16x16x32_bf16 v[108:111], v[180:183], a[236:239], v[108:111]
 v_exp_f32 v165, v165
 v_mfma_f32_16x16x32_bf16 v[112:115], v[180:183], a[240:243], v[112:115]
 v_exp_f32 v166, v166
 v_mfma_f32_16x16x32_bf16 v[116:119], v[180:183], a[244:247], v[116:119]
 v_exp_f32 v167, v167
 v_mfma_f32_16x16x32_bf16 v[120:123], v[180:183], a[248:251], v[120:123]
 v_cvt_pk_bf16_f32 v177, v162, v163
 v_cvt_pk_bf16_f32 v178, v164, v165
 v_mfma_f32_16x16x32_bf16 v[124:127], v[180:183], a[252:255], v[124:127]
 v_cvt_pk_bf16_f32 v179, v166, v167
 v_mul_f32_dpp v91, v216, v91 row_newbcast:3 row_mask:0xf bank_mask:0xf
 v_mfma_f32_16x16x32_bf16 v[168:171], a[96:99], a[0:3], v[156:159]
 v_mul_f32_dpp v95, v216, v95 row_newbcast:3 row_mask:0xf bank_mask:0xf
 v_cvt_pk_bf16_f32 v243, v91, v95
 v_mfma_f32_16x16x32_bf16 v[168:171], a[100:103], a[4:7], v[168:171]
 buffer_store_dwordx4 v[240:243], v244, s[20:23], s33 offen offset:3072 sc1
 v_mfma_f32_16x16x32_bf16 v[168:171], a[104:107], a[8:11], v[168:171]
 ds_read_b128 a[216:219], v249 offset:35840
 ds_read_b128 a[220:223], v249 offset:36352
 v_mfma_f32_16x16x32_bf16 v[168:171], a[108:111], a[12:15], v[168:171]
 ds_read_b128 a[208:211], v249 offset:34816
 ds_read_b128 a[212:215], v249 offset:35328
 v_mfma_f32_16x16x32_bf16 v[172:175], a[124:127], a[12:15], v[156:159]
 s_nop 1
 v_mfma_f32_16x16x32_bf16 v[172:175], a[120:123], a[8:11], v[172:175]
 s_nop 1
 v_mfma_f32_16x16x32_bf16 v[172:175], a[116:119], a[4:7], v[172:175]
 v_exp_f32 v168, v168
 v_mfma_f32_16x16x32_bf16 v[172:175], a[112:115], a[0:3], v[172:175]
 v_exp_f32 v169, v169
 v_mfma_f32_16x16x32_bf16 v[184:187], v[176:179], a[224:227], v[184:187]
 v_exp_f32 v170, v170
 v_mfma_f32_16x16x32_bf16 v[188:191], v[176:179], a[228:231], v[188:191]
 v_exp_f32 v171, v171
 v_mfma_f32_16x16x32_bf16 v[192:195], v[176:179], a[232:235], v[192:195]
 v_cvt_pk_bf16_f32 v180, v168, v169
 v_cvt_pk_bf16_f32 v181, v170, v171
 v_mfma_f32_16x16x32_bf16 v[196:199], v[176:179], a[236:239], v[196:199]
 v_exp_f32 v172, v172
 v_mfma_f32_16x16x32_bf16 v[200:203], v[176:179], a[240:243], v[200:203]
 v_exp_f32 v173, v173
 v_mfma_f32_16x16x32_bf16 v[204:207], v[176:179], a[244:247], v[204:207]
 v_exp_f32 v174, v174
 v_mfma_f32_16x16x32_bf16 v[208:211], v[176:179], a[248:251], v[208:211]
 v_exp_f32 v175, v175
 v_mfma_f32_16x16x32_bf16 v[212:215], v[176:179], a[252:255], v[212:215]
 v_cvt_pk_bf16_f32 v182, v172, v173
 v_cvt_pk_bf16_f32 v183, v174, v175
 v_mfma_f32_16x16x32_bf16 v[160:163], a[128:131], a[16:19], v[144:147]
 v_mfma_f32_16x16x32_bf16 v[160:163], a[132:135], a[20:23], v[160:163]
 v_mfma_f32_16x16x32_bf16 v[160:163], a[136:139], a[24:27], v[160:163]
 v_mfma_f32_16x16x32_bf16 v[160:163], a[140:143], a[28:31], v[160:163]
 s_nop 1
 v_mfma_f32_16x16x32_bf16 v[164:167], a[156:159], a[28:31], v[144:147]
 s_nop 1
 v_mfma_f32_16x16x32_bf16 v[164:167], a[152:155], a[24:27], v[164:167]
 s_nop 1
 v_mfma_f32_16x16x32_bf16 v[164:167], a[148:151], a[20:23], v[164:167]
 v_exp_f32 v160, v160
 v_mfma_f32_16x16x32_bf16 v[164:167], a[144:147], a[16:19], v[164:167]
 v_exp_f32 v161, v161
 v_smfmac_f32_16x16x64_bf16 v[132:135], v[236:239], v[176:183], v138
 v_cvt_pk_bf16_f32 v176, v160, v161
 v_mfma_f32_16x16x32_bf16 v[0:3], v[180:183], a[224:227], v[0:3]
 v_exp_f32 v162, v162
 v_mfma_f32_16x16x32_bf16 v[4:7], v[180:183], a[228:231], v[4:7]
 ds_read_b128 a[224:227], v248 offset:16384
 ds_read_b128 a[228:231], v248 offset:16896
 v_mfma_f32_16x16x32_bf16 v[8:11], v[180:183], a[232:235], v[8:11]
 v_exp_f32 v163, v163
 v_mfma_f32_16x16x32_bf16 v[12:15], v[180:183], a[236:239], v[12:15]
 ds_read_b128 a[232:235], v248 offset:17408
 ds_read_b128 a[236:239], v248 offset:17920
 v_mfma_f32_16x16x32_bf16 v[16:19], v[180:183], a[240:243], v[16:19]
 v_exp_f32 v164, v164
 v_mfma_f32_16x16x32_bf16 v[20:23], v[180:183], a[244:247], v[20:23]
 v_exp_f32 v165, v165
 v_mfma_f32_16x16x32_bf16 v[24:27], v[180:183], a[248:251], v[24:27]
 v_exp_f32 v166, v166
 v_mfma_f32_16x16x32_bf16 v[28:31], v[180:183], a[252:255], v[28:31]
 v_exp_f32 v167, v167
 v_mfma_f32_16x16x32_bf16 v[168:171], a[128:131], a[48:51], v[148:151]
 ds_read_b128 a[240:243], v248 offset:18432
 ds_read_b128 a[244:247], v248 offset:18944
 v_mfma_f32_16x16x32_bf16 v[168:171], a[132:135], a[52:55], v[168:171]
 ds_read_b128 a[248:251], v248 offset:19456
 v_cvt_pk_bf16_f32 v177, v162, v163
 v_mfma_f32_16x16x32_bf16 v[168:171], a[136:139], a[56:59], v[168:171]
 v_cvt_pk_bf16_f32 v178, v164, v165
 v_cvt_pk_bf16_f32 v179, v166, v167
 v_mfma_f32_16x16x32_bf16 v[168:171], a[140:143], a[60:63], v[168:171]
 ds_read_b128 a[252:255], v248 offset:19968
 s_nop 0
 v_mfma_f32_16x16x32_bf16 v[172:175], a[156:159], a[60:63], v[148:151]
 buffer_load_dwordx4 a[60:63], v245, s[8:11], s32 offen offset:192
 v_mfma_f32_16x16x32_bf16 v[172:175], a[152:155], a[56:59], v[172:175]
 s_nop 1
 v_mfma_f32_16x16x32_bf16 v[172:175], a[148:151], a[52:55], v[172:175]
 v_exp_f32 v168, v168
 v_mfma_f32_16x16x32_bf16 v[172:175], a[144:147], a[48:51], v[172:175]
 s_waitcnt lgkmcnt(2)
 v_exp_f32 v169, v169
 v_mfma_f32_16x16x32_bf16 v[32:35], v[176:179], a[224:227], v[32:35]
 buffer_load_dwordx4 a[48:51], v245, s[8:11], s32 offen offset:0
 v_mfma_f32_16x16x32_bf16 v[36:39], v[176:179], a[228:231], v[36:39]
 v_exp_f32 v170, v170
 v_mfma_f32_16x16x32_bf16 v[40:43], v[176:179], a[232:235], v[40:43]
 v_exp_f32 v171, v171
 v_mfma_f32_16x16x32_bf16 v[44:47], v[176:179], a[236:239], v[44:47]
 v_exp_f32 v172, v172
 v_mfma_f32_16x16x32_bf16 v[48:51], v[176:179], a[240:243], v[48:51]
 buffer_load_dwordx4 a[52:55], v245, s[8:11], s32 offen offset:64
 v_mfma_f32_16x16x32_bf16 v[52:55], v[176:179], a[244:247], v[52:55]
 s_waitcnt lgkmcnt(0)
 v_exp_f32 v173, v173
 v_mfma_f32_16x16x32_bf16 v[56:59], v[176:179], a[248:251], v[56:59]
 v_exp_f32 v174, v174
 v_mfma_f32_16x16x32_bf16 v[60:63], v[176:179], a[252:255], v[60:63]
 v_exp_f32 v175, v175
 v_mfma_f32_16x16x32_bf16 v[160:163], a[128:131], v[220:223], v[152:155]
 buffer_load_dwordx4 a[56:59], v245, s[8:11], s32 offen offset:128
 v_mfma_f32_16x16x32_bf16 v[160:163], a[132:135], v[224:227], v[160:163]
 v_cvt_pk_bf16_f32 v180, v168, v169
 v_cvt_pk_bf16_f32 v181, v170, v171
 v_mfma_f32_16x16x32_bf16 v[160:163], a[136:139], v[228:231], v[160:163]
 v_cvt_pk_bf16_f32 v182, v172, v173
 v_cvt_pk_bf16_f32 v183, v174, v175
 v_mfma_f32_16x16x32_bf16 v[160:163], a[140:143], v[232:235], v[160:163]
 s_nop 1
 v_mfma_f32_16x16x32_bf16 v[164:167], a[156:159], v[232:235], v[152:155]
 s_nop 1
 v_mfma_f32_16x16x32_bf16 v[164:167], a[152:155], v[228:231], v[164:167]
 s_nop 1
 v_mfma_f32_16x16x32_bf16 v[164:167], a[148:151], v[224:227], v[164:167]
 v_exp_f32 v160, v160
 v_mfma_f32_16x16x32_bf16 v[164:167], a[144:147], v[220:223], v[164:167]
 v_exp_f32 v161, v161
 v_smfmac_f32_16x16x64_bf16 v[128:131], v[236:239], v[176:183], v138
 v_cvt_pk_bf16_f32 v176, v160, v161
 v_mfma_f32_16x16x32_bf16 v[96:99], v[180:183], a[224:227], v[96:99]
 v_exp_f32 v162, v162
 v_mfma_f32_16x16x32_bf16 v[100:103], v[180:183], a[228:231], v[100:103]
 v_exp_f32 v163, v163
 v_mfma_f32_16x16x32_bf16 v[104:107], v[180:183], a[232:235], v[104:107]
 v_exp_f32 v164, v164
 v_mfma_f32_16x16x32_bf16 v[108:111], v[180:183], a[236:239], v[108:111]
 v_exp_f32 v165, v165
 v_mfma_f32_16x16x32_bf16 v[112:115], v[180:183], a[240:243], v[112:115]
 v_exp_f32 v166, v166
 v_mfma_f32_16x16x32_bf16 v[116:119], v[180:183], a[244:247], v[116:119]
 v_exp_f32 v167, v167
 v_mfma_f32_16x16x32_bf16 v[120:123], v[180:183], a[248:251], v[120:123]
 v_cvt_pk_bf16_f32 v177, v162, v163
 v_cvt_pk_bf16_f32 v178, v164, v165
 v_mfma_f32_16x16x32_bf16 v[124:127], v[180:183], a[252:255], v[124:127]
 s_waitcnt vmcnt(10)
 v_cvt_pk_bf16_f32 v179, v166, v167
 v_add_f32 v217, v130, v131
 v_mfma_f32_16x16x32_bf16 v[252:255], a[160:163], a[32:35], 0
 v_mov_b32 v130, 0
 v_mov_b32 v131, 0
 v_mfma_f32_16x16x32_bf16 v[252:255], a[164:167], a[36:39], v[252:255]
 v_cmp_nge_f32 vcc, s28, v217
 s_nop 0
 v_mfma_f32_16x16x32_bf16 v[252:255], a[168:171], a[40:43], v[252:255]
 s_cmp_lg_u64 vcc, 0
 v_rcp_f32 v217, v217
 v_mfma_f32_16x16x32_bf16 v[252:255], a[172:175], a[44:47], v[252:255]
 s_cselect_b32 s34, 8192, 0
 s_or_b32 s29, s29, s34
 v_mov_b32_dpp v217, v217 row_shl:4 row_mask:0x2 bank_mask:0xf
 v_mfma_f32_16x16x32_bf16 v[168:171], a[128:131], a[0:3], v[156:159]
 s_add_u32 s33, s25, 53248
 s_add_u32 s32, s25, 77824
 v_mov_b32_dpp v217, v217 row_shl:8 row_mask:0x4 bank_mask:0xf
 v_mfma_f32_16x16x32_bf16 v[168:171], a[132:135], a[4:7], v[168:171]
 v_max3_f32 v246, v252, v253, v254
 v_max_f32 v246, v246, v255
 v_mfma_f32_16x16x32_bf16 v[168:171], a[136:139], a[8:11], v[168:171]
 v_mov_b32 v247, v246
 v_mov_b32_dpp v217, v217 row_shl:12 row_mask:0x8 bank_mask:0xf
 v_mfma_f32_16x16x32_bf16 v[168:171], a[140:143], a[12:15], v[168:171]
 v_permlane16_swap_b32 v246, v247
 v_max_f32 v246, v246, v247
 v_mfma_f32_16x16x32_bf16 v[172:175], a[156:159], a[12:15], v[156:159]
 v_mov_b32 v247, v246
 v_mul_f32_dpp v96, v217, v96 row_newbcast:0 row_mask:0xf bank_mask:0xf
 v_mfma_f32_16x16x32_bf16 v[172:175], a[152:155], a[8:11], v[172:175]
 v_permlane32_swap_b32 v246, v247
 v_min_f32 v246, -v246, -v247
 v_mfma_f32_16x16x32_bf16 v[172:175], a[148:151], a[4:7], v[172:175]
 v_exp_f32 v171, v171
 v_mfma_f32_16x16x32_bf16 v[172:175], a[144:147], a[0:3], v[172:175]
 v_exp_f32 v168, v168
 v_mfma_f32_16x16x32_bf16 v[184:187], v[176:179], a[224:227], v[184:187]
 v_exp_f32 v169, v169
 v_mfma_f32_16x16x32_bf16 v[188:191], v[176:179], a[228:231], v[188:191]
 v_exp_f32 v170, v170
 v_mfma_f32_16x16x32_bf16 v[192:195], v[176:179], a[232:235], v[192:195]
 v_cvt_pk_bf16_f32 v180, v168, v169
 v_cvt_pk_bf16_f32 v181, v170, v171
 v_mfma_f32_16x16x32_bf16 v[196:199], v[176:179], a[236:239], v[196:199]
 v_exp_f32 v172, v172
 v_mfma_f32_16x16x32_bf16 v[200:203], v[176:179], a[240:243], v[200:203]
 v_exp_f32 v173, v173
 v_mfma_f32_16x16x32_bf16 v[204:207], v[176:179], a[244:247], v[204:207]
 v_cvt_pk_bf16_f32 v182, v172, v173
 v_mov_b32 v148, v246
 v_mfma_f32_16x16x32_bf16 v[208:211], v[176:179], a[248:251], v[208:211]
 v_exp_f32 v174, v174
 v_mfma_f32_16x16x32_bf16 v[212:215], v[176:179], a[252:255], v[212:215]
 v_exp_f32 v175, v175
 v_mfma_f32_16x16x32_bf16 v[160:163], a[160:163], a[16:19], v[144:147]
 v_cvt_pk_bf16_f32 v183, v174, v175
 v_mov_b32 v149, v246
 v_mfma_f32_16x16x32_bf16 v[160:163], a[164:167], a[20:23], v[160:163]
 v_mov_b32 v150, v246
 v_mov_b32 v151, v246
 v_mfma_f32_16x16x32_bf16 v[160:163], a[168:171], a[24:27], v[160:163]
 v_add_f32 v252, v252, v246
 v_add_f32 v253, v253, v246
 v_mfma_f32_16x16x32_bf16 v[160:163], a[172:175], a[28:31], v[160:163]
 v_add_f32 v254, v254, v246
 v_add_f32 v255, v255, v246
 v_mfma_f32_16x16x32_bf16 v[164:167], a[188:191], a[28:31], v[144:147]
 v_exp_f32 v252, v252
 v_mfma_f32_16x16x32_bf16 v[164:167], a[184:187], a[24:27], v[164:167]
 v_exp_f32 v253, v253
 v_mfma_f32_16x16x32_bf16 v[164:167], a[180:183], a[20:23], v[164:167]
 v_exp_f32 v254, v254
 v_mfma_f32_16x16x32_bf16 v[164:167], a[176:179], a[16:19], v[164:167]
 v_exp_f32 v161, v161
 v_smfmac_f32_16x16x64_bf16 v[132:135], v[236:239], v[176:183], v138
 v_mul_f32_dpp v100, v217, v100 row_newbcast:0 row_mask:0xf bank_mask:0xf
 v_mfma_f32_16x16x32_bf16 v[0:3], v[180:183], a[224:227], v[0:3]
 v_exp_f32 v162, v162
 v_mfma_f32_16x16x32_bf16 v[4:7], v[180:183], a[228:231], v[4:7]
 v_exp_f32 v163, v163
 v_mfma_f32_16x16x32_bf16 v[8:11], v[180:183], a[232:235], v[8:11]
 ds_read_b128 a[224:227], v248 offset:24576
 v_exp_f32 v160, v160
 v_mfma_f32_16x16x32_bf16 v[12:15], v[180:183], a[236:239], v[12:15]
 ds_read_b128 a[228:231], v248 offset:25088
 v_cvt_pk_bf16_f32 v176, v160, v161
 v_cvt_pk_bf16_f32 v177, v162, v163
 v_mfma_f32_16x16x32_bf16 v[16:19], v[180:183], a[240:243], v[16:19]
 ds_read_b128 a[232:235], v248 offset:25600
 ds_read_b128 a[236:239], v248 offset:26112
 v_mfma_f32_16x16x32_bf16 v[20:23], v[180:183], a[244:247], v[20:23]
 ds_read_b128 a[240:243], v248 offset:26624
 ds_read_b128 a[244:247], v248 offset:27136
 v_mfma_f32_16x16x32_bf16 v[24:27], v[180:183], a[248:251], v[24:27]
 v_exp_f32 v164, v164
 v_mfma_f32_16x16x32_bf16 v[28:31], v[180:183], a[252:255], v[28:31]
 v_exp_f32 v165, v165
 v_mfma_f32_16x16x32_bf16 v[172:175], a[188:191], a[44:47], v[148:151]
 ds_read_b128 a[248:251], v248 offset:27648
 v_exp_f32 v166, v166
 v_exp_f32 v167, v167
 v_mfma_f32_16x16x32_bf16 v[172:175], a[184:187], a[40:43], v[172:175]
 ds_read_b128 a[252:255], v248 offset:28160
 v_cvt_pk_bf16_f32 v178, v164, v165
 v_cvt_pk_bf16_f32 v179, v166, v167
 v_mfma_f32_16x16x32_bf16 v[172:175], a[180:183], a[36:39], v[172:175]
 v_exp_f32 v255, v255
 v_mfma_f32_16x16x32_bf16 v[172:175], a[176:179], a[32:35], v[172:175]
 s_waitcnt lgkmcnt(4)
 v_cvt_pk_bf16_f32 v180, v252, v253
 v_cvt_pk_bf16_f32 v181, v254, v255
 v_mfma_f32_16x16x32_bf16 v[32:35], v[176:179], a[224:227], v[32:35]
 v_cvt_pk_bf16_f32 v240, v96, v100
 v_mul_f32_dpp v104, v217, v104 row_newbcast:0 row_mask:0xf bank_mask:0xf
 v_mfma_f32_16x16x32_bf16 v[36:39], v[176:179], a[228:231], v[36:39]
 v_mul_f32_dpp v108, v217, v108 row_newbcast:0 row_mask:0xf bank_mask:0xf
 v_cvt_pk_bf16_f32 v241, v104, v108
 v_mfma_f32_16x16x32_bf16 v[40:43], v[176:179], a[232:235], v[40:43]
 v_exp_f32 v172, v172
 v_mfma_f32_16x16x32_bf16 v[44:47], v[176:179], a[236:239], v[44:47]
 s_waitcnt lgkmcnt(1)
 v_exp_f32 v173, v173
 v_mfma_f32_16x16x32_bf16 v[48:51], v[176:179], a[240:243], v[48:51]
 v_exp_f32 v174, v174
 v_mfma_f32_16x16x32_bf16 v[52:55], v[176:179], a[244:247], v[52:55]
 v_exp_f32 v175, v175
 v_mfma_f32_16x16x32_bf16 v[56:59], v[176:179], a[248:251], v[56:59]
 s_waitcnt lgkmcnt(0)
 v_cvt_pk_bf16_f32 v182, v172, v173
 v_cvt_pk_bf16_f32 v183, v174, v175
 v_mfma_f32_16x16x32_bf16 v[60:63], v[176:179], a[252:255], v[60:63]
 v_mul_f32_dpp v112, v217, v112 row_newbcast:0 row_mask:0xf bank_mask:0xf
 v_mul_f32_dpp v116, v217, v116 row_newbcast:0 row_mask:0xf bank_mask:0xf
 v_mfma_f32_16x16x32_bf16 v[160:163], a[160:163], v[220:223], v[152:155]
 v_cvt_pk_bf16_f32 v242, v112, v116
 v_mul_f32_dpp v120, v217, v120 row_newbcast:0 row_mask:0xf bank_mask:0xf
 v_mfma_f32_16x16x32_bf16 v[160:163], a[164:167], v[224:227], v[160:163]
 v_mul_f32_dpp v124, v217, v124 row_newbcast:0 row_mask:0xf bank_mask:0xf
 v_cvt_pk_bf16_f32 v243, v120, v124
 v_mfma_f32_16x16x32_bf16 v[160:163], a[168:171], v[228:231], v[160:163]
 buffer_store_dwordx4 v[240:243], v244, s[20:23], s33 offen offset:0 sc1
 v_mfma_f32_16x16x32_bf16 v[160:163], a[172:175], v[232:235], v[160:163]
 v_mul_f32_dpp v97, v217, v97 row_newbcast:1 row_mask:0xf bank_mask:0xf
 v_mul_f32_dpp v101, v217, v101 row_newbcast:1 row_mask:0xf bank_mask:0xf
 v_mfma_f32_16x16x32_bf16 v[164:167], a[188:191], v[232:235], v[152:155]
 v_cvt_pk_bf16_f32 v240, v97, v101
 v_mul_f32_dpp v105, v217, v105 row_newbcast:1 row_mask:0xf bank_mask:0xf
 v_mfma_f32_16x16x32_bf16 v[164:167], a[184:187], v[228:231], v[164:167]
 v_mul_f32_dpp v109, v217, v109 row_newbcast:1 row_mask:0xf bank_mask:0xf
 v_cvt_pk_bf16_f32 v241, v105, v109
 v_mfma_f32_16x16x32_bf16 v[164:167], a[180:183], v[224:227], v[164:167]
 v_exp_f32 v160, v160
 v_mfma_f32_16x16x32_bf16 v[164:167], a[176:179], v[220:223], v[164:167]
 v_exp_f32 v161, v161
 v_smfmac_f32_16x16x64_bf16 v[128:131], v[236:239], v[176:183], v138
 v_cvt_pk_bf16_f32 v176, v160, v161
 v_mfma_f32_16x16x32_bf16 v[64:67], v[180:183], a[224:227], 0
 v_exp_f32 v162, v162
 v_mfma_f32_16x16x32_bf16 v[68:71], v[180:183], a[228:231], 0
 v_exp_f32 v163, v163
 v_mfma_f32_16x16x32_bf16 v[72:75], v[180:183], a[232:235], 0
 v_exp_f32 v164, v164
 v_mfma_f32_16x16x32_bf16 v[76:79], v[180:183], a[236:239], 0
 v_exp_f32 v165, v165
 v_mfma_f32_16x16x32_bf16 v[80:83], v[180:183], a[240:243], 0
 v_exp_f32 v166, v166
 v_mfma_f32_16x16x32_bf16 v[84:87], v[180:183], a[244:247], 0
 v_exp_f32 v167, v167
 v_mfma_f32_16x16x32_bf16 v[88:91], v[180:183], a[248:251], 0
 v_cvt_pk_bf16_f32 v177, v162, v163
 v_cvt_pk_bf16_f32 v178, v164, v165
 v_mfma_f32_16x16x32_bf16 v[92:95], v[180:183], a[252:255], 0
 v_cvt_pk_bf16_f32 v179, v166, v167
 v_mul_f32_dpp v113, v217, v113 row_newbcast:1 row_mask:0xf bank_mask:0xf
 v_mfma_f32_16x16x32_bf16 v[168:171], a[160:163], a[0:3], v[156:159]
 v_mul_f32_dpp v117, v217, v117 row_newbcast:1 row_mask:0xf bank_mask:0xf
 v_cvt_pk_bf16_f32 v242, v113, v117
 v_mfma_f32_16x16x32_bf16 v[168:171], a[164:167], a[4:7], v[168:171]
 v_mul_f32_dpp v121, v217, v121 row_newbcast:1 row_mask:0xf bank_mask:0xf
 v_mul_f32_dpp v125, v217, v125 row_newbcast:1 row_mask:0xf bank_mask:0xf
 v_mfma_f32_16x16x32_bf16 v[168:171], a[168:171], a[8:11], v[168:171]
 v_cvt_pk_bf16_f32 v243, v121, v125
 v_mul_f32_dpp v98, v217, v98 row_newbcast:2 row_mask:0xf bank_mask:0xf
 v_mfma_f32_16x16x32_bf16 v[168:171], a[172:175], a[12:15], v[168:171]
 buffer_store_dwordx4 v[240:243], v244, s[20:23], s33 offen offset:1024 sc1
 v_mfma_f32_16x16x32_bf16 v[172:175], a[188:191], a[12:15], v[156:159]
 v_mul_f32_dpp v102, v217, v102 row_newbcast:2 row_mask:0xf bank_mask:0xf
 v_cvt_pk_bf16_f32 v240, v98, v102
 v_mfma_f32_16x16x32_bf16 v[172:175], a[184:187], a[8:11], v[172:175]
 v_mul_f32_dpp v106, v217, v106 row_newbcast:2 row_mask:0xf bank_mask:0xf
 v_mul_f32_dpp v110, v217, v110 row_newbcast:2 row_mask:0xf bank_mask:0xf
 v_mfma_f32_16x16x32_bf16 v[172:175], a[180:183], a[4:7], v[172:175]
 v_exp_f32 v168, v168
 v_mfma_f32_16x16x32_bf16 v[172:175], a[176:179], a[0:3], v[172:175]
 v_exp_f32 v169, v169
 v_mfma_f32_16x16x32_bf16 v[184:187], v[176:179], a[224:227], v[184:187]
 v_exp_f32 v170, v170
 v_mfma_f32_16x16x32_bf16 v[188:191], v[176:179], a[228:231], v[188:191]
 v_exp_f32 v171, v171
 v_mfma_f32_16x16x32_bf16 v[192:195], v[176:179], a[232:235], v[192:195]
 v_cvt_pk_bf16_f32 v180, v168, v169
 v_cvt_pk_bf16_f32 v181, v170, v171
 v_mfma_f32_16x16x32_bf16 v[196:199], v[176:179], a[236:239], v[196:199]
 v_exp_f32 v172, v172
 v_mfma_f32_16x16x32_bf16 v[200:203], v[176:179], a[240:243], v[200:203]
 v_exp_f32 v173, v173
 v_mfma_f32_16x16x32_bf16 v[204:207], v[176:179], a[244:247], v[204:207]
 v_exp_f32 v174, v174
 v_mfma_f32_16x16x32_bf16 v[208:211], v[176:179], a[248:251], v[208:211]
 v_exp_f32 v175, v175
 v_mfma_f32_16x16x32_bf16 v[212:215], v[176:179], a[252:255], v[212:215]
 v_cvt_pk_bf16_f32 v182, v172, v173
 v_cvt_pk_bf16_f32 v183, v174, v175
 v_mfma_f32_16x16x32_bf16 v[160:163], a[192:195], a[16:19], v[144:147]
 v_cvt_pk_bf16_f32 v241, v106, v110
 v_mul_f32_dpp v114, v217, v114 row_newbcast:2 row_mask:0xf bank_mask:0xf
 v_mfma_f32_16x16x32_bf16 v[160:163], a[196:199], a[20:23], v[160:163]
 v_mul_f32_dpp v118, v217, v118 row_newbcast:2 row_mask:0xf bank_mask:0xf
 v_cvt_pk_bf16_f32 v242, v114, v118
 v_mfma_f32_16x16x32_bf16 v[160:163], a[200:203], a[24:27], v[160:163]
 v_mul_f32_dpp v122, v217, v122 row_newbcast:2 row_mask:0xf bank_mask:0xf
 v_mul_f32_dpp v126, v217, v126 row_newbcast:2 row_mask:0xf bank_mask:0xf
 v_mfma_f32_16x16x32_bf16 v[160:163], a[204:207], a[28:31], v[160:163]
 v_cvt_pk_bf16_f32 v243, v122, v126
 v_mul_f32_dpp v99, v217, v99 row_newbcast:3 row_mask:0xf bank_mask:0xf
 v_mfma_f32_16x16x32_bf16 v[164:167], a[220:223], a[28:31], v[144:147]
 v_mul_f32_dpp v103, v217, v103 row_newbcast:3 row_mask:0xf bank_mask:0xf
 v_mul_f32_dpp v107, v217, v107 row_newbcast:3 row_mask:0xf bank_mask:0xf
 v_mfma_f32_16x16x32_bf16 v[164:167], a[216:219], a[24:27], v[164:167]
 v_mul_f32_dpp v111, v217, v111 row_newbcast:3 row_mask:0xf bank_mask:0xf
 v_mul_f32_dpp v115, v217, v115 row_newbcast:3 row_mask:0xf bank_mask:0xf
 v_mfma_f32_16x16x32_bf16 v[164:167], a[212:215], a[20:23], v[164:167]
 v_exp_f32 v160, v160
 v_mfma_f32_16x16x32_bf16 v[164:167], a[208:211], a[16:19], v[164:167]
 v_exp_f32 v161, v161
 v_smfmac_f32_16x16x64_bf16 v[132:135], v[236:239], v[176:183], v138
 v_cvt_pk_bf16_f32 v176, v160, v161
 v_mfma_f32_16x16x32_bf16 v[0:3], v[180:183], a[224:227], v[0:3]
 buffer_store_dwordx4 v[240:243], v244, s[20:23], s33 offen offset:2048 sc1
 v_mfma_f32_16x16x32_bf16 v[4:7], v[180:183], a[228:231], v[4:7]
 ds_read_b128 a[224:227], v248 offset:32768
 ds_read_b128 a[228:231], v248 offset:33280
 v_mfma_f32_16x16x32_bf16 v[8:11], v[180:183], a[232:235], v[8:11]
 ds_read_b128 a[232:235], v248 offset:33792
 v_cvt_pk_bf16_f32 v240, v99, v103
 v_mfma_f32_16x16x32_bf16 v[12:15], v[180:183], a[236:239], v[12:15]
 v_exp_f32 v162, v162
 v_mfma_f32_16x16x32_bf16 v[16:19], v[180:183], a[240:243], v[16:19]
 v_exp_f32 v163, v163
 v_mfma_f32_16x16x32_bf16 v[20:23], v[180:183], a[244:247], v[20:23]
 v_exp_f32 v164, v164
 v_mfma_f32_16x16x32_bf16 v[24:27], v[180:183], a[248:251], v[24:27]
 v_exp_f32 v165, v165
 v_mfma_f32_16x16x32_bf16 v[28:31], v[180:183], a[252:255], v[28:31]
 v_exp_f32 v166, v166
 v_mfma_f32_16x16x32_bf16 v[168:171], a[192:195], a[32:35], v[148:151]
 ds_read_b128 a[236:239], v248 offset:34304
 ds_read_b128 a[240:243], v248 offset:34816
 v_mfma_f32_16x16x32_bf16 v[168:171], a[196:199], a[36:39], v[168:171]
 v_exp_f32 v167, v167
 v_mfma_f32_16x16x32_bf16 v[168:171], a[200:203], a[40:43], v[168:171]
 ds_read_b128 a[244:247], v248 offset:35328
 ds_read_b128 a[248:251], v248 offset:35840
 v_mfma_f32_16x16x32_bf16 v[168:171], a[204:207], a[44:47], v[168:171]
 v_cvt_pk_bf16_f32 v177, v162, v163
 v_cvt_pk_bf16_f32 v178, v164, v165
 v_mfma_f32_16x16x32_bf16 v[172:175], a[220:223], a[44:47], v[148:151]
 ds_read_b128 a[252:255], v248 offset:36352
 v_cvt_pk_bf16_f32 v179, v166, v167
 v_mfma_f32_16x16x32_bf16 v[172:175], a[216:219], a[40:43], v[172:175]
 v_cvt_pk_bf16_f32 v241, v107, v111
 v_mul_f32_dpp v119, v217, v119 row_newbcast:3 row_mask:0xf bank_mask:0xf
 v_mfma_f32_16x16x32_bf16 v[172:175], a[212:215], a[36:39], v[172:175]
 v_exp_f32 v168, v168
 v_mfma_f32_16x16x32_bf16 v[172:175], a[208:211], a[32:35], v[172:175]
 s_waitcnt lgkmcnt(3)
 v_exp_f32 v169, v169
 v_mfma_f32_16x16x32_bf16 v[32:35], v[176:179], a[224:227], v[32:35]
 v_exp_f32 v170, v170
 v_mfma_f32_16x16x32_bf16 v[36:39], v[176:179], a[228:231], v[36:39]
 v_exp_f32 v171, v171
 v_mfma_f32_16x16x32_bf16 v[40:43], v[176:179], a[232:235], v[40:43]
 v_cvt_pk_bf16_f32 v180, v168, v169
 v_cvt_pk_bf16_f32 v181, v170, v171
 v_mfma_f32_16x16x32_bf16 v[44:47], v[176:179], a[236:239], v[44:47]
 v_exp_f32 v172, v172
 v_mfma_f32_16x16x32_bf16 v[48:51], v[176:179], a[240:243], v[48:51]
 s_waitcnt lgkmcnt(0)
 v_exp_f32 v173, v173
 v_mfma_f32_16x16x32_bf16 v[52:55], v[176:179], a[244:247], v[52:55]
 v_exp_f32 v174, v174
 v_mfma_f32_16x16x32_bf16 v[56:59], v[176:179], a[248:251], v[56:59]
 v_exp_f32 v175, v175
 v_mfma_f32_16x16x32_bf16 v[60:63], v[176:179], a[252:255], v[60:63]
 v_cvt_pk_bf16_f32 v182, v172, v173
 v_cvt_pk_bf16_f32 v183, v174, v175
 v_mfma_f32_16x16x32_bf16 v[160:163], a[192:195], v[220:223], v[152:155]
 v_cvt_pk_bf16_f32 v242, v115, v119
 v_mul_f32_dpp v123, v217, v123 row_newbcast:3 row_mask:0xf bank_mask:0xf
 v_mfma_f32_16x16x32_bf16 v[160:163], a[196:199], v[224:227], v[160:163]
 v_mul_f32_dpp v127, v217, v127 row_newbcast:3 row_mask:0xf bank_mask:0xf
 v_cvt_pk_bf16_f32 v243, v123, v127
 v_mfma_f32_16x16x32_bf16 v[160:163], a[200:203], v[228:231], v[160:163]
 buffer_store_dwordx4 v[240:243], v244, s[20:23], s33 offen offset:3072 sc1
 v_mfma_f32_16x16x32_bf16 v[160:163], a[204:207], v[232:235], v[160:163]
 s_nop 1
 v_mfma_f32_16x16x32_bf16 v[164:167], a[220:223], v[232:235], v[152:155]
 s_nop 1
 v_mfma_f32_16x16x32_bf16 v[164:167], a[216:219], v[228:231], v[164:167]
 s_nop 1
 v_mfma_f32_16x16x32_bf16 v[164:167], a[212:215], v[224:227], v[164:167]
 v_exp_f32 v160, v160
 v_mfma_f32_16x16x32_bf16 v[164:167], a[208:211], v[220:223], v[164:167]
 v_exp_f32 v161, v161
 v_smfmac_f32_16x16x64_bf16 v[128:131], v[236:239], v[176:183], v138
 v_cvt_pk_bf16_f32 v176, v160, v161
 v_mfma_f32_16x16x32_bf16 v[64:67], v[180:183], a[224:227], v[64:67]
 v_exp_f32 v162, v162
 v_mfma_f32_16x16x32_bf16 v[68:71], v[180:183], a[228:231], v[68:71]
 v_exp_f32 v163, v163
 v_mfma_f32_16x16x32_bf16 v[72:75], v[180:183], a[232:235], v[72:75]
 v_exp_f32 v164, v164
 v_mfma_f32_16x16x32_bf16 v[76:79], v[180:183], a[236:239], v[76:79]
 v_exp_f32 v165, v165
 v_mfma_f32_16x16x32_bf16 v[80:83], v[180:183], a[240:243], v[80:83]
 v_exp_f32 v166, v166
 v_mfma_f32_16x16x32_bf16 v[84:87], v[180:183], a[244:247], v[84:87]
 v_exp_f32 v167, v167
 v_mfma_f32_16x16x32_bf16 v[88:91], v[180:183], a[248:251], v[88:91]
 v_cvt_pk_bf16_f32 v177, v162, v163
 v_cvt_pk_bf16_f32 v178, v164, v165
 v_mfma_f32_16x16x32_bf16 v[92:95], v[180:183], a[252:255], v[92:95]
 v_cvt_pk_bf16_f32 v179, v166, v167
 v_mfma_f32_16x16x32_bf16 v[168:171], a[192:195], a[0:3], v[156:159]
 ds_read_b128 a[192:195], v249 offset:40960
 v_mfma_f32_16x16x32_bf16 v[168:171], a[196:199], a[4:7], v[168:171]
 ds_read_b128 a[196:199], v249 offset:41472
 v_mfma_f32_16x16x32_bf16 v[168:171], a[200:203], a[8:11], v[168:171]
 ds_read_b128 a[200:203], v249 offset:41984
 v_mfma_f32_16x16x32_bf16 v[168:171], a[204:207], a[12:15], v[168:171]
 ds_read_b128 a[204:207], v249 offset:42496
 s_nop 0
 v_mfma_f32_16x16x32_bf16 v[172:175], a[220:223], a[12:15], v[156:159]
 ds_read_b128 a[220:223], v249 offset:44544
 s_nop 0
 v_mfma_f32_16x16x32_bf16 v[172:175], a[216:219], a[8:11], v[172:175]
 ds_read_b128 a[216:219], v249 offset:44032
 s_nop 0
 v_mfma_f32_16x16x32_bf16 v[172:175], a[212:215], a[4:7], v[172:175]
 v_exp_f32 v168, v168
 v_mfma_f32_16x16x32_bf16 v[172:175], a[208:211], a[0:3], v[172:175]
 ds_read_b128 a[208:211], v249 offset:43008
 ds_read_b128 a[212:215], v249 offset:43520
 v_mfma_f32_16x16x32_bf16 v[184:187], v[176:179], a[224:227], v[184:187]
 v_exp_f32 v169, v169
 v_mfma_f32_16x16x32_bf16 v[188:191], v[176:179], a[228:231], v[188:191]
 v_exp_f32 v170, v170
 v_mfma_f32_16x16x32_bf16 v[192:195], v[176:179], a[232:235], v[192:195]
 v_exp_f32 v171, v171
 v_mfma_f32_16x16x32_bf16 v[196:199], v[176:179], a[236:239], v[196:199]
 v_exp_f32 v172, v172
 v_mfma_f32_16x16x32_bf16 v[200:203], v[176:179], a[240:243], v[200:203]
 v_exp_f32 v173, v173
 v_mfma_f32_16x16x32_bf16 v[204:207], v[176:179], a[244:247], v[204:207]
 v_exp_f32 v174, v174
 v_mfma_f32_16x16x32_bf16 v[208:211], v[176:179], a[248:251], v[208:211]
 v_exp_f32 v175, v175
 v_mfma_f32_16x16x32_bf16 v[212:215], v[176:179], a[252:255], v[212:215]
 s_waitcnt lgkmcnt(0)
 v_cvt_pk_bf16_f32 v180, v168, v169
 v_cvt_pk_bf16_f32 v181, v170, v171
 v_mfma_f32_16x16x32_bf16 v[160:163], a[192:195], a[16:19], v[144:147]
 v_cvt_pk_bf16_f32 v182, v172, v173
 v_cvt_pk_bf16_f32 v183, v174, v175
 v_mfma_f32_16x16x32_bf16 v[160:163], a[196:199], a[20:23], v[160:163]
 v_mfma_f32_16x16x32_bf16 v[160:163], a[200:203], a[24:27], v[160:163]
 v_mfma_f32_16x16x32_bf16 v[160:163], a[204:207], a[28:31], v[160:163]
 s_nop 1
 v_mfma_f32_16x16x32_bf16 v[164:167], a[220:223], a[28:31], v[144:147]
 s_nop 1
 v_mfma_f32_16x16x32_bf16 v[164:167], a[216:219], a[24:27], v[164:167]
 s_nop 1
 v_mfma_f32_16x16x32_bf16 v[164:167], a[212:215], a[20:23], v[164:167]
 v_exp_f32 v160, v160
 v_mfma_f32_16x16x32_bf16 v[164:167], a[208:211], a[16:19], v[164:167]
L_pg14:
 s_cbranch_execz L_pg18
 v_exp_f32 v161, v161
 v_smfmac_f32_16x16x64_bf16 v[132:135], v[236:239], v[176:183], v138
 v_cvt_pk_bf16_f32 v176, v160, v161
 v_mfma_f32_16x16x32_bf16 v[0:3], v[180:183], a[224:227], v[0:3]
 v_exp_f32 v162, v162
 v_mfma_f32_16x16x32_bf16 v[4:7], v[180:183], a[228:231], v[4:7]
 ds_read_b128 a[224:227], v248 offset:40960
 ds_read_b128 a[228:231], v248 offset:41472
 v_mfma_f32_16x16x32_bf16 v[8:11], v[180:183], a[232:235], v[8:11]
 v_exp_f32 v163, v163
 v_mfma_f32_16x16x32_bf16 v[12:15], v[180:183], a[236:239], v[12:15]
 ds_read_b128 a[232:235], v248 offset:41984
 ds_read_b128 a[236:239], v248 offset:42496
 v_mfma_f32_16x16x32_bf16 v[16:19], v[180:183], a[240:243], v[16:19]
 v_exp_f32 v164, v164
 v_mfma_f32_16x16x32_bf16 v[20:23], v[180:183], a[244:247], v[20:23]
 v_exp_f32 v165, v165
 v_mfma_f32_16x16x32_bf16 v[24:27], v[180:183], a[248:251], v[24:27]
 v_exp_f32 v166, v166
 v_mfma_f32_16x16x32_bf16 v[28:31], v[180:183], a[252:255], v[28:31]
 v_exp_f32 v167, v167
 v_mfma_f32_16x16x32_bf16 v[168:171], a[192:195], a[32:35], v[148:151]
 ds_read_b128 a[240:243], v248 offset:43008
 ds_read_b128 a[244:247], v248 offset:43520
 v_mfma_f32_16x16x32_bf16 v[168:171], a[196:199], a[36:39], v[168:171]
 ds_read_b128 a[248:251], v248 offset:44032
 v_cvt_pk_bf16_f32 v177, v162, v163
 v_mfma_f32_16x16x32_bf16 v[168:171], a[200:203], a[40:43], v[168:171]
 v_cvt_pk_bf16_f32 v178, v164, v165
 v_cvt_pk_bf16_f32 v179, v166, v167
 v_mfma_f32_16x16x32_bf16 v[168:171], a[204:207], a[44:47], v[168:171]
 ds_read_b128 a[252:255], v248 offset:44544
 s_nop 0
 v_mfma_f32_16x16x32_bf16 v[172:175], a[220:223], a[44:47], v[148:151]
 s_nop 1
 v_mfma_f32_16x16x32_bf16 v[172:175], a[216:219], a[40:43], v[172:175]
 s_nop 1
 v_mfma_f32_16x16x32_bf16 v[172:175], a[212:215], a[36:39], v[172:175]
 v_exp_f32 v168, v168
 v_mfma_f32_16x16x32_bf16 v[172:175], a[208:211], a[32:35], v[172:175]
 s_waitcnt lgkmcnt(2)
 v_exp_f32 v169, v169
 v_mfma_f32_16x16x32_bf16 v[32:35], v[176:179], a[224:227], v[32:35]
 v_exp_f32 v170, v170
 v_mfma_f32_16x16x32_bf16 v[36:39], v[176:179], a[228:231], v[36:39]
 v_exp_f32 v171, v171
 v_mfma_f32_16x16x32_bf16 v[40:43], v[176:179], a[232:235], v[40:43]
 v_cvt_pk_bf16_f32 v180, v168, v169
 v_cvt_pk_bf16_f32 v181, v170, v171
 v_mfma_f32_16x16x32_bf16 v[44:47], v[176:179], a[236:239], v[44:47]
 v_exp_f32 v172, v172
 v_mfma_f32_16x16x32_bf16 v[48:51], v[176:179], a[240:243], v[48:51]
 v_exp_f32 v173, v173
 v_mfma_f32_16x16x32_bf16 v[52:55], v[176:179], a[244:247], v[52:55]
 s_waitcnt lgkmcnt(0)
 v_exp_f32 v174, v174
 v_mfma_f32_16x16x32_bf16 v[56:59], v[176:179], a[248:251], v[56:59]
 v_exp_f32 v175, v175
 v_mfma_f32_16x16x32_bf16 v[60:63], v[176:179], a[252:255], v[60:63]
 v_cvt_pk_bf16_f32 v182, v172, v173
 v_cvt_pk_bf16_f32 v183, v174, v175
 v_mfma_f32_16x16x32_bf16 v[160:163], a[192:195], v[220:223], v[152:155]
 v_mfma_f32_16x16x32_bf16 v[160:163], a[196:199], v[224:227], v[160:163]
 v_mfma_f32_16x16x32_bf16 v[160:163], a[200:203], v[228:231], v[160:163]
 v_mfma_f32_16x16x32_bf16 v[160:163], a[204:207], v[232:235], v[160:163]
 s_nop 1
 v_mfma_f32_16x16x32_bf16 v[164:167], a[220:223], v[232:235], v[152:155]
 buffer_load_dwordx4 v[232:235], v245, s[8:11], s32 offen offset:192
 v_mfma_f32_16x16x32_bf16 v[164:167], a[216:219], v[228:231], v[164:167]
 s_nop 1
 v_mfma_f32_16x16x32_bf16 v[164:167], a[212:215], v[224:227], v[164:167]
 v_exp_f32 v161, v161
 v_mfma_f32_16x16x32_bf16 v[164:167], a[208:211], v[220:223], v[164:167]
 v_exp_f32 v162, v162
 v_smfmac_f32_16x16x64_bf16 v[128:131], v[236:239], v[176:183], v138
 s_nop 0
 v_mfma_f32_16x16x32_bf16 v[64:67], v[180:183], a[224:227], v[64:67]
 buffer_load_dwordx4 v[220:223], v245, s[8:11], s32 offen offset:0
 v_mfma_f32_16x16x32_bf16 v[68:71], v[180:183], a[228:231], v[68:71]
 v_exp_f32 v163, v163
 v_mfma_f32_16x16x32_bf16 v[72:75], v[180:183], a[232:235], v[72:75]
 v_exp_f32 v164, v164
 v_mfma_f32_16x16x32_bf16 v[76:79], v[180:183], a[236:239], v[76:79]
 v_exp_f32 v165, v165
 v_mfma_f32_16x16x32_bf16 v[80:83], v[180:183], a[240:243], v[80:83]
 buffer_load_dwordx4 v[224:227], v245, s[8:11], s32 offen offset:64
 v_mfma_f32_16x16x32_bf16 v[84:87], v[180:183], a[244:247], v[84:87]
 v_exp_f32 v166, v166
 v_mfma_f32_16x16x32_bf16 v[88:91], v[180:183], a[248:251], v[88:91]
 v_exp_f32 v160, v160
 v_mfma_f32_16x16x32_bf16 v[92:95], v[180:183], a[252:255], v[92:95]
 v_exp_f32 v167, v167
 v_mfma_f32_16x16x32_bf16 v[168:171], a[192:195], a[0:3], v[156:159]
 buffer_load_dwordx4 v[228:231], v245, s[8:11], s32 offen offset:128
 v_mfma_f32_16x16x32_bf16 v[168:171], a[196:199], a[4:7], v[168:171]
 v_cvt_pk_bf16_f32 v176, v160, v161
 v_cvt_pk_bf16_f32 v177, v162, v163
 v_mfma_f32_16x16x32_bf16 v[168:171], a[200:203], a[8:11], v[168:171]
 v_cvt_pk_bf16_f32 v178, v164, v165
 v_cvt_pk_bf16_f32 v179, v166, v167
 v_mfma_f32_16x16x32_bf16 v[168:171], a[204:207], a[12:15], v[168:171]
 ds_read_b128 a[192:195], v249 offset:49152
 ds_read_b128 a[196:199], v249 offset:49664
 v_mfma_f32_16x16x32_bf16 v[172:175], a[220:223], a[12:15], v[156:159]
 ds_read_b128 a[204:207], v249 offset:50688
 ds_read_b128 a[200:203], v249 offset:50176
 v_mfma_f32_16x16x32_bf16 v[172:175], a[216:219], a[8:11], v[172:175]
 ds_read_b128 a[216:219], v249 offset:52224
 ds_read_b128 a[220:223], v249 offset:52736
 v_mfma_f32_16x16x32_bf16 v[172:175], a[212:215], a[4:7], v[172:175]
 v_exp_f32 v168, v168
 v_mfma_f32_16x16x32_bf16 v[172:175], a[208:211], a[0:3], v[172:175]
 ds_read_b128 a[208:211], v249 offset:51200
 ds_read_b128 a[212:215], v249 offset:51712
 v_mfma_f32_16x16x32_bf16 v[184:187], v[176:179], a[224:227], v[184:187]
 v_exp_f32 v169, v169
 v_mfma_f32_16x16x32_bf16 v[188:191], v[176:179], a[228:231], v[188:191]
 v_exp_f32 v170, v170
 v_mfma_f32_16x16x32_bf16 v[192:195], v[176:179], a[232:235], v[192:195]
 v_exp_f32 v171, v171
 v_mfma_f32_16x16x32_bf16 v[196:199], v[176:179], a[236:239], v[196:199]
 v_exp_f32 v172, v172
 v_mfma_f32_16x16x32_bf16 v[200:203], v[176:179], a[240:243], v[200:203]
 v_exp_f32 v173, v173
 v_mfma_f32_16x16x32_bf16 v[204:207], v[176:179], a[244:247], v[204:207]
 v_exp_f32 v174, v174
 v_mfma_f32_16x16x32_bf16 v[208:211], v[176:179], a[248:251], v[208:211]
 v_exp_f32 v175, v175
 v_mfma_f32_16x16x32_bf16 v[212:215], v[176:179], a[252:255], v[212:215]
 s_waitcnt vmcnt(8) lgkmcnt(0)
 v_cvt_pk_bf16_f32 v180, v168, v169
 v_cvt_pk_bf16_f32 v181, v170, v171
 v_mfma_f32_16x16x32_bf16 v[252:255], a[192:195], a[48:51], 0
 v_cvt_pk_bf16_f32 v182, v172, v173
 v_cvt_pk_bf16_f32 v183, v174, v175
 v_mfma_f32_16x16x32_bf16 v[252:255], a[196:199], a[52:55], v[252:255]
 v_mfma_f32_16x16x32_bf16 v[252:255], a[200:203], a[56:59], v[252:255]
 v_mfma_f32_16x16x32_bf16 v[252:255], a[204:207], a[60:63], v[252:255]
 s_nop 1
 v_mfma_f32_16x16x32_bf16 v[160:163], a[192:195], a[16:19], v[144:147]
 s_nop 1
 v_mfma_f32_16x16x32_bf16 v[160:163], a[196:199], a[20:23], v[160:163]
 s_nop 1
 v_mfma_f32_16x16x32_bf16 v[160:163], a[200:203], a[24:27], v[160:163]
 v_max3_f32 v246, v252, v253, v254
 v_max_f32 v246, v246, v255
 v_mfma_f32_16x16x32_bf16 v[160:163], a[204:207], a[28:31], v[160:163]
 v_mov_b32 v247, v246
 s_nop 0
 v_mfma_f32_16x16x32_bf16 v[164:167], a[220:223], a[28:31], v[144:147]
 v_permlane16_swap_b32 v246, v247
 v_max_f32 v246, v246, v247
 v_mfma_f32_16x16x32_bf16 v[164:167], a[216:219], a[24:27], v[164:167]
 v_mov_b32 v247, v246
 s_nop 0
 v_mfma_f32_16x16x32_bf16 v[164:167], a[212:215], a[20:23], v[164:167]
 v_exp_f32 v160, v160
 v_mfma_f32_16x16x32_bf16 v[164:167], a[208:211], a[16:19], v[164:167]
 v_exp_f32 v161, v161
 v_smfmac_f32_16x16x64_bf16 v[132:135], v[236:239], v[176:183], v138
 v_cvt_pk_bf16_f32 v176, v160, v161
 v_mfma_f32_16x16x32_bf16 v[0:3], v[180:183], a[224:227], v[0:3]
 v_exp_f32 v162, v162
 v_mfma_f32_16x16x32_bf16 v[4:7], v[180:183], a[228:231], v[4:7]
 v_exp_f32 v163, v163
 v_mfma_f32_16x16x32_bf16 v[8:11], v[180:183], a[232:235], v[8:11]
 v_exp_f32 v166, v166
 v_mfma_f32_16x16x32_bf16 v[12:15], v[180:183], a[236:239], v[12:15]
 v_exp_f32 v167, v167
 v_mfma_f32_16x16x32_bf16 v[16:19], v[180:183], a[240:243], v[16:19]
 v_exp_f32 v164, v164
 v_mfma_f32_16x16x32_bf16 v[20:23], v[180:183], a[244:247], v[20:23]
 v_exp_f32 v165, v165
 v_mfma_f32_16x16x32_bf16 v[24:27], v[180:183], a[248:251], v[24:27]
 ds_read_b128 a[224:227], v248 offset:49152
 v_cvt_pk_bf16_f32 v177, v162, v163
 v_cvt_pk_bf16_f32 v178, v164, v165
 v_mfma_f32_16x16x32_bf16 v[28:31], v[180:183], a[252:255], v[28:31]
 ds_read_b128 a[228:231], v248 offset:49664
 v_cvt_pk_bf16_f32 v179, v166, v167
 v_mfma_f32_16x16x32_bf16 v[168:171], a[192:195], a[32:35], v[148:151]
 ds_read_b128 a[232:235], v248 offset:50176
 ds_read_b128 a[252:255], v248 offset:52736
 v_mfma_f32_16x16x32_bf16 v[168:171], a[196:199], a[36:39], v[168:171]
 ds_read_b128 a[236:239], v248 offset:50688
 v_permlane32_swap_b32 v246, v247
 v_mfma_f32_16x16x32_bf16 v[168:171], a[200:203], a[40:43], v[168:171]
 ds_read_b128 a[240:243], v248 offset:51200
 v_min_f32 v246, -v246, -v247
 v_mfma_f32_16x16x32_bf16 v[168:171], a[204:207], a[44:47], v[168:171]
 ds_read_b128 a[244:247], v248 offset:51712
 v_mov_b32 v152, v246
 v_mov_b32 v153, v246
 v_mfma_f32_16x16x32_bf16 v[172:175], a[220:223], a[44:47], v[148:151]
 ds_read_b128 a[248:251], v248 offset:52224
 v_mov_b32 v154, v246
 v_mov_b32 v155, v246
 v_mfma_f32_16x16x32_bf16 v[172:175], a[216:219], a[40:43], v[172:175]
 v_exp_f32 v168, v168
 v_mfma_f32_16x16x32_bf16 v[172:175], a[212:215], a[36:39], v[172:175]
 v_exp_f32 v169, v169
 v_mfma_f32_16x16x32_bf16 v[172:175], a[208:211], a[32:35], v[172:175]
 s_waitcnt lgkmcnt(4)
 v_exp_f32 v170, v170
 v_mfma_f32_16x16x32_bf16 v[32:35], v[176:179], a[224:227], v[32:35]
 v_exp_f32 v171, v171
 v_mfma_f32_16x16x32_bf16 v[36:39], v[176:179], a[228:231], v[36:39]
 v_cvt_pk_bf16_f32 v180, v168, v169
 v_cvt_pk_bf16_f32 v181, v170, v171
 v_mfma_f32_16x16x32_bf16 v[40:43], v[176:179], a[232:235], v[40:43]
 s_waitcnt lgkmcnt(1)
 v_add_f32 v252, v252, v246
 v_add_f32 v253, v253, v246
 v_mfma_f32_16x16x32_bf16 v[44:47], v[176:179], a[236:239], v[44:47]
 v_add_f32 v254, v254, v246
 v_add_f32 v255, v255, v246
 v_mfma_f32_16x16x32_bf16 v[48:51], v[176:179], a[240:243], v[48:51]
 v_exp_f32 v172, v172
 v_mfma_f32_16x16x32_bf16 v[52:55], v[176:179], a[244:247], v[52:55]
 s_waitcnt lgkmcnt(0)
 v_exp_f32 v173, v173
 v_mfma_f32_16x16x32_bf16 v[56:59], v[176:179], a[248:251], v[56:59]
 v_exp_f32 v174, v174
 v_mfma_f32_16x16x32_bf16 v[60:63], v[176:179], a[252:255], v[60:63]
 v_exp_f32 v175, v175
 v_mfma_f32_16x16x32_bf16 v[164:167], a[220:223], a[60:63], v[152:155]
 v_exp_f32 v252, v252
 v_mfma_f32_16x16x32_bf16 v[164:167], a[216:219], a[56:59], v[164:167]
 v_cvt_pk_bf16_f32 v182, v172, v173
 v_cvt_pk_bf16_f32 v183, v174, v175
 v_mfma_f32_16x16x32_bf16 v[164:167], a[212:215], a[52:55], v[164:167]
 v_exp_f32 v253, v253
 v_mfma_f32_16x16x32_bf16 v[164:167], a[208:211], a[48:51], v[164:167]
 v_exp_f32 v254, v254
 v_smfmac_f32_16x16x64_bf16 v[128:131], v[236:239], v[176:183], v138
 v_cvt_pk_bf16_f32 v176, v252, v253
 v_mfma_f32_16x16x32_bf16 v[64:67], v[180:183], a[224:227], v[64:67]
 v_exp_f32 v255, v255
 v_mfma_f32_16x16x32_bf16 v[68:71], v[180:183], a[228:231], v[68:71]
 v_cvt_pk_bf16_f32 v177, v254, v255
 v_add_f32 v218, v132, v133
 v_mfma_f32_16x16x32_bf16 v[72:75], v[180:183], a[232:235], v[72:75]
 v_exp_f32 v164, v164
 v_mfma_f32_16x16x32_bf16 v[76:79], v[180:183], a[236:239], v[76:79]
 v_exp_f32 v165, v165
 v_mfma_f32_16x16x32_bf16 v[80:83], v[180:183], a[240:243], v[80:83]
 v_exp_f32 v166, v166
 v_mfma_f32_16x16x32_bf16 v[84:87], v[180:183], a[244:247], v[84:87]
 v_exp_f32 v167, v167
 v_mfma_f32_16x16x32_bf16 v[88:91], v[180:183], a[248:251], v[88:91]
 v_cvt_pk_bf16_f32 v178, v164, v165
 v_cvt_pk_bf16_f32 v179, v166, v167
 v_mfma_f32_16x16x32_bf16 v[92:95], v[180:183], a[252:255], v[92:95]
 v_mov_b32 v132, 0
 v_mov_b32 v133, 0
 v_mfma_f32_16x16x32_bf16 v[168:171], a[192:195], a[0:3], v[156:159]
 ds_read_b128 a[192:195], v249 offset:57344
 v_cmp_nge_f32 vcc, s28, v218
 v_mfma_f32_16x16x32_bf16 v[168:171], a[196:199], a[4:7], v[168:171]
 s_cmp_lg_u64 vcc, 0
 v_rcp_f32 v218, v218
 v_mfma_f32_16x16x32_bf16 v[168:171], a[200:203], a[8:11], v[168:171]
 s_cselect_b32 s34, 16384, 0
 ds_read_b128 a[196:199], v249 offset:57856
 ds_read_b128 a[200:203], v249 offset:58368
 v_mfma_f32_16x16x32_bf16 v[168:171], a[204:207], a[12:15], v[168:171]
 s_or_b32 s29, s29, s34
 s_add_u32 s33, s25, 57344
 ds_read_b128 a[204:207], v249 offset:58880
 v_mfma_f32_16x16x32_bf16 v[172:175], a[220:223], a[12:15], v[156:159]
 s_add_u32 s32, s25, 81920
 ds_read_b128 a[220:223], v249 offset:60928
 v_mov_b32_dpp v218, v218 row_shl:4 row_mask:0x2 bank_mask:0xf
 v_mfma_f32_16x16x32_bf16 v[172:175], a[216:219], a[8:11], v[172:175]
 v_exp_f32 v168, v168
 v_mfma_f32_16x16x32_bf16 v[172:175], a[212:215], a[4:7], v[172:175]
 v_exp_f32 v169, v169
 v_mfma_f32_16x16x32_bf16 v[172:175], a[208:211], a[0:3], v[172:175]
 ds_read_b128 a[216:219], v249 offset:60416
 ds_read_b128 a[212:215], v249 offset:59904
 v_mfma_f32_16x16x32_bf16 v[96:99], v[176:179], a[224:227], 0
 v_exp_f32 v170, v170
 v_mfma_f32_16x16x32_bf16 v[100:103], v[176:179], a[228:231], 0
 v_exp_f32 v171, v171
 v_mfma_f32_16x16x32_bf16 v[104:107], v[176:179], a[232:235], 0
 ds_read_b128 a[208:211], v249 offset:59392
 v_cvt_pk_bf16_f32 v180, v168, v169
 v_mfma_f32_16x16x32_bf16 v[108:111], v[176:179], a[236:239], 0
 v_exp_f32 v172, v172
 v_mfma_f32_16x16x32_bf16 v[112:115], v[176:179], a[240:243], 0
 v_exp_f32 v173, v173
 v_mfma_f32_16x16x32_bf16 v[116:119], v[176:179], a[244:247], 0
 v_exp_f32 v174, v174
 v_mfma_f32_16x16x32_bf16 v[120:123], v[176:179], a[248:251], 0
 v_exp_f32 v175, v175
 v_mfma_f32_16x16x32_bf16 v[124:127], v[176:179], a[252:255], 0
 s_waitcnt lgkmcnt(1)
 v_cvt_pk_bf16_f32 v181, v170, v171
 v_cvt_pk_bf16_f32 v182, v172, v173
 v_mfma_f32_16x16x32_bf16 v[160:163], a[192:195], a[16:19], v[144:147]
 v_cvt_pk_bf16_f32 v183, v174, v175
 v_mov_b32_dpp v218, v218 row_shl:8 row_mask:0x4 bank_mask:0xf
 v_mfma_f32_16x16x32_bf16 v[160:163], a[196:199], a[20:23], v[160:163]
 s_nop 1
 v_mfma_f32_16x16x32_bf16 v[160:163], a[200:203], a[24:27], v[160:163]
 v_mov_b32_dpp v218, v218 row_shl:12 row_mask:0x8 bank_mask:0xf
 s_nop 0
 v_mfma_f32_16x16x32_bf16 v[160:163], a[204:207], a[28:31], v[160:163]
 v_mul_f32_dpp v184, v218, v184 row_newbcast:0 row_mask:0xf bank_mask:0xf
 v_mul_f32_dpp v188, v218, v188 row_newbcast:0 row_mask:0xf bank_mask:0xf
 v_mfma_f32_16x16x32_bf16 v[164:167], a[220:223], a[28:31], v[144:147]
 v_cvt_pk_bf16_f32 v240, v184, v188
 v_mul_f32_dpp v192, v218, v192 row_newbcast:0 row_mask:0xf bank_mask:0xf
 v_mfma_f32_16x16x32_bf16 v[164:167], a[216:219], a[24:27], v[164:167]
 v_mul_f32_dpp v196, v218, v196 row_newbcast:0 row_mask:0xf bank_mask:0xf
 v_cvt_pk_bf16_f32 v241, v192, v196
 v_mfma_f32_16x16x32_bf16 v[164:167], a[212:215], a[20:23], v[164:167]
 s_waitcnt lgkmcnt(0)
 v_exp_f32 v160, v160
 v_mfma_f32_16x16x32_bf16 v[164:167], a[208:211], a[16:19], v[164:167]
 v_exp_f32 v161, v161
 v_smfmac_f32_16x16x64_bf16 v[132:135], v[236:239], v[176:183], v138
 v_cvt_pk_bf16_f32 v176, v160, v161
 v_mfma_f32_16x16x32_bf16 v[0:3], v[180:183], a[224:227], v[0:3]
 ds_read_b128 a[224:227], v248 offset:57344
 v_mul_f32_dpp v200, v218, v200 row_newbcast:0 row_mask:0xf bank_mask:0xf
 v_mfma_f32_16x16x32_bf16 v[4:7], v[180:183], a[228:231], v[4:7]
 ds_read_b128 a[228:231], v248 offset:57856
 v_mul_f32_dpp v204, v218, v204 row_newbcast:0 row_mask:0xf bank_mask:0xf
 v_mfma_f32_16x16x32_bf16 v[8:11], v[180:183], a[232:235], v[8:11]
 ds_read_b128 a[232:235], v248 offset:58368
 v_cvt_pk_bf16_f32 v242, v200, v204
 v_mfma_f32_16x16x32_bf16 v[12:15], v[180:183], a[236:239], v[12:15]
 v_exp_f32 v162, v162
 v_mfma_f32_16x16x32_bf16 v[16:19], v[180:183], a[240:243], v[16:19]
 v_exp_f32 v163, v163
 v_mfma_f32_16x16x32_bf16 v[20:23], v[180:183], a[244:247], v[20:23]
 v_exp_f32 v164, v164
 v_mfma_f32_16x16x32_bf16 v[24:27], v[180:183], a[248:251], v[24:27]
 v_exp_f32 v165, v165
 v_mfma_f32_16x16x32_bf16 v[28:31], v[180:183], a[252:255], v[28:31]
 v_exp_f32 v166, v166
 v_mfma_f32_16x16x32_bf16 v[168:171], a[192:195], a[32:35], v[148:151]
 ds_read_b128 a[236:239], v248 offset:58880
 ds_read_b128 a[240:243], v248 offset:59392
 v_mfma_f32_16x16x32_bf16 v[168:171], a[196:199], a[36:39], v[168:171]
 v_exp_f32 v167, v167
 v_mfma_f32_16x16x32_bf16 v[168:171], a[200:203], a[40:43], v[168:171]
 ds_read_b128 a[244:247], v248 offset:59904
 ds_read_b128 a[248:251], v248 offset:60416
 v_mfma_f32_16x16x32_bf16 v[168:171], a[204:207], a[44:47], v[168:171]
 v_cvt_pk_bf16_f32 v177, v162, v163
 v_cvt_pk_bf16_f32 v178, v164, v165
 v_mfma_f32_16x16x32_bf16 v[172:175], a[220:223], a[44:47], v[148:151]
 ds_read_b128 a[252:255], v248 offset:60928
 v_cvt_pk_bf16_f32 v179, v166, v167
 v_mfma_f32_16x16x32_bf16 v[172:175], a[216:219], a[40:43], v[172:175]
 v_mul_f32_dpp v208, v218, v208 row_newbcast:0 row_mask:0xf bank_mask:0xf
 v_mul_f32_dpp v212, v218, v212 row_newbcast:0 row_mask:0xf bank_mask:0xf
 v_mfma_f32_16x16x32_bf16 v[172:175], a[212:215], a[36:39], v[172:175]
 v_exp_f32 v168, v168
 v_mfma_f32_16x16x32_bf16 v[172:175], a[208:211], a[32:35], v[172:175]
 s_waitcnt lgkmcnt(3)
 v_exp_f32 v169, v169
 v_mfma_f32_16x16x32_bf16 v[32:35], v[176:179], a[224:227], v[32:35]
 v_exp_f32 v170, v170
 v_mfma_f32_16x16x32_bf16 v[36:39], v[176:179], a[228:231], v[36:39]
 v_exp_f32 v171, v171
 v_mfma_f32_16x16x32_bf16 v[40:43], v[176:179], a[232:235], v[40:43]
 v_cvt_pk_bf16_f32 v180, v168, v169
 v_cvt_pk_bf16_f32 v181, v170, v171
 v_mfma_f32_16x16x32_bf16 v[44:47], v[176:179], a[236:239], v[44:47]
 v_exp_f32 v172, v172
 v_mfma_f32_16x16x32_bf16 v[48:51], v[176:179], a[240:243], v[48:51]
 s_waitcnt lgkmcnt(0)
 v_exp_f32 v173, v173
 v_mfma_f32_16x16x32_bf16 v[52:55], v[176:179], a[244:247], v[52:55]
 v_exp_f32 v174, v174
 v_mfma_f32_16x16x32_bf16 v[56:59], v[176:179], a[248:251], v[56:59]
 v_exp_f32 v175, v175
 v_mfma_f32_16x16x32_bf16 v[60:63], v[176:179], a[252:255], v[60:63]
 v_cvt_pk_bf16_f32 v182, v172, v173
 v_cvt_pk_bf16_f32 v183, v174, v175
 v_mfma_f32_16x16x32_bf16 v[160:163], a[192:195], a[48:51], v[152:155]
 v_cvt_pk_bf16_f32 v243, v208, v212
 v_mul_f32_dpp v185, v218, v185 row_newbcast:1 row_mask:0xf bank_mask:0xf
 v_mfma_f32_16x16x32_bf16 v[160:163], a[196:199], a[52:55], v[160:163]
 buffer_store_dwordx4 v[240:243], v244, s[20:23], s33 offen offset:0 sc1
 v_mfma_f32_16x16x32_bf16 v[160:163], a[200:203], a[56:59], v[160:163]
 v_mul_f32_dpp v189, v218, v189 row_newbcast:1 row_mask:0xf bank_mask:0xf
 v_cvt_pk_bf16_f32 v240, v185, v189
 v_mfma_f32_16x16x32_bf16 v[160:163], a[204:207], a[60:63], v[160:163]
 v_mul_f32_dpp v193, v218, v193 row_newbcast:1 row_mask:0xf bank_mask:0xf
 v_mul_f32_dpp v197, v218, v197 row_newbcast:1 row_mask:0xf bank_mask:0xf
 v_mfma_f32_16x16x32_bf16 v[164:167], a[220:223], a[60:63], v[152:155]
 v_cvt_pk_bf16_f32 v241, v193, v197
 v_mul_f32_dpp v201, v218, v201 row_newbcast:1 row_mask:0xf bank_mask:0xf
 v_mfma_f32_16x16x32_bf16 v[164:167], a[216:219], a[56:59], v[164:167]
 v_mul_f32_dpp v205, v218, v205 row_newbcast:1 row_mask:0xf bank_mask:0xf
 v_cvt_pk_bf16_f32 v242, v201, v205
 v_mfma_f32_16x16x32_bf16 v[164:167], a[212:215], a[52:55], v[164:167]
 v_exp_f32 v160, v160
 v_mfma_f32_16x16x32_bf16 v[164:167], a[208:211], a[48:51], v[164:167]
 v_exp_f32 v161, v161
 v_smfmac_f32_16x16x64_bf16 v[128:131], v[236:239], v[176:183], v138
 v_cvt_pk_bf16_f32 v176, v160, v161
 v_mfma_f32_16x16x32_bf16 v[64:67], v[180:183], a[224:227], v[64:67]
 v_exp_f32 v162, v162
 v_mfma_f32_16x16x32_bf16 v[68:71], v[180:183], a[228:231], v[68:71]
 v_exp_f32 v163, v163
 v_mfma_f32_16x16x32_bf16 v[72:75], v[180:183], a[232:235], v[72:75]
 v_exp_f32 v164, v164
 v_mfma_f32_16x16x32_bf16 v[76:79], v[180:183], a[236:239], v[76:79]
 v_exp_f32 v165, v165
 v_mfma_f32_16x16x32_bf16 v[80:83], v[180:183], a[240:243], v[80:83]
 v_exp_f32 v166, v166
 v_mfma_f32_16x16x32_bf16 v[84:87], v[180:183], a[244:247], v[84:87]
 v_exp_f32 v167, v167
 v_mfma_f32_16x16x32_bf16 v[88:91], v[180:183], a[248:251], v[88:91]
 v_cvt_pk_bf16_f32 v177, v162, v163
 v_cvt_pk_bf16_f32 v178, v164, v165
 v_mfma_f32_16x16x32_bf16 v[92:95], v[180:183], a[252:255], v[92:95]
 v_cvt_pk_bf16_f32 v179, v166, v167
 v_mul_f32_dpp v209, v218, v209 row_newbcast:1 row_mask:0xf bank_mask:0xf
 v_mfma_f32_16x16x32_bf16 v[168:171], a[192:195], a[0:3], v[156:159]
 ds_read_b128 a[192:195], v250 offset:0
 v_mul_f32_dpp v213, v218, v213 row_newbcast:1 row_mask:0xf bank_mask:0xf
 v_mfma_f32_16x16x32_bf16 v[168:171], a[196:199], a[4:7], v[168:171]
 ds_read_b128 a[196:199], v250 offset:512
 v_cvt_pk_bf16_f32 v243, v209, v213
 v_mfma_f32_16x16x32_bf16 v[168:171], a[200:203], a[8:11], v[168:171]
 buffer_store_dwordx4 v[240:243], v244, s[20:23], s33 offen offset:1024 sc1
 v_mfma_f32_16x16x32_bf16 v[168:171], a[204:207], a[12:15], v[168:171]
 ds_read_b128 a[200:203], v250 offset:1024
 ds_read_b128 a[204:207], v250 offset:1536
 v_mfma_f32_16x16x32_bf16 v[172:175], a[220:223], a[12:15], v[156:159]
 ds_read_b128 a[220:223], v250 offset:3584
 v_mul_f32_dpp v186, v218, v186 row_newbcast:2 row_mask:0xf bank_mask:0xf
 v_mfma_f32_16x16x32_bf16 v[172:175], a[216:219], a[8:11], v[172:175]
 ds_read_b128 a[216:219], v250 offset:3072
 v_mul_f32_dpp v190, v218, v190 row_newbcast:2 row_mask:0xf bank_mask:0xf
 v_mfma_f32_16x16x32_bf16 v[172:175], a[212:215], a[4:7], v[172:175]
 ds_read_b128 a[212:215], v250 offset:2560
 v_cvt_pk_bf16_f32 v240, v186, v190
 v_mfma_f32_16x16x32_bf16 v[172:175], a[208:211], a[0:3], v[172:175]
 ds_read_b128 a[208:211], v250 offset:2048
 v_mul_f32_dpp v194, v218, v194 row_newbcast:2 row_mask:0xf bank_mask:0xf
 v_mfma_f32_16x16x32_bf16 v[96:99], v[176:179], a[224:227], v[96:99]
 v_exp_f32 v168, v168
 v_mfma_f32_16x16x32_bf16 v[100:103], v[176:179], a[228:231], v[100:103]
 v_exp_f32 v169, v169
 v_mfma_f32_16x16x32_bf16 v[104:107], v[176:179], a[232:235], v[104:107]
 v_exp_f32 v170, v170
 v_mfma_f32_16x16x32_bf16 v[108:111], v[176:179], a[236:239], v[108:111]
 v_exp_f32 v171, v171
 v_mfma_f32_16x16x32_bf16 v[112:115], v[176:179], a[240:243], v[112:115]
 v_exp_f32 v172, v172
 v_mfma_f32_16x16x32_bf16 v[116:119], v[176:179], a[244:247], v[116:119]
 v_exp_f32 v173, v173
 v_mfma_f32_16x16x32_bf16 v[120:123], v[176:179], a[248:251], v[120:123]
 v_exp_f32 v174, v174
 v_mfma_f32_16x16x32_bf16 v[124:127], v[176:179], a[252:255], v[124:127]
 s_waitcnt lgkmcnt(0)
 v_exp_f32 v175, v175
 v_mfma_f32_16x16x32_bf16 v[160:163], a[192:195], a[16:19], v[144:147]
 v_cvt_pk_bf16_f32 v180, v168, v169
 v_cvt_pk_bf16_f32 v181, v170, v171
 v_mfma_f32_16x16x32_bf16 v[160:163], a[196:199], a[20:23], v[160:163]
 v_cvt_pk_bf16_f32 v182, v172, v173
 v_cvt_pk_bf16_f32 v183, v174, v175
 v_mfma_f32_16x16x32_bf16 v[160:163], a[200:203], a[24:27], v[160:163]
 v_mul_f32_dpp v198, v218, v198 row_newbcast:2 row_mask:0xf bank_mask:0xf
 v_cvt_pk_bf16_f32 v241, v194, v198
 v_mfma_f32_16x16x32_bf16 v[160:163], a[204:207], a[28:31], v[160:163]
 v_mul_f32_dpp v202, v218, v202 row_newbcast:2 row_mask:0xf bank_mask:0xf
 v_mul_f32_dpp v206, v218, v206 row_newbcast:2 row_mask:0xf bank_mask:0xf
 v_mfma_f32_16x16x32_bf16 v[164:167], a[220:223], a[28:31], v[144:147]
 v_cvt_pk_bf16_f32 v242, v202, v206
 v_mul_f32_dpp v210, v218, v210 row_newbcast:2 row_mask:0xf bank_mask:0xf
 v_mfma_f32_16x16x32_bf16 v[164:167], a[216:219], a[24:27], v[164:167]
 v_mul_f32_dpp v214, v218, v214 row_newbcast:2 row_mask:0xf bank_mask:0xf
 v_cvt_pk_bf16_f32 v243, v210, v214
 v_mfma_f32_16x16x32_bf16 v[164:167], a[212:215], a[20:23], v[164:167]
 v_exp_f32 v160, v160
 v_mfma_f32_16x16x32_bf16 v[164:167], a[208:211], a[16:19], v[164:167]
 v_exp_f32 v161, v161
 v_smfmac_f32_16x16x64_bf16 v[132:135], v[236:239], v[176:183], v138
 v_cvt_pk_bf16_f32 v176, v160, v161
 v_mfma_f32_16x16x32_bf16 v[0:3], v[180:183], a[224:227], v[0:3]
 buffer_store_dwordx4 v[240:243], v244, s[20:23], s33 offen offset:2048 sc1
 v_mfma_f32_16x16x32_bf16 v[4:7], v[180:183], a[228:231], v[4:7]
 ds_read_b128 a[224:227], v249 offset:0
 ds_read_b128 a[228:231], v249 offset:512
 v_mfma_f32_16x16x32_bf16 v[8:11], v[180:183], a[232:235], v[8:11]
 ds_read_b128 a[232:235], v249 offset:1024
 v_mul_f32_dpp v187, v218, v187 row_newbcast:3 row_mask:0xf bank_mask:0xf
 v_mfma_f32_16x16x32_bf16 v[12:15], v[180:183], a[236:239], v[12:15]
 v_exp_f32 v162, v162
 v_mfma_f32_16x16x32_bf16 v[16:19], v[180:183], a[240:243], v[16:19]
 v_exp_f32 v163, v163
 v_mfma_f32_16x16x32_bf16 v[20:23], v[180:183], a[244:247], v[20:23]
 v_exp_f32 v164, v164
 v_mfma_f32_16x16x32_bf16 v[24:27], v[180:183], a[248:251], v[24:27]
 v_exp_f32 v165, v165
 v_mfma_f32_16x16x32_bf16 v[28:31], v[180:183], a[252:255], v[28:31]
 v_exp_f32 v166, v166
 v_mfma_f32_16x16x32_bf16 v[168:171], a[192:195], a[32:35], v[148:151]
 ds_read_b128 a[236:239], v249 offset:1536
 ds_read_b128 a[240:243], v249 offset:2048
 v_mfma_f32_16x16x32_bf16 v[168:171], a[196:199], a[36:39], v[168:171]
 v_exp_f32 v167, v167
 v_mfma_f32_16x16x32_bf16 v[168:171], a[200:203], a[40:43], v[168:171]
 ds_read_b128 a[244:247], v249 offset:2560
 ds_read_b128 a[248:251], v249 offset:3072
 v_mfma_f32_16x16x32_bf16 v[168:171], a[204:207], a[44:47], v[168:171]
 v_cvt_pk_bf16_f32 v177, v162, v163
 v_cvt_pk_bf16_f32 v178, v164, v165
 v_mfma_f32_16x16x32_bf16 v[172:175], a[220:223], a[44:47], v[148:151]
 ds_read_b128 a[252:255], v249 offset:3584
 v_cvt_pk_bf16_f32 v179, v166, v167
 v_mfma_f32_16x16x32_bf16 v[172:175], a[216:219], a[40:43], v[172:175]
 v_mul_f32_dpp v191, v218, v191 row_newbcast:3 row_mask:0xf bank_mask:0xf
 v_cvt_pk_bf16_f32 v240, v187, v191
 v_mfma_f32_16x16x32_bf16 v[172:175], a[212:215], a[36:39], v[172:175]
 v_exp_f32 v168, v168
 v_mfma_f32_16x16x32_bf16 v[172:175], a[208:211], a[32:35], v[172:175]
 s_waitcnt lgkmcnt(3)
 v_exp_f32 v169, v169
 v_mfma_f32_16x16x32_bf16 v[32:35], v[176:179], a[224:227], v[32:35]
 v_exp_f32 v170, v170
 v_mfma_f32_16x16x32_bf16 v[36:39], v[176:179], a[228:231], v[36:39]
 v_exp_f32 v171, v171
 v_mfma_f32_16x16x32_bf16 v[40:43], v[176:179], a[232:235], v[40:43]
 v_cvt_pk_bf16_f32 v180, v168, v169
 v_cvt_pk_bf16_f32 v181, v170, v171
 v_mfma_f32_16x16x32_bf16 v[44:47], v[176:179], a[236:239], v[44:47]
 v_exp_f32 v172, v172
 v_mfma_f32_16x16x32_bf16 v[48:51], v[176:179], a[240:243], v[48:51]
 s_waitcnt lgkmcnt(0)
 v_exp_f32 v173, v173
 v_mfma_f32_16x16x32_bf16 v[52:55], v[176:179], a[244:247], v[52:55]
 v_exp_f32 v174, v174
 v_mfma_f32_16x16x32_bf16 v[56:59], v[176:179], a[248:251], v[56:59]
 v_exp_f32 v175, v175
 v_mfma_f32_16x16x32_bf16 v[60:63], v[176:179], a[252:255], v[60:63]
 v_cvt_pk_bf16_f32 v182, v172, v173
 v_cvt_pk_bf16_f32 v183, v174, v175
 v_mfma_f32_16x16x32_bf16 v[160:163], a[192:195], a[48:51], v[152:155]
 v_mul_f32_dpp v195, v218, v195 row_newbcast:3 row_mask:0xf bank_mask:0xf
 v_mul_f32_dpp v199, v218, v199 row_newbcast:3 row_mask:0xf bank_mask:0xf
 v_mfma_f32_16x16x32_bf16 v[160:163], a[196:199], a[52:55], v[160:163]
 v_cvt_pk_bf16_f32 v241, v195, v199
 v_mul_f32_dpp v203, v218, v203 row_newbcast:3 row_mask:0xf bank_mask:0xf
 v_mfma_f32_16x16x32_bf16 v[160:163], a[200:203], a[56:59], v[160:163]
 v_mul_f32_dpp v207, v218, v207 row_newbcast:3 row_mask:0xf bank_mask:0xf
 v_cvt_pk_bf16_f32 v242, v203, v207
 v_mfma_f32_16x16x32_bf16 v[160:163], a[204:207], a[60:63], v[160:163]
 v_mul_f32_dpp v211, v218, v211 row_newbcast:3 row_mask:0xf bank_mask:0xf
 v_mul_f32_dpp v215, v218, v215 row_newbcast:3 row_mask:0xf bank_mask:0xf
 v_mfma_f32_16x16x32_bf16 v[164:167], a[220:223], a[60:63], v[152:155]
 v_cvt_pk_bf16_f32 v243, v211, v215
 s_nop 0
 v_mfma_f32_16x16x32_bf16 v[164:167], a[216:219], a[56:59], v[164:167]
 buffer_store_dwordx4 v[240:243], v244, s[20:23], s33 offen offset:3072 sc1
 v_mfma_f32_16x16x32_bf16 v[164:167], a[212:215], a[52:55], v[164:167]
 v_exp_f32 v160, v160
 v_mfma_f32_16x16x32_bf16 v[164:167], a[208:211], a[48:51], v[164:167]
 v_exp_f32 v161, v161
 v_smfmac_f32_16x16x64_bf16 v[128:131], v[236:239], v[176:183], v138
 v_cvt_pk_bf16_f32 v176, v160, v161
 v_mfma_f32_16x16x32_bf16 v[64:67], v[180:183], a[224:227], v[64:67]
 v_exp_f32 v162, v162
 v_mfma_f32_16x16x32_bf16 v[68:71], v[180:183], a[228:231], v[68:71]
 v_exp_f32 v163, v163
 v_mfma_f32_16x16x32_bf16 v[72:75], v[180:183], a[232:235], v[72:75]
 v_exp_f32 v164, v164
 v_mfma_f32_16x16x32_bf16 v[76:79], v[180:183], a[236:239], v[76:79]
 v_exp_f32 v165, v165
 v_mfma_f32_16x16x32_bf16 v[80:83], v[180:183], a[240:243], v[80:83]
 v_exp_f32 v166, v166
 v_mfma_f32_16x16x32_bf16 v[84:87], v[180:183], a[244:247], v[84:87]
 v_exp_f32 v167, v167
 v_mfma_f32_16x16x32_bf16 v[88:91], v[180:183], a[248:251], v[88:91]
 v_cvt_pk_bf16_f32 v177, v162, v163
 v_cvt_pk_bf16_f32 v178, v164, v165
 v_mfma_f32_16x16x32_bf16 v[92:95], v[180:183], a[252:255], v[92:95]
 v_cvt_pk_bf16_f32 v179, v166, v167
 v_mfma_f32_16x16x32_bf16 v[168:171], a[192:195], a[0:3], v[156:159]
 ds_read_b128 a[192:195], v250 offset:8192
 v_mfma_f32_16x16x32_bf16 v[168:171], a[196:199], a[4:7], v[168:171]
 ds_read_b128 a[196:199], v250 offset:8704
 v_mfma_f32_16x16x32_bf16 v[168:171], a[200:203], a[8:11], v[168:171]
 ds_read_b128 a[200:203], v250 offset:9216
 v_mfma_f32_16x16x32_bf16 v[168:171], a[204:207], a[12:15], v[168:171]
 ds_read_b128 a[204:207], v250 offset:9728
 s_nop 0
 v_mfma_f32_16x16x32_bf16 v[172:175], a[220:223], a[12:15], v[156:159]
L_pg15:
 s_cbranch_execz L_pg19
 buffer_load_dwordx4 a[12:15], v245, s[8:11], s32 offen offset:192
 v_mfma_f32_16x16x32_bf16 v[172:175], a[216:219], a[8:11], v[172:175]
 ds_read_b128 a[220:223], v250 offset:11776
 ds_read_b128 a[216:219], v250 offset:11264
 v_mfma_f32_16x16x32_bf16 v[172:175], a[212:215], a[4:7], v[172:175]
 v_exp_f32 v168, v168
 v_mfma_f32_16x16x32_bf16 v[172:175], a[208:211], a[0:3], v[172:175]
 v_exp_f32 v169, v169
 v_mfma_f32_16x16x32_bf16 v[96:99], v[176:179], a[224:227], v[96:99]
 buffer_load_dwordx4 a[0:3], v245, s[8:11], s32 offen offset:0
 v_mfma_f32_16x16x32_bf16 v[100:103], v[176:179], a[228:231], v[100:103]
 v_exp_f32 v170, v170
 v_mfma_f32_16x16x32_bf16 v[104:107], v[176:179], a[232:235], v[104:107]
 v_exp_f32 v171, v171
 v_mfma_f32_16x16x32_bf16 v[108:111], v[176:179], a[236:239], v[108:111]
 v_exp_f32 v173, v173
 v_mfma_f32_16x16x32_bf16 v[112:115], v[176:179], a[240:243], v[112:115]
 buffer_load_dwordx4 a[4:7], v245, s[8:11], s32 offen offset:64
 ds_read_b128 a[212:215], v250 offset:10752
 v_mfma_f32_16x16x32_bf16 v[116:119], v[176:179], a[244:247], v[116:119]
 ds_read_b128 a[208:211], v250 offset:10240
 v_exp_f32 v174, v174
 v_mfma_f32_16x16x32_bf16 v[120:123], v[176:179], a[248:251], v[120:123]
 v_exp_f32 v175, v175
 v_mfma_f32_16x16x32_bf16 v[124:127], v[176:179], a[252:255], v[124:127]
 s_waitcnt lgkmcnt(2)
 v_cvt_pk_bf16_f32 v180, v168, v169
 v_cvt_pk_bf16_f32 v181, v170, v171
 v_mfma_f32_16x16x32_bf16 v[160:163], a[192:195], a[16:19], v[144:147]
 buffer_load_dwordx4 a[8:11], v245, s[8:11], s32 offen offset:128
 v_mfma_f32_16x16x32_bf16 v[160:163], a[196:199], a[20:23], v[160:163]
 v_exp_f32 v172, v172
 v_mfma_f32_16x16x32_bf16 v[160:163], a[200:203], a[24:27], v[160:163]
 v_cvt_pk_bf16_f32 v182, v172, v173
 v_cvt_pk_bf16_f32 v183, v174, v175
 v_mfma_f32_16x16x32_bf16 v[160:163], a[204:207], a[28:31], v[160:163]
 s_nop 1
 v_mfma_f32_16x16x32_bf16 v[164:167], a[220:223], a[28:31], v[144:147]
 s_nop 1
 v_mfma_f32_16x16x32_bf16 v[164:167], a[216:219], a[24:27], v[164:167]
 s_waitcnt lgkmcnt(0)
 s_nop 1
 v_mfma_f32_16x16x32_bf16 v[164:167], a[212:215], a[20:23], v[164:167]
 v_exp_f32 v160, v160
 v_mfma_f32_16x16x32_bf16 v[164:167], a[208:211], a[16:19], v[164:167]
 v_exp_f32 v161, v161
 v_smfmac_f32_16x16x64_bf16 v[132:135], v[236:239], v[176:183], v138
 v_cvt_pk_bf16_f32 v176, v160, v161
 v_mfma_f32_16x16x32_bf16 v[0:3], v[180:183], a[224:227], v[0:3]
 v_exp_f32 v162, v162
 v_mfma_f32_16x16x32_bf16 v[4:7], v[180:183], a[228:231], v[4:7]
 v_exp_f32 v163, v163
 v_mfma_f32_16x16x32_bf16 v[8:11], v[180:183], a[232:235], v[8:11]
 ds_read_b128 a[232:235], v249 offset:9216
 ds_read_b128 a[224:227], v249 offset:8192
 v_mfma_f32_16x16x32_bf16 v[12:15], v[180:183], a[236:239], v[12:15]
 ds_read_b128 a[236:239], v249 offset:9728
 ds_read_b128 a[228:231], v249 offset:8704
 v_mfma_f32_16x16x32_bf16 v[16:19], v[180:183], a[240:243], v[16:19]
 ds_read_b128 a[240:243], v249 offset:10240
 v_cvt_pk_bf16_f32 v177, v162, v163
 v_mfma_f32_16x16x32_bf16 v[20:23], v[180:183], a[244:247], v[20:23]
 ds_read_b128 a[244:247], v249 offset:10752
 v_add_f32 v219, v134, v135
 v_mfma_f32_16x16x32_bf16 v[24:27], v[180:183], a[248:251], v[24:27]
 v_exp_f32 v164, v164
 v_mfma_f32_16x16x32_bf16 v[28:31], v[180:183], a[252:255], v[28:31]
 s_waitcnt vmcnt(8)
 v_exp_f32 v165, v165
 v_mfma_f32_16x16x32_bf16 v[252:255], a[192:195], v[220:223], 0
 v_exp_f32 v166, v166
 v_mfma_f32_16x16x32_bf16 v[252:255], a[196:199], v[224:227], v[252:255]
 v_exp_f32 v167, v167
 v_mfma_f32_16x16x32_bf16 v[252:255], a[200:203], v[228:231], v[252:255]
 ds_read_b128 a[248:251], v249 offset:11264
 v_cvt_pk_bf16_f32 v178, v164, v165
 v_mfma_f32_16x16x32_bf16 v[252:255], a[204:207], v[232:235], v[252:255]
 ds_read_b128 a[252:255], v249 offset:11776
 v_cvt_pk_bf16_f32 v179, v166, v167
 v_mfma_f32_16x16x32_bf16 v[168:171], a[192:195], a[32:35], v[148:151]
 v_mov_b32 v134, 0
 v_mov_b32 v135, 0
 v_mfma_f32_16x16x32_bf16 v[168:171], a[196:199], a[36:39], v[168:171]
 v_cmp_nge_f32 vcc, s28, v219
 s_nop 0
 v_mfma_f32_16x16x32_bf16 v[168:171], a[200:203], a[40:43], v[168:171]
 s_cmp_lg_u64 vcc, 0
 v_max3_f32 v246, v252, v253, v254
 v_max_f32 v246, v246, v255
 v_mfma_f32_16x16x32_bf16 v[168:171], a[204:207], a[44:47], v[168:171]
 s_cselect_b32 s34, 32768, 0
 v_rcp_f32 v219, v219
 v_mfma_f32_16x16x32_bf16 v[172:175], a[220:223], a[44:47], v[148:151]
 s_or_b32 s29, s29, s34
 v_mov_b32 v247, v246
 v_mov_b32_dpp v219, v219 row_shl:4 row_mask:0x2 bank_mask:0xf
 v_mfma_f32_16x16x32_bf16 v[172:175], a[216:219], a[40:43], v[172:175]
 s_add_u32 s33, s25, 61440
 v_permlane16_swap_b32 v246, v247
 v_max_f32 v246, v246, v247
 v_mfma_f32_16x16x32_bf16 v[172:175], a[212:215], a[36:39], v[172:175]
 s_add_u32 s32, s25, 86016
 v_exp_f32 v168, v168
 v_mfma_f32_16x16x32_bf16 v[172:175], a[208:211], a[32:35], v[172:175]
 s_waitcnt lgkmcnt(0)
 v_exp_f32 v169, v169
 v_mfma_f32_16x16x32_bf16 v[32:35], v[176:179], a[224:227], v[32:35]
 v_exp_f32 v170, v170
 v_mfma_f32_16x16x32_bf16 v[36:39], v[176:179], a[228:231], v[36:39]
 v_exp_f32 v171, v171
 v_mfma_f32_16x16x32_bf16 v[40:43], v[176:179], a[232:235], v[40:43]
 v_cvt_pk_bf16_f32 v180, v168, v169
 v_cvt_pk_bf16_f32 v181, v170, v171
 v_mfma_f32_16x16x32_bf16 v[44:47], v[176:179], a[236:239], v[44:47]
 v_exp_f32 v175, v175
 v_mfma_f32_16x16x32_bf16 v[48:51], v[176:179], a[240:243], v[48:51]
 v_exp_f32 v172, v172
 v_mfma_f32_16x16x32_bf16 v[52:55], v[176:179], a[244:247], v[52:55]
 v_exp_f32 v173, v173
 v_mfma_f32_16x16x32_bf16 v[56:59], v[176:179], a[248:251], v[56:59]
 v_cvt_pk_bf16_f32 v182, v172, v173
 v_mov_b32 v247, v246
 v_mfma_f32_16x16x32_bf16 v[60:63], v[176:179], a[252:255], v[60:63]
 v_exp_f32 v174, v174
 v_mfma_f32_16x16x32_bf16 v[160:163], a[192:195], a[48:51], v[152:155]
 v_cvt_pk_bf16_f32 v183, v174, v175
 v_permlane32_swap_b32 v246, v247
 v_mfma_f32_16x16x32_bf16 v[160:163], a[196:199], a[52:55], v[160:163]
 v_min_f32 v246, -v246, -v247
 v_mov_b32 v156, v246
 v_mfma_f32_16x16x32_bf16 v[160:163], a[200:203], a[56:59], v[160:163]
 v_mov_b32 v157, v246
 v_mov_b32 v158, v246
 v_mfma_f32_16x16x32_bf16 v[160:163], a[204:207], a[60:63], v[160:163]
 ds_read_b128 a[192:195], v250 offset:16384
 v_mov_b32 v159, v246
 v_mfma_f32_16x16x32_bf16 v[164:167], a[220:223], a[60:63], v[152:155]
 ds_read_b128 a[196:199], v250 offset:16896
 ds_read_b128 a[200:203], v250 offset:17408
 v_mfma_f32_16x16x32_bf16 v[164:167], a[216:219], a[56:59], v[164:167]
 ds_read_b128 a[204:207], v250 offset:17920
 v_add_f32 v252, v252, v246
 v_mfma_f32_16x16x32_bf16 v[164:167], a[212:215], a[52:55], v[164:167]
 v_exp_f32 v161, v161
 v_mfma_f32_16x16x32_bf16 v[164:167], a[208:211], a[48:51], v[164:167]
 v_exp_f32 v162, v162
 v_smfmac_f32_16x16x64_bf16 v[128:131], v[236:239], v[176:183], v138
 v_add_f32 v253, v253, v246
 v_mfma_f32_16x16x32_bf16 v[64:67], v[180:183], a[224:227], v[64:67]
 v_exp_f32 v163, v163
 v_mfma_f32_16x16x32_bf16 v[68:71], v[180:183], a[228:231], v[68:71]
 v_exp_f32 v160, v160
 v_mfma_f32_16x16x32_bf16 v[72:75], v[180:183], a[232:235], v[72:75]
 v_exp_f32 v164, v164
 v_mfma_f32_16x16x32_bf16 v[76:79], v[180:183], a[236:239], v[76:79]
 v_exp_f32 v165, v165
 v_mfma_f32_16x16x32_bf16 v[80:83], v[180:183], a[240:243], v[80:83]
 v_exp_f32 v166, v166
 v_mfma_f32_16x16x32_bf16 v[84:87], v[180:183], a[244:247], v[84:87]
 v_exp_f32 v167, v167
 v_mfma_f32_16x16x32_bf16 v[88:91], v[180:183], a[248:251], v[88:91]
 v_cvt_pk_bf16_f32 v176, v160, v161
 v_cvt_pk_bf16_f32 v177, v162, v163
 v_mfma_f32_16x16x32_bf16 v[92:95], v[180:183], a[252:255], v[92:95]
 v_cvt_pk_bf16_f32 v178, v164, v165
 v_cvt_pk_bf16_f32 v179, v166, v167
 v_mfma_f32_16x16x32_bf16 v[172:175], a[220:223], v[232:235], v[156:159]
 ds_read_b128 a[220:223], v250 offset:19968
 v_add_f32 v254, v254, v246
 v_mfma_f32_16x16x32_bf16 v[172:175], a[216:219], v[228:231], v[172:175]
 ds_read_b128 a[216:219], v250 offset:19456
 v_add_f32 v255, v255, v246
 v_mfma_f32_16x16x32_bf16 v[172:175], a[212:215], v[224:227], v[172:175]
 v_exp_f32 v252, v252
 v_mfma_f32_16x16x32_bf16 v[172:175], a[208:211], v[220:223], v[172:175]
 v_exp_f32 v253, v253
 v_mfma_f32_16x16x32_bf16 v[96:99], v[176:179], a[224:227], v[96:99]
 v_exp_f32 v254, v254
 v_mfma_f32_16x16x32_bf16 v[100:103], v[176:179], a[228:231], v[100:103]
 v_exp_f32 v255, v255
 v_mfma_f32_16x16x32_bf16 v[104:107], v[176:179], a[232:235], v[104:107]
 ds_read_b128 a[212:215], v250 offset:18944
 ds_read_b128 a[208:211], v250 offset:18432
 v_mfma_f32_16x16x32_bf16 v[108:111], v[176:179], a[236:239], v[108:111]
 v_exp_f32 v172, v172
 v_mfma_f32_16x16x32_bf16 v[112:115], v[176:179], a[240:243], v[112:115]
 v_exp_f32 v173, v173
 v_mfma_f32_16x16x32_bf16 v[116:119], v[176:179], a[244:247], v[116:119]
 v_exp_f32 v174, v174
 v_mfma_f32_16x16x32_bf16 v[120:123], v[176:179], a[248:251], v[120:123]
 v_exp_f32 v175, v175
 v_mfma_f32_16x16x32_bf16 v[124:127], v[176:179], a[252:255], v[124:127]
 s_waitcnt lgkmcnt(2)
 v_cvt_pk_bf16_f32 v180, v252, v253
 v_cvt_pk_bf16_f32 v181, v254, v255
 v_mfma_f32_16x16x32_bf16 v[160:163], a[192:195], a[16:19], v[144:147]
 v_cvt_pk_bf16_f32 v182, v172, v173
 v_cvt_pk_bf16_f32 v183, v174, v175
 v_mfma_f32_16x16x32_bf16 v[160:163], a[196:199], a[20:23], v[160:163]
 v_mov_b32_dpp v219, v219 row_shl:8 row_mask:0x4 bank_mask:0xf
 s_nop 0
 v_mfma_f32_16x16x32_bf16 v[160:163], a[200:203], a[24:27], v[160:163]
 v_mov_b32_dpp v219, v219 row_shl:12 row_mask:0x8 bank_mask:0xf
 s_nop 0
 v_mfma_f32_16x16x32_bf16 v[160:163], a[204:207], a[28:31], v[160:163]
 v_mul_f32_dpp v0, v219, v0 row_newbcast:0 row_mask:0xf bank_mask:0xf
 v_mul_f32_dpp v4, v219, v4 row_newbcast:0 row_mask:0xf bank_mask:0xf
 v_mfma_f32_16x16x32_bf16 v[164:167], a[220:223], a[28:31], v[144:147]
 v_cvt_pk_bf16_f32 v240, v0, v4
 v_mul_f32_dpp v8, v219, v8 row_newbcast:0 row_mask:0xf bank_mask:0xf
 v_mfma_f32_16x16x32_bf16 v[164:167], a[216:219], a[24:27], v[164:167]
 s_waitcnt lgkmcnt(0)
 v_mul_f32_dpp v12, v219, v12 row_newbcast:0 row_mask:0xf bank_mask:0xf
 v_cvt_pk_bf16_f32 v241, v8, v12
 v_mfma_f32_16x16x32_bf16 v[164:167], a[212:215], a[20:23], v[164:167]
 v_exp_f32 v160, v160
 v_mfma_f32_16x16x32_bf16 v[164:167], a[208:211], a[16:19], v[164:167]
 v_exp_f32 v161, v161
 v_smfmac_f32_16x16x64_bf16 v[132:135], v[236:239], v[176:183], v138
 v_cvt_pk_bf16_f32 v176, v160, v161
 v_mfma_f32_16x16x32_bf16 v[184:187], v[180:183], a[224:227], 0
 ds_read_b128 a[224:227], v249 offset:16384
 v_mul_f32_dpp v16, v219, v16 row_newbcast:0 row_mask:0xf bank_mask:0xf
 v_mfma_f32_16x16x32_bf16 v[188:191], v[180:183], a[228:231], 0
 ds_read_b128 a[228:231], v249 offset:16896
 v_mul_f32_dpp v20, v219, v20 row_newbcast:0 row_mask:0xf bank_mask:0xf
 v_mfma_f32_16x16x32_bf16 v[192:195], v[180:183], a[232:235], 0
 ds_read_b128 a[232:235], v249 offset:17408
 v_cvt_pk_bf16_f32 v242, v16, v20
 v_mfma_f32_16x16x32_bf16 v[196:199], v[180:183], a[236:239], 0
 v_exp_f32 v162, v162
 v_mfma_f32_16x16x32_bf16 v[200:203], v[180:183], a[240:243], 0
 v_exp_f32 v163, v163
 v_mfma_f32_16x16x32_bf16 v[204:207], v[180:183], a[244:247], 0
 v_exp_f32 v164, v164
 v_mfma_f32_16x16x32_bf16 v[208:211], v[180:183], a[248:251], 0
 v_exp_f32 v165, v165
 v_mfma_f32_16x16x32_bf16 v[212:215], v[180:183], a[252:255], 0
 v_exp_f32 v166, v166
 v_mfma_f32_16x16x32_bf16 v[168:171], a[192:195], a[32:35], v[148:151]
 ds_read_b128 a[236:239], v249 offset:17920
 ds_read_b128 a[240:243], v249 offset:18432
 v_mfma_f32_16x16x32_bf16 v[168:171], a[196:199], a[36:39], v[168:171]
 v_exp_f32 v167, v167
 v_mfma_f32_16x16x32_bf16 v[168:171], a[200:203], a[40:43], v[168:171]
 ds_read_b128 a[244:247], v249 offset:18944
 ds_read_b128 a[248:251], v249 offset:19456
 v_mfma_f32_16x16x32_bf16 v[168:171], a[204:207], a[44:47], v[168:171]
 v_cvt_pk_bf16_f32 v177, v162, v163
 v_cvt_pk_bf16_f32 v178, v164, v165
 v_mfma_f32_16x16x32_bf16 v[172:175], a[220:223], a[44:47], v[148:151]
 ds_read_b128 a[252:255], v249 offset:19968
 v_cvt_pk_bf16_f32 v179, v166, v167
 v_mfma_f32_16x16x32_bf16 v[172:175], a[216:219], a[40:43], v[172:175]
 v_mul_f32_dpp v24, v219, v24 row_newbcast:0 row_mask:0xf bank_mask:0xf
 v_mul_f32_dpp v28, v219, v28 row_newbcast:0 row_mask:0xf bank_mask:0xf
 v_mfma_f32_16x16x32_bf16 v[172:175], a[212:215], a[36:39], v[172:175]
 v_exp_f32 v168, v168
 v_mfma_f32_16x16x32_bf16 v[172:175], a[208:211], a[32:35], v[172:175]
 s_waitcnt lgkmcnt(3)
 v_exp_f32 v169, v169
 v_mfma_f32_16x16x32_bf16 v[32:35], v[176:179], a[224:227], v[32:35]
 v_exp_f32 v170, v170
 v_mfma_f32_16x16x32_bf16 v[36:39], v[176:179], a[228:231], v[36:39]
 v_exp_f32 v171, v171
 v_mfma_f32_16x16x32_bf16 v[40:43], v[176:179], a[232:235], v[40:43]
 v_cvt_pk_bf16_f32 v180, v168, v169
 v_cvt_pk_bf16_f32 v181, v170, v171
 v_mfma_f32_16x16x32_bf16 v[44:47], v[176:179], a[236:239], v[44:47]
 v_exp_f32 v172, v172
 v_mfma_f32_16x16x32_bf16 v[48:51], v[176:179], a[240:243], v[48:51]
 s_waitcnt lgkmcnt(0)
 v_exp_f32 v173, v173
 v_mfma_f32_16x16x32_bf16 v[52:55], v[176:179], a[244:247], v[52:55]
 v_exp_f32 v174, v174
 v_mfma_f32_16x16x32_bf16 v[56:59], v[176:179], a[248:251], v[56:59]
 v_exp_f32 v175, v175
 v_mfma_f32_16x16x32_bf16 v[60:63], v[176:179], a[252:255], v[60:63]
 v_cvt_pk_bf16_f32 v182, v172, v173
 v_cvt_pk_bf16_f32 v183, v174, v175
 v_mfma_f32_16x16x32_bf16 v[160:163], a[192:195], a[48:51], v[152:155]
 v_cvt_pk_bf16_f32 v243, v24, v28
 v_mul_f32_dpp v1, v219, v1 row_newbcast:1 row_mask:0xf bank_mask:0xf
 v_mfma_f32_16x16x32_bf16 v[160:163], a[196:199], a[52:55], v[160:163]
 buffer_store_dwordx4 v[240:243], v244, s[20:23], s33 offen offset:0 sc1
 v_mfma_f32_16x16x32_bf16 v[160:163], a[200:203], a[56:59], v[160:163]
 v_mul_f32_dpp v5, v219, v5 row_newbcast:1 row_mask:0xf bank_mask:0xf
 v_cvt_pk_bf16_f32 v240, v1, v5
 v_mfma_f32_16x16x32_bf16 v[160:163], a[204:207], a[60:63], v[160:163]
 v_mul_f32_dpp v9, v219, v9 row_newbcast:1 row_mask:0xf bank_mask:0xf
 v_mul_f32_dpp v13, v219, v13 row_newbcast:1 row_mask:0xf bank_mask:0xf
 v_mfma_f32_16x16x32_bf16 v[164:167], a[220:223], a[60:63], v[152:155]
 v_cvt_pk_bf16_f32 v241, v9, v13
 v_mul_f32_dpp v17, v219, v17 row_newbcast:1 row_mask:0xf bank_mask:0xf
 v_mfma_f32_16x16x32_bf16 v[164:167], a[216:219], a[56:59], v[164:167]
 v_mul_f32_dpp v21, v219, v21 row_newbcast:1 row_mask:0xf bank_mask:0xf
 v_cvt_pk_bf16_f32 v242, v17, v21
 v_mfma_f32_16x16x32_bf16 v[164:167], a[212:215], a[52:55], v[164:167]
 v_exp_f32 v160, v160
 v_mfma_f32_16x16x32_bf16 v[164:167], a[208:211], a[48:51], v[164:167]
 v_exp_f32 v161, v161
 v_smfmac_f32_16x16x64_bf16 v[128:131], v[236:239], v[176:183], v138
 v_cvt_pk_bf16_f32 v176, v160, v161
 v_mfma_f32_16x16x32_bf16 v[64:67], v[180:183], a[224:227], v[64:67]
 v_exp_f32 v162, v162
 v_mfma_f32_16x16x32_bf16 v[68:71], v[180:183], a[228:231], v[68:71]
 v_exp_f32 v163, v163
 v_mfma_f32_16x16x32_bf16 v[72:75], v[180:183], a[232:235], v[72:75]
 v_exp_f32 v164, v164
 v_mfma_f32_16x16x32_bf16 v[76:79], v[180:183], a[236:239], v[76:79]
 v_exp_f32 v165, v165
 v_mfma_f32_16x16x32_bf16 v[80:83], v[180:183], a[240:243], v[80:83]
 v_exp_f32 v166, v166
 v_mfma_f32_16x16x32_bf16 v[84:87], v[180:183], a[244:247], v[84:87]
 v_exp_f32 v167, v167
 v_mfma_f32_16x16x32_bf16 v[88:91], v[180:183], a[248:251], v[88:91]
 v_cvt_pk_bf16_f32 v177, v162, v163
 v_cvt_pk_bf16_f32 v178, v164, v165
 v_mfma_f32_16x16x32_bf16 v[92:95], v[180:183], a[252:255], v[92:95]
 v_cvt_pk_bf16_f32 v179, v166, v167
 v_mul_f32_dpp v25, v219, v25 row_newbcast:1 row_mask:0xf bank_mask:0xf
 v_mfma_f32_16x16x32_bf16 v[168:171], a[192:195], v[220:223], v[156:159]
 ds_read_b128 a[192:195], v250 offset:24576
 v_mul_f32_dpp v29, v219, v29 row_newbcast:1 row_mask:0xf bank_mask:0xf
 v_mfma_f32_16x16x32_bf16 v[168:171], a[196:199], v[224:227], v[168:171]
 ds_read_b128 a[196:199], v250 offset:25088
 v_cvt_pk_bf16_f32 v243, v25, v29
 v_mfma_f32_16x16x32_bf16 v[168:171], a[200:203], v[228:231], v[168:171]
 buffer_store_dwordx4 v[240:243], v244, s[20:23], s33 offen offset:1024 sc1
 v_mfma_f32_16x16x32_bf16 v[168:171], a[204:207], v[232:235], v[168:171]
 ds_read_b128 a[200:203], v250 offset:25600
 ds_read_b128 a[204:207], v250 offset:26112
 v_mfma_f32_16x16x32_bf16 v[172:175], a[220:223], v[232:235], v[156:159]
 ds_read_b128 a[220:223], v250 offset:28160
 v_mul_f32_dpp v2, v219, v2 row_newbcast:2 row_mask:0xf bank_mask:0xf
 v_mfma_f32_16x16x32_bf16 v[172:175], a[216:219], v[228:231], v[172:175]
 ds_read_b128 a[216:219], v250 offset:27648
 v_mul_f32_dpp v6, v219, v6 row_newbcast:2 row_mask:0xf bank_mask:0xf
 v_mfma_f32_16x16x32_bf16 v[172:175], a[212:215], v[224:227], v[172:175]
 ds_read_b128 a[212:215], v250 offset:27136
 v_cvt_pk_bf16_f32 v240, v2, v6
 v_mfma_f32_16x16x32_bf16 v[172:175], a[208:211], v[220:223], v[172:175]
 ds_read_b128 a[208:211], v250 offset:26624
 v_mul_f32_dpp v10, v219, v10 row_newbcast:2 row_mask:0xf bank_mask:0xf
 v_mfma_f32_16x16x32_bf16 v[96:99], v[176:179], a[224:227], v[96:99]
 v_exp_f32 v168, v168
 v_mfma_f32_16x16x32_bf16 v[100:103], v[176:179], a[228:231], v[100:103]
 v_exp_f32 v169, v169
 v_mfma_f32_16x16x32_bf16 v[104:107], v[176:179], a[232:235], v[104:107]
 v_exp_f32 v170, v170
 v_mfma_f32_16x16x32_bf16 v[108:111], v[176:179], a[236:239], v[108:111]
 v_exp_f32 v171, v171
 v_mfma_f32_16x16x32_bf16 v[112:115], v[176:179], a[240:243], v[112:115]
 v_exp_f32 v172, v172
 v_mfma_f32_16x16x32_bf16 v[116:119], v[176:179], a[244:247], v[116:119]
 v_exp_f32 v173, v173
 v_mfma_f32_16x16x32_bf16 v[120:123], v[176:179], a[248:251], v[120:123]
 v_exp_f32 v174, v174
 v_mfma_f32_16x16x32_bf16 v[124:127], v[176:179], a[252:255], v[124:127]
 s_waitcnt lgkmcnt(0)
 v_exp_f32 v175, v175
 v_mfma_f32_16x16x32_bf16 v[160:163], a[192:195], a[16:19], v[144:147]
 v_cvt_pk_bf16_f32 v180, v168, v169
 v_cvt_pk_bf16_f32 v181, v170, v171
 v_mfma_f32_16x16x32_bf16 v[160:163], a[196:199], a[20:23], v[160:163]
 v_cvt_pk_bf16_f32 v182, v172, v173
 v_cvt_pk_bf16_f32 v183, v174, v175
 v_mfma_f32_16x16x32_bf16 v[160:163], a[200:203], a[24:27], v[160:163]
 v_mul_f32_dpp v14, v219, v14 row_newbcast:2 row_mask:0xf bank_mask:0xf
 v_cvt_pk_bf16_f32 v241, v10, v14
 v_mfma_f32_16x16x32_bf16 v[160:163], a[204:207], a[28:31], v[160:163]
 v_mul_f32_dpp v18, v219, v18 row_newbcast:2 row_mask:0xf bank_mask:0xf
 v_mul_f32_dpp v22, v219, v22 row_newbcast:2 row_mask:0xf bank_mask:0xf
 v_mfma_f32_16x16x32_bf16 v[164:167], a[220:223], a[28:31], v[144:147]
 buffer_load_dwordx4 a[28:31], v245, s[8:11], s32 offen offset:192
 v_mfma_f32_16x16x32_bf16 v[164:167], a[216:219], a[24:27], v[164:167]
 v_cvt_pk_bf16_f32 v242, v18, v22
 v_mul_f32_dpp v26, v219, v26 row_newbcast:2 row_mask:0xf bank_mask:0xf
 v_mfma_f32_16x16x32_bf16 v[164:167], a[212:215], a[20:23], v[164:167]
 v_exp_f32 v160, v160
 v_mfma_f32_16x16x32_bf16 v[164:167], a[208:211], a[16:19], v[164:167]
 v_exp_f32 v161, v161
 v_smfmac_f32_16x16x64_bf16 v[132:135], v[236:239], v[176:183], v138
 v_cvt_pk_bf16_f32 v176, v160, v161
 v_mfma_f32_16x16x32_bf16 v[184:187], v[180:183], a[224:227], v[184:187]
 buffer_load_dwordx4 a[16:19], v245, s[8:11], s32 offen offset:0
 v_mfma_f32_16x16x32_bf16 v[188:191], v[180:183], a[228:231], v[188:191]
 v_exp_f32 v162, v162
 v_mfma_f32_16x16x32_bf16 v[192:195], v[180:183], a[232:235], v[192:195]
 v_exp_f32 v163, v163
 v_mfma_f32_16x16x32_bf16 v[196:199], v[180:183], a[236:239], v[196:199]
 v_exp_f32 v164, v164
 v_mfma_f32_16x16x32_bf16 v[200:203], v[180:183], a[240:243], v[200:203]
 buffer_load_dwordx4 a[20:23], v245, s[8:11], s32 offen offset:64
 v_mfma_f32_16x16x32_bf16 v[204:207], v[180:183], a[244:247], v[204:207]
 v_exp_f32 v165, v165
 v_mfma_f32_16x16x32_bf16 v[208:211], v[180:183], a[248:251], v[208:211]
 ds_read_b128 a[224:227], v249 offset:24576
 v_exp_f32 v166, v166
 v_mfma_f32_16x16x32_bf16 v[212:215], v[180:183], a[252:255], v[212:215]
 ds_read_b128 a[228:231], v249 offset:25088
 v_exp_f32 v167, v167
 v_mfma_f32_16x16x32_bf16 v[168:171], a[192:195], a[32:35], v[148:151]
 buffer_load_dwordx4 a[24:27], v245, s[8:11], s32 offen offset:128
 ds_read_b128 a[232:235], v249 offset:25600
 v_mfma_f32_16x16x32_bf16 v[168:171], a[196:199], a[36:39], v[168:171]
 ds_read_b128 a[248:251], v249 offset:27648
 ds_read_b128 a[236:239], v249 offset:26112
 v_cvt_pk_bf16_f32 v177, v162, v163
 v_mfma_f32_16x16x32_bf16 v[168:171], a[200:203], a[40:43], v[168:171]
 ds_read_b128 a[240:243], v249 offset:26624
 v_cvt_pk_bf16_f32 v178, v164, v165
 v_cvt_pk_bf16_f32 v179, v166, v167
 v_mfma_f32_16x16x32_bf16 v[168:171], a[204:207], a[44:47], v[168:171]
 ds_read_b128 a[244:247], v249 offset:27136
 ds_read_b128 a[252:255], v249 offset:28160
 v_mfma_f32_16x16x32_bf16 v[172:175], a[220:223], a[44:47], v[148:151]
 v_mul_f32_dpp v30, v219, v30 row_newbcast:2 row_mask:0xf bank_mask:0xf
 v_cvt_pk_bf16_f32 v243, v26, v30
 v_mfma_f32_16x16x32_bf16 v[172:175], a[216:219], a[40:43], v[172:175]
 buffer_store_dwordx4 v[240:243], v244, s[20:23], s33 offen offset:2048 sc1
 v_mfma_f32_16x16x32_bf16 v[172:175], a[212:215], a[36:39], v[172:175]
 v_exp_f32 v168, v168
 v_mfma_f32_16x16x32_bf16 v[172:175], a[208:211], a[32:35], v[172:175]
 s_waitcnt lgkmcnt(5)
 v_exp_f32 v169, v169
 v_mfma_f32_16x16x32_bf16 v[32:35], v[176:179], a[224:227], v[32:35]
 v_exp_f32 v170, v170
 v_mfma_f32_16x16x32_bf16 v[36:39], v[176:179], a[228:231], v[36:39]
 v_exp_f32 v171, v171
 v_mfma_f32_16x16x32_bf16 v[40:43], v[176:179], a[232:235], v[40:43]
 s_waitcnt lgkmcnt(0)
 v_cvt_pk_bf16_f32 v180, v168, v169
 v_cvt_pk_bf16_f32 v181, v170, v171
 v_mfma_f32_16x16x32_bf16 v[44:47], v[176:179], a[236:239], v[44:47]
 v_exp_f32 v172, v172
 v_mfma_f32_16x16x32_bf16 v[48:51], v[176:179], a[240:243], v[48:51]
 v_exp_f32 v173, v173
 v_mfma_f32_16x16x32_bf16 v[52:55], v[176:179], a[244:247], v[52:55]
 v_exp_f32 v174, v174
 v_mfma_f32_16x16x32_bf16 v[56:59], v[176:179], a[248:251], v[56:59]
 v_exp_f32 v175, v175
 v_mfma_f32_16x16x32_bf16 v[60:63], v[176:179], a[252:255], v[60:63]
 s_waitcnt vmcnt(7)
 v_cvt_pk_bf16_f32 v182, v172, v173
 v_cvt_pk_bf16_f32 v183, v174, v175
 v_mfma_f32_16x16x32_bf16 v[252:255], a[64:67], a[0:3], 0
 v_mul_f32_dpp v3, v219, v3 row_newbcast:3 row_mask:0xf bank_mask:0xf
 v_mul_f32_dpp v7, v219, v7 row_newbcast:3 row_mask:0xf bank_mask:0xf
 v_mfma_f32_16x16x32_bf16 v[252:255], a[68:71], a[4:7], v[252:255]
 v_cvt_pk_bf16_f32 v240, v3, v7
 v_mul_f32_dpp v11, v219, v11 row_newbcast:3 row_mask:0xf bank_mask:0xf
 v_mfma_f32_16x16x32_bf16 v[252:255], a[72:75], a[8:11], v[252:255]
 v_mul_f32_dpp v15, v219, v15 row_newbcast:3 row_mask:0xf bank_mask:0xf
 v_cvt_pk_bf16_f32 v241, v11, v15
 v_mfma_f32_16x16x32_bf16 v[252:255], a[76:79], a[12:15], v[252:255]
 v_mul_f32_dpp v19, v219, v19 row_newbcast:3 row_mask:0xf bank_mask:0xf
 v_mul_f32_dpp v23, v219, v23 row_newbcast:3 row_mask:0xf bank_mask:0xf
 v_mfma_f32_16x16x32_bf16 v[160:163], a[192:195], a[48:51], v[152:155]
 v_cvt_pk_bf16_f32 v242, v19, v23
 v_mul_f32_dpp v27, v219, v27 row_newbcast:3 row_mask:0xf bank_mask:0xf
 v_mfma_f32_16x16x32_bf16 v[160:163], a[196:199], a[52:55], v[160:163]
 v_mul_f32_dpp v31, v219, v31 row_newbcast:3 row_mask:0xf bank_mask:0xf
 v_cvt_pk_bf16_f32 v243, v27, v31
 v_mfma_f32_16x16x32_bf16 v[160:163], a[200:203], a[56:59], v[160:163]
 buffer_store_dwordx4 v[240:243], v244, s[20:23], s33 offen offset:3072 sc1
 v_mfma_f32_16x16x32_bf16 v[160:163], a[204:207], a[60:63], v[160:163]
 v_max3_f32 v246, v252, v253, v254
 v_max_f32 v246, v246, v255
 v_mfma_f32_16x16x32_bf16 v[164:167], a[220:223], a[60:63], v[152:155]
 v_mov_b32 v247, v246
 s_nop 0
 v_mfma_f32_16x16x32_bf16 v[164:167], a[216:219], a[56:59], v[164:167]
 v_permlane16_swap_b32 v246, v247
 v_max_f32 v246, v246, v247
 v_mfma_f32_16x16x32_bf16 v[164:167], a[212:215], a[52:55], v[164:167]
 v_exp_f32 v160, v160
 v_mfma_f32_16x16x32_bf16 v[164:167], a[208:211], a[48:51], v[164:167]
 v_exp_f32 v161, v161
 v_smfmac_f32_16x16x64_bf16 v[128:131], v[236:239], v[176:183], v138
 v_cvt_pk_bf16_f32 v176, v160, v161
 v_mfma_f32_16x16x32_bf16 v[64:67], v[180:183], a[224:227], v[64:67]
 v_exp_f32 v162, v162
 v_mfma_f32_16x16x32_bf16 v[68:71], v[180:183], a[228:231], v[68:71]
 v_exp_f32 v163, v163
 v_mfma_f32_16x16x32_bf16 v[72:75], v[180:183], a[232:235], v[72:75]
 v_exp_f32 v166, v166
 v_mfma_f32_16x16x32_bf16 v[76:79], v[180:183], a[236:239], v[76:79]
 v_exp_f32 v167, v167
 v_mfma_f32_16x16x32_bf16 v[80:83], v[180:183], a[240:243], v[80:83]
 v_cvt_pk_bf16_f32 v177, v162, v163
 v_cvt_pk_bf16_f32 v179, v166, v167
 v_mfma_f32_16x16x32_bf16 v[84:87], v[180:183], a[244:247], v[84:87]
 v_exp_f32 v164, v164
 v_mfma_f32_16x16x32_bf16 v[88:91], v[180:183], a[248:251], v[88:91]
 v_exp_f32 v165, v165
 v_mfma_f32_16x16x32_bf16 v[92:95], v[180:183], a[252:255], v[92:95]
 v_cvt_pk_bf16_f32 v178, v164, v165
 v_mov_b32 v247, v246
 v_mfma_f32_16x16x32_bf16 v[168:171], a[192:195], v[220:223], v[156:159]
 v_add_f32 v216, v128, v129
 v_permlane32_swap_b32 v246, v247
 v_mfma_f32_16x16x32_bf16 v[168:171], a[196:199], v[224:227], v[168:171]
 v_min_f32 v246, -v246, -v247
 v_mov_b32 v144, v246
 v_mfma_f32_16x16x32_bf16 v[168:171], a[200:203], v[228:231], v[168:171]
 v_mov_b32 v145, v246
 v_mov_b32 v146, v246
 v_mfma_f32_16x16x32_bf16 v[168:171], a[204:207], v[232:235], v[168:171]
 v_mov_b32 v147, v246
 v_add_f32 v252, v252, v246
 v_mfma_f32_16x16x32_bf16 v[172:175], a[220:223], v[232:235], v[156:159]
 v_add_f32 v253, v253, v246
 v_add_f32 v254, v254, v246
 v_mfma_f32_16x16x32_bf16 v[172:175], a[216:219], v[228:231], v[172:175]
 v_exp_f32 v252, v252
 v_mfma_f32_16x16x32_bf16 v[172:175], a[212:215], v[224:227], v[172:175]
 v_exp_f32 v170, v170
 v_mfma_f32_16x16x32_bf16 v[172:175], a[208:211], v[220:223], v[172:175]
 v_exp_f32 v168, v168
 v_mfma_f32_16x16x32_bf16 v[96:99], v[176:179], a[224:227], v[96:99]
 v_exp_f32 v169, v169
 v_mfma_f32_16x16x32_bf16 v[100:103], v[176:179], a[228:231], v[100:103]
 v_exp_f32 v171, v171
 v_mfma_f32_16x16x32_bf16 v[104:107], v[176:179], a[232:235], v[104:107]
 v_cvt_pk_bf16_f32 v180, v168, v169
 v_cvt_pk_bf16_f32 v181, v170, v171
 v_mfma_f32_16x16x32_bf16 v[108:111], v[176:179], a[236:239], v[108:111]
 v_exp_f32 v174, v174
 v_mfma_f32_16x16x32_bf16 v[112:115], v[176:179], a[240:243], v[112:115]
 v_exp_f32 v175, v175
 v_mfma_f32_16x16x32_bf16 v[116:119], v[176:179], a[244:247], v[116:119]
 v_cvt_pk_bf16_f32 v183, v174, v175
 v_add_f32 v255, v255, v246
 v_mfma_f32_16x16x32_bf16 v[120:123], v[176:179], a[248:251], v[120:123]
 v_exp_f32 v172, v172
 v_mfma_f32_16x16x32_bf16 v[124:127], v[176:179], a[252:255], v[124:127]
 v_exp_f32 v173, v173
 v_mfma_f32_16x16x32_bf16 v[164:167], a[92:95], a[12:15], v[144:147]
 v_cvt_pk_bf16_f32 v182, v172, v173
 v_mov_b32 v128, 0
 v_mfma_f32_16x16x32_bf16 v[164:167], a[88:91], a[8:11], v[164:167]
 v_exp_f32 v253, v253
 v_mfma_f32_16x16x32_bf16 v[164:167], a[84:87], a[4:7], v[164:167]
 v_exp_f32 v254, v254
 v_mfma_f32_16x16x32_bf16 v[164:167], a[80:83], a[0:3], v[164:167]
 v_exp_f32 v255, v255
 v_smfmac_f32_16x16x64_bf16 v[132:135], v[236:239], v[176:183], v138
 v_cvt_pk_bf16_f32 v176, v252, v253
 v_mfma_f32_16x16x32_bf16 v[184:187], v[180:183], a[224:227], v[184:187]
 ds_read_b128 a[224:227], v248 offset:0
 v_cvt_pk_bf16_f32 v177, v254, v255
 v_mfma_f32_16x16x32_bf16 v[188:191], v[180:183], a[228:231], v[188:191]
 ds_read_b128 a[228:231], v248 offset:512
 v_mov_b32 v129, 0
 v_mfma_f32_16x16x32_bf16 v[192:195], v[180:183], a[232:235], v[192:195]
 v_exp_f32 v164, v164
 v_mfma_f32_16x16x32_bf16 v[196:199], v[180:183], a[236:239], v[196:199]
 v_exp_f32 v165, v165
 v_mfma_f32_16x16x32_bf16 v[200:203], v[180:183], a[240:243], v[200:203]
 v_exp_f32 v166, v166
 v_mfma_f32_16x16x32_bf16 v[204:207], v[180:183], a[244:247], v[204:207]
 v_exp_f32 v167, v167
 v_mfma_f32_16x16x32_bf16 v[208:211], v[180:183], a[248:251], v[208:211]
 v_cvt_pk_bf16_f32 v178, v164, v165
 v_cvt_pk_bf16_f32 v179, v166, v167
 v_mfma_f32_16x16x32_bf16 v[212:215], v[180:183], a[252:255], v[212:215]
 ds_read_b128 a[232:235], v248 offset:1024
 ds_read_b128 a[236:239], v248 offset:1536
 v_mfma_f32_16x16x32_bf16 v[168:171], a[64:67], a[32:35], v[148:151]
 ds_read_b128 a[240:243], v248 offset:2048
 ds_read_b128 a[244:247], v248 offset:2560
 v_mfma_f32_16x16x32_bf16 v[168:171], a[68:71], a[36:39], v[168:171]
 ds_read_b128 a[248:251], v248 offset:3072
 ds_read_b128 a[252:255], v248 offset:3584
 v_mfma_f32_16x16x32_bf16 v[168:171], a[72:75], a[40:43], v[168:171]
 ds_read_b128 a[192:195], v249 offset:32768
 v_cmp_nge_f32 vcc, s28, v216
 v_mfma_f32_16x16x32_bf16 v[168:171], a[76:79], a[44:47], v[168:171]
 s_cmp_lg_u64 vcc, 0
 v_rcp_f32 v216, v216
 v_mfma_f32_16x16x32_bf16 v[172:175], a[92:95], a[44:47], v[148:151]
 s_cselect_b32 s34, 65536, 0
 s_or_b32 s29, s29, s34
 v_mov_b32_dpp v216, v216 row_shl:4 row_mask:0x2 bank_mask:0xf
 v_mfma_f32_16x16x32_bf16 v[172:175], a[88:91], a[40:43], v[172:175]
 s_add_u32 s33, s25, 65536
 v_exp_f32 v168, v168
 v_mfma_f32_16x16x32_bf16 v[172:175], a[84:87], a[36:39], v[172:175]
 s_add_u32 s32, s25, 90112
 v_exp_f32 v169, v169
 v_mfma_f32_16x16x32_bf16 v[172:175], a[80:83], a[32:35], v[172:175]
 s_waitcnt lgkmcnt(3)
 v_exp_f32 v170, v170
 v_mfma_f32_16x16x32_bf16 v[0:3], v[176:179], a[224:227], 0
 v_exp_f32 v171, v171
 v_mfma_f32_16x16x32_bf16 v[4:7], v[176:179], a[228:231], 0
 v_cvt_pk_bf16_f32 v180, v168, v169
 v_cvt_pk_bf16_f32 v181, v170, v171
 v_mfma_f32_16x16x32_bf16 v[8:11], v[176:179], a[232:235], 0
L_pg16:
 s_cbranch_execz L_pg20
 ds_read_b128 a[196:199], v249 offset:33280
 v_mov_b32_dpp v216, v216 row_shl:8 row_mask:0x4 bank_mask:0xf
 v_mfma_f32_16x16x32_bf16 v[12:15], v[176:179], a[236:239], 0
 v_exp_f32 v172, v172
 v_mfma_f32_16x16x32_bf16 v[16:19], v[176:179], a[240:243], 0
 v_exp_f32 v173, v173
 v_mfma_f32_16x16x32_bf16 v[20:23], v[176:179], a[244:247], 0
 s_waitcnt lgkmcnt(1)
 v_exp_f32 v174, v174
 v_mfma_f32_16x16x32_bf16 v[24:27], v[176:179], a[248:251], 0
 v_exp_f32 v175, v175
 v_mfma_f32_16x16x32_bf16 v[28:31], v[176:179], a[252:255], 0
 v_cvt_pk_bf16_f32 v182, v172, v173
 v_cvt_pk_bf16_f32 v183, v174, v175
 v_mfma_f32_16x16x32_bf16 v[160:163], a[64:67], a[48:51], v[152:155]
 ds_read_b128 a[200:203], v249 offset:33792
 v_mov_b32_dpp v216, v216 row_shl:12 row_mask:0x8 bank_mask:0xf
 v_mfma_f32_16x16x32_bf16 v[160:163], a[68:71], a[52:55], v[160:163]
 ds_read_b128 a[204:207], v249 offset:34304
 v_mul_f32_dpp v32, v216, v32 row_newbcast:0 row_mask:0xf bank_mask:0xf
 v_mfma_f32_16x16x32_bf16 v[160:163], a[72:75], a[56:59], v[160:163]
 v_mul_f32_dpp v36, v216, v36 row_newbcast:0 row_mask:0xf bank_mask:0xf
 v_cvt_pk_bf16_f32 v240, v32, v36
 v_mfma_f32_16x16x32_bf16 v[160:163], a[76:79], a[60:63], v[160:163]
 v_mul_f32_dpp v40, v216, v40 row_newbcast:0 row_mask:0xf bank_mask:0xf
 v_mul_f32_dpp v44, v216, v44 row_newbcast:0 row_mask:0xf bank_mask:0xf
 v_mfma_f32_16x16x32_bf16 v[164:167], a[92:95], a[60:63], v[152:155]
 v_cvt_pk_bf16_f32 v241, v40, v44
 v_mul_f32_dpp v48, v216, v48 row_newbcast:0 row_mask:0xf bank_mask:0xf
 v_mfma_f32_16x16x32_bf16 v[164:167], a[88:91], a[56:59], v[164:167]
 v_mul_f32_dpp v52, v216, v52 row_newbcast:0 row_mask:0xf bank_mask:0xf
 v_cvt_pk_bf16_f32 v242, v48, v52
 v_mfma_f32_16x16x32_bf16 v[164:167], a[84:87], a[52:55], v[164:167]
 v_exp_f32 v160, v160
 v_mfma_f32_16x16x32_bf16 v[164:167], a[80:83], a[48:51], v[164:167]
 v_exp_f32 v161, v161
 v_smfmac_f32_16x16x64_bf16 v[128:131], v[236:239], v[176:183], v138
 v_cvt_pk_bf16_f32 v176, v160, v161
 v_mfma_f32_16x16x32_bf16 v[64:67], v[180:183], a[224:227], v[64:67]
 v_exp_f32 v162, v162
 v_mfma_f32_16x16x32_bf16 v[68:71], v[180:183], a[228:231], v[68:71]
 v_exp_f32 v163, v163
 v_mfma_f32_16x16x32_bf16 v[72:75], v[180:183], a[232:235], v[72:75]
 v_exp_f32 v164, v164
 v_mfma_f32_16x16x32_bf16 v[76:79], v[180:183], a[236:239], v[76:79]
 v_exp_f32 v165, v165
 v_mfma_f32_16x16x32_bf16 v[80:83], v[180:183], a[240:243], v[80:83]
 v_exp_f32 v166, v166
 v_mfma_f32_16x16x32_bf16 v[84:87], v[180:183], a[244:247], v[84:87]
 v_exp_f32 v167, v167
 v_mfma_f32_16x16x32_bf16 v[88:91], v[180:183], a[248:251], v[88:91]
 v_cvt_pk_bf16_f32 v177, v162, v163
 v_cvt_pk_bf16_f32 v178, v164, v165
 v_mfma_f32_16x16x32_bf16 v[92:95], v[180:183], a[252:255], v[92:95]
 v_cvt_pk_bf16_f32 v179, v166, v167
 v_mul_f32_dpp v56, v216, v56 row_newbcast:0 row_mask:0xf bank_mask:0xf
 v_mfma_f32_16x16x32_bf16 v[168:171], a[64:67], v[220:223], v[156:159]
 v_mul_f32_dpp v60, v216, v60 row_newbcast:0 row_mask:0xf bank_mask:0xf
 v_cvt_pk_bf16_f32 v243, v56, v60
 v_mfma_f32_16x16x32_bf16 v[168:171], a[68:71], v[224:227], v[168:171]
 buffer_store_dwordx4 v[240:243], v244, s[20:23], s33 offen offset:0 sc1
 v_mfma_f32_16x16x32_bf16 v[168:171], a[72:75], v[228:231], v[168:171]
 v_mul_f32_dpp v33, v216, v33 row_newbcast:1 row_mask:0xf bank_mask:0xf
 v_mul_f32_dpp v37, v216, v37 row_newbcast:1 row_mask:0xf bank_mask:0xf
 v_mfma_f32_16x16x32_bf16 v[168:171], a[76:79], v[232:235], v[168:171]
 v_cvt_pk_bf16_f32 v240, v33, v37
 v_mul_f32_dpp v41, v216, v41 row_newbcast:1 row_mask:0xf bank_mask:0xf
 v_mfma_f32_16x16x32_bf16 v[172:175], a[92:95], v[232:235], v[156:159]
 v_mul_f32_dpp v45, v216, v45 row_newbcast:1 row_mask:0xf bank_mask:0xf
 v_cvt_pk_bf16_f32 v241, v41, v45
 v_mfma_f32_16x16x32_bf16 v[172:175], a[88:91], v[228:231], v[172:175]
 v_mul_f32_dpp v49, v216, v49 row_newbcast:1 row_mask:0xf bank_mask:0xf
 v_mul_f32_dpp v53, v216, v53 row_newbcast:1 row_mask:0xf bank_mask:0xf
 v_mfma_f32_16x16x32_bf16 v[172:175], a[84:87], v[224:227], v[172:175]
 v_exp_f32 v168, v168
 v_mfma_f32_16x16x32_bf16 v[172:175], a[80:83], v[220:223], v[172:175]
 v_exp_f32 v169, v169
 v_mfma_f32_16x16x32_bf16 v[96:99], v[176:179], a[224:227], v[96:99]
 v_exp_f32 v170, v170
 v_mfma_f32_16x16x32_bf16 v[100:103], v[176:179], a[228:231], v[100:103]
 v_exp_f32 v171, v171
 v_mfma_f32_16x16x32_bf16 v[104:107], v[176:179], a[232:235], v[104:107]
 v_cvt_pk_bf16_f32 v180, v168, v169
 v_cvt_pk_bf16_f32 v181, v170, v171
 v_mfma_f32_16x16x32_bf16 v[108:111], v[176:179], a[236:239], v[108:111]
 v_exp_f32 v172, v172
 v_mfma_f32_16x16x32_bf16 v[112:115], v[176:179], a[240:243], v[112:115]
 v_exp_f32 v173, v173
 v_mfma_f32_16x16x32_bf16 v[116:119], v[176:179], a[244:247], v[116:119]
 v_exp_f32 v174, v174
 v_mfma_f32_16x16x32_bf16 v[120:123], v[176:179], a[248:251], v[120:123]
 v_exp_f32 v175, v175
 v_mfma_f32_16x16x32_bf16 v[124:127], v[176:179], a[252:255], v[124:127]
 v_cvt_pk_bf16_f32 v182, v172, v173
 v_cvt_pk_bf16_f32 v183, v174, v175
 v_mfma_f32_16x16x32_bf16 v[160:163], a[96:99], a[0:3], v[144:147]
 v_cvt_pk_bf16_f32 v242, v49, v53
 v_mul_f32_dpp v57, v216, v57 row_newbcast:1 row_mask:0xf bank_mask:0xf
 v_mfma_f32_16x16x32_bf16 v[160:163], a[100:103], a[4:7], v[160:163]
 v_mul_f32_dpp v61, v216, v61 row_newbcast:1 row_mask:0xf bank_mask:0xf
 v_cvt_pk_bf16_f32 v243, v57, v61
 v_mfma_f32_16x16x32_bf16 v[160:163], a[104:107], a[8:11], v[160:163]
 buffer_store_dwordx4 v[240:243], v244, s[20:23], s33 offen offset:1024 sc1
 v_mfma_f32_16x16x32_bf16 v[160:163], a[108:111], a[12:15], v[160:163]
 v_mul_f32_dpp v34, v216, v34 row_newbcast:2 row_mask:0xf bank_mask:0xf
 v_mul_f32_dpp v38, v216, v38 row_newbcast:2 row_mask:0xf bank_mask:0xf
 v_mfma_f32_16x16x32_bf16 v[164:167], a[124:127], a[12:15], v[144:147]
 v_cvt_pk_bf16_f32 v240, v34, v38
 v_mul_f32_dpp v42, v216, v42 row_newbcast:2 row_mask:0xf bank_mask:0xf
 v_mfma_f32_16x16x32_bf16 v[164:167], a[120:123], a[8:11], v[164:167]
 v_mul_f32_dpp v46, v216, v46 row_newbcast:2 row_mask:0xf bank_mask:0xf
 v_cvt_pk_bf16_f32 v241, v42, v46
 v_mfma_f32_16x16x32_bf16 v[164:167], a[116:119], a[4:7], v[164:167]
 v_exp_f32 v160, v160
 v_mfma_f32_16x16x32_bf16 v[164:167], a[112:115], a[0:3], v[164:167]
 v_exp_f32 v161, v161
 v_smfmac_f32_16x16x64_bf16 v[132:135], v[236:239], v[176:183], v138
 v_cvt_pk_bf16_f32 v176, v160, v161
 v_mfma_f32_16x16x32_bf16 v[184:187], v[180:183], a[224:227], v[184:187]
 ds_read_b128 a[224:227], v248 offset:8192
 v_mul_f32_dpp v50, v216, v50 row_newbcast:2 row_mask:0xf bank_mask:0xf
 v_mfma_f32_16x16x32_bf16 v[188:191], v[180:183], a[228:231], v[188:191]
 ds_read_b128 a[228:231], v248 offset:8704
 v_mul_f32_dpp v54, v216, v54 row_newbcast:2 row_mask:0xf bank_mask:0xf
 v_mfma_f32_16x16x32_bf16 v[192:195], v[180:183], a[232:235], v[192:195]
 ds_read_b128 a[232:235], v248 offset:9216
 v_cvt_pk_bf16_f32 v242, v50, v54
 v_mfma_f32_16x16x32_bf16 v[196:199], v[180:183], a[236:239], v[196:199]
 v_exp_f32 v162, v162
 v_mfma_f32_16x16x32_bf16 v[200:203], v[180:183], a[240:243], v[200:203]
 v_exp_f32 v163, v163
 v_mfma_f32_16x16x32_bf16 v[204:207], v[180:183], a[244:247], v[204:207]
 v_exp_f32 v164, v164
 v_mfma_f32_16x16x32_bf16 v[208:211], v[180:183], a[248:251], v[208:211]
 v_exp_f32 v165, v165
 v_mfma_f32_16x16x32_bf16 v[212:215], v[180:183], a[252:255], v[212:215]
 v_exp_f32 v166, v166
 v_mfma_f32_16x16x32_bf16 v[168:171], a[96:99], a[32:35], v[148:151]
 ds_read_b128 a[236:239], v248 offset:9728
 ds_read_b128 a[240:243], v248 offset:10240
 v_mfma_f32_16x16x32_bf16 v[168:171], a[100:103], a[36:39], v[168:171]
 v_exp_f32 v167, v167
 v_mfma_f32_16x16x32_bf16 v[168:171], a[104:107], a[40:43], v[168:171]
 ds_read_b128 a[244:247], v248 offset:10752
 ds_read_b128 a[248:251], v248 offset:11264
 v_mfma_f32_16x16x32_bf16 v[168:171], a[108:111], a[44:47], v[168:171]
 v_cvt_pk_bf16_f32 v177, v162, v163
 v_cvt_pk_bf16_f32 v178, v164, v165
 v_mfma_f32_16x16x32_bf16 v[172:175], a[124:127], a[44:47], v[148:151]
 ds_read_b128 a[252:255], v248 offset:11776
 v_cvt_pk_bf16_f32 v179, v166, v167
 v_mfma_f32_16x16x32_bf16 v[172:175], a[120:123], a[40:43], v[172:175]
 v_mul_f32_dpp v58, v216, v58 row_newbcast:2 row_mask:0xf bank_mask:0xf
 v_mul_f32_dpp v62, v216, v62 row_newbcast:2 row_mask:0xf bank_mask:0xf
 v_mfma_f32_16x16x32_bf16 v[172:175], a[116:119], a[36:39], v[172:175]
 v_exp_f32 v168, v168
 v_mfma_f32_16x16x32_bf16 v[172:175], a[112:115], a[32:35], v[172:175]
 s_waitcnt lgkmcnt(3)
 v_exp_f32 v169, v169
 v_mfma_f32_16x16x32_bf16 v[0:3], v[176:179], a[224:227], v[0:3]
 v_exp_f32 v170, v170
 v_mfma_f32_16x16x32_bf16 v[4:7], v[176:179], a[228:231], v[4:7]
 v_exp_f32 v171, v171
 v_mfma_f32_16x16x32_bf16 v[8:11], v[176:179], a[232:235], v[8:11]
 v_cvt_pk_bf16_f32 v180, v168, v169
 v_cvt_pk_bf16_f32 v181, v170, v171
 v_mfma_f32_16x16x32_bf16 v[12:15], v[176:179], a[236:239], v[12:15]
 v_exp_f32 v172, v172
 v_mfma_f32_16x16x32_bf16 v[16:19], v[176:179], a[240:243], v[16:19]
 s_waitcnt lgkmcnt(0)
 v_exp_f32 v173, v173
 v_mfma_f32_16x16x32_bf16 v[20:23], v[176:179], a[244:247], v[20:23]
 v_exp_f32 v174, v174
 v_mfma_f32_16x16x32_bf16 v[24:27], v[176:179], a[248:251], v[24:27]
 v_exp_f32 v175, v175
 v_mfma_f32_16x16x32_bf16 v[28:31], v[176:179], a[252:255], v[28:31]
 v_cvt_pk_bf16_f32 v182, v172, v173
 v_cvt_pk_bf16_f32 v183, v174, v175
 v_mfma_f32_16x16x32_bf16 v[160:163], a[96:99], a[48:51], v[152:155]
 v_cvt_pk_bf16_f32 v243, v58, v62
 v_mul_f32_dpp v35, v216, v35 row_newbcast:3 row_mask:0xf bank_mask:0xf
 v_mfma_f32_16x16x32_bf16 v[160:163], a[100:103], a[52:55], v[160:163]
 buffer_store_dwordx4 v[240:243], v244, s[20:23], s33 offen offset:2048 sc1
 v_mfma_f32_16x16x32_bf16 v[160:163], a[104:107], a[56:59], v[160:163]
 v_mul_f32_dpp v39, v216, v39 row_newbcast:3 row_mask:0xf bank_mask:0xf
 v_cvt_pk_bf16_f32 v240, v35, v39
 v_mfma_f32_16x16x32_bf16 v[160:163], a[108:111], a[60:63], v[160:163]
 v_mul_f32_dpp v43, v216, v43 row_newbcast:3 row_mask:0xf bank_mask:0xf
 v_mul_f32_dpp v47, v216, v47 row_newbcast:3 row_mask:0xf bank_mask:0xf
 v_mfma_f32_16x16x32_bf16 v[164:167], a[124:127], a[60:63], v[152:155]
 v_cvt_pk_bf16_f32 v241, v43, v47
 v_mul_f32_dpp v51, v216, v51 row_newbcast:3 row_mask:0xf bank_mask:0xf
 v_mfma_f32_16x16x32_bf16 v[164:167], a[120:123], a[56:59], v[164:167]
 v_mul_f32_dpp v55, v216, v55 row_newbcast:3 row_mask:0xf bank_mask:0xf
 v_cvt_pk_bf16_f32 v242, v51, v55
 v_mfma_f32_16x16x32_bf16 v[164:167], a[116:119], a[52:55], v[164:167]
 v_exp_f32 v160, v160
 v_mfma_f32_16x16x32_bf16 v[164:167], a[112:115], a[48:51], v[164:167]
 v_exp_f32 v161, v161
 v_smfmac_f32_16x16x64_bf16 v[128:131], v[236:239], v[176:183], v138
 v_cvt_pk_bf16_f32 v176, v160, v161
 v_mfma_f32_16x16x32_bf16 v[64:67], v[180:183], a[224:227], v[64:67]
 v_exp_f32 v162, v162
 v_mfma_f32_16x16x32_bf16 v[68:71], v[180:183], a[228:231], v[68:71]
 v_exp_f32 v163, v163
 v_mfma_f32_16x16x32_bf16 v[72:75], v[180:183], a[232:235], v[72:75]
 v_exp_f32 v164, v164
 v_mfma_f32_16x16x32_bf16 v[76:79], v[180:183], a[236:239], v[76:79]
 v_exp_f32 v165, v165
 v_mfma_f32_16x16x32_bf16 v[80:83], v[180:183], a[240:243], v[80:83]
 v_exp_f32 v166, v166
 v_mfma_f32_16x16x32_bf16 v[84:87], v[180:183], a[244:247], v[84:87]
 v_exp_f32 v167, v167
 v_mfma_f32_16x16x32_bf16 v[88:91], v[180:183], a[248:251], v[88:91]
 v_cvt_pk_bf16_f32 v177, v162, v163
 v_cvt_pk_bf16_f32 v178, v164, v165
 v_mfma_f32_16x16x32_bf16 v[92:95], v[180:183], a[252:255], v[92:95]
 v_cvt_pk_bf16_f32 v179, v166, v167
 v_mul_f32_dpp v59, v216, v59 row_newbcast:3 row_mask:0xf bank_mask:0xf
 v_mfma_f32_16x16x32_bf16 v[168:171], a[96:99], v[220:223], v[156:159]
 v_mul_f32_dpp v63, v216, v63 row_newbcast:3 row_mask:0xf bank_mask:0xf
 v_cvt_pk_bf16_f32 v243, v59, v63
 v_mfma_f32_16x16x32_bf16 v[168:171], a[100:103], v[224:227], v[168:171]
 buffer_store_dwordx4 v[240:243], v244, s[20:23], s33 offen offset:3072 sc1
 v_mfma_f32_16x16x32_bf16 v[168:171], a[104:107], v[228:231], v[168:171]
 ds_read_b128 a[216:219], v249 offset:35840
 ds_read_b128 a[220:223], v249 offset:36352
 v_mfma_f32_16x16x32_bf16 v[168:171], a[108:111], v[232:235], v[168:171]
 ds_read_b128 a[208:211], v249 offset:34816
 ds_read_b128 a[212:215], v249 offset:35328
 v_mfma_f32_16x16x32_bf16 v[172:175], a[124:127], v[232:235], v[156:159]
 s_nop 1
 v_mfma_f32_16x16x32_bf16 v[172:175], a[120:123], v[228:231], v[172:175]
 s_nop 1
 v_mfma_f32_16x16x32_bf16 v[172:175], a[116:119], v[224:227], v[172:175]
 v_exp_f32 v168, v168
 v_mfma_f32_16x16x32_bf16 v[172:175], a[112:115], v[220:223], v[172:175]
 v_exp_f32 v169, v169
 v_mfma_f32_16x16x32_bf16 v[96:99], v[176:179], a[224:227], v[96:99]
 v_exp_f32 v170, v170
 v_mfma_f32_16x16x32_bf16 v[100:103], v[176:179], a[228:231], v[100:103]
 v_exp_f32 v171, v171
 v_mfma_f32_16x16x32_bf16 v[104:107], v[176:179], a[232:235], v[104:107]
 v_cvt_pk_bf16_f32 v180, v168, v169
 v_cvt_pk_bf16_f32 v181, v170, v171
 v_mfma_f32_16x16x32_bf16 v[108:111], v[176:179], a[236:239], v[108:111]
 v_exp_f32 v172, v172
 v_mfma_f32_16x16x32_bf16 v[112:115], v[176:179], a[240:243], v[112:115]
 v_exp_f32 v173, v173
 v_mfma_f32_16x16x32_bf16 v[116:119], v[176:179], a[244:247], v[116:119]
 v_exp_f32 v174, v174
 v_mfma_f32_16x16x32_bf16 v[120:123], v[176:179], a[248:251], v[120:123]
 v_exp_f32 v175, v175
 v_mfma_f32_16x16x32_bf16 v[124:127], v[176:179], a[252:255], v[124:127]
 v_cvt_pk_bf16_f32 v182, v172, v173
 v_cvt_pk_bf16_f32 v183, v174, v175
 v_mfma_f32_16x16x32_bf16 v[160:163], a[128:131], a[0:3], v[144:147]
 v_mfma_f32_16x16x32_bf16 v[160:163], a[132:135], a[4:7], v[160:163]
 v_mfma_f32_16x16x32_bf16 v[160:163], a[136:139], a[8:11], v[160:163]
 v_mfma_f32_16x16x32_bf16 v[160:163], a[140:143], a[12:15], v[160:163]
 s_nop 1
 v_mfma_f32_16x16x32_bf16 v[164:167], a[156:159], a[12:15], v[144:147]
 s_nop 1
 v_mfma_f32_16x16x32_bf16 v[164:167], a[152:155], a[8:11], v[164:167]
 s_nop 1
 v_mfma_f32_16x16x32_bf16 v[164:167], a[148:151], a[4:7], v[164:167]
 v_exp_f32 v160, v160
 v_mfma_f32_16x16x32_bf16 v[164:167], a[144:147], a[0:3], v[164:167]
 v_exp_f32 v161, v161
 v_smfmac_f32_16x16x64_bf16 v[132:135], v[236:239], v[176:183], v138
 v_cvt_pk_bf16_f32 v176, v160, v161
 v_mfma_f32_16x16x32_bf16 v[184:187], v[180:183], a[224:227], v[184:187]
 v_exp_f32 v162, v162
 v_mfma_f32_16x16x32_bf16 v[188:191], v[180:183], a[228:231], v[188:191]
 ds_read_b128 a[224:227], v248 offset:16384
 ds_read_b128 a[228:231], v248 offset:16896
 v_mfma_f32_16x16x32_bf16 v[192:195], v[180:183], a[232:235], v[192:195]
 v_exp_f32 v163, v163
 v_mfma_f32_16x16x32_bf16 v[196:199], v[180:183], a[236:239], v[196:199]
 ds_read_b128 a[232:235], v248 offset:17408
 ds_read_b128 a[236:239], v248 offset:17920
 v_mfma_f32_16x16x32_bf16 v[200:203], v[180:183], a[240:243], v[200:203]
 v_exp_f32 v164, v164
 v_mfma_f32_16x16x32_bf16 v[204:207], v[180:183], a[244:247], v[204:207]
 v_exp_f32 v165, v165
 v_mfma_f32_16x16x32_bf16 v[208:211], v[180:183], a[248:251], v[208:211]
 v_exp_f32 v166, v166
 v_mfma_f32_16x16x32_bf16 v[212:215], v[180:183], a[252:255], v[212:215]
 v_exp_f32 v167, v167
 v_mfma_f32_16x16x32_bf16 v[168:171], a[128:131], a[32:35], v[148:151]
 ds_read_b128 a[240:243], v248 offset:18432
 ds_read_b128 a[244:247], v248 offset:18944
 v_mfma_f32_16x16x32_bf16 v[168:171], a[132:135], a[36:39], v[168:171]
 ds_read_b128 a[248:251], v248 offset:19456
 v_cvt_pk_bf16_f32 v177, v162, v163
 v_mfma_f32_16x16x32_bf16 v[168:171], a[136:139], a[40:43], v[168:171]
 v_cvt_pk_bf16_f32 v178, v164, v165
 v_cvt_pk_bf16_f32 v179, v166, v167
 v_mfma_f32_16x16x32_bf16 v[168:171], a[140:143], a[44:47], v[168:171]
 ds_read_b128 a[252:255], v248 offset:19968
 s_nop 0
 v_mfma_f32_16x16x32_bf16 v[172:175], a[156:159], a[44:47], v[148:151]
 buffer_load_dwordx4 a[44:47], v245, s[8:11], s32 offen offset:192
 v_mfma_f32_16x16x32_bf16 v[172:175], a[152:155], a[40:43], v[172:175]
 s_nop 1
 v_mfma_f32_16x16x32_bf16 v[172:175], a[148:151], a[36:39], v[172:175]
 v_exp_f32 v168, v168
 v_mfma_f32_16x16x32_bf16 v[172:175], a[144:147], a[32:35], v[172:175]
 s_waitcnt lgkmcnt(2)
 v_exp_f32 v169, v169
 v_mfma_f32_16x16x32_bf16 v[0:3], v[176:179], a[224:227], v[0:3]
 buffer_load_dwordx4 a[32:35], v245, s[8:11], s32 offen offset:0
 v_mfma_f32_16x16x32_bf16 v[4:7], v[176:179], a[228:231], v[4:7]
 v_exp_f32 v170, v170
 v_mfma_f32_16x16x32_bf16 v[8:11], v[176:179], a[232:235], v[8:11]
 v_exp_f32 v171, v171
 v_mfma_f32_16x16x32_bf16 v[12:15], v[176:179], a[236:239], v[12:15]
 v_exp_f32 v172, v172
 v_mfma_f32_16x16x32_bf16 v[16:19], v[176:179], a[240:243], v[16:19]
 buffer_load_dwordx4 a[36:39], v245, s[8:11], s32 offen offset:64
 v_mfma_f32_16x16x32_bf16 v[20:23], v[176:179], a[244:247], v[20:23]
 s_waitcnt lgkmcnt(0)
 v_exp_f32 v173, v173
 v_mfma_f32_16x16x32_bf16 v[24:27], v[176:179], a[248:251], v[24:27]
 v_exp_f32 v174, v174
 v_mfma_f32_16x16x32_bf16 v[28:31], v[176:179], a[252:255], v[28:31]
 v_exp_f32 v175, v175
 v_mfma_f32_16x16x32_bf16 v[160:163], a[128:131], a[48:51], v[152:155]
 buffer_load_dwordx4 a[40:43], v245, s[8:11], s32 offen offset:128
 v_mfma_f32_16x16x32_bf16 v[160:163], a[132:135], a[52:55], v[160:163]
 v_cvt_pk_bf16_f32 v180, v168, v169
 v_cvt_pk_bf16_f32 v181, v170, v171
 v_mfma_f32_16x16x32_bf16 v[160:163], a[136:139], a[56:59], v[160:163]
 v_cvt_pk_bf16_f32 v182, v172, v173
 v_cvt_pk_bf16_f32 v183, v174, v175
 v_mfma_f32_16x16x32_bf16 v[160:163], a[140:143], a[60:63], v[160:163]
 s_nop 1
 v_mfma_f32_16x16x32_bf16 v[164:167], a[156:159], a[60:63], v[152:155]
 s_nop 1
 v_mfma_f32_16x16x32_bf16 v[164:167], a[152:155], a[56:59], v[164:167]
 s_nop 1
 v_mfma_f32_16x16x32_bf16 v[164:167], a[148:151], a[52:55], v[164:167]
 v_exp_f32 v160, v160
 v_mfma_f32_16x16x32_bf16 v[164:167], a[144:147], a[48:51], v[164:167]
 v_exp_f32 v161, v161
 v_smfmac_f32_16x16x64_bf16 v[128:131], v[236:239], v[176:183], v138
 v_cvt_pk_bf16_f32 v176, v160, v161
 v_mfma_f32_16x16x32_bf16 v[64:67], v[180:183], a[224:227], v[64:67]
 v_exp_f32 v162, v162
 v_mfma_f32_16x16x32_bf16 v[68:71], v[180:183], a[228:231], v[68:71]
 v_exp_f32 v163, v163
 v_mfma_f32_16x16x32_bf16 v[72:75], v[180:183], a[232:235], v[72:75]
 v_exp_f32 v164, v164
 v_mfma_f32_16x16x32_bf16 v[76:79], v[180:183], a[236:239], v[76:79]
 v_exp_f32 v165, v165
 v_mfma_f32_16x16x32_bf16 v[80:83], v[180:183], a[240:243], v[80:83]
 v_exp_f32 v166, v166
 v_mfma_f32_16x16x32_bf16 v[84:87], v[180:183], a[244:247], v[84:87]
 v_exp_f32 v167, v167
 v_mfma_f32_16x16x32_bf16 v[88:91], v[180:183], a[248:251], v[88:91]
 v_cvt_pk_bf16_f32 v177, v162, v163
 v_cvt_pk_bf16_f32 v178, v164, v165
 v_mfma_f32_16x16x32_bf16 v[92:95], v[180:183], a[252:255], v[92:95]
 s_waitcnt vmcnt(10)
 v_cvt_pk_bf16_f32 v179, v166, v167
 v_add_f32 v217, v130, v131
 v_mfma_f32_16x16x32_bf16 v[252:255], a[160:163], a[16:19], 0
 v_mov_b32 v130, 0
 v_mov_b32 v131, 0
 v_mfma_f32_16x16x32_bf16 v[252:255], a[164:167], a[20:23], v[252:255]
 v_cmp_nge_f32 vcc, s28, v217
 s_nop 0
 v_mfma_f32_16x16x32_bf16 v[252:255], a[168:171], a[24:27], v[252:255]
 s_cmp_lg_u64 vcc, 0
 v_rcp_f32 v217, v217
 v_mfma_f32_16x16x32_bf16 v[252:255], a[172:175], a[28:31], v[252:255]
 s_cselect_b32 s34, 131072, 0
 s_or_b32 s29, s29, s34
 v_mov_b32_dpp v217, v217 row_shl:4 row_mask:0x2 bank_mask:0xf
 v_mfma_f32_16x16x32_bf16 v[168:171], a[128:131], v[220:223], v[156:159]
 s_add_u32 s33, s25, 69632
 s_add_u32 s32, s25, 94208
 v_mov_b32_dpp v217, v217 row_shl:8 row_mask:0x4 bank_mask:0xf
 v_mfma_f32_16x16x32_bf16 v[168:171], a[132:135], v[224:227], v[168:171]
 v_max3_f32 v246, v252, v253, v254
 v_max_f32 v246, v246, v255
 v_mfma_f32_16x16x32_bf16 v[168:171], a[136:139], v[228:231], v[168:171]
 v_mov_b32 v247, v246
 v_mov_b32_dpp v217, v217 row_shl:12 row_mask:0x8 bank_mask:0xf
 v_mfma_f32_16x16x32_bf16 v[168:171], a[140:143], v[232:235], v[168:171]
 v_permlane16_swap_b32 v246, v247
 v_max_f32 v246, v246, v247
 v_mfma_f32_16x16x32_bf16 v[172:175], a[156:159], v[232:235], v[156:159]
 v_mov_b32 v247, v246
 v_mul_f32_dpp v64, v217, v64 row_newbcast:0 row_mask:0xf bank_mask:0xf
 v_mfma_f32_16x16x32_bf16 v[172:175], a[152:155], v[228:231], v[172:175]
 v_permlane32_swap_b32 v246, v247
 v_min_f32 v246, -v246, -v247
 v_mfma_f32_16x16x32_bf16 v[172:175], a[148:151], v[224:227], v[172:175]
 v_exp_f32 v171, v171
 v_mfma_f32_16x16x32_bf16 v[172:175], a[144:147], v[220:223], v[172:175]
 v_exp_f32 v168, v168
 v_mfma_f32_16x16x32_bf16 v[96:99], v[176:179], a[224:227], v[96:99]
 v_exp_f32 v169, v169
 v_mfma_f32_16x16x32_bf16 v[100:103], v[176:179], a[228:231], v[100:103]
 v_exp_f32 v170, v170
 v_mfma_f32_16x16x32_bf16 v[104:107], v[176:179], a[232:235], v[104:107]
 v_cvt_pk_bf16_f32 v180, v168, v169
 v_cvt_pk_bf16_f32 v181, v170, v171
 v_mfma_f32_16x16x32_bf16 v[108:111], v[176:179], a[236:239], v[108:111]
 v_exp_f32 v172, v172
 v_mfma_f32_16x16x32_bf16 v[112:115], v[176:179], a[240:243], v[112:115]
 v_exp_f32 v173, v173
 v_mfma_f32_16x16x32_bf16 v[116:119], v[176:179], a[244:247], v[116:119]
 v_cvt_pk_bf16_f32 v182, v172, v173
 v_mov_b32 v148, v246
 v_mfma_f32_16x16x32_bf16 v[120:123], v[176:179], a[248:251], v[120:123]
 v_exp_f32 v174, v174
 v_mfma_f32_16x16x32_bf16 v[124:127], v[176:179], a[252:255], v[124:127]
 v_exp_f32 v175, v175
 v_mfma_f32_16x16x32_bf16 v[160:163], a[160:163], a[0:3], v[144:147]
 v_cvt_pk_bf16_f32 v183, v174, v175
 v_mov_b32 v149, v246
 v_mfma_f32_16x16x32_bf16 v[160:163], a[164:167], a[4:7], v[160:163]
 v_mov_b32 v150, v246
 v_mov_b32 v151, v246
 v_mfma_f32_16x16x32_bf16 v[160:163], a[168:171], a[8:11], v[160:163]
 v_add_f32 v252, v252, v246
 v_add_f32 v253, v253, v246
 v_mfma_f32_16x16x32_bf16 v[160:163], a[172:175], a[12:15], v[160:163]
 v_add_f32 v254, v254, v246
 v_add_f32 v255, v255, v246
 v_mfma_f32_16x16x32_bf16 v[164:167], a[188:191], a[12:15], v[144:147]
 v_exp_f32 v252, v252
 v_mfma_f32_16x16x32_bf16 v[164:167], a[184:187], a[8:11], v[164:167]
 v_exp_f32 v253, v253
 v_mfma_f32_16x16x32_bf16 v[164:167], a[180:183], a[4:7], v[164:167]
 v_exp_f32 v254, v254
 v_mfma_f32_16x16x32_bf16 v[164:167], a[176:179], a[0:3], v[164:167]
 v_exp_f32 v161, v161
 v_smfmac_f32_16x16x64_bf16 v[132:135], v[236:239], v[176:183], v138
 v_mul_f32_dpp v68, v217, v68 row_newbcast:0 row_mask:0xf bank_mask:0xf
 v_mfma_f32_16x16x32_bf16 v[184:187], v[180:183], a[224:227], v[184:187]
 v_exp_f32 v162, v162
 v_mfma_f32_16x16x32_bf16 v[188:191], v[180:183], a[228:231], v[188:191]
 v_exp_f32 v163, v163
 v_mfma_f32_16x16x32_bf16 v[192:195], v[180:183], a[232:235], v[192:195]
 ds_read_b128 a[224:227], v248 offset:24576
 v_exp_f32 v160, v160
 v_mfma_f32_16x16x32_bf16 v[196:199], v[180:183], a[236:239], v[196:199]
 ds_read_b128 a[228:231], v248 offset:25088
 v_cvt_pk_bf16_f32 v176, v160, v161
 v_cvt_pk_bf16_f32 v177, v162, v163
 v_mfma_f32_16x16x32_bf16 v[200:203], v[180:183], a[240:243], v[200:203]
 ds_read_b128 a[232:235], v248 offset:25600
 ds_read_b128 a[236:239], v248 offset:26112
 v_mfma_f32_16x16x32_bf16 v[204:207], v[180:183], a[244:247], v[204:207]
 ds_read_b128 a[240:243], v248 offset:26624
 ds_read_b128 a[244:247], v248 offset:27136
 v_mfma_f32_16x16x32_bf16 v[208:211], v[180:183], a[248:251], v[208:211]
 v_exp_f32 v164, v164
 v_mfma_f32_16x16x32_bf16 v[212:215], v[180:183], a[252:255], v[212:215]
 v_exp_f32 v165, v165
 v_mfma_f32_16x16x32_bf16 v[172:175], a[188:191], a[28:31], v[148:151]
 ds_read_b128 a[248:251], v248 offset:27648
 v_exp_f32 v166, v166
 v_exp_f32 v167, v167
 v_mfma_f32_16x16x32_bf16 v[172:175], a[184:187], a[24:27], v[172:175]
 ds_read_b128 a[252:255], v248 offset:28160
 v_cvt_pk_bf16_f32 v178, v164, v165
 v_cvt_pk_bf16_f32 v179, v166, v167
 v_mfma_f32_16x16x32_bf16 v[172:175], a[180:183], a[20:23], v[172:175]
 v_exp_f32 v255, v255
 v_mfma_f32_16x16x32_bf16 v[172:175], a[176:179], a[16:19], v[172:175]
 s_waitcnt lgkmcnt(4)
 v_cvt_pk_bf16_f32 v180, v252, v253
 v_cvt_pk_bf16_f32 v181, v254, v255
 v_mfma_f32_16x16x32_bf16 v[0:3], v[176:179], a[224:227], v[0:3]
 v_cvt_pk_bf16_f32 v240, v64, v68
 v_mul_f32_dpp v72, v217, v72 row_newbcast:0 row_mask:0xf bank_mask:0xf
 v_mfma_f32_16x16x32_bf16 v[4:7], v[176:179], a[228:231], v[4:7]
 v_mul_f32_dpp v76, v217, v76 row_newbcast:0 row_mask:0xf bank_mask:0xf
 v_cvt_pk_bf16_f32 v241, v72, v76
 v_mfma_f32_16x16x32_bf16 v[8:11], v[176:179], a[232:235], v[8:11]
 v_exp_f32 v172, v172
 v_mfma_f32_16x16x32_bf16 v[12:15], v[176:179], a[236:239], v[12:15]
 s_waitcnt lgkmcnt(1)
 v_exp_f32 v173, v173
 v_mfma_f32_16x16x32_bf16 v[16:19], v[176:179], a[240:243], v[16:19]
 v_exp_f32 v174, v174
 v_mfma_f32_16x16x32_bf16 v[20:23], v[176:179], a[244:247], v[20:23]
 v_exp_f32 v175, v175
 v_mfma_f32_16x16x32_bf16 v[24:27], v[176:179], a[248:251], v[24:27]
 s_waitcnt lgkmcnt(0)
 v_cvt_pk_bf16_f32 v182, v172, v173
 v_cvt_pk_bf16_f32 v183, v174, v175
 v_mfma_f32_16x16x32_bf16 v[28:31], v[176:179], a[252:255], v[28:31]
 v_mul_f32_dpp v80, v217, v80 row_newbcast:0 row_mask:0xf bank_mask:0xf
 v_mul_f32_dpp v84, v217, v84 row_newbcast:0 row_mask:0xf bank_mask:0xf
 v_mfma_f32_16x16x32_bf16 v[160:163], a[160:163], a[48:51], v[152:155]
 v_cvt_pk_bf16_f32 v242, v80, v84
 v_mul_f32_dpp v88, v217, v88 row_newbcast:0 row_mask:0xf bank_mask:0xf
 v_mfma_f32_16x16x32_bf16 v[160:163], a[164:167], a[52:55], v[160:163]
 v_mul_f32_dpp v92, v217, v92 row_newbcast:0 row_mask:0xf bank_mask:0xf
 v_cvt_pk_bf16_f32 v243, v88, v92
 v_mfma_f32_16x16x32_bf16 v[160:163], a[168:171], a[56:59], v[160:163]
 buffer_store_dwordx4 v[240:243], v244, s[20:23], s33 offen offset:0 sc1
 v_mfma_f32_16x16x32_bf16 v[160:163], a[172:175], a[60:63], v[160:163]
 v_mul_f32_dpp v65, v217, v65 row_newbcast:1 row_mask:0xf bank_mask:0xf
 v_mul_f32_dpp v69, v217, v69 row_newbcast:1 row_mask:0xf bank_mask:0xf
 v_mfma_f32_16x16x32_bf16 v[164:167], a[188:191], a[60:63], v[152:155]
 v_cvt_pk_bf16_f32 v240, v65, v69
 v_mul_f32_dpp v73, v217, v73 row_newbcast:1 row_mask:0xf bank_mask:0xf
 v_mfma_f32_16x16x32_bf16 v[164:167], a[184:187], a[56:59], v[164:167]
 v_mul_f32_dpp v77, v217, v77 row_newbcast:1 row_mask:0xf bank_mask:0xf
 v_cvt_pk_bf16_f32 v241, v73, v77
 v_mfma_f32_16x16x32_bf16 v[164:167], a[180:183], a[52:55], v[164:167]
 v_exp_f32 v160, v160
 v_mfma_f32_16x16x32_bf16 v[164:167], a[176:179], a[48:51], v[164:167]
 v_exp_f32 v161, v161
 v_smfmac_f32_16x16x64_bf16 v[128:131], v[236:239], v[176:183], v138
 v_cvt_pk_bf16_f32 v176, v160, v161
 v_mfma_f32_16x16x32_bf16 v[32:35], v[180:183], a[224:227], 0
 v_exp_f32 v162, v162
 v_mfma_f32_16x16x32_bf16 v[36:39], v[180:183], a[228:231], 0
 v_exp_f32 v163, v163
 v_mfma_f32_16x16x32_bf16 v[40:43], v[180:183], a[232:235], 0
 v_exp_f32 v164, v164
 v_mfma_f32_16x16x32_bf16 v[44:47], v[180:183], a[236:239], 0
 v_exp_f32 v165, v165
 v_mfma_f32_16x16x32_bf16 v[48:51], v[180:183], a[240:243], 0
 v_exp_f32 v166, v166
 v_mfma_f32_16x16x32_bf16 v[52:55], v[180:183], a[244:247], 0
 v_exp_f32 v167, v167
 v_mfma_f32_16x16x32_bf16 v[56:59], v[180:183], a[248:251], 0
 v_cvt_pk_bf16_f32 v177, v162, v163
 v_cvt_pk_bf16_f32 v178, v164, v165
 v_mfma_f32_16x16x32_bf16 v[60:63], v[180:183], a[252:255], 0
 v_cvt_pk_bf16_f32 v179, v166, v167
 v_mul_f32_dpp v81, v217, v81 row_newbcast:1 row_mask:0xf bank_mask:0xf
 v_mfma_f32_16x16x32_bf16 v[168:171], a[160:163], v[220:223], v[156:159]
 v_mul_f32_dpp v85, v217, v85 row_newbcast:1 row_mask:0xf bank_mask:0xf
 v_cvt_pk_bf16_f32 v242, v81, v85
 v_mfma_f32_16x16x32_bf16 v[168:171], a[164:167], v[224:227], v[168:171]
 v_mul_f32_dpp v89, v217, v89 row_newbcast:1 row_mask:0xf bank_mask:0xf
 v_mul_f32_dpp v93, v217, v93 row_newbcast:1 row_mask:0xf bank_mask:0xf
 v_mfma_f32_16x16x32_bf16 v[168:171], a[168:171], v[228:231], v[168:171]
 v_cvt_pk_bf16_f32 v243, v89, v93
 v_mul_f32_dpp v66, v217, v66 row_newbcast:2 row_mask:0xf bank_mask:0xf
 v_mfma_f32_16x16x32_bf16 v[168:171], a[172:175], v[232:235], v[168:171]
 buffer_store_dwordx4 v[240:243], v244, s[20:23], s33 offen offset:1024 sc1
 v_mfma_f32_16x16x32_bf16 v[172:175], a[188:191], v[232:235], v[156:159]
 v_mul_f32_dpp v70, v217, v70 row_newbcast:2 row_mask:0xf bank_mask:0xf
 v_cvt_pk_bf16_f32 v240, v66, v70
 v_mfma_f32_16x16x32_bf16 v[172:175], a[184:187], v[228:231], v[172:175]
 v_mul_f32_dpp v74, v217, v74 row_newbcast:2 row_mask:0xf bank_mask:0xf
 v_mul_f32_dpp v78, v217, v78 row_newbcast:2 row_mask:0xf bank_mask:0xf
 v_mfma_f32_16x16x32_bf16 v[172:175], a[180:183], v[224:227], v[172:175]
 v_exp_f32 v168, v168
 v_mfma_f32_16x16x32_bf16 v[172:175], a[176:179], v[220:223], v[172:175]
 v_exp_f32 v169, v169
 v_mfma_f32_16x16x32_bf16 v[96:99], v[176:179], a[224:227], v[96:99]
 v_exp_f32 v170, v170
 v_mfma_f32_16x16x32_bf16 v[100:103], v[176:179], a[228:231], v[100:103]
 v_exp_f32 v171, v171
 v_mfma_f32_16x16x32_bf16 v[104:107], v[176:179], a[232:235], v[104:107]
 v_cvt_pk_bf16_f32 v180, v168, v169
 v_cvt_pk_bf16_f32 v181, v170, v171
 v_mfma_f32_16x16x32_bf16 v[108:111], v[176:179], a[236:239], v[108:111]
 v_exp_f32 v172, v172
 v_mfma_f32_16x16x32_bf16 v[112:115], v[176:179], a[240:243], v[112:115]
 v_exp_f32 v173, v173
 v_mfma_f32_16x16x32_bf16 v[116:119], v[176:179], a[244:247], v[116:119]
 v_exp_f32 v174, v174
 v_mfma_f32_16x16x32_bf16 v[120:123], v[176:179], a[248:251], v[120:123]
 v_exp_f32 v175, v175
 v_mfma_f32_16x16x32_bf16 v[124:127], v[176:179], a[252:255], v[124:127]
 v_cvt_pk_bf16_f32 v182, v172, v173
 v_cvt_pk_bf16_f32 v183, v174, v175
 v_mfma_f32_16x16x32_bf16 v[160:163], a[192:195], a[0:3], v[144:147]
 v_cvt_pk_bf16_f32 v241, v74, v78
 v_mul_f32_dpp v82, v217, v82 row_newbcast:2 row_mask:0xf bank_mask:0xf
 v_mfma_f32_16x16x32_bf16 v[160:163], a[196:199], a[4:7], v[160:163]
 v_mul_f32_dpp v86, v217, v86 row_newbcast:2 row_mask:0xf bank_mask:0xf
 v_cvt_pk_bf16_f32 v242, v82, v86
 v_mfma_f32_16x16x32_bf16 v[160:163], a[200:203], a[8:11], v[160:163]
 v_mul_f32_dpp v90, v217, v90 row_newbcast:2 row_mask:0xf bank_mask:0xf
 v_mul_f32_dpp v94, v217, v94 row_newbcast:2 row_mask:0xf bank_mask:0xf
 v_mfma_f32_16x16x32_bf16 v[160:163], a[204:207], a[12:15], v[160:163]
L_pg17:
 s_cbranch_execz L_wb1
 v_cvt_pk_bf16_f32 v243, v90, v94
 v_mul_f32_dpp v67, v217, v67 row_newbcast:3 row_mask:0xf bank_mask:0xf
 v_mfma_f32_16x16x32_bf16 v[164:167], a[220:223], a[12:15], v[144:147]
 v_mul_f32_dpp v71, v217, v71 row_newbcast:3 row_mask:0xf bank_mask:0xf
 v_mul_f32_dpp v75, v217, v75 row_newbcast:3 row_mask:0xf bank_mask:0xf
 v_mfma_f32_16x16x32_bf16 v[164:167], a[216:219], a[8:11], v[164:167]
 v_mul_f32_dpp v79, v217, v79 row_newbcast:3 row_mask:0xf bank_mask:0xf
 v_mul_f32_dpp v83, v217, v83 row_newbcast:3 row_mask:0xf bank_mask:0xf
 v_mfma_f32_16x16x32_bf16 v[164:167], a[212:215], a[4:7], v[164:167]
 v_exp_f32 v160, v160
 v_mfma_f32_16x16x32_bf16 v[164:167], a[208:211], a[0:3], v[164:167]
 v_exp_f32 v161, v161
 v_smfmac_f32_16x16x64_bf16 v[132:135], v[236:239], v[176:183], v138
 v_cvt_pk_bf16_f32 v176, v160, v161
 v_mfma_f32_16x16x32_bf16 v[184:187], v[180:183], a[224:227], v[184:187]
 buffer_store_dwordx4 v[240:243], v244, s[20:23], s33 offen offset:2048 sc1
 v_mfma_f32_16x16x32_bf16 v[188:191], v[180:183], a[228:231], v[188:191]
 ds_read_b128 a[224:227], v248 offset:32768
 ds_read_b128 a[228:231], v248 offset:33280
 v_mfma_f32_16x16x32_bf16 v[192:195], v[180:183], a[232:235], v[192:195]
 ds_read_b128 a[232:235], v248 offset:33792
 v_cvt_pk_bf16_f32 v240, v67, v71
 v_mfma_f32_16x16x32_bf16 v[196:199], v[180:183], a[236:239], v[196:199]
 v_exp_f32 v162, v162
 v_mfma_f32_16x16x32_bf16 v[200:203], v[180:183], a[240:243], v[200:203]
 v_exp_f32 v163, v163
 v_mfma_f32_16x16x32_bf16 v[204:207], v[180:183], a[244:247], v[204:207]
 v_exp_f32 v164, v164
 v_mfma_f32_16x16x32_bf16 v[208:211], v[180:183], a[248:251], v[208:211]
 v_exp_f32 v165, v165
 v_mfma_f32_16x16x32_bf16 v[212:215], v[180:183], a[252:255], v[212:215]
 v_exp_f32 v166, v166
 v_mfma_f32_16x16x32_bf16 v[168:171], a[192:195], a[16:19], v[148:151]
 ds_read_b128 a[236:239], v248 offset:34304
 ds_read_b128 a[240:243], v248 offset:34816
 v_mfma_f32_16x16x32_bf16 v[168:171], a[196:199], a[20:23], v[168:171]
 v_exp_f32 v167, v167
 v_mfma_f32_16x16x32_bf16 v[168:171], a[200:203], a[24:27], v[168:171]
 ds_read_b128 a[244:247], v248 offset:35328
 ds_read_b128 a[248:251], v248 offset:35840
 v_mfma_f32_16x16x32_bf16 v[168:171], a[204:207], a[28:31], v[168:171]
 v_cvt_pk_bf16_f32 v177, v162, v163
 v_cvt_pk_bf16_f32 v178, v164, v165
 v_mfma_f32_16x16x32_bf16 v[172:175], a[220:223], a[28:31], v[148:151]
 ds_read_b128 a[252:255], v248 offset:36352
 v_cvt_pk_bf16_f32 v179, v166, v167
 v_mfma_f32_16x16x32_bf16 v[172:175], a[216:219], a[24:27], v[172:175]
 v_cvt_pk_bf16_f32 v241, v75, v79
 v_mul_f32_dpp v87, v217, v87 row_newbcast:3 row_mask:0xf bank_mask:0xf
 v_mfma_f32_16x16x32_bf16 v[172:175], a[212:215], a[20:23], v[172:175]
 v_exp_f32 v168, v168
 v_mfma_f32_16x16x32_bf16 v[172:175], a[208:211], a[16:19], v[172:175]
 s_waitcnt lgkmcnt(3)
 v_exp_f32 v169, v169
 v_mfma_f32_16x16x32_bf16 v[0:3], v[176:179], a[224:227], v[0:3]
 v_exp_f32 v170, v170
 v_mfma_f32_16x16x32_bf16 v[4:7], v[176:179], a[228:231], v[4:7]
 v_exp_f32 v171, v171
 v_mfma_f32_16x16x32_bf16 v[8:11], v[176:179], a[232:235], v[8:11]
 v_cvt_pk_bf16_f32 v180, v168, v169
 v_cvt_pk_bf16_f32 v181, v170, v171
 v_mfma_f32_16x16x32_bf16 v[12:15], v[176:179], a[236:239], v[12:15]
 v_exp_f32 v172, v172
 v_mfma_f32_16x16x32_bf16 v[16:19], v[176:179], a[240:243], v[16:19]
 s_waitcnt lgkmcnt(0)
 v_exp_f32 v173, v173
 v_mfma_f32_16x16x32_bf16 v[20:23], v[176:179], a[244:247], v[20:23]
 v_exp_f32 v174, v174
 v_mfma_f32_16x16x32_bf16 v[24:27], v[176:179], a[248:251], v[24:27]
 v_exp_f32 v175, v175
 v_mfma_f32_16x16x32_bf16 v[28:31], v[176:179], a[252:255], v[28:31]
 v_cvt_pk_bf16_f32 v182, v172, v173
 v_cvt_pk_bf16_f32 v183, v174, v175
 v_mfma_f32_16x16x32_bf16 v[160:163], a[192:195], a[48:51], v[152:155]
 v_cvt_pk_bf16_f32 v242, v83, v87
 v_mul_f32_dpp v91, v217, v91 row_newbcast:3 row_mask:0xf bank_mask:0xf
 v_mfma_f32_16x16x32_bf16 v[160:163], a[196:199], a[52:55], v[160:163]
 v_mul_f32_dpp v95, v217, v95 row_newbcast:3 row_mask:0xf bank_mask:0xf
 v_cvt_pk_bf16_f32 v243, v91, v95
 v_mfma_f32_16x16x32_bf16 v[160:163], a[200:203], a[56:59], v[160:163]
 buffer_store_dwordx4 v[240:243], v244, s[20:23], s33 offen offset:3072 sc1
 v_mfma_f32_16x16x32_bf16 v[160:163], a[204:207], a[60:63], v[160:163]
 s_nop 1
 v_mfma_f32_16x16x32_bf16 v[164:167], a[220:223], a[60:63], v[152:155]
 s_nop 1
 v_mfma_f32_16x16x32_bf16 v[164:167], a[216:219], a[56:59], v[164:167]
 s_nop 1
 v_mfma_f32_16x16x32_bf16 v[164:167], a[212:215], a[52:55], v[164:167]
 v_exp_f32 v160, v160
 v_mfma_f32_16x16x32_bf16 v[164:167], a[208:211], a[48:51], v[164:167]
 v_exp_f32 v161, v161
 v_smfmac_f32_16x16x64_bf16 v[128:131], v[236:239], v[176:183], v138
 v_cvt_pk_bf16_f32 v176, v160, v161
 v_mfma_f32_16x16x32_bf16 v[32:35], v[180:183], a[224:227], v[32:35]
 v_exp_f32 v162, v162
 v_mfma_f32_16x16x32_bf16 v[36:39], v[180:183], a[228:231], v[36:39]
 v_exp_f32 v163, v163
 v_mfma_f32_16x16x32_bf16 v[40:43], v[180:183], a[232:235], v[40:43]
 v_exp_f32 v164, v164
 v_mfma_f32_16x16x32_bf16 v[44:47], v[180:183], a[236:239], v[44:47]
 v_exp_f32 v165, v165
 v_mfma_f32_16x16x32_bf16 v[48:51], v[180:183], a[240:243], v[48:51]
 v_exp_f32 v166, v166
 v_mfma_f32_16x16x32_bf16 v[52:55], v[180:183], a[244:247], v[52:55]
 v_exp_f32 v167, v167
 v_mfma_f32_16x16x32_bf16 v[56:59], v[180:183], a[248:251], v[56:59]
 v_cvt_pk_bf16_f32 v177, v162, v163
 v_cvt_pk_bf16_f32 v178, v164, v165
 v_mfma_f32_16x16x32_bf16 v[60:63], v[180:183], a[252:255], v[60:63]
 v_cvt_pk_bf16_f32 v179, v166, v167
 v_mfma_f32_16x16x32_bf16 v[168:171], a[192:195], v[220:223], v[156:159]
 ds_read_b128 a[192:195], v249 offset:40960
 v_mfma_f32_16x16x32_bf16 v[168:171], a[196:199], v[224:227], v[168:171]
 ds_read_b128 a[196:199], v249 offset:41472
 v_mfma_f32_16x16x32_bf16 v[168:171], a[200:203], v[228:231], v[168:171]
 ds_read_b128 a[200:203], v249 offset:41984
 v_mfma_f32_16x16x32_bf16 v[168:171], a[204:207], v[232:235], v[168:171]
 ds_read_b128 a[204:207], v249 offset:42496
 s_nop 0
 v_mfma_f32_16x16x32_bf16 v[172:175], a[220:223], v[232:235], v[156:159]
 ds_read_b128 a[220:223], v249 offset:44544
 s_nop 0
 v_mfma_f32_16x16x32_bf16 v[172:175], a[216:219], v[228:231], v[172:175]
 ds_read_b128 a[216:219], v249 offset:44032
 s_nop 0
 v_mfma_f32_16x16x32_bf16 v[172:175], a[212:215], v[224:227], v[172:175]
 v_exp_f32 v168, v168
 v_mfma_f32_16x16x32_bf16 v[172:175], a[208:211], v[220:223], v[172:175]
 ds_read_b128 a[208:211], v249 offset:43008
 ds_read_b128 a[212:215], v249 offset:43520
 v_mfma_f32_16x16x32_bf16 v[96:99], v[176:179], a[224:227], v[96:99]
 v_exp_f32 v169, v169
 v_mfma_f32_16x16x32_bf16 v[100:103], v[176:179], a[228:231], v[100:103]
 v_exp_f32 v170, v170
 v_mfma_f32_16x16x32_bf16 v[104:107], v[176:179], a[232:235], v[104:107]
 v_exp_f32 v171, v171
 v_mfma_f32_16x16x32_bf16 v[108:111], v[176:179], a[236:239], v[108:111]
 v_exp_f32 v172, v172
 v_mfma_f32_16x16x32_bf16 v[112:115], v[176:179], a[240:243], v[112:115]
 v_exp_f32 v173, v173
 v_mfma_f32_16x16x32_bf16 v[116:119], v[176:179], a[244:247], v[116:119]
 v_exp_f32 v174, v174
 v_mfma_f32_16x16x32_bf16 v[120:123], v[176:179], a[248:251], v[120:123]
 v_exp_f32 v175, v175
 v_mfma_f32_16x16x32_bf16 v[124:127], v[176:179], a[252:255], v[124:127]
 s_waitcnt lgkmcnt(0)
 v_cvt_pk_bf16_f32 v180, v168, v169
 v_cvt_pk_bf16_f32 v181, v170, v171
 v_mfma_f32_16x16x32_bf16 v[160:163], a[192:195], a[0:3], v[144:147]
 v_cvt_pk_bf16_f32 v182, v172, v173
 v_cvt_pk_bf16_f32 v183, v174, v175
 v_mfma_f32_16x16x32_bf16 v[160:163], a[196:199], a[4:7], v[160:163]
 v_mfma_f32_16x16x32_bf16 v[160:163], a[200:203], a[8:11], v[160:163]
 v_mfma_f32_16x16x32_bf16 v[160:163], a[204:207], a[12:15], v[160:163]
 s_nop 1
 v_mfma_f32_16x16x32_bf16 v[164:167], a[220:223], a[12:15], v[144:147]
 s_nop 1
 v_mfma_f32_16x16x32_bf16 v[164:167], a[216:219], a[8:11], v[164:167]
 s_nop 1
 v_mfma_f32_16x16x32_bf16 v[164:167], a[212:215], a[4:7], v[164:167]
 v_exp_f32 v160, v160
 v_mfma_f32_16x16x32_bf16 v[164:167], a[208:211], a[0:3], v[164:167]
 v_exp_f32 v161, v161
 v_smfmac_f32_16x16x64_bf16 v[132:135], v[236:239], v[176:183], v138
 v_cvt_pk_bf16_f32 v176, v160, v161
 v_mfma_f32_16x16x32_bf16 v[184:187], v[180:183], a[224:227], v[184:187]
 v_exp_f32 v162, v162
 v_mfma_f32_16x16x32_bf16 v[188:191], v[180:183], a[228:231], v[188:191]
 ds_read_b128 a[224:227], v248 offset:40960
 ds_read_b128 a[228:231], v248 offset:41472
 v_mfma_f32_16x16x32_bf16 v[192:195], v[180:183], a[232:235], v[192:195]
 v_exp_f32 v163, v163
 v_mfma_f32_16x16x32_bf16 v[196:199], v[180:183], a[236:239], v[196:199]
 ds_read_b128 a[232:235], v248 offset:41984
 ds_read_b128 a[236:239], v248 offset:42496
 v_mfma_f32_16x16x32_bf16 v[200:203], v[180:183], a[240:243], v[200:203]
 v_exp_f32 v164, v164
 v_mfma_f32_16x16x32_bf16 v[204:207], v[180:183], a[244:247], v[204:207]
 v_exp_f32 v165, v165
 v_mfma_f32_16x16x32_bf16 v[208:211], v[180:183], a[248:251], v[208:211]
 v_exp_f32 v166, v166
 v_mfma_f32_16x16x32_bf16 v[212:215], v[180:183], a[252:255], v[212:215]
 v_exp_f32 v167, v167
 v_mfma_f32_16x16x32_bf16 v[168:171], a[192:195], a[16:19], v[148:151]
 ds_read_b128 a[240:243], v248 offset:43008
 ds_read_b128 a[244:247], v248 offset:43520
 v_mfma_f32_16x16x32_bf16 v[168:171], a[196:199], a[20:23], v[168:171]
 ds_read_b128 a[248:251], v248 offset:44032
 v_cvt_pk_bf16_f32 v177, v162, v163
 v_mfma_f32_16x16x32_bf16 v[168:171], a[200:203], a[24:27], v[168:171]
 v_cvt_pk_bf16_f32 v178, v164, v165
 v_cvt_pk_bf16_f32 v179, v166, v167
 v_mfma_f32_16x16x32_bf16 v[168:171], a[204:207], a[28:31], v[168:171]
 ds_read_b128 a[252:255], v248 offset:44544
 s_nop 0
 v_mfma_f32_16x16x32_bf16 v[172:175], a[220:223], a[28:31], v[148:151]
 s_nop 1
 v_mfma_f32_16x16x32_bf16 v[172:175], a[216:219], a[24:27], v[172:175]
 s_nop 1
 v_mfma_f32_16x16x32_bf16 v[172:175], a[212:215], a[20:23], v[172:175]
 v_exp_f32 v168, v168
 v_mfma_f32_16x16x32_bf16 v[172:175], a[208:211], a[16:19], v[172:175]
 s_waitcnt lgkmcnt(2)
 v_exp_f32 v169, v169
 v_mfma_f32_16x16x32_bf16 v[0:3], v[176:179], a[224:227], v[0:3]
 v_exp_f32 v170, v170
 v_mfma_f32_16x16x32_bf16 v[4:7], v[176:179], a[228:231], v[4:7]
 v_exp_f32 v171, v171
 v_mfma_f32_16x16x32_bf16 v[8:11], v[176:179], a[232:235], v[8:11]
 v_cvt_pk_bf16_f32 v180, v168, v169
 v_cvt_pk_bf16_f32 v181, v170, v171
 v_mfma_f32_16x16x32_bf16 v[12:15], v[176:179], a[236:239], v[12:15]
 v_exp_f32 v172, v172
 v_mfma_f32_16x16x32_bf16 v[16:19], v[176:179], a[240:243], v[16:19]
 v_exp_f32 v173, v173
 v_mfma_f32_16x16x32_bf16 v[20:23], v[176:179], a[244:247], v[20:23]
 s_waitcnt lgkmcnt(0)
 v_exp_f32 v174, v174
 v_mfma_f32_16x16x32_bf16 v[24:27], v[176:179], a[248:251], v[24:27]
 v_exp_f32 v175, v175
 v_mfma_f32_16x16x32_bf16 v[28:31], v[176:179], a[252:255], v[28:31]
 v_cvt_pk_bf16_f32 v182, v172, v173
 v_cvt_pk_bf16_f32 v183, v174, v175
 v_mfma_f32_16x16x32_bf16 v[160:163], a[192:195], a[48:51], v[152:155]
 v_mfma_f32_16x16x32_bf16 v[160:163], a[196:199], a[52:55], v[160:163]
 v_mfma_f32_16x16x32_bf16 v[160:163], a[200:203], a[56:59], v[160:163]
 v_mfma_f32_16x16x32_bf16 v[160:163], a[204:207], a[60:63], v[160:163]
 s_nop 1
 v_mfma_f32_16x16x32_bf16 v[164:167], a[220:223], a[60:63], v[152:155]
 buffer_load_dwordx4 a[60:63], v245, s[8:11], s32 offen offset:192
 v_mfma_f32_16x16x32_bf16 v[164:167], a[216:219], a[56:59], v[164:167]
 s_nop 1
 v_mfma_f32_16x16x32_bf16 v[164:167], a[212:215], a[52:55], v[164:167]
 v_exp_f32 v161, v161
 v_mfma_f32_16x16x32_bf16 v[164:167], a[208:211], a[48:51], v[164:167]
 v_exp_f32 v162, v162
 v_smfmac_f32_16x16x64_bf16 v[128:131], v[236:239], v[176:183], v138
 s_nop 0
 v_mfma_f32_16x16x32_bf16 v[32:35], v[180:183], a[224:227], v[32:35]
 buffer_load_dwordx4 a[48:51], v245, s[8:11], s32 offen offset:0
 v_mfma_f32_16x16x32_bf16 v[36:39], v[180:183], a[228:231], v[36:39]
 v_exp_f32 v163, v163
 v_mfma_f32_16x16x32_bf16 v[40:43], v[180:183], a[232:235], v[40:43]
 v_exp_f32 v164, v164
 v_mfma_f32_16x16x32_bf16 v[44:47], v[180:183], a[236:239], v[44:47]
 v_exp_f32 v165, v165
 v_mfma_f32_16x16x32_bf16 v[48:51], v[180:183], a[240:243], v[48:51]
 buffer_load_dwordx4 a[52:55], v245, s[8:11], s32 offen offset:64
 v_mfma_f32_16x16x32_bf16 v[52:55], v[180:183], a[244:247], v[52:55]
 v_exp_f32 v166, v166
 v_mfma_f32_16x16x32_bf16 v[56:59], v[180:183], a[248:251], v[56:59]
 v_exp_f32 v160, v160
 v_mfma_f32_16x16x32_bf16 v[60:63], v[180:183], a[252:255], v[60:63]
 v_exp_f32 v167, v167
 v_mfma_f32_16x16x32_bf16 v[168:171], a[192:195], v[220:223], v[156:159]
 buffer_load_dwordx4 a[56:59], v245, s[8:11], s32 offen offset:128
 v_mfma_f32_16x16x32_bf16 v[168:171], a[196:199], v[224:227], v[168:171]
 v_cvt_pk_bf16_f32 v176, v160, v161
 v_cvt_pk_bf16_f32 v177, v162, v163
 v_mfma_f32_16x16x32_bf16 v[168:171], a[200:203], v[228:231], v[168:171]
 v_cvt_pk_bf16_f32 v178, v164, v165
 v_cvt_pk_bf16_f32 v179, v166, v167
 v_mfma_f32_16x16x32_bf16 v[168:171], a[204:207], v[232:235], v[168:171]
 ds_read_b128 a[192:195], v249 offset:49152
 ds_read_b128 a[196:199], v249 offset:49664
 v_mfma_f32_16x16x32_bf16 v[172:175], a[220:223], v[232:235], v[156:159]
 ds_read_b128 a[204:207], v249 offset:50688
 ds_read_b128 a[200:203], v249 offset:50176
 v_mfma_f32_16x16x32_bf16 v[172:175], a[216:219], v[228:231], v[172:175]
 ds_read_b128 a[216:219], v249 offset:52224
 ds_read_b128 a[220:223], v249 offset:52736
 v_mfma_f32_16x16x32_bf16 v[172:175], a[212:215], v[224:227], v[172:175]
 v_exp_f32 v168, v168
 v_mfma_f32_16x16x32_bf16 v[172:175], a[208:211], v[220:223], v[172:175]
 ds_read_b128 a[208:211], v249 offset:51200
 ds_read_b128 a[212:215], v249 offset:51712
 v_mfma_f32_16x16x32_bf16 v[96:99], v[176:179], a[224:227], v[96:99]
 v_exp_f32 v169, v169
 v_mfma_f32_16x16x32_bf16 v[100:103], v[176:179], a[228:231], v[100:103]
 v_exp_f32 v170, v170
 v_mfma_f32_16x16x32_bf16 v[104:107], v[176:179], a[232:235], v[104:107]
 v_exp_f32 v171, v171
 v_mfma_f32_16x16x32_bf16 v[108:111], v[176:179], a[236:239], v[108:111]
 v_exp_f32 v172, v172
 v_mfma_f32_16x16x32_bf16 v[112:115], v[176:179], a[240:243], v[112:115]
 v_exp_f32 v173, v173
 v_mfma_f32_16x16x32_bf16 v[116:119], v[176:179], a[244:247], v[116:119]
 v_exp_f32 v174, v174
 v_mfma_f32_16x16x32_bf16 v[120:123], v[176:179], a[248:251], v[120:123]
 v_exp_f32 v175, v175
 v_mfma_f32_16x16x32_bf16 v[124:127], v[176:179], a[252:255], v[124:127]
 s_waitcnt vmcnt(8) lgkmcnt(0)
 v_cvt_pk_bf16_f32 v180, v168, v169
 v_cvt_pk_bf16_f32 v181, v170, v171
 v_mfma_f32_16x16x32_bf16 v[252:255], a[192:195], a[32:35], 0
 v_cvt_pk_bf16_f32 v182, v172, v173
 v_cvt_pk_bf16_f32 v183, v174, v175
 v_mfma_f32_16x16x32_bf16 v[252:255], a[196:199], a[36:39], v[252:255]
 v_mfma_f32_16x16x32_bf16 v[252:255], a[200:203], a[40:43], v[252:255]
 v_mfma_f32_16x16x32_bf16 v[252:255], a[204:207], a[44:47], v[252:255]
 s_nop 1
 v_mfma_f32_16x16x32_bf16 v[160:163], a[192:195], a[0:3], v[144:147]
 s_nop 1
 v_mfma_f32_16x16x32_bf16 v[160:163], a[196:199], a[4:7], v[160:163]
 s_nop 1
 v_mfma_f32_16x16x32_bf16 v[160:163], a[200:203], a[8:11], v[160:163]
 v_max3_f32 v246, v252, v253, v254
 v_max_f32 v246, v246, v255
 v_mfma_f32_16x16x32_bf16 v[160:163], a[204:207], a[12:15], v[160:163]
 v_mov_b32 v247, v246
 s_nop 0
 v_mfma_f32_16x16x32_bf16 v[164:167], a[220:223], a[12:15], v[144:147]
 v_permlane16_swap_b32 v246, v247
 v_max_f32 v246, v246, v247
 v_mfma_f32_16x16x32_bf16 v[164:167], a[216:219], a[8:11], v[164:167]
 v_mov_b32 v247, v246
 s_nop 0
 v_mfma_f32_16x16x32_bf16 v[164:167], a[212:215], a[4:7], v[164:167]
 v_exp_f32 v160, v160
 v_mfma_f32_16x16x32_bf16 v[164:167], a[208:211], a[0:3], v[164:167]
 v_exp_f32 v161, v161
 v_smfmac_f32_16x16x64_bf16 v[132:135], v[236:239], v[176:183], v138
 v_cvt_pk_bf16_f32 v176, v160, v161
 v_mfma_f32_16x16x32_bf16 v[184:187], v[180:183], a[224:227], v[184:187]
 v_exp_f32 v162, v162
 v_mfma_f32_16x16x32_bf16 v[188:191], v[180:183], a[228:231], v[188:191]
 v_exp_f32 v163, v163
 v_mfma_f32_16x16x32_bf16 v[192:195], v[180:183], a[232:235], v[192:195]
 v_exp_f32 v166, v166
 v_mfma_f32_16x16x32_bf16 v[196:199], v[180:183], a[236:239], v[196:199]
 v_exp_f32 v167, v167
 v_mfma_f32_16x16x32_bf16 v[200:203], v[180:183], a[240:243], v[200:203]
 v_exp_f32 v164, v164
 v_mfma_f32_16x16x32_bf16 v[204:207], v[180:183], a[244:247], v[204:207]
 v_exp_f32 v165, v165
 v_mfma_f32_16x16x32_bf16 v[208:211], v[180:183], a[248:251], v[208:211]
 ds_read_b128 a[224:227], v248 offset:49152
 v_cvt_pk_bf16_f32 v177, v162, v163
 v_cvt_pk_bf16_f32 v178, v164, v165
 v_mfma_f32_16x16x32_bf16 v[212:215], v[180:183], a[252:255], v[212:215]
 ds_read_b128 a[228:231], v248 offset:49664
 v_cvt_pk_bf16_f32 v179, v166, v167
 v_mfma_f32_16x16x32_bf16 v[168:171], a[192:195], a[16:19], v[148:151]
 ds_read_b128 a[232:235], v248 offset:50176
 ds_read_b128 a[252:255], v248 offset:52736
 v_mfma_f32_16x16x32_bf16 v[168:171], a[196:199], a[20:23], v[168:171]
 ds_read_b128 a[236:239], v248 offset:50688
 v_permlane32_swap_b32 v246, v247
 v_mfma_f32_16x16x32_bf16 v[168:171], a[200:203], a[24:27], v[168:171]
 ds_read_b128 a[240:243], v248 offset:51200
 v_min_f32 v246, -v246, -v247
 v_mfma_f32_16x16x32_bf16 v[168:171], a[204:207], a[28:31], v[168:171]
 ds_read_b128 a[244:247], v248 offset:51712
 v_mov_b32 v152, v246
 v_mov_b32 v153, v246
 v_mfma_f32_16x16x32_bf16 v[172:175], a[220:223], a[28:31], v[148:151]
 ds_read_b128 a[248:251], v248 offset:52224
 v_mov_b32 v154, v246
 v_mov_b32 v155, v246
 v_mfma_f32_16x16x32_bf16 v[172:175], a[216:219], a[24:27], v[172:175]
 v_exp_f32 v168, v168
 v_mfma_f32_16x16x32_bf16 v[172:175], a[212:215], a[20:23], v[172:175]
 v_exp_f32 v169, v169
 v_mfma_f32_16x16x32_bf16 v[172:175], a[208:211], a[16:19], v[172:175]
 s_waitcnt lgkmcnt(4)
 v_exp_f32 v170, v170
 v_mfma_f32_16x16x32_bf16 v[0:3], v[176:179], a[224:227], v[0:3]
 v_exp_f32 v171, v171
 v_mfma_f32_16x16x32_bf16 v[4:7], v[176:179], a[228:231], v[4:7]
 v_cvt_pk_bf16_f32 v180, v168, v169
 v_cvt_pk_bf16_f32 v181, v170, v171
 v_mfma_f32_16x16x32_bf16 v[8:11], v[176:179], a[232:235], v[8:11]
 s_waitcnt lgkmcnt(1)
 v_add_f32 v252, v252, v246
 v_add_f32 v253, v253, v246
 v_mfma_f32_16x16x32_bf16 v[12:15], v[176:179], a[236:239], v[12:15]
 v_add_f32 v254, v254, v246
 v_add_f32 v255, v255, v246
 v_mfma_f32_16x16x32_bf16 v[16:19], v[176:179], a[240:243], v[16:19]
 v_exp_f32 v172, v172
 v_mfma_f32_16x16x32_bf16 v[20:23], v[176:179], a[244:247], v[20:23]
 s_waitcnt lgkmcnt(0)
 v_exp_f32 v173, v173
 v_mfma_f32_16x16x32_bf16 v[24:27], v[176:179], a[248:251], v[24:27]
 v_exp_f32 v174, v174
 v_mfma_f32_16x16x32_bf16 v[28:31], v[176:179], a[252:255], v[28:31]
 v_exp_f32 v175, v175
 v_mfma_f32_16x16x32_bf16 v[164:167], a[220:223], a[44:47], v[152:155]
 v_exp_f32 v252, v252
 v_mfma_f32_16x16x32_bf16 v[164:167], a[216:219], a[40:43], v[164:167]
 v_cvt_pk_bf16_f32 v182, v172, v173
 v_cvt_pk_bf16_f32 v183, v174, v175
 v_mfma_f32_16x16x32_bf16 v[164:167], a[212:215], a[36:39], v[164:167]
 v_exp_f32 v253, v253
 v_mfma_f32_16x16x32_bf16 v[164:167], a[208:211], a[32:35], v[164:167]
 v_exp_f32 v254, v254
 v_smfmac_f32_16x16x64_bf16 v[128:131], v[236:239], v[176:183], v138
 v_cvt_pk_bf16_f32 v176, v252, v253
 v_mfma_f32_16x16x32_bf16 v[32:35], v[180:183], a[224:227], v[32:35]
 v_exp_f32 v255, v255
 v_mfma_f32_16x16x32_bf16 v[36:39], v[180:183], a[228:231], v[36:39]
 v_cvt_pk_bf16_f32 v177, v254, v255
 v_add_f32 v218, v132, v133
 v_mfma_f32_16x16x32_bf16 v[40:43], v[180:183], a[232:235], v[40:43]
 v_exp_f32 v164, v164
 v_mfma_f32_16x16x32_bf16 v[44:47], v[180:183], a[236:239], v[44:47]
 v_exp_f32 v165, v165
 v_mfma_f32_16x16x32_bf16 v[48:51], v[180:183], a[240:243], v[48:51]
 v_exp_f32 v166, v166
 v_mfma_f32_16x16x32_bf16 v[52:55], v[180:183], a[244:247], v[52:55]
 v_exp_f32 v167, v167
 v_mfma_f32_16x16x32_bf16 v[56:59], v[180:183], a[248:251], v[56:59]
 v_cvt_pk_bf16_f32 v178, v164, v165
 v_cvt_pk_bf16_f32 v179, v166, v167
 v_mfma_f32_16x16x32_bf16 v[60:63], v[180:183], a[252:255], v[60:63]
 v_mov_b32 v132, 0
 v_mov_b32 v133, 0
 v_mfma_f32_16x16x32_bf16 v[168:171], a[192:195], v[220:223], v[156:159]
 ds_read_b128 a[192:195], v249 offset:57344
 v_cmp_nge_f32 vcc, s28, v218
 v_mfma_f32_16x16x32_bf16 v[168:171], a[196:199], v[224:227], v[168:171]
 s_cmp_lg_u64 vcc, 0
 v_rcp_f32 v218, v218
 v_mfma_f32_16x16x32_bf16 v[168:171], a[200:203], v[228:231], v[168:171]
 s_cselect_b32 s34, 262144, 0
 ds_read_b128 a[196:199], v249 offset:57856
 ds_read_b128 a[200:203], v249 offset:58368
 v_mfma_f32_16x16x32_bf16 v[168:171], a[204:207], v[232:235], v[168:171]
 s_or_b32 s29, s29, s34
 ds_read_b128 a[204:207], v249 offset:58880
 v_mov_b32_dpp v218, v218 row_shl:4 row_mask:0x2 bank_mask:0xf
 v_mfma_f32_16x16x32_bf16 v[172:175], a[220:223], v[232:235], v[156:159]
 s_add_u32 s33, s25, 73728
 ds_read_b128 a[220:223], v249 offset:60928
 v_mov_b32_dpp v218, v218 row_shl:8 row_mask:0x4 bank_mask:0xf
 v_mfma_f32_16x16x32_bf16 v[172:175], a[216:219], v[228:231], v[172:175]
 v_exp_f32 v168, v168
 v_mfma_f32_16x16x32_bf16 v[172:175], a[212:215], v[224:227], v[172:175]
 v_exp_f32 v169, v169
 v_mfma_f32_16x16x32_bf16 v[172:175], a[208:211], v[220:223], v[172:175]
 ds_read_b128 a[216:219], v249 offset:60416
 ds_read_b128 a[212:215], v249 offset:59904
 v_mfma_f32_16x16x32_bf16 v[64:67], v[176:179], a[224:227], 0
 v_exp_f32 v170, v170
 v_mfma_f32_16x16x32_bf16 v[68:71], v[176:179], a[228:231], 0
 v_exp_f32 v171, v171
 v_mfma_f32_16x16x32_bf16 v[72:75], v[176:179], a[232:235], 0
 ds_read_b128 a[208:211], v249 offset:59392
 v_cvt_pk_bf16_f32 v180, v168, v169
 v_mfma_f32_16x16x32_bf16 v[76:79], v[176:179], a[236:239], 0
 v_exp_f32 v172, v172
 v_mfma_f32_16x16x32_bf16 v[80:83], v[176:179], a[240:243], 0
 v_exp_f32 v173, v173
 v_mfma_f32_16x16x32_bf16 v[84:87], v[176:179], a[244:247], 0
 v_exp_f32 v174, v174
 v_mfma_f32_16x16x32_bf16 v[88:91], v[176:179], a[248:251], 0
 v_exp_f32 v175, v175
 v_mfma_f32_16x16x32_bf16 v[92:95], v[176:179], a[252:255], 0
 s_waitcnt lgkmcnt(1)
 v_cvt_pk_bf16_f32 v181, v170, v171
 v_cvt_pk_bf16_f32 v182, v172, v173
 v_mfma_f32_16x16x32_bf16 v[160:163], a[192:195], a[0:3], v[144:147]
 v_cvt_pk_bf16_f32 v183, v174, v175
 v_mov_b32_dpp v218, v218 row_shl:12 row_mask:0x8 bank_mask:0xf
 v_mfma_f32_16x16x32_bf16 v[160:163], a[196:199], a[4:7], v[160:163]
 s_nop 1
 v_mfma_f32_16x16x32_bf16 v[160:163], a[200:203], a[8:11], v[160:163]
 v_mul_f32_dpp v96, v218, v96 row_newbcast:0 row_mask:0xf bank_mask:0xf
 v_mul_f32_dpp v100, v218, v100 row_newbcast:0 row_mask:0xf bank_mask:0xf
 v_mfma_f32_16x16x32_bf16 v[160:163], a[204:207], a[12:15], v[160:163]
 v_cvt_pk_bf16_f32 v240, v96, v100
 v_mul_f32_dpp v104, v218, v104 row_newbcast:0 row_mask:0xf bank_mask:0xf
 v_mfma_f32_16x16x32_bf16 v[164:167], a[220:223], a[12:15], v[144:147]
 v_mul_f32_dpp v108, v218, v108 row_newbcast:0 row_mask:0xf bank_mask:0xf
 v_cvt_pk_bf16_f32 v241, v104, v108
 v_mfma_f32_16x16x32_bf16 v[164:167], a[216:219], a[8:11], v[164:167]
 v_mul_f32_dpp v112, v218, v112 row_newbcast:0 row_mask:0xf bank_mask:0xf
 v_mul_f32_dpp v116, v218, v116 row_newbcast:0 row_mask:0xf bank_mask:0xf
 v_mfma_f32_16x16x32_bf16 v[164:167], a[212:215], a[4:7], v[164:167]
 s_waitcnt lgkmcnt(0)
 v_exp_f32 v160, v160
 v_mfma_f32_16x16x32_bf16 v[164:167], a[208:211], a[0:3], v[164:167]
 v_exp_f32 v161, v161
 v_smfmac_f32_16x16x64_bf16 v[132:135], v[236:239], v[176:183], v138
 v_cvt_pk_bf16_f32 v176, v160, v161
 v_mfma_f32_16x16x32_bf16 v[184:187], v[180:183], a[224:227], v[184:187]
 ds_read_b128 a[224:227], v248 offset:57344
 v_cvt_pk_bf16_f32 v242, v112, v116
 v_mfma_f32_16x16x32_bf16 v[188:191], v[180:183], a[228:231], v[188:191]
 ds_read_b128 a[228:231], v248 offset:57856
 v_mul_f32_dpp v120, v218, v120 row_newbcast:0 row_mask:0xf bank_mask:0xf
 v_mfma_f32_16x16x32_bf16 v[192:195], v[180:183], a[232:235], v[192:195]
 ds_read_b128 a[232:235], v248 offset:58368
 v_mul_f32_dpp v124, v218, v124 row_newbcast:0 row_mask:0xf bank_mask:0xf
 v_mfma_f32_16x16x32_bf16 v[196:199], v[180:183], a[236:239], v[196:199]
 v_exp_f32 v162, v162
 v_mfma_f32_16x16x32_bf16 v[200:203], v[180:183], a[240:243], v[200:203]
 v_exp_f32 v163, v163
 v_mfma_f32_16x16x32_bf16 v[204:207], v[180:183], a[244:247], v[204:207]
 v_exp_f32 v164, v164
 v_mfma_f32_16x16x32_bf16 v[208:211], v[180:183], a[248:251], v[208:211]
 v_exp_f32 v165, v165
 v_mfma_f32_16x16x32_bf16 v[212:215], v[180:183], a[252:255], v[212:215]
 v_exp_f32 v166, v166
 v_mfma_f32_16x16x32_bf16 v[168:171], a[192:195], a[16:19], v[148:151]
 ds_read_b128 a[236:239], v248 offset:58880
 ds_read_b128 a[240:243], v248 offset:59392
 v_mfma_f32_16x16x32_bf16 v[168:171], a[196:199], a[20:23], v[168:171]
 v_exp_f32 v167, v167
 v_mfma_f32_16x16x32_bf16 v[168:171], a[200:203], a[24:27], v[168:171]
 ds_read_b128 a[244:247], v248 offset:59904
 ds_read_b128 a[248:251], v248 offset:60416
 v_mfma_f32_16x16x32_bf16 v[168:171], a[204:207], a[28:31], v[168:171]
 v_cvt_pk_bf16_f32 v177, v162, v163
 v_cvt_pk_bf16_f32 v178, v164, v165
 v_mfma_f32_16x16x32_bf16 v[172:175], a[220:223], a[28:31], v[148:151]
 ds_read_b128 a[252:255], v248 offset:60928
 v_cvt_pk_bf16_f32 v179, v166, v167
 v_mfma_f32_16x16x32_bf16 v[172:175], a[216:219], a[24:27], v[172:175]
 v_cvt_pk_bf16_f32 v243, v120, v124
 v_mul_f32_dpp v97, v218, v97 row_newbcast:1 row_mask:0xf bank_mask:0xf
 v_mfma_f32_16x16x32_bf16 v[172:175], a[212:215], a[20:23], v[172:175]
 buffer_store_dwordx4 v[240:243], v244, s[20:23], s33 offen offset:0 sc1
 v_mfma_f32_16x16x32_bf16 v[172:175], a[208:211], a[16:19], v[172:175]
 s_waitcnt lgkmcnt(3)
 v_exp_f32 v168, v168
 v_mfma_f32_16x16x32_bf16 v[0:3], v[176:179], a[224:227], v[0:3]
 v_exp_f32 v169, v169
 v_mfma_f32_16x16x32_bf16 v[4:7], v[176:179], a[228:231], v[4:7]
 v_exp_f32 v170, v170
 v_mfma_f32_16x16x32_bf16 v[8:11], v[176:179], a[232:235], v[8:11]
 v_exp_f32 v171, v171
 v_mfma_f32_16x16x32_bf16 v[12:15], v[176:179], a[236:239], v[12:15]
 v_exp_f32 v172, v172
 v_mfma_f32_16x16x32_bf16 v[16:19], v[176:179], a[240:243], v[16:19]
 s_waitcnt lgkmcnt(0)
 v_exp_f32 v173, v173
 v_mfma_f32_16x16x32_bf16 v[20:23], v[176:179], a[244:247], v[20:23]
 v_exp_f32 v174, v174
 v_mfma_f32_16x16x32_bf16 v[24:27], v[176:179], a[248:251], v[24:27]
 v_exp_f32 v175, v175
 v_mfma_f32_16x16x32_bf16 v[28:31], v[176:179], a[252:255], v[28:31]
 v_cvt_pk_bf16_f32 v180, v168, v169
 v_cvt_pk_bf16_f32 v181, v170, v171
 v_mfma_f32_16x16x32_bf16 v[160:163], a[192:195], a[32:35], v[152:155]
 v_cvt_pk_bf16_f32 v182, v172, v173
 v_cvt_pk_bf16_f32 v183, v174, v175
 v_mfma_f32_16x16x32_bf16 v[160:163], a[196:199], a[36:39], v[160:163]
 v_mul_f32_dpp v101, v218, v101 row_newbcast:1 row_mask:0xf bank_mask:0xf
 v_cvt_pk_bf16_f32 v240, v97, v101
 v_mfma_f32_16x16x32_bf16 v[160:163], a[200:203], a[40:43], v[160:163]
 v_mul_f32_dpp v105, v218, v105 row_newbcast:1 row_mask:0xf bank_mask:0xf
 v_mul_f32_dpp v109, v218, v109 row_newbcast:1 row_mask:0xf bank_mask:0xf
 v_mfma_f32_16x16x32_bf16 v[160:163], a[204:207], a[44:47], v[160:163]
 v_cvt_pk_bf16_f32 v241, v105, v109
 v_mul_f32_dpp v113, v218, v113 row_newbcast:1 row_mask:0xf bank_mask:0xf
 v_mfma_f32_16x16x32_bf16 v[164:167], a[220:223], a[44:47], v[152:155]
 v_mul_f32_dpp v117, v218, v117 row_newbcast:1 row_mask:0xf bank_mask:0xf
 v_cvt_pk_bf16_f32 v242, v113, v117
 v_mfma_f32_16x16x32_bf16 v[164:167], a[216:219], a[40:43], v[164:167]
 v_mul_f32_dpp v121, v218, v121 row_newbcast:1 row_mask:0xf bank_mask:0xf
 v_mul_f32_dpp v125, v218, v125 row_newbcast:1 row_mask:0xf bank_mask:0xf
 v_mfma_f32_16x16x32_bf16 v[164:167], a[212:215], a[36:39], v[164:167]
 v_exp_f32 v160, v160
 v_mfma_f32_16x16x32_bf16 v[164:167], a[208:211], a[32:35], v[164:167]
 v_exp_f32 v161, v161
 v_smfmac_f32_16x16x64_bf16 v[128:131], v[236:239], v[176:183], v138
 v_cvt_pk_bf16_f32 v176, v160, v161
 v_mfma_f32_16x16x32_bf16 v[32:35], v[180:183], a[224:227], v[32:35]
 v_exp_f32 v162, v162
 v_mfma_f32_16x16x32_bf16 v[36:39], v[180:183], a[228:231], v[36:39]
 v_exp_f32 v163, v163
 v_mfma_f32_16x16x32_bf16 v[40:43], v[180:183], a[232:235], v[40:43]
 v_exp_f32 v164, v164
 v_mfma_f32_16x16x32_bf16 v[44:47], v[180:183], a[236:239], v[44:47]
 v_exp_f32 v165, v165
 v_mfma_f32_16x16x32_bf16 v[48:51], v[180:183], a[240:243], v[48:51]
 v_exp_f32 v166, v166
 v_mfma_f32_16x16x32_bf16 v[52:55], v[180:183], a[244:247], v[52:55]
 v_exp_f32 v167, v167
 v_mfma_f32_16x16x32_bf16 v[56:59], v[180:183], a[248:251], v[56:59]
 v_cvt_pk_bf16_f32 v177, v162, v163
 v_cvt_pk_bf16_f32 v178, v164, v165
 v_mfma_f32_16x16x32_bf16 v[60:63], v[180:183], a[252:255], v[60:63]
 v_cvt_pk_bf16_f32 v179, v166, v167
 v_cvt_pk_bf16_f32 v243, v121, v125
 v_mfma_f32_16x16x32_bf16 v[168:171], a[192:195], v[220:223], v[156:159]
 buffer_store_dwordx4 v[240:243], v244, s[20:23], s33 offen offset:1024 sc1
 v_mfma_f32_16x16x32_bf16 v[168:171], a[196:199], v[224:227], v[168:171]
 ds_read_b128 a[192:195], v250 offset:0
 ds_read_b128 a[196:199], v250 offset:512
 v_mfma_f32_16x16x32_bf16 v[168:171], a[200:203], v[228:231], v[168:171]
 ds_read_b128 a[200:203], v250 offset:1024
 v_mul_f32_dpp v98, v218, v98 row_newbcast:2 row_mask:0xf bank_mask:0xf
 v_mfma_f32_16x16x32_bf16 v[168:171], a[204:207], v[232:235], v[168:171]
 ds_read_b128 a[204:207], v250 offset:1536
 v_mul_f32_dpp v102, v218, v102 row_newbcast:2 row_mask:0xf bank_mask:0xf
 v_mfma_f32_16x16x32_bf16 v[172:175], a[220:223], v[232:235], v[156:159]
 ds_read_b128 a[220:223], v250 offset:3584
 v_cvt_pk_bf16_f32 v240, v98, v102
 v_mfma_f32_16x16x32_bf16 v[172:175], a[216:219], v[228:231], v[172:175]
L_pg18:
 s_cbranch_execz L_wb1
 ds_read_b128 a[216:219], v250 offset:3072
 v_mul_f32_dpp v106, v218, v106 row_newbcast:2 row_mask:0xf bank_mask:0xf
 v_mfma_f32_16x16x32_bf16 v[172:175], a[212:215], v[224:227], v[172:175]
 ds_read_b128 a[212:215], v250 offset:2560
 v_mul_f32_dpp v110, v218, v110 row_newbcast:2 row_mask:0xf bank_mask:0xf
 v_mfma_f32_16x16x32_bf16 v[172:175], a[208:211], v[220:223], v[172:175]
 ds_read_b128 a[208:211], v250 offset:2048
 v_cvt_pk_bf16_f32 v241, v106, v110
 v_mfma_f32_16x16x32_bf16 v[64:67], v[176:179], a[224:227], v[64:67]
 v_exp_f32 v168, v168
 v_mfma_f32_16x16x32_bf16 v[68:71], v[176:179], a[228:231], v[68:71]
 v_exp_f32 v169, v169
 v_mfma_f32_16x16x32_bf16 v[72:75], v[176:179], a[232:235], v[72:75]
 v_exp_f32 v170, v170
 v_mfma_f32_16x16x32_bf16 v[76:79], v[176:179], a[236:239], v[76:79]
 v_exp_f32 v171, v171
 v_mfma_f32_16x16x32_bf16 v[80:83], v[176:179], a[240:243], v[80:83]
 v_exp_f32 v172, v172
 v_mfma_f32_16x16x32_bf16 v[84:87], v[176:179], a[244:247], v[84:87]
 v_exp_f32 v173, v173
 v_mfma_f32_16x16x32_bf16 v[88:91], v[176:179], a[248:251], v[88:91]
 v_exp_f32 v174, v174
 v_mfma_f32_16x16x32_bf16 v[92:95], v[176:179], a[252:255], v[92:95]
 s_waitcnt lgkmcnt(0)
 v_exp_f32 v175, v175
 v_mfma_f32_16x16x32_bf16 v[160:163], a[192:195], a[0:3], v[144:147]
 v_cvt_pk_bf16_f32 v180, v168, v169
 v_cvt_pk_bf16_f32 v181, v170, v171
 v_mfma_f32_16x16x32_bf16 v[160:163], a[196:199], a[4:7], v[160:163]
 v_cvt_pk_bf16_f32 v182, v172, v173
 v_cvt_pk_bf16_f32 v183, v174, v175
 v_mfma_f32_16x16x32_bf16 v[160:163], a[200:203], a[8:11], v[160:163]
 v_mul_f32_dpp v114, v218, v114 row_newbcast:2 row_mask:0xf bank_mask:0xf
 v_mul_f32_dpp v118, v218, v118 row_newbcast:2 row_mask:0xf bank_mask:0xf
 v_mfma_f32_16x16x32_bf16 v[160:163], a[204:207], a[12:15], v[160:163]
 v_cvt_pk_bf16_f32 v242, v114, v118
 v_mul_f32_dpp v122, v218, v122 row_newbcast:2 row_mask:0xf bank_mask:0xf
 v_mfma_f32_16x16x32_bf16 v[164:167], a[220:223], a[12:15], v[144:147]
 v_mul_f32_dpp v126, v218, v126 row_newbcast:2 row_mask:0xf bank_mask:0xf
 v_cvt_pk_bf16_f32 v243, v122, v126
 v_mfma_f32_16x16x32_bf16 v[164:167], a[216:219], a[8:11], v[164:167]
 buffer_store_dwordx4 v[240:243], v244, s[20:23], s33 offen offset:2048 sc1
 v_mfma_f32_16x16x32_bf16 v[164:167], a[212:215], a[4:7], v[164:167]
 v_exp_f32 v160, v160
 v_mfma_f32_16x16x32_bf16 v[164:167], a[208:211], a[0:3], v[164:167]
 v_exp_f32 v161, v161
 v_smfmac_f32_16x16x64_bf16 v[132:135], v[236:239], v[176:183], v138
 v_cvt_pk_bf16_f32 v176, v160, v161
 v_mfma_f32_16x16x32_bf16 v[184:187], v[180:183], a[224:227], v[184:187]
 ds_read_b128 a[224:227], v249 offset:0
 v_mul_f32_dpp v99, v218, v99 row_newbcast:3 row_mask:0xf bank_mask:0xf
 v_mfma_f32_16x16x32_bf16 v[188:191], v[180:183], a[228:231], v[188:191]
 ds_read_b128 a[228:231], v249 offset:512
 v_mul_f32_dpp v103, v218, v103 row_newbcast:3 row_mask:0xf bank_mask:0xf
 v_mfma_f32_16x16x32_bf16 v[192:195], v[180:183], a[232:235], v[192:195]
 ds_read_b128 a[232:235], v249 offset:1024
 v_cvt_pk_bf16_f32 v240, v99, v103
 v_mfma_f32_16x16x32_bf16 v[196:199], v[180:183], a[236:239], v[196:199]
 v_exp_f32 v162, v162
 v_mfma_f32_16x16x32_bf16 v[200:203], v[180:183], a[240:243], v[200:203]
 v_exp_f32 v163, v163
 v_mfma_f32_16x16x32_bf16 v[204:207], v[180:183], a[244:247], v[204:207]
 v_exp_f32 v164, v164
 v_mfma_f32_16x16x32_bf16 v[208:211], v[180:183], a[248:251], v[208:211]
 v_exp_f32 v165, v165
 v_mfma_f32_16x16x32_bf16 v[212:215], v[180:183], a[252:255], v[212:215]
 v_exp_f32 v166, v166
 v_mfma_f32_16x16x32_bf16 v[168:171], a[192:195], a[16:19], v[148:151]
 ds_read_b128 a[236:239], v249 offset:1536
 ds_read_b128 a[240:243], v249 offset:2048
 v_mfma_f32_16x16x32_bf16 v[168:171], a[196:199], a[20:23], v[168:171]
 v_exp_f32 v167, v167
 v_mfma_f32_16x16x32_bf16 v[168:171], a[200:203], a[24:27], v[168:171]
 ds_read_b128 a[244:247], v249 offset:2560
 ds_read_b128 a[248:251], v249 offset:3072
 v_mfma_f32_16x16x32_bf16 v[168:171], a[204:207], a[28:31], v[168:171]
 v_cvt_pk_bf16_f32 v177, v162, v163
 v_cvt_pk_bf16_f32 v178, v164, v165
 v_mfma_f32_16x16x32_bf16 v[172:175], a[220:223], a[28:31], v[148:151]
 ds_read_b128 a[252:255], v249 offset:3584
 v_cvt_pk_bf16_f32 v179, v166, v167
 v_mfma_f32_16x16x32_bf16 v[172:175], a[216:219], a[24:27], v[172:175]
 v_mul_f32_dpp v107, v218, v107 row_newbcast:3 row_mask:0xf bank_mask:0xf
 v_mul_f32_dpp v111, v218, v111 row_newbcast:3 row_mask:0xf bank_mask:0xf
 v_mfma_f32_16x16x32_bf16 v[172:175], a[212:215], a[20:23], v[172:175]
 v_exp_f32 v168, v168
 v_mfma_f32_16x16x32_bf16 v[172:175], a[208:211], a[16:19], v[172:175]
 s_waitcnt lgkmcnt(3)
 v_exp_f32 v169, v169
 v_mfma_f32_16x16x32_bf16 v[0:3], v[176:179], a[224:227], v[0:3]
 v_exp_f32 v170, v170
 v_mfma_f32_16x16x32_bf16 v[4:7], v[176:179], a[228:231], v[4:7]
 v_exp_f32 v171, v171
 v_mfma_f32_16x16x32_bf16 v[8:11], v[176:179], a[232:235], v[8:11]
 v_cvt_pk_bf16_f32 v180, v168, v169
 v_cvt_pk_bf16_f32 v181, v170, v171
 v_mfma_f32_16x16x32_bf16 v[12:15], v[176:179], a[236:239], v[12:15]
 v_exp_f32 v172, v172
 v_mfma_f32_16x16x32_bf16 v[16:19], v[176:179], a[240:243], v[16:19]
 s_waitcnt lgkmcnt(0)
 v_exp_f32 v173, v173
 v_mfma_f32_16x16x32_bf16 v[20:23], v[176:179], a[244:247], v[20:23]
 v_exp_f32 v174, v174
 v_mfma_f32_16x16x32_bf16 v[24:27], v[176:179], a[248:251], v[24:27]
 v_exp_f32 v175, v175
 v_mfma_f32_16x16x32_bf16 v[28:31], v[176:179], a[252:255], v[28:31]
 v_cvt_pk_bf16_f32 v182, v172, v173
 v_cvt_pk_bf16_f32 v183, v174, v175
 v_mfma_f32_16x16x32_bf16 v[160:163], a[192:195], a[32:35], v[152:155]
 v_cvt_pk_bf16_f32 v241, v107, v111
 v_mul_f32_dpp v115, v218, v115 row_newbcast:3 row_mask:0xf bank_mask:0xf
 v_mfma_f32_16x16x32_bf16 v[160:163], a[196:199], a[36:39], v[160:163]
 v_mul_f32_dpp v119, v218, v119 row_newbcast:3 row_mask:0xf bank_mask:0xf
 v_cvt_pk_bf16_f32 v242, v115, v119
 v_mfma_f32_16x16x32_bf16 v[160:163], a[200:203], a[40:43], v[160:163]
 v_mul_f32_dpp v123, v218, v123 row_newbcast:3 row_mask:0xf bank_mask:0xf
 v_mul_f32_dpp v127, v218, v127 row_newbcast:3 row_mask:0xf bank_mask:0xf
 v_mfma_f32_16x16x32_bf16 v[160:163], a[204:207], a[44:47], v[160:163]
 v_cvt_pk_bf16_f32 v243, v123, v127
 s_nop 0
 v_mfma_f32_16x16x32_bf16 v[164:167], a[220:223], a[44:47], v[152:155]
 buffer_store_dwordx4 v[240:243], v244, s[20:23], s33 offen offset:3072 sc1
 v_mfma_f32_16x16x32_bf16 v[164:167], a[216:219], a[40:43], v[164:167]
 s_nop 1
 v_mfma_f32_16x16x32_bf16 v[164:167], a[212:215], a[36:39], v[164:167]
 v_exp_f32 v160, v160
 v_mfma_f32_16x16x32_bf16 v[164:167], a[208:211], a[32:35], v[164:167]
 v_exp_f32 v161, v161
 v_smfmac_f32_16x16x64_bf16 v[128:131], v[236:239], v[176:183], v138
 v_cvt_pk_bf16_f32 v176, v160, v161
 v_mfma_f32_16x16x32_bf16 v[32:35], v[180:183], a[224:227], v[32:35]
 v_exp_f32 v162, v162
 v_mfma_f32_16x16x32_bf16 v[36:39], v[180:183], a[228:231], v[36:39]
 v_exp_f32 v163, v163
 v_mfma_f32_16x16x32_bf16 v[40:43], v[180:183], a[232:235], v[40:43]
 v_exp_f32 v164, v164
 v_mfma_f32_16x16x32_bf16 v[44:47], v[180:183], a[236:239], v[44:47]
 v_exp_f32 v165, v165
 v_mfma_f32_16x16x32_bf16 v[48:51], v[180:183], a[240:243], v[48:51]
 v_exp_f32 v166, v166
 v_mfma_f32_16x16x32_bf16 v[52:55], v[180:183], a[244:247], v[52:55]
 v_exp_f32 v167, v167
 v_mfma_f32_16x16x32_bf16 v[56:59], v[180:183], a[248:251], v[56:59]
 v_cvt_pk_bf16_f32 v177, v162, v163
 v_cvt_pk_bf16_f32 v178, v164, v165
 v_mfma_f32_16x16x32_bf16 v[60:63], v[180:183], a[252:255], v[60:63]
 v_cvt_pk_bf16_f32 v179, v166, v167
 v_mfma_f32_16x16x32_bf16 v[168:171], a[192:195], v[220:223], v[156:159]
 ds_read_b128 a[192:195], v250 offset:8192
 v_mfma_f32_16x16x32_bf16 v[168:171], a[196:199], v[224:227], v[168:171]
 ds_read_b128 a[196:199], v250 offset:8704
 v_mfma_f32_16x16x32_bf16 v[168:171], a[200:203], v[228:231], v[168:171]
 ds_read_b128 a[200:203], v250 offset:9216
 v_mfma_f32_16x16x32_bf16 v[168:171], a[204:207], v[232:235], v[168:171]
 ds_read_b128 a[204:207], v250 offset:9728
 s_nop 0
 v_mfma_f32_16x16x32_bf16 v[172:175], a[220:223], v[232:235], v[156:159]
 ds_read_b128 a[220:223], v250 offset:11776
 s_nop 0
 v_mfma_f32_16x16x32_bf16 v[172:175], a[216:219], v[228:231], v[172:175]
 ds_read_b128 a[216:219], v250 offset:11264
 s_nop 0
 v_mfma_f32_16x16x32_bf16 v[172:175], a[212:215], v[224:227], v[172:175]
 v_exp_f32 v168, v168
 v_mfma_f32_16x16x32_bf16 v[172:175], a[208:211], v[220:223], v[172:175]
 ds_read_b128 a[208:211], v250 offset:10240
 ds_read_b128 a[212:215], v250 offset:10752
 v_mfma_f32_16x16x32_bf16 v[64:67], v[176:179], a[224:227], v[64:67]
 v_exp_f32 v169, v169
 v_mfma_f32_16x16x32_bf16 v[68:71], v[176:179], a[228:231], v[68:71]
 v_exp_f32 v170, v170
 v_mfma_f32_16x16x32_bf16 v[72:75], v[176:179], a[232:235], v[72:75]
 v_exp_f32 v171, v171
 v_mfma_f32_16x16x32_bf16 v[76:79], v[176:179], a[236:239], v[76:79]
 v_exp_f32 v172, v172
 v_mfma_f32_16x16x32_bf16 v[80:83], v[176:179], a[240:243], v[80:83]
 v_exp_f32 v173, v173
 v_mfma_f32_16x16x32_bf16 v[84:87], v[176:179], a[244:247], v[84:87]
 v_exp_f32 v174, v174
 v_mfma_f32_16x16x32_bf16 v[88:91], v[176:179], a[248:251], v[88:91]
 v_exp_f32 v175, v175
 v_mfma_f32_16x16x32_bf16 v[92:95], v[176:179], a[252:255], v[92:95]
 s_waitcnt lgkmcnt(0)
 v_cvt_pk_bf16_f32 v180, v168, v169
 v_cvt_pk_bf16_f32 v181, v170, v171
 v_mfma_f32_16x16x32_bf16 v[160:163], a[192:195], a[0:3], v[144:147]
 v_cvt_pk_bf16_f32 v182, v172, v173
 v_cvt_pk_bf16_f32 v183, v174, v175
 v_mfma_f32_16x16x32_bf16 v[160:163], a[196:199], a[4:7], v[160:163]
 v_mfma_f32_16x16x32_bf16 v[160:163], a[200:203], a[8:11], v[160:163]
 v_mfma_f32_16x16x32_bf16 v[160:163], a[204:207], a[12:15], v[160:163]
 s_nop 1
 v_mfma_f32_16x16x32_bf16 v[164:167], a[220:223], a[12:15], v[144:147]
 s_nop 1
 v_mfma_f32_16x16x32_bf16 v[164:167], a[216:219], a[8:11], v[164:167]
 s_nop 1
 v_mfma_f32_16x16x32_bf16 v[164:167], a[212:215], a[4:7], v[164:167]
 v_exp_f32 v160, v160
 v_mfma_f32_16x16x32_bf16 v[164:167], a[208:211], a[0:3], v[164:167]
 v_exp_f32 v161, v161
 v_smfmac_f32_16x16x64_bf16 v[132:135], v[236:239], v[176:183], v138
 v_cvt_pk_bf16_f32 v176, v160, v161
 v_mfma_f32_16x16x32_bf16 v[184:187], v[180:183], a[224:227], v[184:187]
 v_exp_f32 v162, v162
 v_mfma_f32_16x16x32_bf16 v[188:191], v[180:183], a[228:231], v[188:191]
 v_exp_f32 v163, v163
 v_mfma_f32_16x16x32_bf16 v[192:195], v[180:183], a[232:235], v[192:195]
 ds_read_b128 a[232:235], v249 offset:9216
 ds_read_b128 a[224:227], v249 offset:8192
 v_mfma_f32_16x16x32_bf16 v[196:199], v[180:183], a[236:239], v[196:199]
 ds_read_b128 a[236:239], v249 offset:9728
 ds_read_b128 a[228:231], v249 offset:8704
 v_mfma_f32_16x16x32_bf16 v[200:203], v[180:183], a[240:243], v[200:203]
 ds_read_b128 a[240:243], v249 offset:10240
 v_cvt_pk_bf16_f32 v177, v162, v163
 v_mfma_f32_16x16x32_bf16 v[204:207], v[180:183], a[244:247], v[204:207]
 ds_read_b128 a[244:247], v249 offset:10752
 v_add_f32 v219, v134, v135
 v_mfma_f32_16x16x32_bf16 v[208:211], v[180:183], a[248:251], v[208:211]
 v_exp_f32 v164, v164
 v_mfma_f32_16x16x32_bf16 v[212:215], v[180:183], a[252:255], v[212:215]
 s_waitcnt vmcnt(4)
 v_exp_f32 v165, v165
 v_mfma_f32_16x16x32_bf16 v[252:255], a[192:195], a[48:51], 0
 v_exp_f32 v166, v166
 v_mfma_f32_16x16x32_bf16 v[252:255], a[196:199], a[52:55], v[252:255]
 v_exp_f32 v167, v167
 v_mfma_f32_16x16x32_bf16 v[252:255], a[200:203], a[56:59], v[252:255]
 ds_read_b128 a[248:251], v249 offset:11264
 v_cvt_pk_bf16_f32 v178, v164, v165
 v_mfma_f32_16x16x32_bf16 v[252:255], a[204:207], a[60:63], v[252:255]
 ds_read_b128 a[252:255], v249 offset:11776
 v_cvt_pk_bf16_f32 v179, v166, v167
 v_mfma_f32_16x16x32_bf16 v[168:171], a[192:195], a[16:19], v[148:151]
 v_mov_b32 v134, 0
 v_mov_b32 v135, 0
 v_mfma_f32_16x16x32_bf16 v[168:171], a[196:199], a[20:23], v[168:171]
 v_cmp_nge_f32 vcc, s28, v219
 s_nop 0
 v_mfma_f32_16x16x32_bf16 v[168:171], a[200:203], a[24:27], v[168:171]
 s_cmp_lg_u64 vcc, 0
 v_max3_f32 v246, v252, v253, v254
 v_max_f32 v246, v246, v255
 v_mfma_f32_16x16x32_bf16 v[168:171], a[204:207], a[28:31], v[168:171]
 s_cselect_b32 s34, 524288, 0
 v_rcp_f32 v219, v219
 v_mfma_f32_16x16x32_bf16 v[172:175], a[220:223], a[28:31], v[148:151]
 s_or_b32 s29, s29, s34
 v_mov_b32 v247, v246
 v_mov_b32_dpp v219, v219 row_shl:4 row_mask:0x2 bank_mask:0xf
 v_mfma_f32_16x16x32_bf16 v[172:175], a[216:219], a[24:27], v[172:175]
 s_add_u32 s33, s25, 77824
 v_permlane16_swap_b32 v246, v247
 v_max_f32 v246, v246, v247
 v_mfma_f32_16x16x32_bf16 v[172:175], a[212:215], a[20:23], v[172:175]
 v_exp_f32 v168, v168
 v_mfma_f32_16x16x32_bf16 v[172:175], a[208:211], a[16:19], v[172:175]
 s_waitcnt lgkmcnt(0)
 v_exp_f32 v169, v169
 v_mfma_f32_16x16x32_bf16 v[0:3], v[176:179], a[224:227], v[0:3]
 v_exp_f32 v170, v170
 v_mfma_f32_16x16x32_bf16 v[4:7], v[176:179], a[228:231], v[4:7]
 v_exp_f32 v171, v171
 v_mfma_f32_16x16x32_bf16 v[8:11], v[176:179], a[232:235], v[8:11]
 v_cvt_pk_bf16_f32 v180, v168, v169
 v_cvt_pk_bf16_f32 v181, v170, v171
 v_mfma_f32_16x16x32_bf16 v[12:15], v[176:179], a[236:239], v[12:15]
 v_exp_f32 v175, v175
 v_mfma_f32_16x16x32_bf16 v[16:19], v[176:179], a[240:243], v[16:19]
 v_exp_f32 v172, v172
 v_mfma_f32_16x16x32_bf16 v[20:23], v[176:179], a[244:247], v[20:23]
 v_exp_f32 v173, v173
 v_mfma_f32_16x16x32_bf16 v[24:27], v[176:179], a[248:251], v[24:27]
 v_cvt_pk_bf16_f32 v182, v172, v173
 v_mov_b32 v247, v246
 v_mfma_f32_16x16x32_bf16 v[28:31], v[176:179], a[252:255], v[28:31]
 v_exp_f32 v174, v174
 v_mfma_f32_16x16x32_bf16 v[160:163], a[192:195], a[32:35], v[152:155]
 v_cvt_pk_bf16_f32 v183, v174, v175
 v_permlane32_swap_b32 v246, v247
 v_mfma_f32_16x16x32_bf16 v[160:163], a[196:199], a[36:39], v[160:163]
 v_min_f32 v246, -v246, -v247
 v_mov_b32 v156, v246
 v_mfma_f32_16x16x32_bf16 v[160:163], a[200:203], a[40:43], v[160:163]
 v_mov_b32 v157, v246
 v_mov_b32 v158, v246
 v_mfma_f32_16x16x32_bf16 v[160:163], a[204:207], a[44:47], v[160:163]
 ds_read_b128 a[192:195], v250 offset:16384
 v_mov_b32 v159, v246
 v_mfma_f32_16x16x32_bf16 v[164:167], a[220:223], a[44:47], v[152:155]
 ds_read_b128 a[196:199], v250 offset:16896
 ds_read_b128 a[200:203], v250 offset:17408
 v_mfma_f32_16x16x32_bf16 v[164:167], a[216:219], a[40:43], v[164:167]
 ds_read_b128 a[204:207], v250 offset:17920
 v_add_f32 v252, v252, v246
 v_mfma_f32_16x16x32_bf16 v[164:167], a[212:215], a[36:39], v[164:167]
 v_exp_f32 v161, v161
 v_mfma_f32_16x16x32_bf16 v[164:167], a[208:211], a[32:35], v[164:167]
 v_exp_f32 v162, v162
 v_smfmac_f32_16x16x64_bf16 v[128:131], v[236:239], v[176:183], v138
 v_add_f32 v253, v253, v246
 v_mfma_f32_16x16x32_bf16 v[32:35], v[180:183], a[224:227], v[32:35]
 v_exp_f32 v163, v163
 v_mfma_f32_16x16x32_bf16 v[36:39], v[180:183], a[228:231], v[36:39]
 v_exp_f32 v160, v160
 v_mfma_f32_16x16x32_bf16 v[40:43], v[180:183], a[232:235], v[40:43]
 v_exp_f32 v164, v164
 v_mfma_f32_16x16x32_bf16 v[44:47], v[180:183], a[236:239], v[44:47]
 v_exp_f32 v165, v165
 v_mfma_f32_16x16x32_bf16 v[48:51], v[180:183], a[240:243], v[48:51]
 v_exp_f32 v166, v166
 v_mfma_f32_16x16x32_bf16 v[52:55], v[180:183], a[244:247], v[52:55]
 v_exp_f32 v167, v167
 v_mfma_f32_16x16x32_bf16 v[56:59], v[180:183], a[248:251], v[56:59]
 v_cvt_pk_bf16_f32 v176, v160, v161
 v_cvt_pk_bf16_f32 v177, v162, v163
 v_mfma_f32_16x16x32_bf16 v[60:63], v[180:183], a[252:255], v[60:63]
 v_cvt_pk_bf16_f32 v178, v164, v165
 v_cvt_pk_bf16_f32 v179, v166, v167
 v_mfma_f32_16x16x32_bf16 v[172:175], a[220:223], a[60:63], v[156:159]
 ds_read_b128 a[220:223], v250 offset:19968
 v_add_f32 v254, v254, v246
 v_mfma_f32_16x16x32_bf16 v[172:175], a[216:219], a[56:59], v[172:175]
 ds_read_b128 a[216:219], v250 offset:19456
 v_add_f32 v255, v255, v246
 v_mfma_f32_16x16x32_bf16 v[172:175], a[212:215], a[52:55], v[172:175]
 v_exp_f32 v252, v252
 v_mfma_f32_16x16x32_bf16 v[172:175], a[208:211], a[48:51], v[172:175]
 v_exp_f32 v253, v253
 v_mfma_f32_16x16x32_bf16 v[64:67], v[176:179], a[224:227], v[64:67]
 v_exp_f32 v254, v254
 v_mfma_f32_16x16x32_bf16 v[68:71], v[176:179], a[228:231], v[68:71]
 v_exp_f32 v255, v255
 v_mfma_f32_16x16x32_bf16 v[72:75], v[176:179], a[232:235], v[72:75]
 ds_read_b128 a[212:215], v250 offset:18944
 ds_read_b128 a[208:211], v250 offset:18432
 v_mfma_f32_16x16x32_bf16 v[76:79], v[176:179], a[236:239], v[76:79]
 v_exp_f32 v172, v172
 v_mfma_f32_16x16x32_bf16 v[80:83], v[176:179], a[240:243], v[80:83]
 v_exp_f32 v173, v173
 v_mfma_f32_16x16x32_bf16 v[84:87], v[176:179], a[244:247], v[84:87]
 v_exp_f32 v174, v174
 v_mfma_f32_16x16x32_bf16 v[88:91], v[176:179], a[248:251], v[88:91]
 v_exp_f32 v175, v175
 v_mfma_f32_16x16x32_bf16 v[92:95], v[176:179], a[252:255], v[92:95]
 s_waitcnt lgkmcnt(2)
 v_cvt_pk_bf16_f32 v180, v252, v253
 v_cvt_pk_bf16_f32 v181, v254, v255
 v_mfma_f32_16x16x32_bf16 v[160:163], a[192:195], a[0:3], v[144:147]
 v_cvt_pk_bf16_f32 v182, v172, v173
 v_cvt_pk_bf16_f32 v183, v174, v175
 v_mfma_f32_16x16x32_bf16 v[160:163], a[196:199], a[4:7], v[160:163]
 v_mov_b32_dpp v219, v219 row_shl:8 row_mask:0x4 bank_mask:0xf
 s_nop 0
 v_mfma_f32_16x16x32_bf16 v[160:163], a[200:203], a[8:11], v[160:163]
 v_mov_b32_dpp v219, v219 row_shl:12 row_mask:0x8 bank_mask:0xf
 s_nop 0
 v_mfma_f32_16x16x32_bf16 v[160:163], a[204:207], a[12:15], v[160:163]
 v_mul_f32_dpp v184, v219, v184 row_newbcast:0 row_mask:0xf bank_mask:0xf
 v_mul_f32_dpp v188, v219, v188 row_newbcast:0 row_mask:0xf bank_mask:0xf
 v_mfma_f32_16x16x32_bf16 v[164:167], a[220:223], a[12:15], v[144:147]
 v_cvt_pk_bf16_f32 v240, v184, v188
 v_mul_f32_dpp v192, v219, v192 row_newbcast:0 row_mask:0xf bank_mask:0xf
 v_mfma_f32_16x16x32_bf16 v[164:167], a[216:219], a[8:11], v[164:167]
 s_waitcnt lgkmcnt(0)
 v_mul_f32_dpp v196, v219, v196 row_newbcast:0 row_mask:0xf bank_mask:0xf
 v_cvt_pk_bf16_f32 v241, v192, v196
 v_mfma_f32_16x16x32_bf16 v[164:167], a[212:215], a[4:7], v[164:167]
 v_exp_f32 v160, v160
 v_mfma_f32_16x16x32_bf16 v[164:167], a[208:211], a[0:3], v[164:167]
 v_exp_f32 v161, v161
 v_smfmac_f32_16x16x64_bf16 v[132:135], v[236:239], v[176:183], v138
 v_cvt_pk_bf16_f32 v176, v160, v161
 v_mfma_f32_16x16x32_bf16 v[96:99], v[180:183], a[224:227], 0
 ds_read_b128 a[224:227], v249 offset:16384
 v_mul_f32_dpp v200, v219, v200 row_newbcast:0 row_mask:0xf bank_mask:0xf
 v_mfma_f32_16x16x32_bf16 v[100:103], v[180:183], a[228:231], 0
 ds_read_b128 a[228:231], v249 offset:16896
 v_mul_f32_dpp v204, v219, v204 row_newbcast:0 row_mask:0xf bank_mask:0xf
 v_mfma_f32_16x16x32_bf16 v[104:107], v[180:183], a[232:235], 0
 ds_read_b128 a[232:235], v249 offset:17408
 v_cvt_pk_bf16_f32 v242, v200, v204
 v_mfma_f32_16x16x32_bf16 v[108:111], v[180:183], a[236:239], 0
 v_exp_f32 v162, v162
 v_mfma_f32_16x16x32_bf16 v[112:115], v[180:183], a[240:243], 0
 v_exp_f32 v163, v163
 v_mfma_f32_16x16x32_bf16 v[116:119], v[180:183], a[244:247], 0
 v_exp_f32 v164, v164
 v_mfma_f32_16x16x32_bf16 v[120:123], v[180:183], a[248:251], 0
 v_exp_f32 v165, v165
 v_mfma_f32_16x16x32_bf16 v[124:127], v[180:183], a[252:255], 0
 v_exp_f32 v166, v166
 v_mfma_f32_16x16x32_bf16 v[168:171], a[192:195], a[16:19], v[148:151]
 ds_read_b128 a[236:239], v249 offset:17920
 ds_read_b128 a[240:243], v249 offset:18432
 v_mfma_f32_16x16x32_bf16 v[168:171], a[196:199], a[20:23], v[168:171]
 v_exp_f32 v167, v167
 v_mfma_f32_16x16x32_bf16 v[168:171], a[200:203], a[24:27], v[168:171]
 ds_read_b128 a[244:247], v249 offset:18944
 ds_read_b128 a[248:251], v249 offset:19456
 v_mfma_f32_16x16x32_bf16 v[168:171], a[204:207], a[28:31], v[168:171]
 v_cvt_pk_bf16_f32 v177, v162, v163
 v_cvt_pk_bf16_f32 v178, v164, v165
 v_mfma_f32_16x16x32_bf16 v[172:175], a[220:223], a[28:31], v[148:151]
 ds_read_b128 a[252:255], v249 offset:19968
 v_cvt_pk_bf16_f32 v179, v166, v167
 v_mfma_f32_16x16x32_bf16 v[172:175], a[216:219], a[24:27], v[172:175]
 v_mul_f32_dpp v208, v219, v208 row_newbcast:0 row_mask:0xf bank_mask:0xf
 v_mul_f32_dpp v212, v219, v212 row_newbcast:0 row_mask:0xf bank_mask:0xf
 v_mfma_f32_16x16x32_bf16 v[172:175], a[212:215], a[20:23], v[172:175]
 v_exp_f32 v168, v168
 v_mfma_f32_16x16x32_bf16 v[172:175], a[208:211], a[16:19], v[172:175]
 s_waitcnt lgkmcnt(3)
 v_exp_f32 v169, v169
 v_mfma_f32_16x16x32_bf16 v[0:3], v[176:179], a[224:227], v[0:3]
 v_exp_f32 v170, v170
 v_mfma_f32_16x16x32_bf16 v[4:7], v[176:179], a[228:231], v[4:7]
 v_exp_f32 v171, v171
 v_mfma_f32_16x16x32_bf16 v[8:11], v[176:179], a[232:235], v[8:11]
 v_cvt_pk_bf16_f32 v180, v168, v169
 v_cvt_pk_bf16_f32 v181, v170, v171
 v_mfma_f32_16x16x32_bf16 v[12:15], v[176:179], a[236:239], v[12:15]
 v_exp_f32 v172, v172
 v_mfma_f32_16x16x32_bf16 v[16:19], v[176:179], a[240:243], v[16:19]
 s_waitcnt lgkmcnt(0)
 v_exp_f32 v173, v173
 v_mfma_f32_16x16x32_bf16 v[20:23], v[176:179], a[244:247], v[20:23]
 v_exp_f32 v174, v174
 v_mfma_f32_16x16x32_bf16 v[24:27], v[176:179], a[248:251], v[24:27]
 v_exp_f32 v175, v175
 v_mfma_f32_16x16x32_bf16 v[28:31], v[176:179], a[252:255], v[28:31]
 v_cvt_pk_bf16_f32 v182, v172, v173
 v_cvt_pk_bf16_f32 v183, v174, v175
 v_mfma_f32_16x16x32_bf16 v[160:163], a[192:195], a[32:35], v[152:155]
 v_cvt_pk_bf16_f32 v243, v208, v212
 v_mul_f32_dpp v185, v219, v185 row_newbcast:1 row_mask:0xf bank_mask:0xf
 v_mfma_f32_16x16x32_bf16 v[160:163], a[196:199], a[36:39], v[160:163]
 buffer_store_dwordx4 v[240:243], v244, s[20:23], s33 offen offset:0 sc1
 v_mfma_f32_16x16x32_bf16 v[160:163], a[200:203], a[40:43], v[160:163]
 v_mul_f32_dpp v189, v219, v189 row_newbcast:1 row_mask:0xf bank_mask:0xf
 v_cvt_pk_bf16_f32 v240, v185, v189
 v_mfma_f32_16x16x32_bf16 v[160:163], a[204:207], a[44:47], v[160:163]
 v_mul_f32_dpp v193, v219, v193 row_newbcast:1 row_mask:0xf bank_mask:0xf
 v_mul_f32_dpp v197, v219, v197 row_newbcast:1 row_mask:0xf bank_mask:0xf
 v_mfma_f32_16x16x32_bf16 v[164:167], a[220:223], a[44:47], v[152:155]
 v_cvt_pk_bf16_f32 v241, v193, v197
 v_mul_f32_dpp v201, v219, v201 row_newbcast:1 row_mask:0xf bank_mask:0xf
 v_mfma_f32_16x16x32_bf16 v[164:167], a[216:219], a[40:43], v[164:167]
 v_mul_f32_dpp v205, v219, v205 row_newbcast:1 row_mask:0xf bank_mask:0xf
 v_cvt_pk_bf16_f32 v242, v201, v205
 v_mfma_f32_16x16x32_bf16 v[164:167], a[212:215], a[36:39], v[164:167]
 v_exp_f32 v161, v161
 v_mfma_f32_16x16x32_bf16 v[164:167], a[208:211], a[32:35], v[164:167]
 v_exp_f32 v162, v162
 v_smfmac_f32_16x16x64_bf16 v[128:131], v[236:239], v[176:183], v138
 v_mul_f32_dpp v209, v219, v209 row_newbcast:1 row_mask:0xf bank_mask:0xf
 v_mfma_f32_16x16x32_bf16 v[32:35], v[180:183], a[224:227], v[32:35]
 v_exp_f32 v163, v163
 v_mfma_f32_16x16x32_bf16 v[36:39], v[180:183], a[228:231], v[36:39]
 v_exp_f32 v160, v160
 v_mfma_f32_16x16x32_bf16 v[40:43], v[180:183], a[232:235], v[40:43]
 v_exp_f32 v165, v165
 v_mfma_f32_16x16x32_bf16 v[44:47], v[180:183], a[236:239], v[44:47]
 v_exp_f32 v166, v166
 v_mfma_f32_16x16x32_bf16 v[48:51], v[180:183], a[240:243], v[48:51]
 v_exp_f32 v167, v167
 v_mfma_f32_16x16x32_bf16 v[52:55], v[180:183], a[244:247], v[52:55]
 v_cvt_pk_bf16_f32 v176, v160, v161
 v_cvt_pk_bf16_f32 v177, v162, v163
 v_mfma_f32_16x16x32_bf16 v[56:59], v[180:183], a[248:251], v[56:59]
 v_exp_f32 v164, v164
 v_mfma_f32_16x16x32_bf16 v[60:63], v[180:183], a[252:255], v[60:63]
 v_cvt_pk_bf16_f32 v178, v164, v165
 v_cvt_pk_bf16_f32 v179, v166, v167
 v_mfma_f32_16x16x32_bf16 v[168:171], a[192:195], a[48:51], v[156:159]
 ds_read_b128 a[192:195], v250 offset:24576
 v_mul_f32_dpp v213, v219, v213 row_newbcast:1 row_mask:0xf bank_mask:0xf
 v_mfma_f32_16x16x32_bf16 v[168:171], a[196:199], a[52:55], v[168:171]
 ds_read_b128 a[196:199], v250 offset:25088
 v_cvt_pk_bf16_f32 v243, v209, v213
 v_mfma_f32_16x16x32_bf16 v[168:171], a[200:203], a[56:59], v[168:171]
 buffer_store_dwordx4 v[240:243], v244, s[20:23], s33 offen offset:1024 sc1
 v_mfma_f32_16x16x32_bf16 v[168:171], a[204:207], a[60:63], v[168:171]
 ds_read_b128 a[200:203], v250 offset:25600
 ds_read_b128 a[204:207], v250 offset:26112
 v_mfma_f32_16x16x32_bf16 v[172:175], a[220:223], a[60:63], v[156:159]
 ds_read_b128 a[220:223], v250 offset:28160
 v_mul_f32_dpp v186, v219, v186 row_newbcast:2 row_mask:0xf bank_mask:0xf
 v_mfma_f32_16x16x32_bf16 v[172:175], a[216:219], a[56:59], v[172:175]
 ds_read_b128 a[216:219], v250 offset:27648
 v_mul_f32_dpp v190, v219, v190 row_newbcast:2 row_mask:0xf bank_mask:0xf
 v_mfma_f32_16x16x32_bf16 v[172:175], a[212:215], a[52:55], v[172:175]
 ds_read_b128 a[212:215], v250 offset:27136
 v_cvt_pk_bf16_f32 v240, v186, v190
 v_mfma_f32_16x16x32_bf16 v[172:175], a[208:211], a[48:51], v[172:175]
 ds_read_b128 a[208:211], v250 offset:26624
 v_mul_f32_dpp v194, v219, v194 row_newbcast:2 row_mask:0xf bank_mask:0xf
 v_mfma_f32_16x16x32_bf16 v[64:67], v[176:179], a[224:227], v[64:67]
 v_exp_f32 v168, v168
 v_mfma_f32_16x16x32_bf16 v[68:71], v[176:179], a[228:231], v[68:71]
 v_exp_f32 v169, v169
 v_mfma_f32_16x16x32_bf16 v[72:75], v[176:179], a[232:235], v[72:75]
 v_exp_f32 v170, v170
 v_mfma_f32_16x16x32_bf16 v[76:79], v[176:179], a[236:239], v[76:79]
 v_exp_f32 v171, v171
 v_mfma_f32_16x16x32_bf16 v[80:83], v[176:179], a[240:243], v[80:83]
 v_exp_f32 v172, v172
 v_mfma_f32_16x16x32_bf16 v[84:87], v[176:179], a[244:247], v[84:87]
 v_exp_f32 v173, v173
 v_mfma_f32_16x16x32_bf16 v[88:91], v[176:179], a[248:251], v[88:91]
 v_exp_f32 v174, v174
 v_mfma_f32_16x16x32_bf16 v[92:95], v[176:179], a[252:255], v[92:95]
 s_waitcnt lgkmcnt(0)
 v_exp_f32 v175, v175
 v_mfma_f32_16x16x32_bf16 v[160:163], a[192:195], a[0:3], v[144:147]
 v_cvt_pk_bf16_f32 v180, v168, v169
 v_cvt_pk_bf16_f32 v181, v170, v171
 v_mfma_f32_16x16x32_bf16 v[160:163], a[196:199], a[4:7], v[160:163]
 v_cvt_pk_bf16_f32 v182, v172, v173
 v_cvt_pk_bf16_f32 v183, v174, v175
 v_mfma_f32_16x16x32_bf16 v[160:163], a[200:203], a[8:11], v[160:163]
 v_mul_f32_dpp v198, v219, v198 row_newbcast:2 row_mask:0xf bank_mask:0xf
 v_cvt_pk_bf16_f32 v241, v194, v198
 v_mfma_f32_16x16x32_bf16 v[160:163], a[204:207], a[12:15], v[160:163]
 v_mul_f32_dpp v202, v219, v202 row_newbcast:2 row_mask:0xf bank_mask:0xf
 v_mul_f32_dpp v206, v219, v206 row_newbcast:2 row_mask:0xf bank_mask:0xf
 v_mfma_f32_16x16x32_bf16 v[164:167], a[220:223], a[12:15], v[144:147]
 v_cvt_pk_bf16_f32 v242, v202, v206
 v_mul_f32_dpp v210, v219, v210 row_newbcast:2 row_mask:0xf bank_mask:0xf
 v_mfma_f32_16x16x32_bf16 v[164:167], a[216:219], a[8:11], v[164:167]
 v_mul_f32_dpp v214, v219, v214 row_newbcast:2 row_mask:0xf bank_mask:0xf
 v_cvt_pk_bf16_f32 v243, v210, v214
 v_mfma_f32_16x16x32_bf16 v[164:167], a[212:215], a[4:7], v[164:167]
 v_exp_f32 v162, v162
 v_mfma_f32_16x16x32_bf16 v[164:167], a[208:211], a[0:3], v[164:167]
 v_exp_f32 v163, v163
 v_smfmac_f32_16x16x64_bf16 v[132:135], v[236:239], v[176:183], v138
 v_cvt_pk_bf16_f32 v177, v162, v163
 v_mfma_f32_16x16x32_bf16 v[96:99], v[180:183], a[224:227], v[96:99]
 buffer_store_dwordx4 v[240:243], v244, s[20:23], s33 offen offset:2048 sc1
 v_mfma_f32_16x16x32_bf16 v[100:103], v[180:183], a[228:231], v[100:103]
 ds_read_b128 a[224:227], v249 offset:24576
 ds_read_b128 a[228:231], v249 offset:25088
 v_mfma_f32_16x16x32_bf16 v[104:107], v[180:183], a[232:235], v[104:107]
 v_exp_f32 v164, v164
 v_mfma_f32_16x16x32_bf16 v[108:111], v[180:183], a[236:239], v[108:111]
 v_exp_f32 v165, v165
 v_mfma_f32_16x16x32_bf16 v[112:115], v[180:183], a[240:243], v[112:115]
 v_exp_f32 v166, v166
 v_mfma_f32_16x16x32_bf16 v[116:119], v[180:183], a[244:247], v[116:119]
 ds_read_b128 a[232:235], v249 offset:25600
 ds_read_b128 a[236:239], v249 offset:26112
 v_mfma_f32_16x16x32_bf16 v[120:123], v[180:183], a[248:251], v[120:123]
 v_exp_f32 v160, v160
 v_mfma_f32_16x16x32_bf16 v[124:127], v[180:183], a[252:255], v[124:127]
 v_exp_f32 v161, v161
 v_mfma_f32_16x16x32_bf16 v[168:171], a[192:195], a[16:19], v[148:151]
 v_exp_f32 v167, v167
 v_mfma_f32_16x16x32_bf16 v[168:171], a[196:199], a[20:23], v[168:171]
 ds_read_b128 a[240:243], v249 offset:26624
 v_cvt_pk_bf16_f32 v176, v160, v161
 v_mfma_f32_16x16x32_bf16 v[168:171], a[200:203], a[24:27], v[168:171]
 ds_read_b128 a[248:251], v249 offset:27648
 v_cvt_pk_bf16_f32 v178, v164, v165
 v_mfma_f32_16x16x32_bf16 v[168:171], a[204:207], a[28:31], v[168:171]
 ds_read_b128 a[244:247], v249 offset:27136
 v_cvt_pk_bf16_f32 v179, v166, v167
 v_mfma_f32_16x16x32_bf16 v[172:175], a[220:223], a[28:31], v[148:151]
 ds_read_b128 a[252:255], v249 offset:28160
 v_mul_f32_dpp v187, v219, v187 row_newbcast:3 row_mask:0xf bank_mask:0xf
 v_mfma_f32_16x16x32_bf16 v[172:175], a[216:219], a[24:27], v[172:175]
 v_mul_f32_dpp v191, v219, v191 row_newbcast:3 row_mask:0xf bank_mask:0xf
 v_cvt_pk_bf16_f32 v240, v187, v191
 v_mfma_f32_16x16x32_bf16 v[172:175], a[212:215], a[20:23], v[172:175]
 v_exp_f32 v168, v168
 v_mfma_f32_16x16x32_bf16 v[172:175], a[208:211], a[16:19], v[172:175]
 s_waitcnt lgkmcnt(4)
 v_exp_f32 v169, v169
 v_mfma_f32_16x16x32_bf16 v[0:3], v[176:179], a[224:227], v[0:3]
 v_exp_f32 v170, v170
 v_mfma_f32_16x16x32_bf16 v[4:7], v[176:179], a[228:231], v[4:7]
 v_exp_f32 v171, v171
 v_mfma_f32_16x16x32_bf16 v[8:11], v[176:179], a[232:235], v[8:11]
 v_cvt_pk_bf16_f32 v180, v168, v169
 v_cvt_pk_bf16_f32 v181, v170, v171
 v_mfma_f32_16x16x32_bf16 v[12:15], v[176:179], a[236:239], v[12:15]
 s_waitcnt lgkmcnt(0)
 v_exp_f32 v173, v173
 v_mfma_f32_16x16x32_bf16 v[16:19], v[176:179], a[240:243], v[16:19]
 v_exp_f32 v174, v174
 v_mfma_f32_16x16x32_bf16 v[20:23], v[176:179], a[244:247], v[20:23]
L_pg19:
 s_cbranch_execz L_wb1
 v_exp_f32 v175, v175
 v_mfma_f32_16x16x32_bf16 v[24:27], v[176:179], a[248:251], v[24:27]
 v_exp_f32 v172, v172
 v_mfma_f32_16x16x32_bf16 v[28:31], v[176:179], a[252:255], v[28:31]
 v_cvt_pk_bf16_f32 v182, v172, v173
 v_cvt_pk_bf16_f32 v183, v174, v175
 v_mfma_f32_16x16x32_bf16 v[160:163], a[192:195], a[32:35], v[152:155]
 v_mul_f32_dpp v195, v219, v195 row_newbcast:3 row_mask:0xf bank_mask:0xf
 v_mul_f32_dpp v199, v219, v199 row_newbcast:3 row_mask:0xf bank_mask:0xf
 v_mfma_f32_16x16x32_bf16 v[160:163], a[196:199], a[36:39], v[160:163]
 v_cvt_pk_bf16_f32 v241, v195, v199
 v_mul_f32_dpp v203, v219, v203 row_newbcast:3 row_mask:0xf bank_mask:0xf
 v_mfma_f32_16x16x32_bf16 v[160:163], a[200:203], a[40:43], v[160:163]
 v_mul_f32_dpp v207, v219, v207 row_newbcast:3 row_mask:0xf bank_mask:0xf
 v_cvt_pk_bf16_f32 v242, v203, v207
 v_mfma_f32_16x16x32_bf16 v[160:163], a[204:207], a[44:47], v[160:163]
 v_mul_f32_dpp v211, v219, v211 row_newbcast:3 row_mask:0xf bank_mask:0xf
 v_mul_f32_dpp v215, v219, v215 row_newbcast:3 row_mask:0xf bank_mask:0xf
 v_mfma_f32_16x16x32_bf16 v[164:167], a[220:223], a[44:47], v[152:155]
 v_cvt_pk_bf16_f32 v243, v211, v215
 s_nop 0
 v_mfma_f32_16x16x32_bf16 v[164:167], a[216:219], a[40:43], v[164:167]
 buffer_store_dwordx4 v[240:243], v244, s[20:23], s33 offen offset:3072 sc1
 v_mfma_f32_16x16x32_bf16 v[164:167], a[212:215], a[36:39], v[164:167]
 v_exp_f32 v161, v161
 v_mfma_f32_16x16x32_bf16 v[164:167], a[208:211], a[32:35], v[164:167]
 v_exp_f32 v162, v162
 v_smfmac_f32_16x16x64_bf16 v[128:131], v[236:239], v[176:183], v138
 s_nop 0
 v_mfma_f32_16x16x32_bf16 v[32:35], v[180:183], a[224:227], v[32:35]
 v_exp_f32 v163, v163
 v_mfma_f32_16x16x32_bf16 v[36:39], v[180:183], a[228:231], v[36:39]
 v_exp_f32 v160, v160
 v_mfma_f32_16x16x32_bf16 v[40:43], v[180:183], a[232:235], v[40:43]
 v_exp_f32 v165, v165
 v_mfma_f32_16x16x32_bf16 v[44:47], v[180:183], a[236:239], v[44:47]
 v_exp_f32 v166, v166
 v_mfma_f32_16x16x32_bf16 v[48:51], v[180:183], a[240:243], v[48:51]
 v_exp_f32 v167, v167
 v_mfma_f32_16x16x32_bf16 v[52:55], v[180:183], a[244:247], v[52:55]
 v_cvt_pk_bf16_f32 v176, v160, v161
 v_cvt_pk_bf16_f32 v177, v162, v163
 v_mfma_f32_16x16x32_bf16 v[56:59], v[180:183], a[248:251], v[56:59]
 v_exp_f32 v164, v164
 v_mfma_f32_16x16x32_bf16 v[60:63], v[180:183], a[252:255], v[60:63]
 v_cvt_pk_bf16_f32 v178, v164, v165
 v_cvt_pk_bf16_f32 v179, v166, v167
 v_mfma_f32_16x16x32_bf16 v[168:171], a[192:195], a[48:51], v[156:159]
 v_add_f32 v216, v128, v129
 v_cmp_nge_f32 vcc, s28, v216
 v_mfma_f32_16x16x32_bf16 v[168:171], a[196:199], a[52:55], v[168:171]
 s_cmp_lg_u64 vcc, 0
 v_rcp_f32 v216, v216
 v_mfma_f32_16x16x32_bf16 v[168:171], a[200:203], a[56:59], v[168:171]
 s_cselect_b32 s34, 1048576, 0
 s_or_b32 s29, s29, s34
 v_mov_b32_dpp v216, v216 row_shl:4 row_mask:0x2 bank_mask:0xf
 v_mfma_f32_16x16x32_bf16 v[168:171], a[204:207], a[60:63], v[168:171]
 s_add_u32 s33, s25, 81920
 ds_read_b128 a[192:195], v249 offset:32768
 v_mov_b32_dpp v216, v216 row_shl:8 row_mask:0x4 bank_mask:0xf
 v_mfma_f32_16x16x32_bf16 v[172:175], a[220:223], a[60:63], v[156:159]
 ds_read_b128 a[196:199], v249 offset:33280
 v_mov_b32_dpp v216, v216 row_shl:12 row_mask:0x8 bank_mask:0xf
 v_mfma_f32_16x16x32_bf16 v[172:175], a[216:219], a[56:59], v[172:175]
 ds_read_b128 a[200:203], v249 offset:33792
 v_mul_f32_dpp v0, v216, v0 row_newbcast:0 row_mask:0xf bank_mask:0xf
 v_mfma_f32_16x16x32_bf16 v[172:175], a[212:215], a[52:55], v[172:175]
 v_exp_f32 v168, v168
 v_mfma_f32_16x16x32_bf16 v[172:175], a[208:211], a[48:51], v[172:175]
 v_exp_f32 v169, v169
 v_mfma_f32_16x16x32_bf16 v[64:67], v[176:179], a[224:227], v[64:67]
 v_exp_f32 v170, v170
 v_mfma_f32_16x16x32_bf16 v[68:71], v[176:179], a[228:231], v[68:71]
 v_exp_f32 v171, v171
 v_mfma_f32_16x16x32_bf16 v[72:75], v[176:179], a[232:235], v[72:75]
 v_cvt_pk_bf16_f32 v180, v168, v169
 v_cvt_pk_bf16_f32 v181, v170, v171
 v_mfma_f32_16x16x32_bf16 v[76:79], v[176:179], a[236:239], v[76:79]
 v_exp_f32 v172, v172
 v_mfma_f32_16x16x32_bf16 v[80:83], v[176:179], a[240:243], v[80:83]
 v_exp_f32 v173, v173
 v_mfma_f32_16x16x32_bf16 v[84:87], v[176:179], a[244:247], v[84:87]
 v_exp_f32 v174, v174
 v_mfma_f32_16x16x32_bf16 v[88:91], v[176:179], a[248:251], v[88:91]
 v_exp_f32 v175, v175
 v_mfma_f32_16x16x32_bf16 v[92:95], v[176:179], a[252:255], v[92:95]
 v_cvt_pk_bf16_f32 v182, v172, v173
 v_cvt_pk_bf16_f32 v183, v174, v175
 v_mfma_f32_16x16x32_bf16 v[160:163], a[64:67], a[16:19], v[148:151]
 v_mul_f32_dpp v4, v216, v4 row_newbcast:0 row_mask:0xf bank_mask:0xf
 v_cvt_pk_bf16_f32 v240, v0, v4
 v_mfma_f32_16x16x32_bf16 v[160:163], a[68:71], a[20:23], v[160:163]
 v_mul_f32_dpp v8, v216, v8 row_newbcast:0 row_mask:0xf bank_mask:0xf
 v_mul_f32_dpp v12, v216, v12 row_newbcast:0 row_mask:0xf bank_mask:0xf
 v_mfma_f32_16x16x32_bf16 v[160:163], a[72:75], a[24:27], v[160:163]
 v_cvt_pk_bf16_f32 v241, v8, v12
 v_mul_f32_dpp v16, v216, v16 row_newbcast:0 row_mask:0xf bank_mask:0xf
 v_mfma_f32_16x16x32_bf16 v[160:163], a[76:79], a[28:31], v[160:163]
 v_mul_f32_dpp v20, v216, v20 row_newbcast:0 row_mask:0xf bank_mask:0xf
 v_cvt_pk_bf16_f32 v242, v16, v20
 v_mfma_f32_16x16x32_bf16 v[164:167], a[92:95], a[28:31], v[148:151]
 v_mul_f32_dpp v24, v216, v24 row_newbcast:0 row_mask:0xf bank_mask:0xf
 v_mul_f32_dpp v28, v216, v28 row_newbcast:0 row_mask:0xf bank_mask:0xf
 v_mfma_f32_16x16x32_bf16 v[164:167], a[88:91], a[24:27], v[164:167]
 v_cvt_pk_bf16_f32 v243, v24, v28
 v_mul_f32_dpp v1, v216, v1 row_newbcast:1 row_mask:0xf bank_mask:0xf
 v_mfma_f32_16x16x32_bf16 v[164:167], a[84:87], a[20:23], v[164:167]
 buffer_store_dwordx4 v[240:243], v244, s[20:23], s33 offen offset:0 sc1
 v_mfma_f32_16x16x32_bf16 v[164:167], a[80:83], a[16:19], v[164:167]
 v_exp_f32 v160, v160
 v_smfmac_f32_16x16x64_bf16 v[132:135], v[236:239], v[176:183], v138
 v_mul_f32_dpp v5, v216, v5 row_newbcast:1 row_mask:0xf bank_mask:0xf
 v_mfma_f32_16x16x32_bf16 v[96:99], v[180:183], a[224:227], v[96:99]
 ds_read_b128 a[224:227], v248 offset:0
 v_cvt_pk_bf16_f32 v240, v1, v5
 v_mfma_f32_16x16x32_bf16 v[100:103], v[180:183], a[228:231], v[100:103]
 ds_read_b128 a[228:231], v248 offset:512
 v_mul_f32_dpp v9, v216, v9 row_newbcast:1 row_mask:0xf bank_mask:0xf
 v_mfma_f32_16x16x32_bf16 v[104:107], v[180:183], a[232:235], v[104:107]
 v_exp_f32 v161, v161
 v_mfma_f32_16x16x32_bf16 v[108:111], v[180:183], a[236:239], v[108:111]
 v_exp_f32 v162, v162
 v_mfma_f32_16x16x32_bf16 v[112:115], v[180:183], a[240:243], v[112:115]
 v_exp_f32 v163, v163
 v_mfma_f32_16x16x32_bf16 v[116:119], v[180:183], a[244:247], v[116:119]
 v_exp_f32 v164, v164
 v_mfma_f32_16x16x32_bf16 v[120:123], v[180:183], a[248:251], v[120:123]
 v_exp_f32 v165, v165
 v_mfma_f32_16x16x32_bf16 v[124:127], v[180:183], a[252:255], v[124:127]
 v_exp_f32 v166, v166
 v_mfma_f32_16x16x32_bf16 v[168:171], a[64:67], a[32:35], v[152:155]
 v_exp_f32 v167, v167
 v_mfma_f32_16x16x32_bf16 v[168:171], a[68:71], a[36:39], v[168:171]
 ds_read_b128 a[232:235], v248 offset:1024
 ds_read_b128 a[236:239], v248 offset:1536
 v_mfma_f32_16x16x32_bf16 v[168:171], a[72:75], a[40:43], v[168:171]
 ds_read_b128 a[240:243], v248 offset:2048
 ds_read_b128 a[244:247], v248 offset:2560
 v_mfma_f32_16x16x32_bf16 v[168:171], a[76:79], a[44:47], v[168:171]
 v_cvt_pk_bf16_f32 v176, v160, v161
 v_cvt_pk_bf16_f32 v177, v162, v163
 v_mfma_f32_16x16x32_bf16 v[172:175], a[92:95], a[44:47], v[152:155]
 v_cvt_pk_bf16_f32 v178, v164, v165
 v_cvt_pk_bf16_f32 v179, v166, v167
 v_mfma_f32_16x16x32_bf16 v[172:175], a[88:91], a[40:43], v[172:175]
 ds_read_b128 a[248:251], v248 offset:3072
 ds_read_b128 a[252:255], v248 offset:3584
 v_mfma_f32_16x16x32_bf16 v[172:175], a[84:87], a[36:39], v[172:175]
 v_mul_f32_dpp v13, v216, v13 row_newbcast:1 row_mask:0xf bank_mask:0xf
 v_cvt_pk_bf16_f32 v241, v9, v13
 v_mfma_f32_16x16x32_bf16 v[172:175], a[80:83], a[32:35], v[172:175]
 v_mul_f32_dpp v17, v216, v17 row_newbcast:1 row_mask:0xf bank_mask:0xf
 v_mul_f32_dpp v21, v216, v21 row_newbcast:1 row_mask:0xf bank_mask:0xf
 v_mfma_f32_16x16x32_bf16 v[130:133], v[140:143], v[176:179], v[130:133]
 s_waitcnt lgkmcnt(4)
 v_cvt_pk_bf16_f32 v242, v17, v21
 v_mul_f32_dpp v25, v216, v25 row_newbcast:1 row_mask:0xf bank_mask:0xf
 v_mfma_f32_16x16x32_bf16 v[32:35], v[176:179], a[224:227], v[32:35]
 v_mul_f32_dpp v29, v216, v29 row_newbcast:1 row_mask:0xf bank_mask:0xf
 v_cvt_pk_bf16_f32 v243, v25, v29
 v_mfma_f32_16x16x32_bf16 v[36:39], v[176:179], a[228:231], v[36:39]
 buffer_store_dwordx4 v[240:243], v244, s[20:23], s33 offen offset:1024 sc1
 v_mfma_f32_16x16x32_bf16 v[40:43], v[176:179], a[232:235], v[40:43]
 v_exp_f32 v168, v168
 v_mfma_f32_16x16x32_bf16 v[44:47], v[176:179], a[236:239], v[44:47]
 s_waitcnt lgkmcnt(0)
 v_exp_f32 v169, v169
 v_mfma_f32_16x16x32_bf16 v[48:51], v[176:179], a[240:243], v[48:51]
 v_exp_f32 v170, v170
 v_mfma_f32_16x16x32_bf16 v[52:55], v[176:179], a[244:247], v[52:55]
 v_exp_f32 v171, v171
 v_mfma_f32_16x16x32_bf16 v[56:59], v[176:179], a[248:251], v[56:59]
 v_exp_f32 v172, v172
 v_mfma_f32_16x16x32_bf16 v[60:63], v[176:179], a[252:255], v[60:63]
 v_exp_f32 v173, v173
 v_mfma_f32_16x16x32_bf16 v[160:163], a[64:67], a[48:51], v[156:159]
 v_exp_f32 v174, v174
 v_mfma_f32_16x16x32_bf16 v[160:163], a[68:71], a[52:55], v[160:163]
 v_exp_f32 v175, v175
 v_mfma_f32_16x16x32_bf16 v[160:163], a[72:75], a[56:59], v[160:163]
 v_cvt_pk_bf16_f32 v176, v168, v169
 v_cvt_pk_bf16_f32 v177, v170, v171
 v_mfma_f32_16x16x32_bf16 v[160:163], a[76:79], a[60:63], v[160:163]
 v_cvt_pk_bf16_f32 v178, v172, v173
 v_cvt_pk_bf16_f32 v179, v174, v175
 v_mfma_f32_16x16x32_bf16 v[164:167], a[92:95], a[60:63], v[156:159]
 v_mul_f32_dpp v2, v216, v2 row_newbcast:2 row_mask:0xf bank_mask:0xf
 v_mul_f32_dpp v6, v216, v6 row_newbcast:2 row_mask:0xf bank_mask:0xf
 v_mfma_f32_16x16x32_bf16 v[164:167], a[88:91], a[56:59], v[164:167]
 v_cvt_pk_bf16_f32 v240, v2, v6
 v_mul_f32_dpp v10, v216, v10 row_newbcast:2 row_mask:0xf bank_mask:0xf
 v_mfma_f32_16x16x32_bf16 v[164:167], a[84:87], a[52:55], v[164:167]
 v_exp_f32 v160, v160
 v_mfma_f32_16x16x32_bf16 v[164:167], a[80:83], a[48:51], v[164:167]
 v_exp_f32 v161, v161
 v_mfma_f32_16x16x32_bf16 v[64:67], v[176:179], a[224:227], v[64:67]
 v_exp_f32 v162, v162
 v_mfma_f32_16x16x32_bf16 v[68:71], v[176:179], a[228:231], v[68:71]
 v_exp_f32 v163, v163
 v_mfma_f32_16x16x32_bf16 v[72:75], v[176:179], a[232:235], v[72:75]
 v_cvt_pk_bf16_f32 v180, v160, v161
 v_cvt_pk_bf16_f32 v181, v162, v163
 v_mfma_f32_16x16x32_bf16 v[76:79], v[176:179], a[236:239], v[76:79]
 v_exp_f32 v164, v164
 v_mfma_f32_16x16x32_bf16 v[80:83], v[176:179], a[240:243], v[80:83]
 v_exp_f32 v165, v165
 v_mfma_f32_16x16x32_bf16 v[84:87], v[176:179], a[244:247], v[84:87]
 v_exp_f32 v166, v166
 v_mfma_f32_16x16x32_bf16 v[88:91], v[176:179], a[248:251], v[88:91]
 v_exp_f32 v167, v167
 v_mfma_f32_16x16x32_bf16 v[92:95], v[176:179], a[252:255], v[92:95]
 v_cvt_pk_bf16_f32 v182, v164, v165
 v_cvt_pk_bf16_f32 v183, v166, v167
 v_mfma_f32_16x16x32_bf16 v[168:171], a[96:99], a[16:19], v[148:151]
 v_mul_f32_dpp v14, v216, v14 row_newbcast:2 row_mask:0xf bank_mask:0xf
 v_cvt_pk_bf16_f32 v241, v10, v14
 v_mfma_f32_16x16x32_bf16 v[168:171], a[100:103], a[20:23], v[168:171]
 v_mul_f32_dpp v18, v216, v18 row_newbcast:2 row_mask:0xf bank_mask:0xf
 v_mul_f32_dpp v22, v216, v22 row_newbcast:2 row_mask:0xf bank_mask:0xf
 v_mfma_f32_16x16x32_bf16 v[168:171], a[104:107], a[24:27], v[168:171]
 v_cvt_pk_bf16_f32 v242, v18, v22
 v_mul_f32_dpp v26, v216, v26 row_newbcast:2 row_mask:0xf bank_mask:0xf
 v_mfma_f32_16x16x32_bf16 v[168:171], a[108:111], a[28:31], v[168:171]
 v_mul_f32_dpp v30, v216, v30 row_newbcast:2 row_mask:0xf bank_mask:0xf
 v_cvt_pk_bf16_f32 v243, v26, v30
 v_mfma_f32_16x16x32_bf16 v[172:175], a[124:127], a[28:31], v[148:151]
 buffer_store_dwordx4 v[240:243], v244, s[20:23], s33 offen offset:2048 sc1
 v_mfma_f32_16x16x32_bf16 v[172:175], a[120:123], a[24:27], v[172:175]
 v_mul_f32_dpp v3, v216, v3 row_newbcast:3 row_mask:0xf bank_mask:0xf
 v_mul_f32_dpp v7, v216, v7 row_newbcast:3 row_mask:0xf bank_mask:0xf
 v_mfma_f32_16x16x32_bf16 v[172:175], a[116:119], a[20:23], v[172:175]
 v_exp_f32 v168, v168
 v_mfma_f32_16x16x32_bf16 v[172:175], a[112:115], a[16:19], v[172:175]
 v_exp_f32 v169, v169
 v_smfmac_f32_16x16x64_bf16 v[132:135], v[236:239], v[176:183], v138
 v_cvt_pk_bf16_f32 v176, v168, v169
 v_mfma_f32_16x16x32_bf16 v[96:99], v[180:183], a[224:227], v[96:99]
 v_exp_f32 v170, v170
 v_mfma_f32_16x16x32_bf16 v[100:103], v[180:183], a[228:231], v[100:103]
 v_exp_f32 v171, v171
 v_mfma_f32_16x16x32_bf16 v[104:107], v[180:183], a[232:235], v[104:107]
 v_exp_f32 v172, v172
 v_mfma_f32_16x16x32_bf16 v[108:111], v[180:183], a[236:239], v[108:111]
 ds_read_b128 a[224:227], v248 offset:8192
 ds_read_b128 a[228:231], v248 offset:8704
 v_mfma_f32_16x16x32_bf16 v[112:115], v[180:183], a[240:243], v[112:115]
 v_exp_f32 v173, v173
 v_mfma_f32_16x16x32_bf16 v[116:119], v[180:183], a[244:247], v[116:119]
 v_exp_f32 v174, v174
 v_mfma_f32_16x16x32_bf16 v[120:123], v[180:183], a[248:251], v[120:123]
 ds_read_b128 a[232:235], v248 offset:9216
 ds_read_b128 a[236:239], v248 offset:9728
 v_mfma_f32_16x16x32_bf16 v[124:127], v[180:183], a[252:255], v[124:127]
 v_exp_f32 v175, v175
 v_mfma_f32_16x16x32_bf16 v[160:163], a[96:99], a[32:35], v[152:155]
 ds_read_b128 a[240:243], v248 offset:10240
 ds_read_b128 a[244:247], v248 offset:10752
 v_mfma_f32_16x16x32_bf16 v[160:163], a[100:103], a[36:39], v[160:163]
 v_cvt_pk_bf16_f32 v177, v170, v171
 v_cvt_pk_bf16_f32 v178, v172, v173
 v_mfma_f32_16x16x32_bf16 v[160:163], a[104:107], a[40:43], v[160:163]
 ds_read_b128 a[248:251], v248 offset:11264
 v_cvt_pk_bf16_f32 v179, v174, v175
 v_mfma_f32_16x16x32_bf16 v[160:163], a[108:111], a[44:47], v[160:163]
 ds_read_b128 a[252:255], v248 offset:11776
 v_cvt_pk_bf16_f32 v240, v3, v7
 v_mfma_f32_16x16x32_bf16 v[164:167], a[124:127], a[44:47], v[152:155]
 v_mul_f32_dpp v11, v216, v11 row_newbcast:3 row_mask:0xf bank_mask:0xf
 v_mul_f32_dpp v15, v216, v15 row_newbcast:3 row_mask:0xf bank_mask:0xf
 v_mfma_f32_16x16x32_bf16 v[164:167], a[120:123], a[40:43], v[164:167]
 v_cvt_pk_bf16_f32 v241, v11, v15
 v_mul_f32_dpp v19, v216, v19 row_newbcast:3 row_mask:0xf bank_mask:0xf
 v_mfma_f32_16x16x32_bf16 v[164:167], a[116:119], a[36:39], v[164:167]
 v_exp_f32 v160, v160
 v_mfma_f32_16x16x32_bf16 v[164:167], a[112:115], a[32:35], v[164:167]
 v_exp_f32 v161, v161
 v_mfma_f32_16x16x32_bf16 v[130:133], v[140:143], v[176:179], v[130:133]
 s_waitcnt lgkmcnt(2)
 v_exp_f32 v162, v162
 v_mfma_f32_16x16x32_bf16 v[32:35], v[176:179], a[224:227], v[32:35]
 v_exp_f32 v163, v163
 v_mfma_f32_16x16x32_bf16 v[36:39], v[176:179], a[228:231], v[36:39]
 v_mul_f32_dpp v23, v216, v23 row_newbcast:3 row_mask:0xf bank_mask:0xf
 v_cvt_pk_bf16_f32 v242, v19, v23
 v_mfma_f32_16x16x32_bf16 v[40:43], v[176:179], a[232:235], v[40:43]
 v_exp_f32 v164, v164
 v_mfma_f32_16x16x32_bf16 v[44:47], v[176:179], a[236:239], v[44:47]
 v_exp_f32 v165, v165
 v_mfma_f32_16x16x32_bf16 v[48:51], v[176:179], a[240:243], v[48:51]
 v_exp_f32 v166, v166
 v_mfma_f32_16x16x32_bf16 v[52:55], v[176:179], a[244:247], v[52:55]
 s_waitcnt lgkmcnt(0)
 v_exp_f32 v167, v167
 v_mfma_f32_16x16x32_bf16 v[56:59], v[176:179], a[248:251], v[56:59]
 v_mul_f32_dpp v27, v216, v27 row_newbcast:3 row_mask:0xf bank_mask:0xf
 v_mul_f32_dpp v31, v216, v31 row_newbcast:3 row_mask:0xf bank_mask:0xf
 v_mfma_f32_16x16x32_bf16 v[60:63], v[176:179], a[252:255], v[60:63]
 v_cvt_pk_bf16_f32 v176, v160, v161
 v_cvt_pk_bf16_f32 v177, v162, v163
 v_mfma_f32_16x16x32_bf16 v[168:171], a[96:99], a[48:51], v[156:159]
 v_cvt_pk_bf16_f32 v178, v164, v165
 v_cvt_pk_bf16_f32 v179, v166, v167
 v_mfma_f32_16x16x32_bf16 v[168:171], a[100:103], a[52:55], v[168:171]
 ds_read_b128 a[204:207], v249 offset:34304
 v_cvt_pk_bf16_f32 v243, v27, v31
 v_mfma_f32_16x16x32_bf16 v[168:171], a[104:107], a[56:59], v[168:171]
 buffer_store_dwordx4 v[240:243], v244, s[20:23], s33 offen offset:3072 sc1
 v_mfma_f32_16x16x32_bf16 v[168:171], a[108:111], a[60:63], v[168:171]
 ds_read_b128 a[216:219], v249 offset:35840
 ds_read_b128 a[220:223], v249 offset:36352
 v_mfma_f32_16x16x32_bf16 v[172:175], a[124:127], a[60:63], v[156:159]
 ds_read_b128 a[208:211], v249 offset:34816
 ds_read_b128 a[212:215], v249 offset:35328
 v_mfma_f32_16x16x32_bf16 v[172:175], a[120:123], a[56:59], v[172:175]
 v_mov_b32 v128, 0
 v_mov_b32 v129, 0
 v_mfma_f32_16x16x32_bf16 v[172:175], a[116:119], a[52:55], v[172:175]
 v_exp_f32 v168, v168
 v_mfma_f32_16x16x32_bf16 v[172:175], a[112:115], a[48:51], v[172:175]
 v_exp_f32 v169, v169
 v_mfma_f32_16x16x32_bf16 v[64:67], v[176:179], a[224:227], v[64:67]
 v_exp_f32 v170, v170
 v_mfma_f32_16x16x32_bf16 v[68:71], v[176:179], a[228:231], v[68:71]
 v_exp_f32 v171, v171
 v_mfma_f32_16x16x32_bf16 v[72:75], v[176:179], a[232:235], v[72:75]
 v_cvt_pk_bf16_f32 v180, v168, v169
 v_cvt_pk_bf16_f32 v181, v170, v171
 v_mfma_f32_16x16x32_bf16 v[76:79], v[176:179], a[236:239], v[76:79]
 v_exp_f32 v172, v172
 v_mfma_f32_16x16x32_bf16 v[80:83], v[176:179], a[240:243], v[80:83]
 v_exp_f32 v173, v173
 v_mfma_f32_16x16x32_bf16 v[84:87], v[176:179], a[244:247], v[84:87]
 v_exp_f32 v174, v174
 v_mfma_f32_16x16x32_bf16 v[88:91], v[176:179], a[248:251], v[88:91]
 v_exp_f32 v175, v175
 v_mfma_f32_16x16x32_bf16 v[92:95], v[176:179], a[252:255], v[92:95]
 v_cvt_pk_bf16_f32 v182, v172, v173
 v_cvt_pk_bf16_f32 v183, v174, v175
 v_mfma_f32_16x16x32_bf16 v[160:163], a[128:131], a[16:19], v[148:151]
 v_mfma_f32_16x16x32_bf16 v[160:163], a[132:135], a[20:23], v[160:163]
 v_mfma_f32_16x16x32_bf16 v[160:163], a[136:139], a[24:27], v[160:163]
 v_mfma_f32_16x16x32_bf16 v[160:163], a[140:143], a[28:31], v[160:163]
 s_nop 1
 v_mfma_f32_16x16x32_bf16 v[164:167], a[156:159], a[28:31], v[148:151]
 s_nop 1
 v_mfma_f32_16x16x32_bf16 v[164:167], a[152:155], a[24:27], v[164:167]
 s_nop 1
 v_mfma_f32_16x16x32_bf16 v[164:167], a[148:151], a[20:23], v[164:167]
 v_exp_f32 v160, v160
 v_mfma_f32_16x16x32_bf16 v[164:167], a[144:147], a[16:19], v[164:167]
 v_exp_f32 v161, v161
 v_smfmac_f32_16x16x64_bf16 v[132:135], v[236:239], v[176:183], v138
 v_cvt_pk_bf16_f32 v176, v160, v161
 v_mfma_f32_16x16x32_bf16 v[96:99], v[180:183], a[224:227], v[96:99]
 v_exp_f32 v162, v162
 v_mfma_f32_16x16x32_bf16 v[100:103], v[180:183], a[228:231], v[100:103]
 ds_read_b128 a[224:227], v248 offset:16384
 ds_read_b128 a[228:231], v248 offset:16896
 v_mfma_f32_16x16x32_bf16 v[104:107], v[180:183], a[232:235], v[104:107]
 v_exp_f32 v163, v163
 v_mfma_f32_16x16x32_bf16 v[108:111], v[180:183], a[236:239], v[108:111]
 ds_read_b128 a[232:235], v248 offset:17408
 ds_read_b128 a[236:239], v248 offset:17920
 v_mfma_f32_16x16x32_bf16 v[112:115], v[180:183], a[240:243], v[112:115]
 v_exp_f32 v164, v164
 v_mfma_f32_16x16x32_bf16 v[116:119], v[180:183], a[244:247], v[116:119]
 v_exp_f32 v165, v165
 v_mfma_f32_16x16x32_bf16 v[120:123], v[180:183], a[248:251], v[120:123]
 v_exp_f32 v166, v166
 v_mfma_f32_16x16x32_bf16 v[124:127], v[180:183], a[252:255], v[124:127]
 v_exp_f32 v167, v167
 v_mfma_f32_16x16x32_bf16 v[168:171], a[128:131], a[32:35], v[152:155]
 ds_read_b128 a[240:243], v248 offset:18432
 ds_read_b128 a[244:247], v248 offset:18944
 v_mfma_f32_16x16x32_bf16 v[168:171], a[132:135], a[36:39], v[168:171]
 v_cvt_pk_bf16_f32 v177, v162, v163
 v_cvt_pk_bf16_f32 v178, v164, v165
 v_mfma_f32_16x16x32_bf16 v[168:171], a[136:139], a[40:43], v[168:171]
 ds_read_b128 a[248:251], v248 offset:19456
 v_cvt_pk_bf16_f32 v179, v166, v167
 v_mfma_f32_16x16x32_bf16 v[168:171], a[140:143], a[44:47], v[168:171]
 ds_read_b128 a[252:255], v248 offset:19968
 s_nop 0
 v_mfma_f32_16x16x32_bf16 v[172:175], a[156:159], a[44:47], v[152:155]
 s_nop 1
 v_mfma_f32_16x16x32_bf16 v[172:175], a[152:155], a[40:43], v[172:175]
 s_nop 1
 v_mfma_f32_16x16x32_bf16 v[172:175], a[148:151], a[36:39], v[172:175]
 v_exp_f32 v168, v168
 v_mfma_f32_16x16x32_bf16 v[172:175], a[144:147], a[32:35], v[172:175]
 v_exp_f32 v169, v169
 v_mfma_f32_16x16x32_bf16 v[130:133], v[140:143], v[176:179], v[130:133]
 s_waitcnt lgkmcnt(2)
 v_exp_f32 v170, v170
 v_mfma_f32_16x16x32_bf16 v[32:35], v[176:179], a[224:227], v[32:35]
 v_exp_f32 v171, v171
 v_mfma_f32_16x16x32_bf16 v[36:39], v[176:179], a[228:231], v[36:39]
 s_nop 1
 v_mfma_f32_16x16x32_bf16 v[40:43], v[176:179], a[232:235], v[40:43]
 v_exp_f32 v172, v172
 v_mfma_f32_16x16x32_bf16 v[44:47], v[176:179], a[236:239], v[44:47]
 v_exp_f32 v173, v173
 v_mfma_f32_16x16x32_bf16 v[48:51], v[176:179], a[240:243], v[48:51]
 v_exp_f32 v174, v174
 v_mfma_f32_16x16x32_bf16 v[52:55], v[176:179], a[244:247], v[52:55]
 s_waitcnt lgkmcnt(0)
 v_exp_f32 v175, v175
 v_mfma_f32_16x16x32_bf16 v[56:59], v[176:179], a[248:251], v[56:59]
 v_add_f32 v217, v130, v131
 v_cmp_nge_f32 vcc, s28, v217
 v_mfma_f32_16x16x32_bf16 v[60:63], v[176:179], a[252:255], v[60:63]
 s_cmp_lg_u64 vcc, 0
 v_cvt_pk_bf16_f32 v176, v168, v169
 v_cvt_pk_bf16_f32 v177, v170, v171
 v_mfma_f32_16x16x32_bf16 v[160:163], a[128:131], a[48:51], v[156:159]
 s_cselect_b32 s34, 2097152, 0
 v_cvt_pk_bf16_f32 v178, v172, v173
 v_cvt_pk_bf16_f32 v179, v174, v175
 v_mfma_f32_16x16x32_bf16 v[160:163], a[132:135], a[52:55], v[160:163]
 s_or_b32 s29, s29, s34
 v_rcp_f32 v217, v217
 v_mfma_f32_16x16x32_bf16 v[160:163], a[136:139], a[56:59], v[160:163]
 s_add_u32 s33, s25, 86016
 v_mov_b32_dpp v217, v217 row_shl:4 row_mask:0x2 bank_mask:0xf
 v_mov_b32 v130, 0
 v_mfma_f32_16x16x32_bf16 v[160:163], a[140:143], a[60:63], v[160:163]
 v_mov_b32_dpp v217, v217 row_shl:8 row_mask:0x4 bank_mask:0xf
 v_mov_b32 v131, 0
 v_mfma_f32_16x16x32_bf16 v[164:167], a[156:159], a[60:63], v[156:159]
 v_mov_b32_dpp v217, v217 row_shl:12 row_mask:0x8 bank_mask:0xf
 s_nop 0
 v_mfma_f32_16x16x32_bf16 v[164:167], a[152:155], a[56:59], v[164:167]
 v_mul_f32_dpp v32, v217, v32 row_newbcast:0 row_mask:0xf bank_mask:0xf
 v_mul_f32_dpp v36, v217, v36 row_newbcast:0 row_mask:0xf bank_mask:0xf
 v_mfma_f32_16x16x32_bf16 v[164:167], a[148:151], a[52:55], v[164:167]
 v_exp_f32 v161, v161
 v_mfma_f32_16x16x32_bf16 v[164:167], a[144:147], a[48:51], v[164:167]
 v_exp_f32 v162, v162
 v_mfma_f32_16x16x32_bf16 v[64:67], v[176:179], a[224:227], v[64:67]
 v_exp_f32 v160, v160
 v_mfma_f32_16x16x32_bf16 v[68:71], v[176:179], a[228:231], v[68:71]
 v_exp_f32 v163, v163
 v_mfma_f32_16x16x32_bf16 v[72:75], v[176:179], a[232:235], v[72:75]
 v_cvt_pk_bf16_f32 v180, v160, v161
 v_cvt_pk_bf16_f32 v181, v162, v163
 v_mfma_f32_16x16x32_bf16 v[76:79], v[176:179], a[236:239], v[76:79]
 v_exp_f32 v164, v164
 v_mfma_f32_16x16x32_bf16 v[80:83], v[176:179], a[240:243], v[80:83]
 v_exp_f32 v165, v165
 v_mfma_f32_16x16x32_bf16 v[84:87], v[176:179], a[244:247], v[84:87]
 v_cvt_pk_bf16_f32 v182, v164, v165
 v_cvt_pk_bf16_f32 v240, v32, v36
 v_mfma_f32_16x16x32_bf16 v[88:91], v[176:179], a[248:251], v[88:91]
 v_exp_f32 v166, v166
 v_mfma_f32_16x16x32_bf16 v[92:95], v[176:179], a[252:255], v[92:95]
 v_exp_f32 v167, v167
 v_mfma_f32_16x16x32_bf16 v[168:171], a[160:163], a[32:35], v[152:155]
 v_cvt_pk_bf16_f32 v183, v166, v167
 v_mul_f32_dpp v40, v217, v40 row_newbcast:0 row_mask:0xf bank_mask:0xf
 v_mfma_f32_16x16x32_bf16 v[168:171], a[164:167], a[36:39], v[168:171]
 v_mul_f32_dpp v44, v217, v44 row_newbcast:0 row_mask:0xf bank_mask:0xf
 v_cvt_pk_bf16_f32 v241, v40, v44
 v_mfma_f32_16x16x32_bf16 v[168:171], a[168:171], a[40:43], v[168:171]
 v_mul_f32_dpp v48, v217, v48 row_newbcast:0 row_mask:0xf bank_mask:0xf
 v_mul_f32_dpp v52, v217, v52 row_newbcast:0 row_mask:0xf bank_mask:0xf
 v_mfma_f32_16x16x32_bf16 v[168:171], a[172:175], a[44:47], v[168:171]
 v_cvt_pk_bf16_f32 v242, v48, v52
 v_mul_f32_dpp v56, v217, v56 row_newbcast:0 row_mask:0xf bank_mask:0xf
 v_mfma_f32_16x16x32_bf16 v[172:175], a[188:191], a[44:47], v[152:155]
 v_mul_f32_dpp v60, v217, v60 row_newbcast:0 row_mask:0xf bank_mask:0xf
 v_cvt_pk_bf16_f32 v243, v56, v60
 v_mfma_f32_16x16x32_bf16 v[172:175], a[184:187], a[40:43], v[172:175]
 buffer_store_dwordx4 v[240:243], v244, s[20:23], s33 offen offset:0 sc1
 v_mfma_f32_16x16x32_bf16 v[172:175], a[180:183], a[36:39], v[172:175]
 v_exp_f32 v168, v168
 v_mfma_f32_16x16x32_bf16 v[172:175], a[176:179], a[32:35], v[172:175]
 v_exp_f32 v169, v169
 v_smfmac_f32_16x16x64_bf16 v[132:135], v[236:239], v[176:183], v138
 v_cvt_pk_bf16_f32 v176, v168, v169
 v_mfma_f32_16x16x32_bf16 v[96:99], v[180:183], a[224:227], v[96:99]
 v_exp_f32 v170, v170
 v_mfma_f32_16x16x32_bf16 v[100:103], v[180:183], a[228:231], v[100:103]
 v_exp_f32 v171, v171
 v_mfma_f32_16x16x32_bf16 v[104:107], v[180:183], a[232:235], v[104:107]
 v_exp_f32 v172, v172
 v_mfma_f32_16x16x32_bf16 v[108:111], v[180:183], a[236:239], v[108:111]
 v_exp_f32 v173, v173
 v_mfma_f32_16x16x32_bf16 v[112:115], v[180:183], a[240:243], v[112:115]
 v_exp_f32 v174, v174
 v_mfma_f32_16x16x32_bf16 v[116:119], v[180:183], a[244:247], v[116:119]
 v_exp_f32 v175, v175
 v_mfma_f32_16x16x32_bf16 v[120:123], v[180:183], a[248:251], v[120:123]
 ds_read_b128 a[244:247], v248 offset:27136
 ds_read_b128 a[224:227], v248 offset:24576
 v_cvt_pk_bf16_f32 v177, v170, v171
 v_mfma_f32_16x16x32_bf16 v[124:127], v[180:183], a[252:255], v[124:127]
 ds_read_b128 a[228:231], v248 offset:25088
 v_cvt_pk_bf16_f32 v178, v172, v173
 v_cvt_pk_bf16_f32 v179, v174, v175
 v_mfma_f32_16x16x32_bf16 v[160:163], a[160:163], a[48:51], v[156:159]
 ds_read_b128 a[252:255], v248 offset:28160
 ds_read_b128 a[232:235], v248 offset:25600
 v_mfma_f32_16x16x32_bf16 v[160:163], a[164:167], a[52:55], v[160:163]
 ds_read_b128 a[236:239], v248 offset:26112
 ds_read_b128 a[240:243], v248 offset:26624
 v_mfma_f32_16x16x32_bf16 v[160:163], a[168:171], a[56:59], v[160:163]
 v_mul_f32_dpp v33, v217, v33 row_newbcast:1 row_mask:0xf bank_mask:0xf
 v_mul_f32_dpp v37, v217, v37 row_newbcast:1 row_mask:0xf bank_mask:0xf
 v_mfma_f32_16x16x32_bf16 v[160:163], a[172:175], a[60:63], v[160:163]
 ds_read_b128 a[248:251], v248 offset:27648
 v_cvt_pk_bf16_f32 v240, v33, v37
 v_mfma_f32_16x16x32_bf16 v[164:167], a[188:191], a[60:63], v[156:159]
 v_mul_f32_dpp v41, v217, v41 row_newbcast:1 row_mask:0xf bank_mask:0xf
 v_mul_f32_dpp v45, v217, v45 row_newbcast:1 row_mask:0xf bank_mask:0xf
 v_mfma_f32_16x16x32_bf16 v[164:167], a[184:187], a[56:59], v[164:167]
 v_cvt_pk_bf16_f32 v241, v41, v45
 v_mul_f32_dpp v49, v217, v49 row_newbcast:1 row_mask:0xf bank_mask:0xf
 v_mfma_f32_16x16x32_bf16 v[164:167], a[180:183], a[52:55], v[164:167]
 v_mul_f32_dpp v53, v217, v53 row_newbcast:1 row_mask:0xf bank_mask:0xf
 v_cvt_pk_bf16_f32 v242, v49, v53
 v_mfma_f32_16x16x32_bf16 v[164:167], a[176:179], a[48:51], v[164:167]
 s_waitcnt lgkmcnt(3)
 v_mul_f32_dpp v57, v217, v57 row_newbcast:1 row_mask:0xf bank_mask:0xf
 v_mul_f32_dpp v61, v217, v61 row_newbcast:1 row_mask:0xf bank_mask:0xf
 v_mfma_f32_16x16x32_bf16 v[64:67], v[176:179], a[224:227], v[64:67]
 v_cvt_pk_bf16_f32 v243, v57, v61
 v_mul_f32_dpp v34, v217, v34 row_newbcast:2 row_mask:0xf bank_mask:0xf
 v_mfma_f32_16x16x32_bf16 v[68:71], v[176:179], a[228:231], v[68:71]
 buffer_store_dwordx4 v[240:243], v244, s[20:23], s33 offen offset:1024 sc1
 v_mfma_f32_16x16x32_bf16 v[72:75], v[176:179], a[232:235], v[72:75]
 s_waitcnt lgkmcnt(0)
 v_exp_f32 v160, v160
 v_mfma_f32_16x16x32_bf16 v[76:79], v[176:179], a[236:239], v[76:79]
 v_exp_f32 v161, v161
 v_mfma_f32_16x16x32_bf16 v[80:83], v[176:179], a[240:243], v[80:83]
 v_exp_f32 v162, v162
 v_mfma_f32_16x16x32_bf16 v[84:87], v[176:179], a[244:247], v[84:87]
 v_exp_f32 v163, v163
 v_mfma_f32_16x16x32_bf16 v[88:91], v[176:179], a[248:251], v[88:91]
 v_exp_f32 v164, v164
 v_mfma_f32_16x16x32_bf16 v[92:95], v[176:179], a[252:255], v[92:95]
 v_exp_f32 v165, v165
 v_mfma_f32_16x16x32_bf16 v[168:171], a[192:195], a[32:35], v[152:155]
 v_exp_f32 v166, v166
 v_mfma_f32_16x16x32_bf16 v[168:171], a[196:199], a[36:39], v[168:171]
 v_exp_f32 v167, v167
 v_mfma_f32_16x16x32_bf16 v[168:171], a[200:203], a[40:43], v[168:171]
 v_cvt_pk_bf16_f32 v180, v160, v161
 v_cvt_pk_bf16_f32 v181, v162, v163
 v_mfma_f32_16x16x32_bf16 v[168:171], a[204:207], a[44:47], v[168:171]
 v_cvt_pk_bf16_f32 v182, v164, v165
 v_cvt_pk_bf16_f32 v183, v166, v167
 v_mfma_f32_16x16x32_bf16 v[172:175], a[220:223], a[44:47], v[152:155]
 v_mul_f32_dpp v38, v217, v38 row_newbcast:2 row_mask:0xf bank_mask:0xf
 v_cvt_pk_bf16_f32 v240, v34, v38
 v_mfma_f32_16x16x32_bf16 v[172:175], a[216:219], a[40:43], v[172:175]
 v_mul_f32_dpp v42, v217, v42 row_newbcast:2 row_mask:0xf bank_mask:0xf
 v_mul_f32_dpp v46, v217, v46 row_newbcast:2 row_mask:0xf bank_mask:0xf
 v_mfma_f32_16x16x32_bf16 v[172:175], a[212:215], a[36:39], v[172:175]
 v_exp_f32 v169, v169
 v_mfma_f32_16x16x32_bf16 v[172:175], a[208:211], a[32:35], v[172:175]
 v_exp_f32 v170, v170
 v_smfmac_f32_16x16x64_bf16 v[132:135], v[236:239], v[176:183], v138
 v_cvt_pk_bf16_f32 v241, v42, v46
 v_mfma_f32_16x16x32_bf16 v[96:99], v[180:183], a[224:227], v[96:99]
 v_exp_f32 v171, v171
 v_mfma_f32_16x16x32_bf16 v[100:103], v[180:183], a[228:231], v[100:103]
 v_exp_f32 v168, v168
 v_mfma_f32_16x16x32_bf16 v[104:107], v[180:183], a[232:235], v[104:107]
 v_exp_f32 v173, v173
 v_mfma_f32_16x16x32_bf16 v[108:111], v[180:183], a[236:239], v[108:111]
 v_exp_f32 v174, v174
 v_mfma_f32_16x16x32_bf16 v[112:115], v[180:183], a[240:243], v[112:115]
 v_exp_f32 v175, v175
 v_mfma_f32_16x16x32_bf16 v[116:119], v[180:183], a[244:247], v[116:119]
 v_cvt_pk_bf16_f32 v176, v168, v169
 v_cvt_pk_bf16_f32 v177, v170, v171
 v_mfma_f32_16x16x32_bf16 v[120:123], v[180:183], a[248:251], v[120:123]
 ds_read_b128 a[224:227], v248 offset:32768
 v_exp_f32 v172, v172
 v_mfma_f32_16x16x32_bf16 v[124:127], v[180:183], a[252:255], v[124:127]
 ds_read_b128 a[228:231], v248 offset:33280
 v_cvt_pk_bf16_f32 v178, v172, v173
 v_cvt_pk_bf16_f32 v179, v174, v175
 v_mfma_f32_16x16x32_bf16 v[160:163], a[192:195], a[48:51], v[156:159]
L_pg20:
 s_cbranch_execz L_wb1
 ds_read_b128 a[232:235], v248 offset:33792
 v_mul_f32_dpp v50, v217, v50 row_newbcast:2 row_mask:0xf bank_mask:0xf
 v_mfma_f32_16x16x32_bf16 v[160:163], a[196:199], a[52:55], v[160:163]
 ds_read_b128 a[236:239], v248 offset:34304
 v_mul_f32_dpp v54, v217, v54 row_newbcast:2 row_mask:0xf bank_mask:0xf
 v_cvt_pk_bf16_f32 v242, v50, v54
 v_mfma_f32_16x16x32_bf16 v[160:163], a[200:203], a[56:59], v[160:163]
 ds_read_b128 a[240:243], v248 offset:34816
 v_mul_f32_dpp v58, v217, v58 row_newbcast:2 row_mask:0xf bank_mask:0xf
 v_mul_f32_dpp v62, v217, v62 row_newbcast:2 row_mask:0xf bank_mask:0xf
 v_mfma_f32_16x16x32_bf16 v[160:163], a[204:207], a[60:63], v[160:163]
 ds_read_b128 a[244:247], v248 offset:35328
 v_cvt_pk_bf16_f32 v243, v58, v62
 v_mfma_f32_16x16x32_bf16 v[164:167], a[220:223], a[60:63], v[156:159]
 buffer_store_dwordx4 v[240:243], v244, s[20:23], s33 offen offset:2048 sc1
 ds_read_b128 a[248:251], v248 offset:35840
 v_mfma_f32_16x16x32_bf16 v[164:167], a[216:219], a[56:59], v[164:167]
 ds_read_b128 a[200:203], v249 offset:41984
 ds_read_b128 a[252:255], v248 offset:36352
 v_mfma_f32_16x16x32_bf16 v[164:167], a[212:215], a[52:55], v[164:167]
 ds_read_b128 a[204:207], v249 offset:42496
 ds_read_b128 a[220:223], v249 offset:44544
 ds_read_b128 a[192:195], v249 offset:40960
 v_mfma_f32_16x16x32_bf16 v[164:167], a[208:211], a[48:51], v[164:167]
 s_waitcnt lgkmcnt(9)
 ds_read_b128 a[212:215], v249 offset:43520
 ds_read_b128 a[216:219], v249 offset:44032
 ds_read_b128 a[196:199], v249 offset:41472
 v_mfma_f32_16x16x32_bf16 v[64:67], v[176:179], a[224:227], v[64:67]
 v_exp_f32 v160, v160
 v_mfma_f32_16x16x32_bf16 v[68:71], v[176:179], a[228:231], v[68:71]
 v_exp_f32 v161, v161
 v_mfma_f32_16x16x32_bf16 v[72:75], v[176:179], a[232:235], v[72:75]
 s_waitcnt lgkmcnt(9)
 v_exp_f32 v162, v162
 v_mfma_f32_16x16x32_bf16 v[76:79], v[176:179], a[236:239], v[76:79]
 v_exp_f32 v163, v163
 v_mfma_f32_16x16x32_bf16 v[80:83], v[176:179], a[240:243], v[80:83]
 v_exp_f32 v164, v164
 v_mfma_f32_16x16x32_bf16 v[84:87], v[176:179], a[244:247], v[84:87]
 s_waitcnt lgkmcnt(3)
 ds_read_b128 a[208:211], v249 offset:43008
 v_exp_f32 v165, v165
 v_mfma_f32_16x16x32_bf16 v[88:91], v[176:179], a[248:251], v[88:91]
 v_exp_f32 v166, v166
 v_mfma_f32_16x16x32_bf16 v[92:95], v[176:179], a[252:255], v[92:95]
 v_exp_f32 v167, v167
 v_mfma_f32_16x16x32_bf16 v[168:171], a[192:195], a[32:35], v[152:155]
 s_waitcnt lgkmcnt(1)
 v_cvt_pk_bf16_f32 v180, v160, v161
 v_cvt_pk_bf16_f32 v181, v162, v163
 v_mfma_f32_16x16x32_bf16 v[168:171], a[196:199], a[36:39], v[168:171]
 v_cvt_pk_bf16_f32 v182, v164, v165
 v_cvt_pk_bf16_f32 v183, v166, v167
 v_mfma_f32_16x16x32_bf16 v[168:171], a[200:203], a[40:43], v[168:171]
 v_mul_f32_dpp v35, v217, v35 row_newbcast:3 row_mask:0xf bank_mask:0xf
 v_mul_f32_dpp v39, v217, v39 row_newbcast:3 row_mask:0xf bank_mask:0xf
 v_mfma_f32_16x16x32_bf16 v[168:171], a[204:207], a[44:47], v[168:171]
 v_cvt_pk_bf16_f32 v240, v35, v39
 v_mul_f32_dpp v43, v217, v43 row_newbcast:3 row_mask:0xf bank_mask:0xf
 v_mfma_f32_16x16x32_bf16 v[172:175], a[220:223], a[44:47], v[152:155]
 v_mul_f32_dpp v47, v217, v47 row_newbcast:3 row_mask:0xf bank_mask:0xf
 v_cvt_pk_bf16_f32 v241, v43, v47
 v_mfma_f32_16x16x32_bf16 v[172:175], a[216:219], a[40:43], v[172:175]
 v_mul_f32_dpp v51, v217, v51 row_newbcast:3 row_mask:0xf bank_mask:0xf
 v_mul_f32_dpp v55, v217, v55 row_newbcast:3 row_mask:0xf bank_mask:0xf
 v_mfma_f32_16x16x32_bf16 v[172:175], a[212:215], a[36:39], v[172:175]
 s_waitcnt lgkmcnt(0)
 v_cvt_pk_bf16_f32 v242, v51, v55
 v_mul_f32_dpp v59, v217, v59 row_newbcast:3 row_mask:0xf bank_mask:0xf
 v_mfma_f32_16x16x32_bf16 v[172:175], a[208:211], a[32:35], v[172:175]
 v_mul_f32_dpp v63, v217, v63 row_newbcast:3 row_mask:0xf bank_mask:0xf
 v_cvt_pk_bf16_f32 v243, v59, v63
 v_smfmac_f32_16x16x64_bf16 v[132:135], v[236:239], v[176:183], v138
 s_nop 0
 v_mfma_f32_16x16x32_bf16 v[96:99], v[180:183], a[224:227], v[96:99]
 buffer_store_dwordx4 v[240:243], v244, s[20:23], s33 offen offset:3072 sc1
 v_mfma_f32_16x16x32_bf16 v[100:103], v[180:183], a[228:231], v[100:103]
 ds_read_b128 a[224:227], v248 offset:40960
 ds_read_b128 a[228:231], v248 offset:41472
 v_mfma_f32_16x16x32_bf16 v[104:107], v[180:183], a[232:235], v[104:107]
 v_exp_f32 v168, v168
 v_mfma_f32_16x16x32_bf16 v[108:111], v[180:183], a[236:239], v[108:111]
 v_exp_f32 v169, v169
 v_mfma_f32_16x16x32_bf16 v[112:115], v[180:183], a[240:243], v[112:115]
 v_exp_f32 v170, v170
 v_mfma_f32_16x16x32_bf16 v[116:119], v[180:183], a[244:247], v[116:119]
 v_exp_f32 v171, v171
 v_mfma_f32_16x16x32_bf16 v[120:123], v[180:183], a[248:251], v[120:123]
 v_exp_f32 v172, v172
 v_mfma_f32_16x16x32_bf16 v[124:127], v[180:183], a[252:255], v[124:127]
 v_exp_f32 v173, v173
 v_mfma_f32_16x16x32_bf16 v[160:163], a[192:195], a[48:51], v[156:159]
 ds_read_b128 a[232:235], v248 offset:41984
 v_exp_f32 v174, v174
 v_mfma_f32_16x16x32_bf16 v[160:163], a[196:199], a[52:55], v[160:163]
 ds_read_b128 a[236:239], v248 offset:42496
 v_exp_f32 v175, v175
 v_mfma_f32_16x16x32_bf16 v[160:163], a[200:203], a[56:59], v[160:163]
 ds_read_b128 a[248:251], v248 offset:44032
 ds_read_b128 a[240:243], v248 offset:43008
 v_cvt_pk_bf16_f32 v176, v168, v169
 v_mfma_f32_16x16x32_bf16 v[160:163], a[204:207], a[60:63], v[160:163]
 ds_read_b128 a[244:247], v248 offset:43520
 v_cvt_pk_bf16_f32 v177, v170, v171
 v_cvt_pk_bf16_f32 v178, v172, v173
 v_mfma_f32_16x16x32_bf16 v[164:167], a[220:223], a[60:63], v[156:159]
 ds_read_b128 a[252:255], v248 offset:44544
 v_cvt_pk_bf16_f32 v179, v174, v175
 v_mfma_f32_16x16x32_bf16 v[164:167], a[216:219], a[56:59], v[164:167]
 ds_read_b128 a[192:195], v249 offset:49152
 ds_read_b128 a[196:199], v249 offset:49664
 v_mfma_f32_16x16x32_bf16 v[164:167], a[212:215], a[52:55], v[164:167]
 ds_read_b128 a[200:203], v249 offset:50176
 ds_read_b128 a[204:207], v249 offset:50688
 v_mfma_f32_16x16x32_bf16 v[164:167], a[208:211], a[48:51], v[164:167]
 s_waitcnt lgkmcnt(9)
 ds_read_b128 a[216:219], v249 offset:52224
 ds_read_b128 a[220:223], v249 offset:52736
 v_mfma_f32_16x16x32_bf16 v[64:67], v[176:179], a[224:227], v[64:67]
 ds_read_b128 a[208:211], v249 offset:51200
 ds_read_b128 a[212:215], v249 offset:51712
 v_mfma_f32_16x16x32_bf16 v[68:71], v[176:179], a[228:231], v[68:71]
 v_exp_f32 v160, v160
 v_mfma_f32_16x16x32_bf16 v[72:75], v[176:179], a[232:235], v[72:75]
 s_waitcnt lgkmcnt(9)
 v_exp_f32 v161, v161
 v_mfma_f32_16x16x32_bf16 v[76:79], v[176:179], a[236:239], v[76:79]
 v_exp_f32 v162, v162
 v_mfma_f32_16x16x32_bf16 v[80:83], v[176:179], a[240:243], v[80:83]
 v_exp_f32 v163, v163
 v_mfma_f32_16x16x32_bf16 v[84:87], v[176:179], a[244:247], v[84:87]
 v_exp_f32 v164, v164
 v_mfma_f32_16x16x32_bf16 v[88:91], v[176:179], a[248:251], v[88:91]
 s_waitcnt lgkmcnt(2)
 v_exp_f32 v165, v165
 v_mfma_f32_16x16x32_bf16 v[92:95], v[176:179], a[252:255], v[92:95]
 v_exp_f32 v166, v166
 v_mfma_f32_16x16x32_bf16 v[168:171], a[192:195], a[48:51], v[156:159]
 v_exp_f32 v167, v167
 v_mfma_f32_16x16x32_bf16 v[168:171], a[196:199], a[52:55], v[168:171]
 v_cvt_pk_bf16_f32 v180, v160, v161
 v_cvt_pk_bf16_f32 v181, v162, v163
 v_mfma_f32_16x16x32_bf16 v[168:171], a[200:203], a[56:59], v[168:171]
 v_cvt_pk_bf16_f32 v182, v164, v165
 v_cvt_pk_bf16_f32 v183, v166, v167
 v_mfma_f32_16x16x32_bf16 v[168:171], a[204:207], a[60:63], v[168:171]
 ds_read_b128 a[192:195], v249 offset:57344
 ds_read_b128 a[196:199], v249 offset:57856
 v_mfma_f32_16x16x32_bf16 v[172:175], a[220:223], a[60:63], v[156:159]
 ds_read_b128 a[200:203], v249 offset:58368
 ds_read_b128 a[204:207], v249 offset:58880
 v_mfma_f32_16x16x32_bf16 v[172:175], a[216:219], a[56:59], v[172:175]
 s_waitcnt lgkmcnt(4)
 ds_read_b128 a[220:223], v249 offset:60928
 ds_read_b128 a[216:219], v249 offset:60416
 v_mfma_f32_16x16x32_bf16 v[172:175], a[212:215], a[52:55], v[172:175]
 v_exp_f32 v169, v169
 v_mfma_f32_16x16x32_bf16 v[172:175], a[208:211], a[48:51], v[172:175]
 v_exp_f32 v170, v170
 v_smfmac_f32_16x16x64_bf16 v[132:135], v[236:239], v[176:183], v138
 ds_read_b128 a[208:211], v249 offset:59392
 v_mfma_f32_16x16x32_bf16 v[96:99], v[180:183], a[224:227], v[96:99]
 v_exp_f32 v171, v171
 v_mfma_f32_16x16x32_bf16 v[100:103], v[180:183], a[228:231], v[100:103]
 v_exp_f32 v168, v168
 v_mfma_f32_16x16x32_bf16 v[104:107], v[180:183], a[232:235], v[104:107]
 v_exp_f32 v172, v172
 v_mfma_f32_16x16x32_bf16 v[108:111], v[180:183], a[236:239], v[108:111]
 v_add_f32 v218, v132, v133
 v_cmp_nge_f32 vcc, s28, v218
 v_mfma_f32_16x16x32_bf16 v[112:115], v[180:183], a[240:243], v[112:115]
 s_cmp_lg_u64 vcc, 0
 ds_read_b128 a[212:215], v249 offset:59904
 v_exp_f32 v173, v173
 v_mfma_f32_16x16x32_bf16 v[116:119], v[180:183], a[244:247], v[116:119]
 s_cselect_b32 s34, 4194304, 0
 v_rcp_f32 v218, v218
 v_mfma_f32_16x16x32_bf16 v[120:123], v[180:183], a[248:251], v[120:123]
 s_or_b32 s29, s29, s34
 v_exp_f32 v174, v174
 v_mfma_f32_16x16x32_bf16 v[124:127], v[180:183], a[252:255], v[124:127]
 s_waitcnt lgkmcnt(1)
 s_add_u32 s33, s25, 90112
 ds_read_b128 a[224:227], v248 offset:49152
 v_mov_b32_dpp v218, v218 row_shl:4 row_mask:0x2 bank_mask:0xf
 v_cvt_pk_bf16_f32 v176, v168, v169
 v_mfma_f32_16x16x32_bf16 v[160:163], a[192:195], a[48:51], v[156:159]
 ds_read_b128 a[228:231], v248 offset:49664
 v_exp_f32 v175, v175
 v_mfma_f32_16x16x32_bf16 v[160:163], a[196:199], a[52:55], v[160:163]
 ds_read_b128 a[232:235], v248 offset:50176
 v_mov_b32_dpp v218, v218 row_shl:8 row_mask:0x4 bank_mask:0xf
 v_cvt_pk_bf16_f32 v177, v170, v171
 v_mfma_f32_16x16x32_bf16 v[160:163], a[200:203], a[56:59], v[160:163]
 ds_read_b128 a[236:239], v248 offset:50688
 v_mov_b32_dpp v218, v218 row_shl:12 row_mask:0x8 bank_mask:0xf
 v_cvt_pk_bf16_f32 v178, v172, v173
 v_mfma_f32_16x16x32_bf16 v[160:163], a[204:207], a[60:63], v[160:163]
 ds_read_b128 a[240:243], v248 offset:51200
 v_cvt_pk_bf16_f32 v179, v174, v175
 v_mul_f32_dpp v81, v218, v81 row_newbcast:1 row_mask:0xf bank_mask:0xf
 v_mul_f32_dpp v64, v218, v64 row_newbcast:0 row_mask:0xf bank_mask:0xf
 v_mul_f32_dpp v68, v218, v68 row_newbcast:0 row_mask:0xf bank_mask:0xf
 v_cvt_pk_bf16_f32 v240, v64, v68
 v_mul_f32_dpp v72, v218, v72 row_newbcast:0 row_mask:0xf bank_mask:0xf
 v_mul_f32_dpp v76, v218, v76 row_newbcast:0 row_mask:0xf bank_mask:0xf
 v_cvt_pk_bf16_f32 v241, v72, v76
 v_mul_f32_dpp v80, v218, v80 row_newbcast:0 row_mask:0xf bank_mask:0xf
 v_mul_f32_dpp v84, v218, v84 row_newbcast:0 row_mask:0xf bank_mask:0xf
 v_cvt_pk_bf16_f32 v242, v80, v84
 v_mul_f32_dpp v88, v218, v88 row_newbcast:0 row_mask:0xf bank_mask:0xf
 v_mul_f32_dpp v92, v218, v92 row_newbcast:0 row_mask:0xf bank_mask:0xf
 v_cvt_pk_bf16_f32 v243, v88, v92
 v_mfma_f32_16x16x32_bf16 v[164:167], a[220:223], a[60:63], v[156:159]
 buffer_store_dwordx4 v[240:243], v244, s[20:23], s33 offen offset:0 sc1
 ds_read_b128 a[244:247], v248 offset:51712
 v_mfma_f32_16x16x32_bf16 v[164:167], a[216:219], a[56:59], v[164:167]
 s_waitcnt lgkmcnt(6)
 ds_read_b128 a[248:251], v248 offset:52224
 v_mul_f32_dpp v85, v218, v85 row_newbcast:1 row_mask:0xf bank_mask:0xf
 v_mul_f32_dpp v89, v218, v89 row_newbcast:1 row_mask:0xf bank_mask:0xf
 v_mfma_f32_16x16x32_bf16 v[164:167], a[212:215], a[52:55], v[164:167]
 ds_read_b128 a[252:255], v248 offset:52736
 v_mul_f32_dpp v93, v218, v93 row_newbcast:1 row_mask:0xf bank_mask:0xf
 v_mul_f32_dpp v66, v218, v66 row_newbcast:2 row_mask:0xf bank_mask:0xf
 v_mfma_f32_16x16x32_bf16 v[164:167], a[208:211], a[48:51], v[164:167]
 ds_read_b128 a[192:195], v250 offset:0
 v_mul_f32_dpp v70, v218, v70 row_newbcast:2 row_mask:0xf bank_mask:0xf
 v_mul_f32_dpp v65, v218, v65 row_newbcast:1 row_mask:0xf bank_mask:0xf
 v_mfma_f32_16x16x32_bf16 v[134:137], v[140:143], v[176:179], v[134:137]
 s_waitcnt lgkmcnt(6)
 ds_read_b128 a[196:199], v250 offset:512
 v_mul_f32_dpp v69, v218, v69 row_newbcast:1 row_mask:0xf bank_mask:0xf
 v_cvt_pk_bf16_f32 v240, v65, v69
 v_mfma_f32_16x16x32_bf16 v[96:99], v[176:179], a[224:227], v[96:99]
 ds_read_b128 a[200:203], v250 offset:1024
 v_mul_f32_dpp v73, v218, v73 row_newbcast:1 row_mask:0xf bank_mask:0xf
 v_mul_f32_dpp v77, v218, v77 row_newbcast:1 row_mask:0xf bank_mask:0xf
 v_mfma_f32_16x16x32_bf16 v[100:103], v[176:179], a[228:231], v[100:103]
 ds_read_b128 a[204:207], v250 offset:1536
 v_cvt_pk_bf16_f32 v241, v73, v77
 v_cvt_pk_bf16_f32 v242, v81, v85
 v_mfma_f32_16x16x32_bf16 v[104:107], v[176:179], a[232:235], v[104:107]
 s_waitcnt lgkmcnt(6)
 ds_read_b128 a[220:223], v250 offset:3584
 v_cvt_pk_bf16_f32 v243, v89, v93
 v_mul_f32_dpp v74, v218, v74 row_newbcast:2 row_mask:0xf bank_mask:0xf
 v_mfma_f32_16x16x32_bf16 v[108:111], v[176:179], a[236:239], v[108:111]
 buffer_store_dwordx4 v[240:243], v244, s[20:23], s33 offen offset:1024 sc1
 ds_read_b128 a[216:219], v250 offset:3072
 v_mfma_f32_16x16x32_bf16 v[112:115], v[176:179], a[240:243], v[112:115]
 ds_read_b128 a[212:215], v250 offset:2560
 v_mul_f32_dpp v78, v218, v78 row_newbcast:2 row_mask:0xf bank_mask:0xf
 v_mul_f32_dpp v82, v218, v82 row_newbcast:2 row_mask:0xf bank_mask:0xf
 v_mfma_f32_16x16x32_bf16 v[116:119], v[176:179], a[244:247], v[116:119]
 s_waitcnt lgkmcnt(6)
 ds_read_b128 a[208:211], v250 offset:2048
 v_mul_f32_dpp v86, v218, v86 row_newbcast:2 row_mask:0xf bank_mask:0xf
 v_cvt_pk_bf16_f32 v242, v82, v86
 v_mfma_f32_16x16x32_bf16 v[120:123], v[176:179], a[248:251], v[120:123]
 v_mul_f32_dpp v90, v218, v90 row_newbcast:2 row_mask:0xf bank_mask:0xf
 v_mul_f32_dpp v94, v218, v94 row_newbcast:2 row_mask:0xf bank_mask:0xf
 v_mfma_f32_16x16x32_bf16 v[124:127], v[176:179], a[252:255], v[124:127]
 ds_read_b128 a[224:227], v248 offset:57344
 v_cvt_pk_bf16_f32 v243, v90, v94
 v_cvt_pk_bf16_f32 v240, v66, v70
 v_mfma_f32_16x16x32_bf16 v[168:171], a[192:195], a[48:51], v[156:159]
 s_waitcnt lgkmcnt(5)
 ds_read_b128 a[228:231], v248 offset:57856
 v_exp_f32 v160, v160
 v_mfma_f32_16x16x32_bf16 v[168:171], a[196:199], a[52:55], v[168:171]
 ds_read_b128 a[232:235], v248 offset:58368
 v_exp_f32 v161, v161
 v_mfma_f32_16x16x32_bf16 v[168:171], a[200:203], a[56:59], v[168:171]
 ds_read_b128 a[236:239], v248 offset:58880
 v_exp_f32 v162, v162
 v_mfma_f32_16x16x32_bf16 v[168:171], a[204:207], a[60:63], v[168:171]
 s_waitcnt lgkmcnt(5)
 ds_read_b128 a[240:243], v248 offset:59392
 v_exp_f32 v163, v163
 v_mfma_f32_16x16x32_bf16 v[172:175], a[220:223], a[60:63], v[156:159]
 ds_read_b128 a[244:247], v248 offset:59904
 v_exp_f32 v165, v165
 v_cvt_pk_bf16_f32 v241, v74, v78
 v_exp_f32 v164, v164
 v_exp_f32 v166, v166
 v_exp_f32 v167, v167
 v_mfma_f32_16x16x32_bf16 v[172:175], a[216:219], a[56:59], v[172:175]
 buffer_store_dwordx4 v[240:243], v244, s[20:23], s33 offen offset:2048 sc1
 ds_read_b128 a[248:251], v248 offset:60416
 v_cvt_pk_bf16_f32 v180, v160, v161
 v_cvt_pk_bf16_f32 v181, v162, v163
 v_cvt_pk_bf16_f32 v182, v164, v165
 v_cvt_pk_bf16_f32 v183, v166, v167
 v_mfma_f32_16x16x32_bf16 v[172:175], a[212:215], a[52:55], v[172:175]
 s_waitcnt lgkmcnt(6)
 ds_read_b128 a[252:255], v248 offset:60928
 v_mul_f32_dpp v67, v218, v67 row_newbcast:3 row_mask:0xf bank_mask:0xf
 v_mul_f32_dpp v71, v218, v71 row_newbcast:3 row_mask:0xf bank_mask:0xf
 v_mfma_f32_16x16x32_bf16 v[172:175], a[208:211], a[48:51], v[172:175]
 v_cvt_pk_bf16_f32 v240, v67, v71
 v_mul_f32_dpp v75, v218, v75 row_newbcast:3 row_mask:0xf bank_mask:0xf
 v_mfma_f32_16x16x32_bf16 v[134:137], v[140:143], v[180:183], v[134:137]
 v_mul_f32_dpp v79, v218, v79 row_newbcast:3 row_mask:0xf bank_mask:0xf
 v_cvt_pk_bf16_f32 v241, v75, v79
 v_mfma_f32_16x16x32_bf16 v[96:99], v[180:183], a[224:227], v[96:99]
 s_waitcnt lgkmcnt(4)
 ds_read_b128 a[224:227], v249 offset:0
 v_mul_f32_dpp v83, v218, v83 row_newbcast:3 row_mask:0xf bank_mask:0xf
 v_mul_f32_dpp v87, v218, v87 row_newbcast:3 row_mask:0xf bank_mask:0xf
 v_mfma_f32_16x16x32_bf16 v[100:103], v[180:183], a[228:231], v[100:103]
 ds_read_b128 a[228:231], v249 offset:512
 v_cvt_pk_bf16_f32 v242, v83, v87
 v_mul_f32_dpp v91, v218, v91 row_newbcast:3 row_mask:0xf bank_mask:0xf
 v_mfma_f32_16x16x32_bf16 v[104:107], v[180:183], a[232:235], v[104:107]
 ds_read_b128 a[232:235], v249 offset:1024
 v_mul_f32_dpp v95, v218, v95 row_newbcast:3 row_mask:0xf bank_mask:0xf
 v_cvt_pk_bf16_f32 v243, v91, v95
 v_mfma_f32_16x16x32_bf16 v[108:111], v[180:183], a[236:239], v[108:111]
 s_waitcnt lgkmcnt(4)
 ds_read_b128 a[236:239], v249 offset:1536
 v_exp_f32 v168, v168
 v_mfma_f32_16x16x32_bf16 v[112:115], v[180:183], a[240:243], v[112:115]
 ds_read_b128 a[240:243], v249 offset:2048
 v_exp_f32 v169, v169
 v_exp_f32 v170, v170
 v_exp_f32 v171, v171
 v_exp_f32 v172, v172
 v_exp_f32 v173, v173
 v_exp_f32 v174, v174
 v_exp_f32 v175, v175
 v_mfma_f32_16x16x32_bf16 v[116:119], v[180:183], a[244:247], v[116:119]
 buffer_store_dwordx4 v[240:243], v244, s[20:23], s33 offen offset:3072 sc1
 ds_read_b128 a[244:247], v249 offset:2560
 v_cvt_pk_bf16_f32 v176, v168, v169
 v_cvt_pk_bf16_f32 v177, v170, v171
 v_cvt_pk_bf16_f32 v178, v172, v173
 v_cvt_pk_bf16_f32 v179, v174, v175
 v_mfma_f32_16x16x32_bf16 v[120:123], v[180:183], a[248:251], v[120:123]
 s_waitcnt lgkmcnt(6)
 ds_read_b128 a[248:251], v249 offset:3072
 v_mov_b32 v132, 0
 v_mfma_f32_16x16x32_bf16 v[124:127], v[180:183], a[252:255], v[124:127]
 ds_read_b128 a[252:255], v249 offset:3584
 v_mov_b32 v133, 0
 v_mfma_f32_16x16x32_bf16 v[134:137], v[140:143], v[176:179], v[134:137]
 s_waitcnt lgkmcnt(6)
 s_nop 1
 v_mfma_f32_16x16x32_bf16 v[96:99], v[176:179], a[224:227], v[96:99]
 s_nop 1
 v_mfma_f32_16x16x32_bf16 v[100:103], v[176:179], a[228:231], v[100:103]
 s_waitcnt lgkmcnt(4)
 s_nop 1
 v_mfma_f32_16x16x32_bf16 v[104:107], v[176:179], a[232:235], v[104:107]
 v_add_f32 v219, v134, v135
 v_mov_b32 v134, 0
 v_mfma_f32_16x16x32_bf16 v[108:111], v[176:179], a[236:239], v[108:111]
 s_waitcnt lgkmcnt(2)
 v_mov_b32 v135, 0
 v_cmp_nge_f32 vcc, s28, v219
 v_mfma_f32_16x16x32_bf16 v[112:115], v[176:179], a[240:243], v[112:115]
 s_cmp_lg_u64 vcc, 0
 s_cselect_b32 s34, 8388608, 0
 s_or_b32 s29, s29, s34
 v_mfma_f32_16x16x32_bf16 v[116:119], v[176:179], a[244:247], v[116:119]
 s_waitcnt lgkmcnt(0)
 s_add_u32 s33, s25, 94208
 v_rcp_f32 v219, v219
 v_mfma_f32_16x16x32_bf16 v[120:123], v[176:179], a[248:251], v[120:123]
 s_nop 1
 v_mfma_f32_16x16x32_bf16 v[124:127], v[176:179], a[252:255], v[124:127]
 v_mov_b32_dpp v219, v219 row_shl:4 row_mask:0x2 bank_mask:0xf
 s_nop 1
 v_mov_b32_dpp v219, v219 row_shl:8 row_mask:0x4 bank_mask:0xf
 s_nop 1
 v_mov_b32_dpp v219, v219 row_shl:12 row_mask:0x8 bank_mask:0xf
 s_nop 1
 v_mul_f32_dpp v96, v219, v96 row_newbcast:0 row_mask:0xf bank_mask:0xf
 v_mul_f32_dpp v100, v219, v100 row_newbcast:0 row_mask:0xf bank_mask:0xf
 v_cvt_pk_bf16_f32 v240, v96, v100
 v_mul_f32_dpp v104, v219, v104 row_newbcast:0 row_mask:0xf bank_mask:0xf
 v_mul_f32_dpp v108, v219, v108 row_newbcast:0 row_mask:0xf bank_mask:0xf
 v_cvt_pk_bf16_f32 v241, v104, v108
 v_mul_f32_dpp v112, v219, v112 row_newbcast:0 row_mask:0xf bank_mask:0xf
 v_mul_f32_dpp v116, v219, v116 row_newbcast:0 row_mask:0xf bank_mask:0xf
 v_cvt_pk_bf16_f32 v242, v112, v116
 v_mul_f32_dpp v120, v219, v120 row_newbcast:0 row_mask:0xf bank_mask:0xf
 v_mul_f32_dpp v124, v219, v124 row_newbcast:0 row_mask:0xf bank_mask:0xf
 v_cvt_pk_bf16_f32 v243, v120, v124
 buffer_store_dwordx4 v[240:243], v244, s[20:23], s33 offen offset:0 sc1
 v_mul_f32_dpp v97, v219, v97 row_newbcast:1 row_mask:0xf bank_mask:0xf
 v_mul_f32_dpp v101, v219, v101 row_newbcast:1 row_mask:0xf bank_mask:0xf
 v_cvt_pk_bf16_f32 v240, v97, v101
 v_mul_f32_dpp v105, v219, v105 row_newbcast:1 row_mask:0xf bank_mask:0xf
 v_mul_f32_dpp v109, v219, v109 row_newbcast:1 row_mask:0xf bank_mask:0xf
 v_cvt_pk_bf16_f32 v241, v105, v109
 v_mul_f32_dpp v113, v219, v113 row_newbcast:1 row_mask:0xf bank_mask:0xf
 v_mul_f32_dpp v117, v219, v117 row_newbcast:1 row_mask:0xf bank_mask:0xf
 v_cvt_pk_bf16_f32 v242, v113, v117
 v_mul_f32_dpp v121, v219, v121 row_newbcast:1 row_mask:0xf bank_mask:0xf
 v_mul_f32_dpp v125, v219, v125 row_newbcast:1 row_mask:0xf bank_mask:0xf
 v_cvt_pk_bf16_f32 v243, v121, v125
 buffer_store_dwordx4 v[240:243], v244, s[20:23], s33 offen offset:1024 sc1
 v_mul_f32_dpp v98, v219, v98 row_newbcast:2 row_mask:0xf bank_mask:0xf
 v_mul_f32_dpp v102, v219, v102 row_newbcast:2 row_mask:0xf bank_mask:0xf
 v_cvt_pk_bf16_f32 v240, v98, v102
 v_mul_f32_dpp v106, v219, v106 row_newbcast:2 row_mask:0xf bank_mask:0xf
 v_mul_f32_dpp v110, v219, v110 row_newbcast:2 row_mask:0xf bank_mask:0xf
 v_cvt_pk_bf16_f32 v241, v106, v110
 v_mul_f32_dpp v114, v219, v114 row_newbcast:2 row_mask:0xf bank_mask:0xf
 v_mul_f32_dpp v118, v219, v118 row_newbcast:2 row_mask:0xf bank_mask:0xf
 v_cvt_pk_bf16_f32 v242, v114, v118
 v_mul_f32_dpp v122, v219, v122 row_newbcast:2 row_mask:0xf bank_mask:0xf
 v_mul_f32_dpp v126, v219, v126 row_newbcast:2 row_mask:0xf bank_mask:0xf
 v_cvt_pk_bf16_f32 v243, v122, v126
 buffer_store_dwordx4 v[240:243], v244, s[20:23], s33 offen offset:2048 sc1
 v_mul_f32_dpp v99, v219, v99 row_newbcast:3 row_mask:0xf bank_mask:0xf
 v_mul_f32_dpp v103, v219, v103 row_newbcast:3 row_mask:0xf bank_mask:0xf
 v_cvt_pk_bf16_f32 v240, v99, v103
 v_mul_f32_dpp v107, v219, v107 row_newbcast:3 row_mask:0xf bank_mask:0xf
 v_mul_f32_dpp v111, v219, v111 row_newbcast:3 row_mask:0xf bank_mask:0xf
 v_cvt_pk_bf16_f32 v241, v107, v111
 v_mul_f32_dpp v115, v219, v115 row_newbcast:3 row_mask:0xf bank_mask:0xf
 v_mul_f32_dpp v119, v219, v119 row_newbcast:3 row_mask:0xf bank_mask:0xf
 v_cvt_pk_bf16_f32 v242, v115, v119
 v_mul_f32_dpp v123, v219, v123 row_newbcast:3 row_mask:0xf bank_mask:0xf
 v_mul_f32_dpp v127, v219, v127 row_newbcast:3 row_mask:0xf bank_mask:0xf
 v_cvt_pk_bf16_f32 v243, v123, v127
 buffer_store_dwordx4 v[240:243], v244, s[20:23], s33 offen offset:3072 sc1
L_slow:
 s_cmp_eq_u32 s29, 0
 s_cbranch_scc1 L_end
 s_waitcnt vmcnt(0) lgkmcnt(0)
 s_nop 15
 s_ff1_i32_b32 s35, s29
 s_bitset0_b32 s29, s35
 s_mul_i32 s34, s35, 4096
 s_add_u32 s32, s25, s34
 buffer_load_dwordx4 a[0:3], v245, s[8:11], s32 offen offset:0
 buffer_load_dwordx4 a[4:7], v245, s[8:11], s32 offen offset:64
 buffer_load_dwordx4 a[8:11], v245, s[8:11], s32 offen offset:128
 buffer_load_dwordx4 a[12:15], v245, s[8:11], s32 offen offset:192
 v_mov_b32 v128, 0
 v_mov_b32 v129, 0
 s_waitcnt vmcnt(3)
 v_mfma_f32_16x16x32_bf16 v[160:163], a[64:67], a[0:3], 0
 s_waitcnt vmcnt(2)
 v_mfma_f32_16x16x32_bf16 v[160:163], a[68:71], a[4:7], v[160:163]
 s_waitcnt vmcnt(1)
 v_mfma_f32_16x16x32_bf16 v[160:163], a[72:75], a[8:11], v[160:163]
 s_waitcnt vmcnt(0)
 v_mfma_f32_16x16x32_bf16 v[160:163], a[76:79], a[12:15], v[160:163]
 v_mfma_f32_16x16x32_bf16 v[164:167], a[80:83], a[0:3], 0
 v_mfma_f32_16x16x32_bf16 v[164:167], a[84:87], a[4:7], v[164:167]
 v_mfma_f32_16x16x32_bf16 v[164:167], a[88:91], a[8:11], v[164:167]
 v_mfma_f32_16x16x32_bf16 v[164:167], a[92:95], a[12:15], v[164:167]
 s_nop 7
 v_max_f32 v144, v160, v164
 v_max_f32 v145, v161, v165
 v_max_f32 v146, v162, v166
 v_max_f32 v147, v163, v167
 v_mfma_f32_16x16x32_bf16 v[160:163], a[96:99], a[0:3], 0
 v_mfma_f32_16x16x32_bf16 v[160:163], a[100:103], a[4:7], v[160:163]
 v_mfma_f32_16x16x32_bf16 v[160:163], a[104:107], a[8:11], v[160:163]
 v_mfma_f32_16x16x32_bf16 v[160:163], a[108:111], a[12:15], v[160:163]
 v_mfma_f32_16x16x32_bf16 v[164:167], a[112:115], a[0:3], 0
 v_mfma_f32_16x16x32_bf16 v[164:167], a[116:119], a[4:7], v[164:167]
 v_mfma_f32_16x16x32_bf16 v[164:167], a[120:123], a[8:11], v[164:167]
 v_mfma_f32_16x16x32_bf16 v[164:167], a[124:127], a[12:15], v[164:167]
 s_nop 7
 v_max3_f32 v144, v144, v160, v164
 v_max3_f32 v145, v145, v161, v165
 v_max3_f32 v146, v146, v162, v166
 v_max3_f32 v147, v147, v163, v167
 v_mfma_f32_16x16x32_bf16 v[160:163], a[128:131], a[0:3], 0
 v_mfma_f32_16x16x32_bf16 v[160:163], a[132:135], a[4:7], v[160:163]
 v_mfma_f32_16x16x32_bf16 v[160:163], a[136:139], a[8:11], v[160:163]
 v_mfma_f32_16x16x32_bf16 v[160:163], a[140:143], a[12:15], v[160:163]
 v_mfma_f32_16x16x32_bf16 v[164:167], a[144:147], a[0:3], 0
 v_mfma_f32_16x16x32_bf16 v[164:167], a[148:151], a[4:7], v[164:167]
 v_mfma_f32_16x16x32_bf16 v[164:167], a[152:155], a[8:11], v[164:167]
 v_mfma_f32_16x16x32_bf16 v[164:167], a[156:159], a[12:15], v[164:167]
 s_nop 7
 v_max3_f32 v144, v144, v160, v164
 v_max3_f32 v145, v145, v161, v165
 v_max3_f32 v146, v146, v162, v166
 v_max3_f32 v147, v147, v163, v167
 v_mfma_f32_16x16x32_bf16 v[160:163], a[160:163], a[0:3], 0
 v_mfma_f32_16x16x32_bf16 v[160:163], a[164:167], a[4:7], v[160:163]
 v_mfma_f32_16x16x32_bf16 v[160:163], a[168:171], a[8:11], v[160:163]
 v_mfma_f32_16x16x32_bf16 v[160:163], a[172:175], a[12:15], v[160:163]
 v_mfma_f32_16x16x32_bf16 v[164:167], a[176:179], a[0:3], 0
 v_mfma_f32_16x16x32_bf16 v[164:167], a[180:183], a[4:7], v[164:167]
 v_mfma_f32_16x16x32_bf16 v[164:167], a[184:187], a[8:11], v[164:167]
 v_mfma_f32_16x16x32_bf16 v[164:167], a[188:191], a[12:15], v[164:167]
 s_nop 7
 v_max3_f32 v144, v144, v160, v164
 v_max3_f32 v145, v145, v161, v165
 v_max3_f32 v146, v146, v162, v166
 v_max3_f32 v147, v147, v163, v167
 ds_read_b128 a[192:195], v249 offset:32768
 ds_read_b128 a[196:199], v249 offset:33280
 ds_read_b128 a[200:203], v249 offset:33792
 ds_read_b128 a[204:207], v249 offset:34304
 ds_read_b128 a[208:211], v249 offset:34816
 ds_read_b128 a[212:215], v249 offset:35328
 ds_read_b128 a[216:219], v249 offset:35840
 ds_read_b128 a[220:223], v249 offset:36352
 s_waitcnt lgkmcnt(7)
 v_mfma_f32_16x16x32_bf16 v[160:163], a[192:195], a[0:3], 0
 s_waitcnt lgkmcnt(6)
 v_mfma_f32_16x16x32_bf16 v[160:163], a[196:199], a[4:7], v[160:163]
 s_waitcnt lgkmcnt(5)
 v_mfma_f32_16x16x32_bf16 v[160:163], a[200:203], a[8:11], v[160:163]
 s_waitcnt lgkmcnt(4)
 v_mfma_f32_16x16x32_bf16 v[160:163], a[204:207], a[12:15], v[160:163]
 s_waitcnt lgkmcnt(3)
 v_mfma_f32_16x16x32_bf16 v[164:167], a[208:211], a[0:3], 0
 s_waitcnt lgkmcnt(2)
 v_mfma_f32_16x16x32_bf16 v[164:167], a[212:215], a[4:7], v[164:167]
 s_waitcnt lgkmcnt(1)
 v_mfma_f32_16x16x32_bf16 v[164:167], a[216:219], a[8:11], v[164:167]
 s_waitcnt lgkmcnt(0)
 v_mfma_f32_16x16x32_bf16 v[164:167], a[220:223], a[12:15], v[164:167]
 s_nop 7
 v_max3_f32 v144, v144, v160, v164
 v_max3_f32 v145, v145, v161, v165
 v_max3_f32 v146, v146, v162, v166
 v_max3_f32 v147, v147, v163, v167
 ds_read_b128 a[192:195], v249 offset:40960
 ds_read_b128 a[196:199], v249 offset:41472
 ds_read_b128 a[200:203], v249 offset:41984
 ds_read_b128 a[204:207], v249 offset:42496
 ds_read_b128 a[208:211], v249 offset:43008
 ds_read_b128 a[212:215], v249 offset:43520
 ds_read_b128 a[216:219], v249 offset:44032
 ds_read_b128 a[220:223], v249 offset:44544
 s_waitcnt lgkmcnt(7)
 v_mfma_f32_16x16x32_bf16 v[160:163], a[192:195], a[0:3], 0
 s_waitcnt lgkmcnt(6)
 v_mfma_f32_16x16x32_bf16 v[160:163], a[196:199], a[4:7], v[160:163]
 s_waitcnt lgkmcnt(5)
 v_mfma_f32_16x16x32_bf16 v[160:163], a[200:203], a[8:11], v[160:163]
 s_waitcnt lgkmcnt(4)
 v_mfma_f32_16x16x32_bf16 v[160:163], a[204:207], a[12:15], v[160:163]
 s_waitcnt lgkmcnt(3)
 v_mfma_f32_16x16x32_bf16 v[164:167], a[208:211], a[0:3], 0
 s_waitcnt lgkmcnt(2)
 v_mfma_f32_16x16x32_bf16 v[164:167], a[212:215], a[4:7], v[164:167]
 s_waitcnt lgkmcnt(1)
 v_mfma_f32_16x16x32_bf16 v[164:167], a[216:219], a[8:11], v[164:167]
 s_waitcnt lgkmcnt(0)
 v_mfma_f32_16x16x32_bf16 v[164:167], a[220:223], a[12:15], v[164:167]
 s_nop 7
 v_max3_f32 v144, v144, v160, v164
 v_max3_f32 v145, v145, v161, v165
 v_max3_f32 v146, v146, v162, v166
 v_max3_f32 v147, v147, v163, v167
 ds_read_b128 a[192:195], v249 offset:49152
 ds_read_b128 a[196:199], v249 offset:49664
 ds_read_b128 a[200:203], v249 offset:50176
 ds_read_b128 a[204:207], v249 offset:50688
 ds_read_b128 a[208:211], v249 offset:51200
 ds_read_b128 a[212:215], v249 offset:51712
 ds_read_b128 a[216:219], v249 offset:52224
 ds_read_b128 a[220:223], v249 offset:52736
 s_waitcnt lgkmcnt(7)
 v_mfma_f32_16x16x32_bf16 v[160:163], a[192:195], a[0:3], 0
 s_waitcnt lgkmcnt(6)
 v_mfma_f32_16x16x32_bf16 v[160:163], a[196:199], a[4:7], v[160:163]
 s_waitcnt lgkmcnt(5)
 v_mfma_f32_16x16x32_bf16 v[160:163], a[200:203], a[8:11], v[160:163]
 s_waitcnt lgkmcnt(4)
 v_mfma_f32_16x16x32_bf16 v[160:163], a[204:207], a[12:15], v[160:163]
 s_waitcnt lgkmcnt(3)
 v_mfma_f32_16x16x32_bf16 v[164:167], a[208:211], a[0:3], 0
 s_waitcnt lgkmcnt(2)
 v_mfma_f32_16x16x32_bf16 v[164:167], a[212:215], a[4:7], v[164:167]
 s_waitcnt lgkmcnt(1)
 v_mfma_f32_16x16x32_bf16 v[164:167], a[216:219], a[8:11], v[164:167]
 s_waitcnt lgkmcnt(0)
 v_mfma_f32_16x16x32_bf16 v[164:167], a[220:223], a[12:15], v[164:167]
 s_nop 7
 v_max3_f32 v144, v144, v160, v164
 v_max3_f32 v145, v145, v161, v165
 v_max3_f32 v146, v146, v162, v166
 v_max3_f32 v147, v147, v163, v167
 ds_read_b128 a[192:195], v249 offset:57344
 ds_read_b128 a[196:199], v249 offset:57856
 ds_read_b128 a[200:203], v249 offset:58368
 ds_read_b128 a[204:207], v249 offset:58880
 ds_read_b128 a[208:211], v249 offset:59392
 ds_read_b128 a[212:215], v249 offset:59904
 ds_read_b128 a[216:219], v249 offset:60416
 ds_read_b128 a[220:223], v249 offset:60928
 s_waitcnt lgkmcnt(7)
 v_mfma_f32_16x16x32_bf16 v[160:163], a[192:195], a[0:3], 0
 s_waitcnt lgkmcnt(6)
 v_mfma_f32_16x16x32_bf16 v[160:163], a[196:199], a[4:7], v[160:163]
 s_waitcnt lgkmcnt(5)
 v_mfma_f32_16x16x32_bf16 v[160:163], a[200:203], a[8:11], v[160:163]
 s_waitcnt lgkmcnt(4)
 v_mfma_f32_16x16x32_bf16 v[160:163], a[204:207], a[12:15], v[160:163]
 s_waitcnt lgkmcnt(3)
 v_mfma_f32_16x16x32_bf16 v[164:167], a[208:211], a[0:3], 0
 s_waitcnt lgkmcnt(2)
 v_mfma_f32_16x16x32_bf16 v[164:167], a[212:215], a[4:7], v[164:167]
 s_waitcnt lgkmcnt(1)
 v_mfma_f32_16x16x32_bf16 v[164:167], a[216:219], a[8:11], v[164:167]
 s_waitcnt lgkmcnt(0)
 v_mfma_f32_16x16x32_bf16 v[164:167], a[220:223], a[12:15], v[164:167]
 s_nop 7
 v_max3_f32 v144, v144, v160, v164
 v_max3_f32 v145, v145, v161, v165
 v_max3_f32 v146, v146, v162, v166
 v_max3_f32 v147, v147, v163, v167
 ds_read_b128 a[192:195], v250 offset:0
 ds_read_b128 a[196:199], v250 offset:512
 ds_read_b128 a[200:203], v250 offset:1024
 ds_read_b128 a[204:207], v250 offset:1536
 ds_read_b128 a[208:211], v250 offset:2048
 ds_read_b128 a[212:215], v250 offset:2560
 ds_read_b128 a[216:219], v250 offset:3072
 ds_read_b128 a[220:223], v250 offset:3584
 s_waitcnt lgkmcnt(7)
 v_mfma_f32_16x16x32_bf16 v[160:163], a[192:195], a[0:3], 0
 s_waitcnt lgkmcnt(6)
 v_mfma_f32_16x16x32_bf16 v[160:163], a[196:199], a[4:7], v[160:163]
 s_waitcnt lgkmcnt(5)
 v_mfma_f32_16x16x32_bf16 v[160:163], a[200:203], a[8:11], v[160:163]
 s_waitcnt lgkmcnt(4)
 v_mfma_f32_16x16x32_bf16 v[160:163], a[204:207], a[12:15], v[160:163]
 s_waitcnt lgkmcnt(3)
 v_mfma_f32_16x16x32_bf16 v[164:167], a[208:211], a[0:3], 0
 s_waitcnt lgkmcnt(2)
 v_mfma_f32_16x16x32_bf16 v[164:167], a[212:215], a[4:7], v[164:167]
 s_waitcnt lgkmcnt(1)
 v_mfma_f32_16x16x32_bf16 v[164:167], a[216:219], a[8:11], v[164:167]
 s_waitcnt lgkmcnt(0)
 v_mfma_f32_16x16x32_bf16 v[164:167], a[220:223], a[12:15], v[164:167]
 s_nop 7
 v_max3_f32 v144, v144, v160, v164
 v_max3_f32 v145, v145, v161, v165
 v_max3_f32 v146, v146, v162, v166
 v_max3_f32 v147, v147, v163, v167
 ds_read_b128 a[192:195], v250 offset:8192
 ds_read_b128 a[196:199], v250 offset:8704
 ds_read_b128 a[200:203], v250 offset:9216
 ds_read_b128 a[204:207], v250 offset:9728
 ds_read_b128 a[208:211], v250 offset:10240
 ds_read_b128 a[212:215], v250 offset:10752
 ds_read_b128 a[216:219], v250 offset:11264
 ds_read_b128 a[220:223], v250 offset:11776
 s_waitcnt lgkmcnt(7)
 v_mfma_f32_16x16x32_bf16 v[160:163], a[192:195], a[0:3], 0
 s_waitcnt lgkmcnt(6)
 v_mfma_f32_16x16x32_bf16 v[160:163], a[196:199], a[4:7], v[160:163]
 s_waitcnt lgkmcnt(5)
 v_mfma_f32_16x16x32_bf16 v[160:163], a[200:203], a[8:11], v[160:163]
 s_waitcnt lgkmcnt(4)
 v_mfma_f32_16x16x32_bf16 v[160:163], a[204:207], a[12:15], v[160:163]
 s_waitcnt lgkmcnt(3)
 v_mfma_f32_16x16x32_bf16 v[164:167], a[208:211], a[0:3], 0
 s_waitcnt lgkmcnt(2)
 v_mfma_f32_16x16x32_bf16 v[164:167], a[212:215], a[4:7], v[164:167]
 s_waitcnt lgkmcnt(1)
 v_mfma_f32_16x16x32_bf16 v[164:167], a[216:219], a[8:11], v[164:167]
 s_waitcnt lgkmcnt(0)
 v_mfma_f32_16x16x32_bf16 v[164:167], a[220:223], a[12:15], v[164:167]
 s_nop 7
 v_max3_f32 v144, v144, v160, v164
 v_max3_f32 v145, v145, v161, v165
 v_max3_f32 v146, v146, v162, v166
 v_max3_f32 v147, v147, v163, v167
 ds_read_b128 a[192:195], v250 offset:16384
 ds_read_b128 a[196:199], v250 offset:16896
 ds_read_b128 a[200:203], v250 offset:17408
 ds_read_b128 a[204:207], v250 offset:17920
 ds_read_b128 a[208:211], v250 offset:18432
 ds_read_b128 a[212:215], v250 offset:18944
 ds_read_b128 a[216:219], v250 offset:19456
 ds_read_b128 a[220:223], v250 offset:19968
 s_waitcnt lgkmcnt(7)
 v_mfma_f32_16x16x32_bf16 v[160:163], a[192:195], a[0:3], 0
 s_waitcnt lgkmcnt(6)
 v_mfma_f32_16x16x32_bf16 v[160:163], a[196:199], a[4:7], v[160:163]
 s_waitcnt lgkmcnt(5)
 v_mfma_f32_16x16x32_bf16 v[160:163], a[200:203], a[8:11], v[160:163]
 s_waitcnt lgkmcnt(4)
 v_mfma_f32_16x16x32_bf16 v[160:163], a[204:207], a[12:15], v[160:163]
 s_waitcnt lgkmcnt(3)
 v_mfma_f32_16x16x32_bf16 v[164:167], a[208:211], a[0:3], 0
 s_waitcnt lgkmcnt(2)
 v_mfma_f32_16x16x32_bf16 v[164:167], a[212:215], a[4:7], v[164:167]
 s_waitcnt lgkmcnt(1)
 v_mfma_f32_16x16x32_bf16 v[164:167], a[216:219], a[8:11], v[164:167]
 s_waitcnt lgkmcnt(0)
 v_mfma_f32_16x16x32_bf16 v[164:167], a[220:223], a[12:15], v[164:167]
 s_nop 7
 v_max3_f32 v144, v144, v160, v164
 v_max3_f32 v145, v145, v161, v165
 v_max3_f32 v146, v146, v162, v166
 v_max3_f32 v147, v147, v163, v167
 ds_read_b128 a[192:195], v250 offset:24576
 ds_read_b128 a[196:199], v250 offset:25088
 ds_read_b128 a[200:203], v250 offset:25600
 ds_read_b128 a[204:207], v250 offset:26112
 ds_read_b128 a[208:211], v250 offset:26624
 ds_read_b128 a[212:215], v250 offset:27136
 ds_read_b128 a[216:219], v250 offset:27648
 ds_read_b128 a[220:223], v250 offset:28160
 s_waitcnt lgkmcnt(7)
 v_mfma_f32_16x16x32_bf16 v[160:163], a[192:195], a[0:3], 0
 s_waitcnt lgkmcnt(6)
 v_mfma_f32_16x16x32_bf16 v[160:163], a[196:199], a[4:7], v[160:163]
 s_waitcnt lgkmcnt(5)
 v_mfma_f32_16x16x32_bf16 v[160:163], a[200:203], a[8:11], v[160:163]
 s_waitcnt lgkmcnt(4)
 v_mfma_f32_16x16x32_bf16 v[160:163], a[204:207], a[12:15], v[160:163]
 s_waitcnt lgkmcnt(3)
 v_mfma_f32_16x16x32_bf16 v[164:167], a[208:211], a[0:3], 0
 s_waitcnt lgkmcnt(2)
 v_mfma_f32_16x16x32_bf16 v[164:167], a[212:215], a[4:7], v[164:167]
 s_waitcnt lgkmcnt(1)
 v_mfma_f32_16x16x32_bf16 v[164:167], a[216:219], a[8:11], v[164:167]
 s_waitcnt lgkmcnt(0)
 v_mfma_f32_16x16x32_bf16 v[164:167], a[220:223], a[12:15], v[164:167]
 s_nop 7
 v_max3_f32 v144, v144, v160, v164
 v_max3_f32 v145, v145, v161, v165
 v_max3_f32 v146, v146, v162, v166
 v_max3_f32 v147, v147, v163, v167
 v_max3_f32 v246, v144, v145, v146
 v_max_f32 v246, v246, v147
 v_mov_b32 v247, v246
 s_nop 1
 v_permlane16_swap_b32 v246, v247
 v_max_f32 v246, v246, v247
 v_mov_b32 v247, v246
 s_nop 1
 v_permlane32_swap_b32 v246, v247
 v_min_f32 v246, -v246, -v247
 v_mov_b32 v144, v246
 v_mov_b32 v145, v246
 v_mov_b32 v146, v246
 v_mov_b32 v147, v246
 ds_read_b128 a[224:227], v248 offset:0
 ds_read_b128 a[228:231], v248 offset:512
 ds_read_b128 a[232:235], v248 offset:1024
 ds_read_b128 a[236:239], v248 offset:1536
 ds_read_b128 a[240:243], v248 offset:2048
 ds_read_b128 a[244:247], v248 offset:2560
 ds_read_b128 a[248:251], v248 offset:3072
 ds_read_b128 a[252:255], v248 offset:3584
 v_mfma_f32_16x16x32_bf16 v[160:163], a[64:67], a[0:3], v[144:147]
 v_mfma_f32_16x16x32_bf16 v[160:163], a[68:71], a[4:7], v[160:163]
 v_mfma_f32_16x16x32_bf16 v[160:163], a[72:75], a[8:11], v[160:163]
 v_mfma_f32_16x16x32_bf16 v[160:163], a[76:79], a[12:15], v[160:163]
 v_mfma_f32_16x16x32_bf16 v[164:167], a[80:83], a[0:3], v[144:147]
 v_mfma_f32_16x16x32_bf16 v[164:167], a[84:87], a[4:7], v[164:167]
 v_mfma_f32_16x16x32_bf16 v[164:167], a[88:91], a[8:11], v[164:167]
 v_mfma_f32_16x16x32_bf16 v[164:167], a[92:95], a[12:15], v[164:167]
 s_nop 3
 v_exp_f32 v160, v160
 v_exp_f32 v161, v161
 s_nop 0
 v_cvt_pk_bf16_f32 v176, v160, v161
 v_exp_f32 v162, v162
 v_exp_f32 v163, v163
 s_nop 0
 v_cvt_pk_bf16_f32 v177, v162, v163
 v_exp_f32 v164, v164
 v_exp_f32 v165, v165
 s_nop 0
 v_cvt_pk_bf16_f32 v178, v164, v165
 v_exp_f32 v166, v166
 v_exp_f32 v167, v167
 s_nop 0
 v_cvt_pk_bf16_f32 v179, v166, v167
 s_nop 1
 v_mfma_f32_16x16x32_bf16 v[128:131], v[140:143], v[176:179], v[128:131]
 s_waitcnt lgkmcnt(7)
 v_mfma_f32_16x16x32_bf16 v[0:3], v[176:179], a[224:227], 0
 s_waitcnt lgkmcnt(6)
 v_mfma_f32_16x16x32_bf16 v[4:7], v[176:179], a[228:231], 0
 s_waitcnt lgkmcnt(5)
 v_mfma_f32_16x16x32_bf16 v[8:11], v[176:179], a[232:235], 0
 s_waitcnt lgkmcnt(4)
 v_mfma_f32_16x16x32_bf16 v[12:15], v[176:179], a[236:239], 0
 s_waitcnt lgkmcnt(3)
 v_mfma_f32_16x16x32_bf16 v[16:19], v[176:179], a[240:243], 0
 s_waitcnt lgkmcnt(2)
 v_mfma_f32_16x16x32_bf16 v[20:23], v[176:179], a[244:247], 0
 s_waitcnt lgkmcnt(1)
 v_mfma_f32_16x16x32_bf16 v[24:27], v[176:179], a[248:251], 0
 s_waitcnt lgkmcnt(0)
 v_mfma_f32_16x16x32_bf16 v[28:31], v[176:179], a[252:255], 0
 ds_read_b128 a[224:227], v248 offset:8192
 ds_read_b128 a[228:231], v248 offset:8704
 ds_read_b128 a[232:235], v248 offset:9216
 ds_read_b128 a[236:239], v248 offset:9728
 ds_read_b128 a[240:243], v248 offset:10240
 ds_read_b128 a[244:247], v248 offset:10752
 ds_read_b128 a[248:251], v248 offset:11264
 ds_read_b128 a[252:255], v248 offset:11776
 v_mfma_f32_16x16x32_bf16 v[160:163], a[96:99], a[0:3], v[144:147]
 v_mfma_f32_16x16x32_bf16 v[160:163], a[100:103], a[4:7], v[160:163]
 v_mfma_f32_16x16x32_bf16 v[160:163], a[104:107], a[8:11], v[160:163]
 v_mfma_f32_16x16x32_bf16 v[160:163], a[108:111], a[12:15], v[160:163]
 v_mfma_f32_16x16x32_bf16 v[164:167], a[112:115], a[0:3], v[144:147]
 v_mfma_f32_16x16x32_bf16 v[164:167], a[116:119], a[4:7], v[164:167]
 v_mfma_f32_16x16x32_bf16 v[164:167], a[120:123], a[8:11], v[164:167]
 v_mfma_f32_16x16x32_bf16 v[164:167], a[124:127], a[12:15], v[164:167]
 s_nop 3
 v_exp_f32 v160, v160
 v_exp_f32 v161, v161
 s_nop 0
 v_cvt_pk_bf16_f32 v176, v160, v161
 v_exp_f32 v162, v162
 v_exp_f32 v163, v163
 s_nop 0
 v_cvt_pk_bf16_f32 v177, v162, v163
 v_exp_f32 v164, v164
 v_exp_f32 v165, v165
 s_nop 0
 v_cvt_pk_bf16_f32 v178, v164, v165
 v_exp_f32 v166, v166
 v_exp_f32 v167, v167
 s_nop 0
 v_cvt_pk_bf16_f32 v179, v166, v167
 s_nop 1
 v_mfma_f32_16x16x32_bf16 v[128:131], v[140:143], v[176:179], v[128:131]
 s_waitcnt lgkmcnt(7)
 v_mfma_f32_16x16x32_bf16 v[0:3], v[176:179], a[224:227], v[0:3]
 s_waitcnt lgkmcnt(6)
 v_mfma_f32_16x16x32_bf16 v[4:7], v[176:179], a[228:231], v[4:7]
 s_waitcnt lgkmcnt(5)
 v_mfma_f32_16x16x32_bf16 v[8:11], v[176:179], a[232:235], v[8:11]
 s_waitcnt lgkmcnt(4)
 v_mfma_f32_16x16x32_bf16 v[12:15], v[176:179], a[236:239], v[12:15]
 s_waitcnt lgkmcnt(3)
 v_mfma_f32_16x16x32_bf16 v[16:19], v[176:179], a[240:243], v[16:19]
 s_waitcnt lgkmcnt(2)
 v_mfma_f32_16x16x32_bf16 v[20:23], v[176:179], a[244:247], v[20:23]
 s_waitcnt lgkmcnt(1)
 v_mfma_f32_16x16x32_bf16 v[24:27], v[176:179], a[248:251], v[24:27]
 s_waitcnt lgkmcnt(0)
 v_mfma_f32_16x16x32_bf16 v[28:31], v[176:179], a[252:255], v[28:31]
 ds_read_b128 a[224:227], v248 offset:16384
 ds_read_b128 a[228:231], v248 offset:16896
 ds_read_b128 a[232:235], v248 offset:17408
 ds_read_b128 a[236:239], v248 offset:17920
 ds_read_b128 a[240:243], v248 offset:18432
 ds_read_b128 a[244:247], v248 offset:18944
 ds_read_b128 a[248:251], v248 offset:19456
 ds_read_b128 a[252:255], v248 offset:19968
 v_mfma_f32_16x16x32_bf16 v[160:163], a[128:131], a[0:3], v[144:147]
 v_mfma_f32_16x16x32_bf16 v[160:163], a[132:135], a[4:7], v[160:163]
 v_mfma_f32_16x16x32_bf16 v[160:163], a[136:139], a[8:11], v[160:163]
 v_mfma_f32_16x16x32_bf16 v[160:163], a[140:143], a[12:15], v[160:163]
 v_mfma_f32_16x16x32_bf16 v[164:167], a[144:147], a[0:3], v[144:147]
 v_mfma_f32_16x16x32_bf16 v[164:167], a[148:151], a[4:7], v[164:167]
 v_mfma_f32_16x16x32_bf16 v[164:167], a[152:155], a[8:11], v[164:167]
 v_mfma_f32_16x16x32_bf16 v[164:167], a[156:159], a[12:15], v[164:167]
 s_nop 3
 v_exp_f32 v160, v160
 v_exp_f32 v161, v161
 s_nop 0
 v_cvt_pk_bf16_f32 v176, v160, v161
 v_exp_f32 v162, v162
 v_exp_f32 v163, v163
 s_nop 0
 v_cvt_pk_bf16_f32 v177, v162, v163
 v_exp_f32 v164, v164
 v_exp_f32 v165, v165
 s_nop 0
 v_cvt_pk_bf16_f32 v178, v164, v165
 v_exp_f32 v166, v166
 v_exp_f32 v167, v167
 s_nop 0
 v_cvt_pk_bf16_f32 v179, v166, v167
 s_nop 1
 v_mfma_f32_16x16x32_bf16 v[128:131], v[140:143], v[176:179], v[128:131]
 s_waitcnt lgkmcnt(7)
 v_mfma_f32_16x16x32_bf16 v[0:3], v[176:179], a[224:227], v[0:3]
 s_waitcnt lgkmcnt(6)
 v_mfma_f32_16x16x32_bf16 v[4:7], v[176:179], a[228:231], v[4:7]
 s_waitcnt lgkmcnt(5)
 v_mfma_f32_16x16x32_bf16 v[8:11], v[176:179], a[232:235], v[8:11]
 s_waitcnt lgkmcnt(4)
 v_mfma_f32_16x16x32_bf16 v[12:15], v[176:179], a[236:239], v[12:15]
 s_waitcnt lgkmcnt(3)
 v_mfma_f32_16x16x32_bf16 v[16:19], v[176:179], a[240:243], v[16:19]
 s_waitcnt lgkmcnt(2)
 v_mfma_f32_16x16x32_bf16 v[20:23], v[176:179], a[244:247], v[20:23]
 s_waitcnt lgkmcnt(1)
 v_mfma_f32_16x16x32_bf16 v[24:27], v[176:179], a[248:251], v[24:27]
 s_waitcnt lgkmcnt(0)
 v_mfma_f32_16x16x32_bf16 v[28:31], v[176:179], a[252:255], v[28:31]
 ds_read_b128 a[224:227], v248 offset:24576
 ds_read_b128 a[228:231], v248 offset:25088
 ds_read_b128 a[232:235], v248 offset:25600
 ds_read_b128 a[236:239], v248 offset:26112
 ds_read_b128 a[240:243], v248 offset:26624
 ds_read_b128 a[244:247], v248 offset:27136
 ds_read_b128 a[248:251], v248 offset:27648
 ds_read_b128 a[252:255], v248 offset:28160
 v_mfma_f32_16x16x32_bf16 v[160:163], a[160:163], a[0:3], v[144:147]
 v_mfma_f32_16x16x32_bf16 v[160:163], a[164:167], a[4:7], v[160:163]
 v_mfma_f32_16x16x32_bf16 v[160:163], a[168:171], a[8:11], v[160:163]
 v_mfma_f32_16x16x32_bf16 v[160:163], a[172:175], a[12:15], v[160:163]
 v_mfma_f32_16x16x32_bf16 v[164:167], a[176:179], a[0:3], v[144:147]
 v_mfma_f32_16x16x32_bf16 v[164:167], a[180:183], a[4:7], v[164:167]
 v_mfma_f32_16x16x32_bf16 v[164:167], a[184:187], a[8:11], v[164:167]
 v_mfma_f32_16x16x32_bf16 v[164:167], a[188:191], a[12:15], v[164:167]
 s_nop 3
 v_exp_f32 v160, v160
 v_exp_f32 v161, v161
 s_nop 0
 v_cvt_pk_bf16_f32 v176, v160, v161
 v_exp_f32 v162, v162
 v_exp_f32 v163, v163
 s_nop 0
 v_cvt_pk_bf16_f32 v177, v162, v163
 v_exp_f32 v164, v164
 v_exp_f32 v165, v165
 s_nop 0
 v_cvt_pk_bf16_f32 v178, v164, v165
 v_exp_f32 v166, v166
 v_exp_f32 v167, v167
 s_nop 0
 v_cvt_pk_bf16_f32 v179, v166, v167
 s_nop 1
 v_mfma_f32_16x16x32_bf16 v[128:131], v[140:143], v[176:179], v[128:131]
 s_waitcnt lgkmcnt(7)
 v_mfma_f32_16x16x32_bf16 v[0:3], v[176:179], a[224:227], v[0:3]
 s_waitcnt lgkmcnt(6)
 v_mfma_f32_16x16x32_bf16 v[4:7], v[176:179], a[228:231], v[4:7]
 s_waitcnt lgkmcnt(5)
 v_mfma_f32_16x16x32_bf16 v[8:11], v[176:179], a[232:235], v[8:11]
 s_waitcnt lgkmcnt(4)
 v_mfma_f32_16x16x32_bf16 v[12:15], v[176:179], a[236:239], v[12:15]
 s_waitcnt lgkmcnt(3)
 v_mfma_f32_16x16x32_bf16 v[16:19], v[176:179], a[240:243], v[16:19]
 s_waitcnt lgkmcnt(2)
 v_mfma_f32_16x16x32_bf16 v[20:23], v[176:179], a[244:247], v[20:23]
 s_waitcnt lgkmcnt(1)
 v_mfma_f32_16x16x32_bf16 v[24:27], v[176:179], a[248:251], v[24:27]
 s_waitcnt lgkmcnt(0)
 v_mfma_f32_16x16x32_bf16 v[28:31], v[176:179], a[252:255], v[28:31]
 ds_read_b128 a[192:195], v249 offset:32768
 ds_read_b128 a[196:199], v249 offset:33280
 ds_read_b128 a[200:203], v249 offset:33792
 ds_read_b128 a[204:207], v249 offset:34304
 ds_read_b128 a[208:211], v249 offset:34816
 ds_read_b128 a[212:215], v249 offset:35328
 ds_read_b128 a[216:219], v249 offset:35840
 ds_read_b128 a[220:223], v249 offset:36352
 ds_read_b128 a[224:227], v248 offset:32768
 ds_read_b128 a[228:231], v248 offset:33280
 ds_read_b128 a[232:235], v248 offset:33792
 ds_read_b128 a[236:239], v248 offset:34304
 ds_read_b128 a[240:243], v248 offset:34816
 ds_read_b128 a[244:247], v248 offset:35328
 ds_read_b128 a[248:251], v248 offset:35840
 ds_read_b128 a[252:255], v248 offset:36352
 s_waitcnt lgkmcnt(15)
 v_mfma_f32_16x16x32_bf16 v[160:163], a[192:195], a[0:3], v[144:147]
 s_waitcnt lgkmcnt(14)
 v_mfma_f32_16x16x32_bf16 v[160:163], a[196:199], a[4:7], v[160:163]
 s_waitcnt lgkmcnt(13)
 v_mfma_f32_16x16x32_bf16 v[160:163], a[200:203], a[8:11], v[160:163]
 s_waitcnt lgkmcnt(12)
 v_mfma_f32_16x16x32_bf16 v[160:163], a[204:207], a[12:15], v[160:163]
 s_waitcnt lgkmcnt(11)
 v_mfma_f32_16x16x32_bf16 v[164:167], a[208:211], a[0:3], v[144:147]
 s_waitcnt lgkmcnt(10)
 v_mfma_f32_16x16x32_bf16 v[164:167], a[212:215], a[4:7], v[164:167]
 s_waitcnt lgkmcnt(9)
 v_mfma_f32_16x16x32_bf16 v[164:167], a[216:219], a[8:11], v[164:167]
 s_waitcnt lgkmcnt(8)
 v_mfma_f32_16x16x32_bf16 v[164:167], a[220:223], a[12:15], v[164:167]
 v_exp_f32 v160, v160
 v_exp_f32 v161, v161
 s_nop 0
 v_cvt_pk_bf16_f32 v176, v160, v161
 v_exp_f32 v162, v162
 v_exp_f32 v163, v163
 s_nop 0
 v_cvt_pk_bf16_f32 v177, v162, v163
 v_exp_f32 v164, v164
 v_exp_f32 v165, v165
 s_nop 0
 v_cvt_pk_bf16_f32 v178, v164, v165
 v_exp_f32 v166, v166
 v_exp_f32 v167, v167
 s_nop 0
 v_cvt_pk_bf16_f32 v179, v166, v167
 s_nop 1
 v_mfma_f32_16x16x32_bf16 v[128:131], v[140:143], v[176:179], v[128:131]
 s_waitcnt lgkmcnt(7)
 v_mfma_f32_16x16x32_bf16 v[0:3], v[176:179], a[224:227], v[0:3]
 s_waitcnt lgkmcnt(6)
 v_mfma_f32_16x16x32_bf16 v[4:7], v[176:179], a[228:231], v[4:7]
 s_waitcnt lgkmcnt(5)
 v_mfma_f32_16x16x32_bf16 v[8:11], v[176:179], a[232:235], v[8:11]
 s_waitcnt lgkmcnt(4)
 v_mfma_f32_16x16x32_bf16 v[12:15], v[176:179], a[236:239], v[12:15]
 s_waitcnt lgkmcnt(3)
 v_mfma_f32_16x16x32_bf16 v[16:19], v[176:179], a[240:243], v[16:19]
 s_waitcnt lgkmcnt(2)
 v_mfma_f32_16x16x32_bf16 v[20:23], v[176:179], a[244:247], v[20:23]
 s_waitcnt lgkmcnt(1)
 v_mfma_f32_16x16x32_bf16 v[24:27], v[176:179], a[248:251], v[24:27]
 s_waitcnt lgkmcnt(0)
 v_mfma_f32_16x16x32_bf16 v[28:31], v[176:179], a[252:255], v[28:31]
 ds_read_b128 a[192:195], v249 offset:40960
 ds_read_b128 a[196:199], v249 offset:41472
 ds_read_b128 a[200:203], v249 offset:41984
 ds_read_b128 a[204:207], v249 offset:42496
 ds_read_b128 a[208:211], v249 offset:43008
 ds_read_b128 a[212:215], v249 offset:43520
 ds_read_b128 a[216:219], v249 offset:44032
 ds_read_b128 a[220:223], v249 offset:44544
 ds_read_b128 a[224:227], v248 offset:40960
 ds_read_b128 a[228:231], v248 offset:41472
 ds_read_b128 a[232:235], v248 offset:41984
 ds_read_b128 a[236:239], v248 offset:42496
 ds_read_b128 a[240:243], v248 offset:43008
 ds_read_b128 a[244:247], v248 offset:43520
 ds_read_b128 a[248:251], v248 offset:44032
 ds_read_b128 a[252:255], v248 offset:44544
 s_waitcnt lgkmcnt(15)
 v_mfma_f32_16x16x32_bf16 v[160:163], a[192:195], a[0:3], v[144:147]
 s_waitcnt lgkmcnt(14)
 v_mfma_f32_16x16x32_bf16 v[160:163], a[196:199], a[4:7], v[160:163]
 s_waitcnt lgkmcnt(13)
 v_mfma_f32_16x16x32_bf16 v[160:163], a[200:203], a[8:11], v[160:163]
 s_waitcnt lgkmcnt(12)
 v_mfma_f32_16x16x32_bf16 v[160:163], a[204:207], a[12:15], v[160:163]
 s_waitcnt lgkmcnt(11)
 v_mfma_f32_16x16x32_bf16 v[164:167], a[208:211], a[0:3], v[144:147]
 s_waitcnt lgkmcnt(10)
 v_mfma_f32_16x16x32_bf16 v[164:167], a[212:215], a[4:7], v[164:167]
 s_waitcnt lgkmcnt(9)
 v_mfma_f32_16x16x32_bf16 v[164:167], a[216:219], a[8:11], v[164:167]
 s_waitcnt lgkmcnt(8)
 v_mfma_f32_16x16x32_bf16 v[164:167], a[220:223], a[12:15], v[164:167]
 v_exp_f32 v160, v160
 v_exp_f32 v161, v161
 s_nop 0
 v_cvt_pk_bf16_f32 v176, v160, v161
 v_exp_f32 v162, v162
 v_exp_f32 v163, v163
 s_nop 0
 v_cvt_pk_bf16_f32 v177, v162, v163
 v_exp_f32 v164, v164
 v_exp_f32 v165, v165
 s_nop 0
 v_cvt_pk_bf16_f32 v178, v164, v165
 v_exp_f32 v166, v166
 v_exp_f32 v167, v167
 s_nop 0
 v_cvt_pk_bf16_f32 v179, v166, v167
 s_nop 1
 v_mfma_f32_16x16x32_bf16 v[128:131], v[140:143], v[176:179], v[128:131]
 s_waitcnt lgkmcnt(7)
 v_mfma_f32_16x16x32_bf16 v[0:3], v[176:179], a[224:227], v[0:3]
 s_waitcnt lgkmcnt(6)
 v_mfma_f32_16x16x32_bf16 v[4:7], v[176:179], a[228:231], v[4:7]
 s_waitcnt lgkmcnt(5)
 v_mfma_f32_16x16x32_bf16 v[8:11], v[176:179], a[232:235], v[8:11]
 s_waitcnt lgkmcnt(4)
 v_mfma_f32_16x16x32_bf16 v[12:15], v[176:179], a[236:239], v[12:15]
 s_waitcnt lgkmcnt(3)
 v_mfma_f32_16x16x32_bf16 v[16:19], v[176:179], a[240:243], v[16:19]
 s_waitcnt lgkmcnt(2)
 v_mfma_f32_16x16x32_bf16 v[20:23], v[176:179], a[244:247], v[20:23]
 s_waitcnt lgkmcnt(1)
 v_mfma_f32_16x16x32_bf16 v[24:27], v[176:179], a[248:251], v[24:27]
 s_waitcnt lgkmcnt(0)
 v_mfma_f32_16x16x32_bf16 v[28:31], v[176:179], a[252:255], v[28:31]
 ds_read_b128 a[192:195], v249 offset:49152
 ds_read_b128 a[196:199], v249 offset:49664
 ds_read_b128 a[200:203], v249 offset:50176
 ds_read_b128 a[204:207], v249 offset:50688
 ds_read_b128 a[208:211], v249 offset:51200
 ds_read_b128 a[212:215], v249 offset:51712
 ds_read_b128 a[216:219], v249 offset:52224
 ds_read_b128 a[220:223], v249 offset:52736
 ds_read_b128 a[224:227], v248 offset:49152
 ds_read_b128 a[228:231], v248 offset:49664
 ds_read_b128 a[232:235], v248 offset:50176
 ds_read_b128 a[236:239], v248 offset:50688
 ds_read_b128 a[240:243], v248 offset:51200
 ds_read_b128 a[244:247], v248 offset:51712
 ds_read_b128 a[248:251], v248 offset:52224
 ds_read_b128 a[252:255], v248 offset:52736
 s_waitcnt lgkmcnt(15)
 v_mfma_f32_16x16x32_bf16 v[160:163], a[192:195], a[0:3], v[144:147]
 s_waitcnt lgkmcnt(14)
 v_mfma_f32_16x16x32_bf16 v[160:163], a[196:199], a[4:7], v[160:163]
 s_waitcnt lgkmcnt(13)
 v_mfma_f32_16x16x32_bf16 v[160:163], a[200:203], a[8:11], v[160:163]
 s_waitcnt lgkmcnt(12)
 v_mfma_f32_16x16x32_bf16 v[160:163], a[204:207], a[12:15], v[160:163]
 s_waitcnt lgkmcnt(11)
 v_mfma_f32_16x16x32_bf16 v[164:167], a[208:211], a[0:3], v[144:147]
 s_waitcnt lgkmcnt(10)
 v_mfma_f32_16x16x32_bf16 v[164:167], a[212:215], a[4:7], v[164:167]
 s_waitcnt lgkmcnt(9)
 v_mfma_f32_16x16x32_bf16 v[164:167], a[216:219], a[8:11], v[164:167]
 s_waitcnt lgkmcnt(8)
 v_mfma_f32_16x16x32_bf16 v[164:167], a[220:223], a[12:15], v[164:167]
 v_exp_f32 v160, v160
 v_exp_f32 v161, v161
 s_nop 0
 v_cvt_pk_bf16_f32 v176, v160, v161
 v_exp_f32 v162, v162
 v_exp_f32 v163, v163
 s_nop 0
 v_cvt_pk_bf16_f32 v177, v162, v163
 v_exp_f32 v164, v164
 v_exp_f32 v165, v165
 s_nop 0
 v_cvt_pk_bf16_f32 v178, v164, v165
 v_exp_f32 v166, v166
 v_exp_f32 v167, v167
 s_nop 0
 v_cvt_pk_bf16_f32 v179, v166, v167
 s_nop 1
 v_mfma_f32_16x16x32_bf16 v[128:131], v[140:143], v[176:179], v[128:131]
 s_waitcnt lgkmcnt(7)
 v_mfma_f32_16x16x32_bf16 v[0:3], v[176:179], a[224:227], v[0:3]
 s_waitcnt lgkmcnt(6)
 v_mfma_f32_16x16x32_bf16 v[4:7], v[176:179], a[228:231], v[4:7]
 s_waitcnt lgkmcnt(5)
 v_mfma_f32_16x16x32_bf16 v[8:11], v[176:179], a[232:235], v[8:11]
 s_waitcnt lgkmcnt(4)
 v_mfma_f32_16x16x32_bf16 v[12:15], v[176:179], a[236:239], v[12:15]
 s_waitcnt lgkmcnt(3)
 v_mfma_f32_16x16x32_bf16 v[16:19], v[176:179], a[240:243], v[16:19]
 s_waitcnt lgkmcnt(2)
 v_mfma_f32_16x16x32_bf16 v[20:23], v[176:179], a[244:247], v[20:23]
 s_waitcnt lgkmcnt(1)
 v_mfma_f32_16x16x32_bf16 v[24:27], v[176:179], a[248:251], v[24:27]
 s_waitcnt lgkmcnt(0)
 v_mfma_f32_16x16x32_bf16 v[28:31], v[176:179], a[252:255], v[28:31]
 ds_read_b128 a[192:195], v249 offset:57344
 ds_read_b128 a[196:199], v249 offset:57856
 ds_read_b128 a[200:203], v249 offset:58368
 ds_read_b128 a[204:207], v249 offset:58880
 ds_read_b128 a[208:211], v249 offset:59392
 ds_read_b128 a[212:215], v249 offset:59904
 ds_read_b128 a[216:219], v249 offset:60416
 ds_read_b128 a[220:223], v249 offset:60928
 ds_read_b128 a[224:227], v248 offset:57344
 ds_read_b128 a[228:231], v248 offset:57856
 ds_read_b128 a[232:235], v248 offset:58368
 ds_read_b128 a[236:239], v248 offset:58880
 ds_read_b128 a[240:243], v248 offset:59392
 ds_read_b128 a[244:247], v248 offset:59904
 ds_read_b128 a[248:251], v248 offset:60416
 ds_read_b128 a[252:255], v248 offset:60928
 s_waitcnt lgkmcnt(15)
 v_mfma_f32_16x16x32_bf16 v[160:163], a[192:195], a[0:3], v[144:147]
 s_waitcnt lgkmcnt(14)
 v_mfma_f32_16x16x32_bf16 v[160:163], a[196:199], a[4:7], v[160:163]
 s_waitcnt lgkmcnt(13)
 v_mfma_f32_16x16x32_bf16 v[160:163], a[200:203], a[8:11], v[160:163]
 s_waitcnt lgkmcnt(12)
 v_mfma_f32_16x16x32_bf16 v[160:163], a[204:207], a[12:15], v[160:163]
 s_waitcnt lgkmcnt(11)
 v_mfma_f32_16x16x32_bf16 v[164:167], a[208:211], a[0:3], v[144:147]
 s_waitcnt lgkmcnt(10)
 v_mfma_f32_16x16x32_bf16 v[164:167], a[212:215], a[4:7], v[164:167]
 s_waitcnt lgkmcnt(9)
 v_mfma_f32_16x16x32_bf16 v[164:167], a[216:219], a[8:11], v[164:167]
 s_waitcnt lgkmcnt(8)
 v_mfma_f32_16x16x32_bf16 v[164:167], a[220:223], a[12:15], v[164:167]
 v_exp_f32 v160, v160
 v_exp_f32 v161, v161
 s_nop 0
 v_cvt_pk_bf16_f32 v176, v160, v161
 v_exp_f32 v162, v162
 v_exp_f32 v163, v163
 s_nop 0
 v_cvt_pk_bf16_f32 v177, v162, v163
 v_exp_f32 v164, v164
 v_exp_f32 v165, v165
 s_nop 0
 v_cvt_pk_bf16_f32 v178, v164, v165
 v_exp_f32 v166, v166
 v_exp_f32 v167, v167
 s_nop 0
 v_cvt_pk_bf16_f32 v179, v166, v167
 s_nop 1
 v_mfma_f32_16x16x32_bf16 v[128:131], v[140:143], v[176:179], v[128:131]
 s_waitcnt lgkmcnt(7)
 v_mfma_f32_16x16x32_bf16 v[0:3], v[176:179], a[224:227], v[0:3]
 s_waitcnt lgkmcnt(6)
 v_mfma_f32_16x16x32_bf16 v[4:7], v[176:179], a[228:231], v[4:7]
 s_waitcnt lgkmcnt(5)
 v_mfma_f32_16x16x32_bf16 v[8:11], v[176:179], a[232:235], v[8:11]
 s_waitcnt lgkmcnt(4)
 v_mfma_f32_16x16x32_bf16 v[12:15], v[176:179], a[236:239], v[12:15]
 s_waitcnt lgkmcnt(3)
 v_mfma_f32_16x16x32_bf16 v[16:19], v[176:179], a[240:243], v[16:19]
 s_waitcnt lgkmcnt(2)
 v_mfma_f32_16x16x32_bf16 v[20:23], v[176:179], a[244:247], v[20:23]
 s_waitcnt lgkmcnt(1)
 v_mfma_f32_16x16x32_bf16 v[24:27], v[176:179], a[248:251], v[24:27]
 s_waitcnt lgkmcnt(0)
 v_mfma_f32_16x16x32_bf16 v[28:31], v[176:179], a[252:255], v[28:31]
 ds_read_b128 a[192:195], v250 offset:0
 ds_read_b128 a[196:199], v250 offset:512
 ds_read_b128 a[200:203], v250 offset:1024
 ds_read_b128 a[204:207], v250 offset:1536
 ds_read_b128 a[208:211], v250 offset:2048
 ds_read_b128 a[212:215], v250 offset:2560
 ds_read_b128 a[216:219], v250 offset:3072
 ds_read_b128 a[220:223], v250 offset:3584
 ds_read_b128 a[224:227], v249 offset:0
 ds_read_b128 a[228:231], v249 offset:512
 ds_read_b128 a[232:235], v249 offset:1024
 ds_read_b128 a[236:239], v249 offset:1536
 ds_read_b128 a[240:243], v249 offset:2048
 ds_read_b128 a[244:247], v249 offset:2560
 ds_read_b128 a[248:251], v249 offset:3072
 ds_read_b128 a[252:255], v249 offset:3584
 s_waitcnt lgkmcnt(15)
 v_mfma_f32_16x16x32_bf16 v[160:163], a[192:195], a[0:3], v[144:147]
 s_waitcnt lgkmcnt(14)
 v_mfma_f32_16x16x32_bf16 v[160:163], a[196:199], a[4:7], v[160:163]
 s_waitcnt lgkmcnt(13)
 v_mfma_f32_16x16x32_bf16 v[160:163], a[200:203], a[8:11], v[160:163]
 s_waitcnt lgkmcnt(12)
 v_mfma_f32_16x16x32_bf16 v[160:163], a[204:207], a[12:15], v[160:163]
 s_waitcnt lgkmcnt(11)
 v_mfma_f32_16x16x32_bf16 v[164:167], a[208:211], a[0:3], v[144:147]
 s_waitcnt lgkmcnt(10)
 v_mfma_f32_16x16x32_bf16 v[164:167], a[212:215], a[4:7], v[164:167]
 s_waitcnt lgkmcnt(9)
 v_mfma_f32_16x16x32_bf16 v[164:167], a[216:219], a[8:11], v[164:167]
 s_waitcnt lgkmcnt(8)
 v_mfma_f32_16x16x32_bf16 v[164:167], a[220:223], a[12:15], v[164:167]
 v_exp_f32 v160, v160
 v_exp_f32 v161, v161
 s_nop 0
 v_cvt_pk_bf16_f32 v176, v160, v161
 v_exp_f32 v162, v162
 v_exp_f32 v163, v163
 s_nop 0
 v_cvt_pk_bf16_f32 v177, v162, v163
 v_exp_f32 v164, v164
 v_exp_f32 v165, v165
 s_nop 0
 v_cvt_pk_bf16_f32 v178, v164, v165
 v_exp_f32 v166, v166
 v_exp_f32 v167, v167
 s_nop 0
 v_cvt_pk_bf16_f32 v179, v166, v167
 s_nop 1
 v_mfma_f32_16x16x32_bf16 v[128:131], v[140:143], v[176:179], v[128:131]
 s_waitcnt lgkmcnt(7)
 v_mfma_f32_16x16x32_bf16 v[0:3], v[176:179], a[224:227], v[0:3]
 s_waitcnt lgkmcnt(6)
 v_mfma_f32_16x16x32_bf16 v[4:7], v[176:179], a[228:231], v[4:7]
 s_waitcnt lgkmcnt(5)
 v_mfma_f32_16x16x32_bf16 v[8:11], v[176:179], a[232:235], v[8:11]
 s_waitcnt lgkmcnt(4)
 v_mfma_f32_16x16x32_bf16 v[12:15], v[176:179], a[236:239], v[12:15]
 s_waitcnt lgkmcnt(3)
 v_mfma_f32_16x16x32_bf16 v[16:19], v[176:179], a[240:243], v[16:19]
 s_waitcnt lgkmcnt(2)
 v_mfma_f32_16x16x32_bf16 v[20:23], v[176:179], a[244:247], v[20:23]
 s_waitcnt lgkmcnt(1)
 v_mfma_f32_16x16x32_bf16 v[24:27], v[176:179], a[248:251], v[24:27]
 s_waitcnt lgkmcnt(0)
 v_mfma_f32_16x16x32_bf16 v[28:31], v[176:179], a[252:255], v[28:31]
 ds_read_b128 a[192:195], v250 offset:8192
 ds_read_b128 a[196:199], v250 offset:8704
 ds_read_b128 a[200:203], v250 offset:9216
 ds_read_b128 a[204:207], v250 offset:9728
 ds_read_b128 a[208:211], v250 offset:10240
 ds_read_b128 a[212:215], v250 offset:10752
 ds_read_b128 a[216:219], v250 offset:11264
 ds_read_b128 a[220:223], v250 offset:11776
 ds_read_b128 a[224:227], v249 offset:8192
 ds_read_b128 a[228:231], v249 offset:8704
 ds_read_b128 a[232:235], v249 offset:9216
 ds_read_b128 a[236:239], v249 offset:9728
 ds_read_b128 a[240:243], v249 offset:10240
 ds_read_b128 a[244:247], v249 offset:10752
 ds_read_b128 a[248:251], v249 offset:11264
 ds_read_b128 a[252:255], v249 offset:11776
 s_waitcnt lgkmcnt(15)
 v_mfma_f32_16x16x32_bf16 v[160:163], a[192:195], a[0:3], v[144:147]
 s_waitcnt lgkmcnt(14)
 v_mfma_f32_16x16x32_bf16 v[160:163], a[196:199], a[4:7], v[160:163]
 s_waitcnt lgkmcnt(13)
 v_mfma_f32_16x16x32_bf16 v[160:163], a[200:203], a[8:11], v[160:163]
 s_waitcnt lgkmcnt(12)
 v_mfma_f32_16x16x32_bf16 v[160:163], a[204:207], a[12:15], v[160:163]
 s_waitcnt lgkmcnt(11)
 v_mfma_f32_16x16x32_bf16 v[164:167], a[208:211], a[0:3], v[144:147]
 s_waitcnt lgkmcnt(10)
 v_mfma_f32_16x16x32_bf16 v[164:167], a[212:215], a[4:7], v[164:167]
 s_waitcnt lgkmcnt(9)
 v_mfma_f32_16x16x32_bf16 v[164:167], a[216:219], a[8:11], v[164:167]
 s_waitcnt lgkmcnt(8)
 v_mfma_f32_16x16x32_bf16 v[164:167], a[220:223], a[12:15], v[164:167]
 v_exp_f32 v160, v160
 v_exp_f32 v161, v161
 s_nop 0
 v_cvt_pk_bf16_f32 v176, v160, v161
 v_exp_f32 v162, v162
 v_exp_f32 v163, v163
 s_nop 0
 v_cvt_pk_bf16_f32 v177, v162, v163
 v_exp_f32 v164, v164
 v_exp_f32 v165, v165
 s_nop 0
 v_cvt_pk_bf16_f32 v178, v164, v165
 v_exp_f32 v166, v166
 v_exp_f32 v167, v167
 s_nop 0
 v_cvt_pk_bf16_f32 v179, v166, v167
 s_nop 1
 v_mfma_f32_16x16x32_bf16 v[128:131], v[140:143], v[176:179], v[128:131]
 s_waitcnt lgkmcnt(7)
 v_mfma_f32_16x16x32_bf16 v[0:3], v[176:179], a[224:227], v[0:3]
 s_waitcnt lgkmcnt(6)
 v_mfma_f32_16x16x32_bf16 v[4:7], v[176:179], a[228:231], v[4:7]
 s_waitcnt lgkmcnt(5)
 v_mfma_f32_16x16x32_bf16 v[8:11], v[176:179], a[232:235], v[8:11]
 s_waitcnt lgkmcnt(4)
 v_mfma_f32_16x16x32_bf16 v[12:15], v[176:179], a[236:239], v[12:15]
 s_waitcnt lgkmcnt(3)
 v_mfma_f32_16x16x32_bf16 v[16:19], v[176:179], a[240:243], v[16:19]
 s_waitcnt lgkmcnt(2)
 v_mfma_f32_16x16x32_bf16 v[20:23], v[176:179], a[244:247], v[20:23]
 s_waitcnt lgkmcnt(1)
 v_mfma_f32_16x16x32_bf16 v[24:27], v[176:179], a[248:251], v[24:27]
 s_waitcnt lgkmcnt(0)
 v_mfma_f32_16x16x32_bf16 v[28:31], v[176:179], a[252:255], v[28:31]
 ds_read_b128 a[192:195], v250 offset:16384
 ds_read_b128 a[196:199], v250 offset:16896
 ds_read_b128 a[200:203], v250 offset:17408
 ds_read_b128 a[204:207], v250 offset:17920
 ds_read_b128 a[208:211], v250 offset:18432
 ds_read_b128 a[212:215], v250 offset:18944
 ds_read_b128 a[216:219], v250 offset:19456
 ds_read_b128 a[220:223], v250 offset:19968
 ds_read_b128 a[224:227], v249 offset:16384
 ds_read_b128 a[228:231], v249 offset:16896
 ds_read_b128 a[232:235], v249 offset:17408
 ds_read_b128 a[236:239], v249 offset:17920
 ds_read_b128 a[240:243], v249 offset:18432
 ds_read_b128 a[244:247], v249 offset:18944
 ds_read_b128 a[248:251], v249 offset:19456
 ds_read_b128 a[252:255], v249 offset:19968
 s_waitcnt lgkmcnt(15)
 v_mfma_f32_16x16x32_bf16 v[160:163], a[192:195], a[0:3], v[144:147]
 s_waitcnt lgkmcnt(14)
 v_mfma_f32_16x16x32_bf16 v[160:163], a[196:199], a[4:7], v[160:163]
 s_waitcnt lgkmcnt(13)
 v_mfma_f32_16x16x32_bf16 v[160:163], a[200:203], a[8:11], v[160:163]
 s_waitcnt lgkmcnt(12)
 v_mfma_f32_16x16x32_bf16 v[160:163], a[204:207], a[12:15], v[160:163]
 s_waitcnt lgkmcnt(11)
 v_mfma_f32_16x16x32_bf16 v[164:167], a[208:211], a[0:3], v[144:147]
 s_waitcnt lgkmcnt(10)
 v_mfma_f32_16x16x32_bf16 v[164:167], a[212:215], a[4:7], v[164:167]
 s_waitcnt lgkmcnt(9)
 v_mfma_f32_16x16x32_bf16 v[164:167], a[216:219], a[8:11], v[164:167]
 s_waitcnt lgkmcnt(8)
 v_mfma_f32_16x16x32_bf16 v[164:167], a[220:223], a[12:15], v[164:167]
 v_exp_f32 v160, v160
 v_exp_f32 v161, v161
 s_nop 0
 v_cvt_pk_bf16_f32 v176, v160, v161
 v_exp_f32 v162, v162
 v_exp_f32 v163, v163
 s_nop 0
 v_cvt_pk_bf16_f32 v177, v162, v163
 v_exp_f32 v164, v164
 v_exp_f32 v165, v165
 s_nop 0
 v_cvt_pk_bf16_f32 v178, v164, v165
 v_exp_f32 v166, v166
 v_exp_f32 v167, v167
 s_nop 0
 v_cvt_pk_bf16_f32 v179, v166, v167
 s_nop 1
 v_mfma_f32_16x16x32_bf16 v[128:131], v[140:143], v[176:179], v[128:131]
 s_waitcnt lgkmcnt(7)
 v_mfma_f32_16x16x32_bf16 v[0:3], v[176:179], a[224:227], v[0:3]
 s_waitcnt lgkmcnt(6)
 v_mfma_f32_16x16x32_bf16 v[4:7], v[176:179], a[228:231], v[4:7]
 s_waitcnt lgkmcnt(5)
 v_mfma_f32_16x16x32_bf16 v[8:11], v[176:179], a[232:235], v[8:11]
 s_waitcnt lgkmcnt(4)
 v_mfma_f32_16x16x32_bf16 v[12:15], v[176:179], a[236:239], v[12:15]
 s_waitcnt lgkmcnt(3)
 v_mfma_f32_16x16x32_bf16 v[16:19], v[176:179], a[240:243], v[16:19]
 s_waitcnt lgkmcnt(2)
 v_mfma_f32_16x16x32_bf16 v[20:23], v[176:179], a[244:247], v[20:23]
 s_waitcnt lgkmcnt(1)
 v_mfma_f32_16x16x32_bf16 v[24:27], v[176:179], a[248:251], v[24:27]
 s_waitcnt lgkmcnt(0)
 v_mfma_f32_16x16x32_bf16 v[28:31], v[176:179], a[252:255], v[28:31]
 ds_read_b128 a[192:195], v250 offset:24576
 ds_read_b128 a[196:199], v250 offset:25088
 ds_read_b128 a[200:203], v250 offset:25600
 ds_read_b128 a[204:207], v250 offset:26112
 ds_read_b128 a[208:211], v250 offset:26624
 ds_read_b128 a[212:215], v250 offset:27136
 ds_read_b128 a[216:219], v250 offset:27648
 ds_read_b128 a[220:223], v250 offset:28160
 ds_read_b128 a[224:227], v249 offset:24576
 ds_read_b128 a[228:231], v249 offset:25088
 ds_read_b128 a[232:235], v249 offset:25600
 ds_read_b128 a[236:239], v249 offset:26112
 ds_read_b128 a[240:243], v249 offset:26624
 ds_read_b128 a[244:247], v249 offset:27136
 ds_read_b128 a[248:251], v249 offset:27648
 ds_read_b128 a[252:255], v249 offset:28160
 s_waitcnt lgkmcnt(15)
 v_mfma_f32_16x16x32_bf16 v[160:163], a[192:195], a[0:3], v[144:147]
 s_waitcnt lgkmcnt(14)
 v_mfma_f32_16x16x32_bf16 v[160:163], a[196:199], a[4:7], v[160:163]
 s_waitcnt lgkmcnt(13)
 v_mfma_f32_16x16x32_bf16 v[160:163], a[200:203], a[8:11], v[160:163]
 s_waitcnt lgkmcnt(12)
 v_mfma_f32_16x16x32_bf16 v[160:163], a[204:207], a[12:15], v[160:163]
 s_waitcnt lgkmcnt(11)
 v_mfma_f32_16x16x32_bf16 v[164:167], a[208:211], a[0:3], v[144:147]
 s_waitcnt lgkmcnt(10)
 v_mfma_f32_16x16x32_bf16 v[164:167], a[212:215], a[4:7], v[164:167]
 s_waitcnt lgkmcnt(9)
 v_mfma_f32_16x16x32_bf16 v[164:167], a[216:219], a[8:11], v[164:167]
 s_waitcnt lgkmcnt(8)
 v_mfma_f32_16x16x32_bf16 v[164:167], a[220:223], a[12:15], v[164:167]
 v_exp_f32 v160, v160
 v_exp_f32 v161, v161
 s_nop 0
 v_cvt_pk_bf16_f32 v176, v160, v161
 v_exp_f32 v162, v162
 v_exp_f32 v163, v163
 s_nop 0
 v_cvt_pk_bf16_f32 v177, v162, v163
 v_exp_f32 v164, v164
 v_exp_f32 v165, v165
 s_nop 0
 v_cvt_pk_bf16_f32 v178, v164, v165
 v_exp_f32 v166, v166
 v_exp_f32 v167, v167
 s_nop 0
 v_cvt_pk_bf16_f32 v179, v166, v167
 s_nop 1
 v_mfma_f32_16x16x32_bf16 v[128:131], v[140:143], v[176:179], v[128:131]
 s_waitcnt lgkmcnt(7)
 v_mfma_f32_16x16x32_bf16 v[0:3], v[176:179], a[224:227], v[0:3]
 s_waitcnt lgkmcnt(6)
 v_mfma_f32_16x16x32_bf16 v[4:7], v[176:179], a[228:231], v[4:7]
 s_waitcnt lgkmcnt(5)
 v_mfma_f32_16x16x32_bf16 v[8:11], v[176:179], a[232:235], v[8:11]
 s_waitcnt lgkmcnt(4)
 v_mfma_f32_16x16x32_bf16 v[12:15], v[176:179], a[236:239], v[12:15]
 s_waitcnt lgkmcnt(3)
 v_mfma_f32_16x16x32_bf16 v[16:19], v[176:179], a[240:243], v[16:19]
 s_waitcnt lgkmcnt(2)
 v_mfma_f32_16x16x32_bf16 v[20:23], v[176:179], a[244:247], v[20:23]
 s_waitcnt lgkmcnt(1)
 v_mfma_f32_16x16x32_bf16 v[24:27], v[176:179], a[248:251], v[24:27]
 s_waitcnt lgkmcnt(0)
 v_mfma_f32_16x16x32_bf16 v[28:31], v[176:179], a[252:255], v[28:31]
 v_add_f32 v216, v128, v129
 v_mov_b32 v128, 0
 v_mov_b32 v129, 0
 v_rcp_f32 v216, v216
 s_nop 1
 v_mov_b32_dpp v216, v216 row_shl:4 row_mask:0x2 bank_mask:0xf
 s_nop 1
 v_mov_b32_dpp v216, v216 row_shl:8 row_mask:0x4 bank_mask:0xf
 s_nop 1
 v_mov_b32_dpp v216, v216 row_shl:12 row_mask:0x8 bank_mask:0xf
 s_mov_b32 s33, s32
 s_nop 0
 v_mul_f32_dpp v0, v216, v0 row_newbcast:0 row_mask:0xf bank_mask:0xf
 v_mul_f32_dpp v4, v216, v4 row_newbcast:0 row_mask:0xf bank_mask:0xf
 v_cvt_pk_bf16_f32 v240, v0, v4
 v_mul_f32_dpp v8, v216, v8 row_newbcast:0 row_mask:0xf bank_mask:0xf
 v_mul_f32_dpp v12, v216, v12 row_newbcast:0 row_mask:0xf bank_mask:0xf
 v_cvt_pk_bf16_f32 v241, v8, v12
 v_mul_f32_dpp v16, v216, v16 row_newbcast:0 row_mask:0xf bank_mask:0xf
 v_mul_f32_dpp v20, v216, v20 row_newbcast:0 row_mask:0xf bank_mask:0xf
 v_cvt_pk_bf16_f32 v242, v16, v20
 v_mul_f32_dpp v24, v216, v24 row_newbcast:0 row_mask:0xf bank_mask:0xf
 v_mul_f32_dpp v28, v216, v28 row_newbcast:0 row_mask:0xf bank_mask:0xf
 v_cvt_pk_bf16_f32 v243, v24, v28
 buffer_store_dwordx4 v[240:243], v244, s[20:23], s33 offen offset:0 sc1
 v_mul_f32_dpp v1, v216, v1 row_newbcast:1 row_mask:0xf bank_mask:0xf
 v_mul_f32_dpp v5, v216, v5 row_newbcast:1 row_mask:0xf bank_mask:0xf
 v_cvt_pk_bf16_f32 v240, v1, v5
 v_mul_f32_dpp v9, v216, v9 row_newbcast:1 row_mask:0xf bank_mask:0xf
 v_mul_f32_dpp v13, v216, v13 row_newbcast:1 row_mask:0xf bank_mask:0xf
 v_cvt_pk_bf16_f32 v241, v9, v13
 v_mul_f32_dpp v17, v216, v17 row_newbcast:1 row_mask:0xf bank_mask:0xf
 v_mul_f32_dpp v21, v216, v21 row_newbcast:1 row_mask:0xf bank_mask:0xf
 v_cvt_pk_bf16_f32 v242, v17, v21
 v_mul_f32_dpp v25, v216, v25 row_newbcast:1 row_mask:0xf bank_mask:0xf
 v_mul_f32_dpp v29, v216, v29 row_newbcast:1 row_mask:0xf bank_mask:0xf
 v_cvt_pk_bf16_f32 v243, v25, v29
 buffer_store_dwordx4 v[240:243], v244, s[20:23], s33 offen offset:1024 sc1
 v_mul_f32_dpp v2, v216, v2 row_newbcast:2 row_mask:0xf bank_mask:0xf
 v_mul_f32_dpp v6, v216, v6 row_newbcast:2 row_mask:0xf bank_mask:0xf
 v_cvt_pk_bf16_f32 v240, v2, v6
 v_mul_f32_dpp v10, v216, v10 row_newbcast:2 row_mask:0xf bank_mask:0xf
 v_mul_f32_dpp v14, v216, v14 row_newbcast:2 row_mask:0xf bank_mask:0xf
 v_cvt_pk_bf16_f32 v241, v10, v14
 v_mul_f32_dpp v18, v216, v18 row_newbcast:2 row_mask:0xf bank_mask:0xf
 v_mul_f32_dpp v22, v216, v22 row_newbcast:2 row_mask:0xf bank_mask:0xf
 v_cvt_pk_bf16_f32 v242, v18, v22
 v_mul_f32_dpp v26, v216, v26 row_newbcast:2 row_mask:0xf bank_mask:0xf
 v_mul_f32_dpp v30, v216, v30 row_newbcast:2 row_mask:0xf bank_mask:0xf
 v_cvt_pk_bf16_f32 v243, v26, v30
 buffer_store_dwordx4 v[240:243], v244, s[20:23], s33 offen offset:2048 sc1
 v_mul_f32_dpp v3, v216, v3 row_newbcast:3 row_mask:0xf bank_mask:0xf
 v_mul_f32_dpp v7, v216, v7 row_newbcast:3 row_mask:0xf bank_mask:0xf
 v_cvt_pk_bf16_f32 v240, v3, v7
 v_mul_f32_dpp v11, v216, v11 row_newbcast:3 row_mask:0xf bank_mask:0xf
 v_mul_f32_dpp v15, v216, v15 row_newbcast:3 row_mask:0xf bank_mask:0xf
 v_cvt_pk_bf16_f32 v241, v11, v15
 v_mul_f32_dpp v19, v216, v19 row_newbcast:3 row_mask:0xf bank_mask:0xf
 v_mul_f32_dpp v23, v216, v23 row_newbcast:3 row_mask:0xf bank_mask:0xf
 v_cvt_pk_bf16_f32 v242, v19, v23
 v_mul_f32_dpp v27, v216, v27 row_newbcast:3 row_mask:0xf bank_mask:0xf
 v_mul_f32_dpp v31, v216, v31 row_newbcast:3 row_mask:0xf bank_mask:0xf
 v_cvt_pk_bf16_f32 v243, v27, v31
 buffer_store_dwordx4 v[240:243], v244, s[20:23], s33 offen offset:3072 sc1
 s_branch L_slow
L_end:
 s_endpgm
.fill 4096, 4, 0xbf810000
.section .rodata,"a"
.p2align 6
.amdhsa_kernel standalone__gqa_softmax__near_ridge_kernel
  .amdhsa_next_free_vgpr 512
  .amdhsa_next_free_sgpr 64
  .amdhsa_accum_offset 256
  .amdhsa_group_segment_fixed_size 0
  .amdhsa_kernarg_size 48
  .amdhsa_user_sgpr_count 2
  .amdhsa_user_sgpr_kernarg_segment_ptr 1
  .amdhsa_system_sgpr_workgroup_id_x 1
.end_amdhsa_kernel
```
